```python
import torch

def _softmax(x, axis=-1):
    return torch.softmax(x, dim=axis)
def _gelu(x):
    return torch.nn.functional.gelu(x, approximate="tanh")
def _silu(x):
    return torch.nn.functional.silu(x)
def _sigmoid(x):
    return torch.sigmoid(x)
def _layernorm(x, axis=-1, eps=1e-5):
    m = x.mean(dim=axis, keepdim=True)
    v = x.var(dim=axis, keepdim=True, unbiased=False)
    return (x - m) / torch.sqrt(v + eps)
def _scatter_add(tgt, idx, src, axis=0):
    return tgt.clone().index_add_(axis, idx, src)
def _segment_sum(src, seg, n):
    out = torch.zeros((n,) + src.shape[1:], dtype=src.dtype)
    return out.index_add_(0, seg, src)
def _pad(x, pw):
    flat = tuple(v for pair in reversed(pw) for v in pair)
    return torch.nn.functional.pad(x, flat)

kernel_name = 'concat_heads__mha_block_cached__gqa_block_cached__near_ridge'

def setup_inputs():

    _w = (lambda a: (lambda t: t.to(torch.bfloat16) if t.is_floating_point() else t)(torch.as_tensor(a)))
    def _A_setup():
        B, Sq, D = 8, 224, 640
        H, Sk, Dh = 32, 512, 128
        return {
            "x": _w((lambda *s: torch.randn(*s, dtype=torch.bfloat16) * 0.8)(B, Sq, D)),
            "k_cache": _w((lambda *s: torch.randn(*s, dtype=torch.bfloat16) * 0.8)(B, H, Sk, Dh)),
            "v_cache": _w((lambda *s: torch.randn(*s, dtype=torch.bfloat16) * 0.05)(B, H, Sk, Dh)),
            "wq": _w((lambda *s: torch.randn(*s, dtype=torch.bfloat16) * 0.8)(D, H * Dh) * (D ** -0.5)),
            "wo": _w((lambda *s: torch.randn(*s, dtype=torch.bfloat16) * 0.05)(H * Dh, D) * ((H * Dh) ** -0.5)),
        }
    _A_in = _A_setup()

    def _B_setup():
        B, Sq, D = 8, 224, 640
        Hq, Hkv, Sk, Dh = 32, 32, 512, 128
        assert Hq % Hkv == 0, (Hq, Hkv)
        return {
            "x": _w((lambda *s: torch.randn(*s, dtype=torch.bfloat16) * 0.8)(B, Sq, D)),
            "k_cache": _w((lambda *s: torch.randn(*s, dtype=torch.bfloat16) * 0.8)(B, Hkv, Sk, Dh)),
            "v_cache": _w((lambda *s: torch.randn(*s, dtype=torch.bfloat16) * 0.05)(B, Hkv, Sk, Dh)),
            "wq": _w((lambda *s: torch.randn(*s, dtype=torch.bfloat16) * 0.8)(D, Hq * Dh) * (D ** -0.5)),
            "wo": _w((lambda *s: torch.randn(*s, dtype=torch.bfloat16) * 0.05)(Hq * Dh, D) * ((Hq * Dh) ** -0.5)),
        }
    _B_in = _B_setup()

    return {
        "A_x": _A_in["x"],
        "A_k_cache": _A_in["k_cache"],
        "A_v_cache": _A_in["v_cache"],
        "A_wq": _A_in["wq"],
        "A_wo": _A_in["wo"],
        "B_x": _B_in["x"],
        "B_k_cache": _B_in["k_cache"],
        "B_v_cache": _B_in["v_cache"],
        "B_wq": _B_in["wq"],
        "B_wo": _B_in["wo"],
    }

def reference(A_x, A_k_cache, A_v_cache, A_wq, A_wo, B_x, B_k_cache, B_v_cache, B_wq, B_wo):
    def _A_ref(x, k_cache, v_cache, wq, wo):
        B, Sq, D = x.shape
        H, Dh = 32, 128
        q = (lambda x, *d: x.permute(*d))((x @ wq).reshape(B, Sq, H, Dh), 0, 2, 1, 3)
        scores = torch.einsum("bhqd,bhkd->bhqk", q, k_cache) * (Dh ** -0.5)
        p = _softmax(scores, axis=-1)
        o = torch.einsum("bhqk,bhkd->bhqd", p, v_cache)
        return (lambda x, *d: x.permute(*d))(o, 0, 2, 1, 3).reshape(B, Sq, H * Dh) @ wo

    def _B_ref(x, k_cache, v_cache, wq, wo):
        B, Sq, D = x.shape
        Hq, Dh = 32, 128
        Hkv = k_cache.shape[1]
        rep = Hq // Hkv
        q = (lambda x, *d: x.permute(*d))((x @ wq).reshape(B, Sq, Hq, Dh), 0, 2, 1, 3)
        k = (lambda x, n, axis: torch.repeat_interleave(x, n, dim=axis))(k_cache, rep, axis=1)
        v = (lambda x, n, axis: torch.repeat_interleave(x, n, dim=axis))(v_cache, rep, axis=1)
        scores = torch.einsum("bhqd,bhkd->bhqk", q, k) * (Dh ** -0.5)
        p = _softmax(scores, axis=-1)
        o = torch.einsum("bhqk,bhkd->bhqd", p, v)
        return (lambda x, *d: x.permute(*d))(o, 0, 2, 1, 3).reshape(B, Sq, Hq * Dh) @ wo

    a = _A_ref(A_x, A_k_cache, A_v_cache, A_wq, A_wo)
    b = _B_ref(B_x, B_k_cache, B_v_cache, B_wq, B_wo)
    return torch.concatenate([a, b], axis=-1)
```

```asm
; @launch grid=(256,1,1) block=(256,1,1) lds=163840
.amdgcn_target "amdgcn-amd-amdhsa--gfx950"
.text
.globl concat_heads__mha_block_cached__gqa_block_cached__near_ridge_kernel
.p2align 8
.type concat_heads__mha_block_cached__gqa_block_cached__near_ridge_kernel,@function
concat_heads__mha_block_cached__gqa_block_cached__near_ridge_kernel:
 s_cmp_ge_u32 s2, 256
 s_cbranch_scc1 K1_END
 s_load_dwordx16 s[48:63], s[0:1], 0
 s_load_dwordx8 s[64:71], s[0:1], 64
 s_load_dwordx2 s[72:73], s[0:1], 96
 s_branch K1_SETUP
.p2align 12
K1_SETUP:
 s_getpc_b64 s[96:97]
K1_BASE:
 s_and_b32 s96, s96, 0xffffff80
 s_and_b32 s97, s97, 0xffff
 s_mov_b32 s98, K1_SLOW-K1_BASE
 s_mov_b32 s99, 0x20000
 s_lshr_b32 s74, s2, 3
 s_lshl_b32 s74, s74, 10
 v_lshlrev_b32 v25, 7, v0
 v_add_u32 v25, s74, v25
 v_cmp_lt_u32 vcc, 7, v0
 v_mov_b32 v33, 0x40000000
 s_nop 0
 v_cndmask_b32 v25, v25, v33, vcc
 v_lshrrev_b32 v32, 6, v0
 v_and_b32 v0, 63, v0
 s_and_b32 s39, s2, 7
 v_readfirstlane_b32 s36, v32
 s_lshr_b32 s43, s2, 3
 s_lshr_b32 s3, s39, 2
 s_and_b32 s39, s39, 3
 s_lshl_b32 s39, s39, 2
 s_and_b32 s74, s43, 3
 s_add_u32 s39, s39, s74
 s_lshr_b32 s43, s43, 2
 s_lshr_b32 s37, s36, 1
 s_and_b32 s38, s36, 1
 s_lshl_b32 s44, s36, 10
 s_lshl_b32 s74, s74, 1
 s_add_u32 s74, s74, s43
 s_and_b32 s74, s74, 7
 s_lshl_b32 s74, s74, 2
 s_lshr_b32 s74, 2002076672, s74
 s_and_b32 s94, s74, 15
 s_cmp_ge_u32 s94, 10
 s_cselect_b32 s74, 10, 0
 s_sub_u32 s94, s94, s74
 s_lshl_b32 s92, s94, 7
 s_lshl_b32 s93, s94, 19
 s_lshr_b32 s74, s2, 4
 s_xor_b32 s74, s74, s2
 s_and_b32 s74, s74, 15
 s_mul_i32 s101, s74, 512
 s_mov_b32 s101, 0
 s_bfe_u32 s75, s74, 0x10000
 s_lshl_b32 s75, s75, 10
 s_or_b32 s101, s101, s75
 s_bfe_u32 s75, s74, 0x10001
 s_lshl_b32 s75, s75, 11
 s_or_b32 s101, s101, s75
 s_bfe_u32 s75, s74, 0x10002
 s_lshl_b32 s75, s75, 12
 s_or_b32 s101, s101, s75
 s_bfe_u32 s75, s74, 0x10003
 s_lshl_b32 s75, s75, 13
 s_or_b32 s101, s101, s75
 v_lshrrev_b32 v32, 3, v0
 v_and_b32 v33, 7, v0
 v_lshrrev_b32 v34, 1, v32
 v_xor_b32 v33, v33, v34
 s_lshl_b32 s74, s38, 2
 v_xor_b32 v33, s74, v33
 s_lshl_b32 s75, s36, 3
 v_add_u32 v32, s75, v32
 v_mul_u32_u24 v32, 1280, v32
 v_lshl_add_u32 v8, v33, 4, v32
 v_lshrrev_b32 v32, 5, v0
 v_and_b32 v33, 31, v0
 s_lshl_b32 s74, s38, 1
 v_add_u32 v34, s74, v32
 v_lshlrev_b32 v34, 2, v34
 v_xor_b32 v33, v33, v34
 s_lshl_b32 s75, s36, 1
 v_add_u32 v32, s75, v32
 v_lshlrev_b32 v32, 13, v32
 v_lshl_add_u32 v9, v33, 4, v32
 s_cmp_eq_u32 s3, 0
 s_waitcnt lgkmcnt(0)
 s_cselect_b64 s[48:49], s[48:49], s[58:59]
 s_cselect_b64 s[50:51], s[50:51], s[60:61]
 s_cselect_b64 s[52:53], s[52:53], s[62:63]
 s_cselect_b64 s[54:55], s[54:55], s[64:65]
 s_cselect_b64 s[56:57], s[56:57], s[66:67]
 s_mul_i32 s74, s43, 286720
 s_add_u32 s4, s48, s74
 s_addc_u32 s5, s49, 0
 s_and_b32 s5, s5, 0xffff
 s_mov_b32 s6, 286720
 s_mov_b32 s7, 0x20000
 s_lshl_b32 s74, s39, 9
 s_add_u32 s8, s54, s74
 s_addc_u32 s9, s55, 0
 s_and_b32 s9, s9, 0xffff
 s_sub_u32 s10, 5242880, s74
 s_mov_b32 s11, 0x20000
 s_add_u32 m0, s44, 40960
 s_add_u32 s40, s92, 0
 s_nop 0
 buffer_load_dwordx4 v8, s[4:7], s40 offen lds
 s_add_u32 m0, s44, 45056
 s_add_u32 s40, s92, 40960
 buffer_load_dwordx4 v8, s[4:7], s40 offen lds
 s_add_u32 m0, s44, 49152
 s_add_u32 s40, s92, 81920
 buffer_load_dwordx4 v8, s[4:7], s40 offen lds
 s_add_u32 m0, s44, 53248
 s_add_u32 s40, s92, 122880
 buffer_load_dwordx4 v8, s[4:7], s40 offen lds
 s_add_u32 m0, s44, 57344
 s_add_u32 s40, s92, 163840
 buffer_load_dwordx4 v8, s[4:7], s40 offen lds
 s_add_u32 m0, s44, 61440
 s_add_u32 s40, s92, 204800
 buffer_load_dwordx4 v8, s[4:7], s40 offen lds
 s_add_u32 m0, s44, 65536
 s_add_u32 s40, s92, 245760
 buffer_load_dwordx4 v8, s[4:7], s40 offen lds
 s_add_u32 m0, s44, 98304
 s_add_u32 s40, s93, 0
 buffer_load_dwordx4 v9, s[8:11], s40 offen lds
 s_add_u32 m0, s44, 102400
 s_add_u32 s40, s93, 65536
 buffer_load_dwordx4 v9, s[8:11], s40 offen lds
 s_add_u32 m0, s44, 106496
 s_add_u32 s40, s93, 131072
 buffer_load_dwordx4 v9, s[8:11], s40 offen lds
 s_add_u32 m0, s44, 110592
 s_add_u32 s40, s93, 196608
 buffer_load_dwordx4 v9, s[8:11], s40 offen lds
 s_add_u32 m0, s44, 114688
 s_add_u32 s40, s93, 262144
 buffer_load_dwordx4 v9, s[8:11], s40 offen lds
 s_add_u32 m0, s44, 118784
 s_add_u32 s40, s93, 327680
 buffer_load_dwordx4 v9, s[8:11], s40 offen lds
 s_add_u32 m0, s44, 122880
 s_add_u32 s40, s93, 393216
 buffer_load_dwordx4 v9, s[8:11], s40 offen lds
 s_add_u32 m0, s44, 126976
 s_add_u32 s40, s93, 458752
 buffer_load_dwordx4 v9, s[8:11], s40 offen lds
CPF1:
 s_mov_b32 s75, CPF1-K1_BASE+0
 buffer_load_dword a255, v25, s[96:99], s75 offen
CPF2:
 s_mov_b32 s75, CPF2-K1_BASE+32768
 buffer_load_dword a255, v25, s[96:99], s75 offen
 s_mul_i32 s74, s3, 557056
 s_add_u32 s74, s74, 50331648
 s_add_u32 s80, s72, s74
 s_addc_u32 s81, s73, 0
 s_and_b32 s81, s81, 0xffff
 s_mov_b32 s82, 557056
 s_mov_b32 s83, 0x20000
 s_lshl_b32 s74, s3, 7
 s_add_u32 s84, s70, s74
 s_addc_u32 s85, s71, 0
 s_and_b32 s85, s85, 0xffff
 s_mov_b32 s86, 128
 s_mov_b32 s87, 0x20000
 s_lshl_b32 s74, s43, 4
 s_add_u32 s74, s74, s39
 s_mul_i32 s74, s74, 4352
 s_lshl_b32 s100, s36, 2
 s_add_u32 s100, s100, s74
 s_lshl_b32 s95, s39, 3
 s_add_u32 s95, s95, s43
 s_mov_b32 s89, s36
 s_mul_i32 s74, s95, 40960
 s_add_u32 s20, s56, s74
 s_addc_u32 s21, s57, 0
 s_and_b32 s21, s21, 0xffff
 s_mov_b32 s22, 40960
 s_mov_b32 s23, 0x20000
 s_mul_i32 s47, s36, 320
 s_lshl_b32 s74, s39, 1
 s_add_u32 s74, s74, s37
 s_lshl_b32 s75, s43, 5
 s_add_u32 s75, s75, s74
 s_lshl_b32 s75, s75, 17
 s_add_u32 s12, s50, s75
 s_addc_u32 s13, s51, 0
 s_and_b32 s13, s13, 0xffff
 s_mov_b32 s14, 131072
 s_mov_b32 s15, 0x20000
 s_add_u32 s16, s52, s75
 s_addc_u32 s17, s53, 0
 s_and_b32 s17, s17, 0xffff
 s_mov_b32 s18, 131072
 s_mov_b32 s19, 0x20000
 s_mul_i32 s74, s74, 7168
 s_lshl_b32 s75, s43, 1
 s_add_u32 s75, s75, s38
 s_mul_i32 s75, s75, 917504
 s_add_u32 s74, s74, s75
 s_mul_i32 s75, s3, 14680064
 s_add_u32 s74, s74, s75
 s_add_u32 s24, s72, s74
 s_addc_u32 s25, s73, 0
 s_and_b32 s25, s25, 0xffff
 s_mov_b32 s26, 695296
 s_mov_b32 s27, 0x20000
 s_and_b32 s74, s95, 3
 s_lshl_b32 s74, s74, 5
 s_lshr_b32 s95, s95, 2
 s_add_u32 s95, s95, s74
 s_mul_i32 s74, s95, 5120
 s_mul_i32 s75, s89, 1310720
 s_add_u32 s74, s74, s75
 s_mul_i32 s75, s3, 5242880
 s_add_u32 s74, s74, s75
 s_add_u32 s74, s74, 33554432
 s_add_u32 s28, s72, s74
 s_addc_u32 s29, s73, 0
 s_and_b32 s29, s29, 0xffff
 s_mov_b32 s30, 660480
 s_mov_b32 s31, 0x20000
 s_lshl_b32 s74, s37, 14
 s_lshl_b32 s75, s38, 10
 s_add_u32 s45, s74, s75
 s_lshl_b32 s75, s38, 10
 s_add_u32 s46, s74, s75
 s_add_u32 s46, s46, 65536
 s_mov_b32 s42, 0x3e0293ee
 v_lshrrev_b32 v32, 4, v0
 v_and_b32 v33, 15, v0
 v_bfe_u32 v34, v0, 2, 2
 v_and_b32 v35, 3, v0
 s_mul_i32 s75, s38, 14336
 s_add_u32 s75, s75, 40960
 v_lshrrev_b32 v36, 1, v33
 v_xor_b32 v36, v36, v32
 v_lshlrev_b32 v37, 7, v33
 v_add_u32 v37, s75, v37
 v_lshl_add_u32 v2, v36, 4, v37
 v_xor_b32 v3, 64, v2
 s_lshl_b32 s75, s37, 8
 s_add_u32 s75, s75, 98304
 v_lshl_add_u32 v36, v32, 3, v34
 v_lshlrev_b32 v36, 9, v36
 v_lshl_add_u32 v36, v35, 4, v36
 v_add_u32 v36, s75, v36
 v_lshl_add_u32 v4, v34, 6, v36
 v_xor_b32 v5, 64, v4
 v_xor_b32 v6, 128, v4
 v_xor_b32 v7, 192, v4
 v_xor_b32 v36, v32, v33
 v_lshlrev_b32 v37, 8, v33
 v_add_u32 v37, s74, v37
 v_lshl_add_u32 v10, v36, 4, v37
 v_xor_b32 v11, 64, v10
 v_xor_b32 v12, 128, v10
 v_xor_b32 v13, 192, v10
 s_add_u32 s75, s74, 65536
 v_lshl_add_u32 v36, v32, 2, v34
 v_and_b32 v37, 7, v36
 v_lshlrev_b32 v37, 5, v37
 v_lshl_add_u32 v37, v36, 8, v37
 v_lshl_add_u32 v37, v35, 3, v37
 v_add_u32 v14, s75, v37
 v_xor_b32 v15, 32, v14
 v_xor_b32 v16, 64, v14
 v_xor_b32 v17, 96, v14
 v_xor_b32 v18, 128, v14
 v_xor_b32 v19, 160, v14
 v_xor_b32 v20, 192, v14
 v_xor_b32 v21, 224, v14
 v_mul_u32_u24 v37, 1280, v36
 v_lshl_add_u32 v37, v35, 3, v37
 v_add_u32 v29, s47, v37
 v_lshl_add_u32 v28, v35, 3, v29
 v_xor_b32 v36, v33, v32
 s_lshl_b32 s75, s38, 2
 v_xor_b32 v36, s75, v36
 v_and_b32 v38, 1, v32
 v_mul_u32_u24 v38, 256, v38
 v_lshrrev_b32 v39, 1, v32
 v_mul_u32_u24 v39, 32768, v39
 v_add_u32 v38, v38, v39
 s_mul_i32 s75, s38, 512
 v_add_u32 v37, s75, v38
 v_lshl_add_u32 v22, v36, 4, v37
 v_xor_b32 v23, 128, v22
 v_add_u32 v23, 63488, v23
 v_lshlrev_b32 v36, 1, v32
 v_xor_b32 v36, v36, v33
 s_lshl_b32 s75, s38, 3
 v_xor_b32 v36, s75, v36
 s_mul_i32 s75, s38, 512
 v_add_u32 v37, s75, v38
 v_lshl_add_u32 v24, v36, 4, v37
 v_lshlrev_b32 v0, 4, v0
 v_add_u32 v26, s45, v0
 v_add_u32 v27, s46, v0
 v_mov_b32 v32, 0
 v_mov_b32 v33, 0
 v_mov_b32 v34, 0
 v_mov_b32 v35, 0
 v_mov_b32 v36, 0
 v_mov_b32 v37, 0
 v_mov_b32 v38, 0
 v_mov_b32 v39, 0
 v_mov_b32 v40, 0
 v_mov_b32 v41, 0
 v_mov_b32 v42, 0
 v_mov_b32 v43, 0
 v_mov_b32 v44, 0
 v_mov_b32 v45, 0
 v_mov_b32 v46, 0
 v_mov_b32 v47, 0
 v_mov_b32 v48, 0
 v_mov_b32 v49, 0
 v_mov_b32 v50, 0
 v_mov_b32 v51, 0
 v_mov_b32 v52, 0
 v_mov_b32 v53, 0
 v_mov_b32 v54, 0
 v_mov_b32 v55, 0
 v_mov_b32 v56, 0
 v_mov_b32 v57, 0
 v_mov_b32 v58, 0
 v_mov_b32 v59, 0
 v_mov_b32 v60, 0
 v_mov_b32 v61, 0
 v_mov_b32 v62, 0
 v_mov_b32 v63, 0
 v_mov_b32 v64, 0
 v_mov_b32 v65, 0
 v_mov_b32 v66, 0
 v_mov_b32 v67, 0
 v_mov_b32 v68, 0
 v_mov_b32 v69, 0
 v_mov_b32 v70, 0
 v_mov_b32 v71, 0
 v_mov_b32 v72, 0
 v_mov_b32 v73, 0
 v_mov_b32 v74, 0
 v_mov_b32 v75, 0
 v_mov_b32 v76, 0
 v_mov_b32 v77, 0
 v_mov_b32 v78, 0
 v_mov_b32 v79, 0
 v_mov_b32 v80, 0
 v_mov_b32 v81, 0
 v_mov_b32 v82, 0
 v_mov_b32 v83, 0
 v_mov_b32 v84, 0
 v_mov_b32 v85, 0
 v_mov_b32 v86, 0
 v_mov_b32 v87, 0
 v_mov_b32 v88, 0
 v_mov_b32 v89, 0
 v_mov_b32 v90, 0
 v_mov_b32 v91, 0
 v_mov_b32 v92, 0
 v_mov_b32 v93, 0
 v_mov_b32 v94, 0
 v_mov_b32 v95, 0
 v_mov_b32 v96, 0
 v_mov_b32 v97, 0
 v_mov_b32 v98, 0
 v_mov_b32 v99, 0
 v_mov_b32 v100, 0
 v_mov_b32 v101, 0
 v_mov_b32 v102, 0
 v_mov_b32 v103, 0
 v_mov_b32 v104, 0
 v_mov_b32 v105, 0
 v_mov_b32 v106, 0
 v_mov_b32 v107, 0
 v_mov_b32 v108, 0
 v_mov_b32 v109, 0
 v_mov_b32 v110, 0
 v_mov_b32 v111, 0
 v_mov_b32 v112, 0
 v_mov_b32 v113, 0
 v_mov_b32 v114, 0
 v_mov_b32 v115, 0
 v_mov_b32 v116, 0
 v_mov_b32 v117, 0
 v_mov_b32 v118, 0
 v_mov_b32 v119, 0
 v_mov_b32 v120, 0
 v_mov_b32 v121, 0
 v_mov_b32 v122, 0
 v_mov_b32 v123, 0
 v_mov_b32 v124, 0
 v_mov_b32 v125, 0
 v_mov_b32 v126, 0
 v_mov_b32 v127, 0
 v_mov_b32 v128, 0
 v_mov_b32 v129, 0
 v_mov_b32 v130, 0
 v_mov_b32 v131, 0
 v_mov_b32 v132, 0
 v_mov_b32 v133, 0
 v_mov_b32 v134, 0
 v_mov_b32 v135, 0
 v_mov_b32 v136, 0
 v_mov_b32 v137, 0
 v_mov_b32 v138, 0
 v_mov_b32 v139, 0
 v_mov_b32 v140, 0
 v_mov_b32 v141, 0
 v_mov_b32 v142, 0
 v_mov_b32 v143, 0
 s_add_u32 s94, s94, 1
 s_cmp_eq_u32 s94, 10
 s_cselect_b32 s94, 0, s94
 s_lshl_b32 s92, s94, 7
 s_lshl_b32 s93, s94, 19
 s_add_u32 m0, s44, 69632
 s_add_u32 s40, s92, 0
 buffer_load_dwordx4 v8, s[4:7], s40 offen lds
 s_add_u32 m0, s44, 73728
 s_add_u32 s40, s92, 40960
 buffer_load_dwordx4 v8, s[4:7], s40 offen lds
 s_add_u32 m0, s44, 77824
 s_add_u32 s40, s92, 81920
 buffer_load_dwordx4 v8, s[4:7], s40 offen lds
 s_add_u32 m0, s44, 81920
 s_add_u32 s40, s92, 122880
 buffer_load_dwordx4 v8, s[4:7], s40 offen lds
 s_add_u32 m0, s44, 86016
 s_add_u32 s40, s92, 163840
 buffer_load_dwordx4 v8, s[4:7], s40 offen lds
 s_add_u32 m0, s44, 90112
 s_add_u32 s40, s92, 204800
 buffer_load_dwordx4 v8, s[4:7], s40 offen lds
 s_add_u32 m0, s44, 94208
 s_add_u32 s40, s92, 245760
 buffer_load_dwordx4 v8, s[4:7], s40 offen lds
 s_add_u32 m0, s44, 131072
 s_add_u32 s40, s93, 0
 buffer_load_dwordx4 v9, s[8:11], s40 offen lds
 s_add_u32 m0, s44, 135168
 s_add_u32 s40, s93, 65536
 buffer_load_dwordx4 v9, s[8:11], s40 offen lds
 s_add_u32 m0, s44, 139264
 s_add_u32 s40, s93, 131072
 buffer_load_dwordx4 v9, s[8:11], s40 offen lds
 s_add_u32 m0, s44, 143360
 s_add_u32 s40, s93, 196608
 buffer_load_dwordx4 v9, s[8:11], s40 offen lds
 s_add_u32 m0, s44, 147456
 s_add_u32 s40, s93, 262144
 buffer_load_dwordx4 v9, s[8:11], s40 offen lds
 s_add_u32 m0, s44, 151552
 s_add_u32 s40, s93, 327680
 buffer_load_dwordx4 v9, s[8:11], s40 offen lds
 s_add_u32 m0, s44, 155648
 s_add_u32 s40, s93, 393216
 buffer_load_dwordx4 v9, s[8:11], s40 offen lds
 s_add_u32 m0, s44, 159744
 s_add_u32 s40, s93, 458752
 buffer_load_dwordx4 v9, s[8:11], s40 offen lds
 v_mov_b32 v32, 0
 s_mov_b64 exec, 1
 buffer_store_dword v32, v32, s[80:83], s100 offen sc1
 s_mov_b64 exec, -1
 v_mov_b32 v144, 0
 v_mov_b32 v145, 0
 v_mov_b32 v146, 0
 v_mov_b32 v147, 0
 v_mov_b32 v148, 0
 v_mov_b32 v149, 0
 v_mov_b32 v150, 0
 v_mov_b32 v151, 0
 v_mov_b32 v152, 0
 v_mov_b32 v153, 0
 v_mov_b32 v154, 0
 v_mov_b32 v155, 0
 v_mov_b32 v156, 0
 v_mov_b32 v157, 0
 v_mov_b32 v158, 0
 v_mov_b32 v159, 0
 v_mov_b32 v160, 0
 v_mov_b32 v161, 0
 v_mov_b32 v162, 0
 v_mov_b32 v163, 0
 v_mov_b32 v164, 0
 v_mov_b32 v165, 0
 v_mov_b32 v166, 0
 v_mov_b32 v167, 0
 v_mov_b32 v168, 0
 v_mov_b32 v169, 0
 v_mov_b32 v170, 0
 v_mov_b32 v171, 0
 v_mov_b32 v172, 0
 v_mov_b32 v173, 0
 v_mov_b32 v174, 0
 v_mov_b32 v175, 0
 v_mov_b32 v176, 0
 v_mov_b32 v177, 0
 v_mov_b32 v178, 0
 v_mov_b32 v179, 0
 v_mov_b32 v180, 0
 v_mov_b32 v181, 0
 v_mov_b32 v182, 0
 v_mov_b32 v183, 0
 v_mov_b32 v184, 0
 v_mov_b32 v185, 0
 v_mov_b32 v186, 0
 v_mov_b32 v187, 0
 v_mov_b32 v188, 0
 v_mov_b32 v189, 0
 v_mov_b32 v190, 0
 v_mov_b32 v191, 0
 v_mov_b32 v192, 0
 v_mov_b32 v193, 0
 v_mov_b32 v194, 0
 v_mov_b32 v195, 0
 v_mov_b32 v196, 0
 v_mov_b32 v197, 0
 v_mov_b32 v198, 0
 v_mov_b32 v199, 0
 v_mov_b32 v200, 0
 v_mov_b32 v201, 0
 v_mov_b32 v202, 0
 v_mov_b32 v203, 0
 v_mov_b32 v204, 0
 v_mov_b32 v205, 0
 v_mov_b32 v206, 0
 v_mov_b32 v207, 0
 v_mov_b32 v208, 0
 v_mov_b32 v209, 0
 v_mov_b32 v210, 0
 v_mov_b32 v211, 0
 v_mov_b32 v212, 0
 v_mov_b32 v213, 0
 v_mov_b32 v214, 0
 v_mov_b32 v215, 0
 v_mov_b32 v216, 0
 v_mov_b32 v217, 0
 v_mov_b32 v218, 0
 v_mov_b32 v219, 0
 v_mov_b32 v220, 0
 v_mov_b32 v221, 0
 v_mov_b32 v222, 0
 v_mov_b32 v223, 0
 v_mov_b32 v224, 0
 v_mov_b32 v225, 0
 v_mov_b32 v226, 0
 v_mov_b32 v227, 0
 v_mov_b32 v228, 0
 v_mov_b32 v229, 0
 v_mov_b32 v230, 0
 v_mov_b32 v231, 0
 v_mov_b32 v232, 0
 v_mov_b32 v233, 0
 v_mov_b32 v234, 0
 v_mov_b32 v235, 0
 v_mov_b32 v236, 0
 v_mov_b32 v237, 0
 v_mov_b32 v238, 0
 v_mov_b32 v239, 0
 v_mov_b32 v240, 0
 v_mov_b32 v241, 0
 v_mov_b32 v242, 0
 v_mov_b32 v243, 0
 v_mov_b32 v244, 0
 v_mov_b32 v245, 0
 v_mov_b32 v246, 0
 v_mov_b32 v247, 0
 v_mov_b32 v248, 0
 v_mov_b32 v249, 0
 v_mov_b32 v250, 0
 v_mov_b32 v251, 0
 v_mov_b32 v252, 0
 v_mov_b32 v253, 0
 v_mov_b32 v254, 0
 v_mov_b32 v255, 0
 s_cmp_eq_u32 s36, 0
 s_cbranch_scc1 C1_0
 s_cmp_eq_u32 s36, 1
 s_cbranch_scc1 C1_1
 s_cmp_eq_u32 s36, 2
 s_cbranch_scc1 C1_2
 s_branch C1_3
RET1:
 s_waitcnt vmcnt(18)
 s_barrier
 ds_read_b64_tr_b16 a[112:113], v4 offset:0
 ds_read_b64_tr_b16 a[114:115], v4 offset:2048
 ds_read_b64_tr_b16 a[116:117], v4 offset:16384
 ds_read_b64_tr_b16 a[118:119], v4 offset:18432
 ds_read_b128 a[0:3], v2 offset:0
 ds_read_b128 a[4:7], v3 offset:0
 ds_read_b128 a[8:11], v2 offset:2048
 ds_read_b128 a[12:15], v3 offset:2048
 ds_read_b128 a[16:19], v2 offset:4096
 ds_read_b128 a[20:23], v3 offset:4096
 ds_read_b128 a[24:27], v2 offset:6144
 ds_read_b128 a[28:31], v3 offset:6144
 ds_read_b128 a[32:35], v2 offset:8192
 ds_read_b128 a[36:39], v3 offset:8192
 ds_read_b128 a[40:43], v2 offset:10240
 ds_read_b128 a[44:47], v3 offset:10240
 ds_read_b128 a[48:51], v2 offset:12288
 ds_read_b128 a[52:55], v3 offset:12288
 ds_read_b64_tr_b16 a[120:121], v4 offset:8
 ds_read_b64_tr_b16 a[122:123], v4 offset:2056
 ds_read_b64_tr_b16 a[124:125], v4 offset:16392
 ds_read_b64_tr_b16 a[126:127], v4 offset:18440
 s_waitcnt lgkmcnt(15)
 v_mfma_f32_16x16x32_bf16 v[32:35], a[112:115], a[0:3], v[32:35]
 s_add_u32 s94, s94, 1
 v_mfma_f32_16x16x32_bf16 v[32:35], a[116:119], a[4:7], v[32:35]
 s_waitcnt lgkmcnt(14)
 ds_read_b64_tr_b16 a[128:129], v5 offset:0
 v_mfma_f32_16x16x32_bf16 v[64:67], a[112:115], a[8:11], v[64:67]
 s_cmp_eq_u32 s94, 10
 s_cselect_b32 s94, 0, s94
 v_mfma_f32_16x16x32_bf16 v[64:67], a[116:119], a[12:15], v[64:67]
 s_waitcnt lgkmcnt(13)
 ds_read_b64_tr_b16 a[130:131], v5 offset:2048
 v_mfma_f32_16x16x32_bf16 v[96:99], a[112:115], a[16:19], v[96:99]
 s_lshl_b32 s92, s94, 7
 v_mfma_f32_16x16x32_bf16 v[96:99], a[116:119], a[20:23], v[96:99]
 s_waitcnt lgkmcnt(12)
 ds_read_b64_tr_b16 a[132:133], v5 offset:16384
 v_mfma_f32_16x16x32_bf16 v[128:131], a[112:115], a[24:27], v[128:131]
 s_lshl_b32 s93, s94, 19
 v_mfma_f32_16x16x32_bf16 v[128:131], a[116:119], a[28:31], v[128:131]
 s_waitcnt lgkmcnt(11)
 ds_read_b64_tr_b16 a[134:135], v5 offset:18432
 v_mfma_f32_16x16x32_bf16 v[160:163], a[112:115], a[32:35], v[160:163]
 s_add_u32 m0, s44, 40960
 v_mfma_f32_16x16x32_bf16 v[160:163], a[116:119], a[36:39], v[160:163]
 s_waitcnt lgkmcnt(10)
 v_mfma_f32_16x16x32_bf16 v[192:195], a[112:115], a[40:43], v[192:195]
 s_add_u32 s40, s92, 0
 v_mfma_f32_16x16x32_bf16 v[192:195], a[116:119], a[44:47], v[192:195]
 s_waitcnt lgkmcnt(8)
 v_mfma_f32_16x16x32_bf16 v[224:227], a[112:115], a[48:51], v[224:227]
 v_mfma_f32_16x16x32_bf16 v[224:227], a[116:119], a[52:55], v[224:227]
 s_waitcnt lgkmcnt(4)
 v_mfma_f32_16x16x32_bf16 v[36:39], a[120:123], a[0:3], v[36:39]
 v_mfma_f32_16x16x32_bf16 v[36:39], a[124:127], a[4:7], v[36:39]
 ds_read_b64_tr_b16 a[136:137], v5 offset:8
 v_mfma_f32_16x16x32_bf16 v[68:71], a[120:123], a[8:11], v[68:71]
 v_mfma_f32_16x16x32_bf16 v[68:71], a[124:127], a[12:15], v[68:71]
 ds_read_b64_tr_b16 a[138:139], v5 offset:2056
 v_mfma_f32_16x16x32_bf16 v[100:103], a[120:123], a[16:19], v[100:103]
 v_mfma_f32_16x16x32_bf16 v[100:103], a[124:127], a[20:23], v[100:103]
 ds_read_b64_tr_b16 a[140:141], v5 offset:16392
 v_mfma_f32_16x16x32_bf16 v[132:135], a[120:123], a[24:27], v[132:135]
 v_mfma_f32_16x16x32_bf16 v[132:135], a[124:127], a[28:31], v[132:135]
 ds_read_b64_tr_b16 a[142:143], v5 offset:18440
 v_mfma_f32_16x16x32_bf16 v[164:167], a[120:123], a[32:35], v[164:167]
 v_mfma_f32_16x16x32_bf16 v[164:167], a[124:127], a[36:39], v[164:167]
 v_mfma_f32_16x16x32_bf16 v[196:199], a[120:123], a[40:43], v[196:199]
 v_mfma_f32_16x16x32_bf16 v[196:199], a[124:127], a[44:47], v[196:199]
 v_mfma_f32_16x16x32_bf16 v[228:231], a[120:123], a[48:51], v[228:231]
 v_mfma_f32_16x16x32_bf16 v[228:231], a[124:127], a[52:55], v[228:231]
 s_waitcnt lgkmcnt(4)
 v_mfma_f32_16x16x32_bf16 v[40:43], a[128:131], a[0:3], v[40:43]
 v_mfma_f32_16x16x32_bf16 v[40:43], a[132:135], a[4:7], v[40:43]
 ds_read_b64_tr_b16 a[112:113], v6 offset:0
 v_mfma_f32_16x16x32_bf16 v[72:75], a[128:131], a[8:11], v[72:75]
 v_mfma_f32_16x16x32_bf16 v[72:75], a[132:135], a[12:15], v[72:75]
 ds_read_b64_tr_b16 a[114:115], v6 offset:2048
 v_mfma_f32_16x16x32_bf16 v[104:107], a[128:131], a[16:19], v[104:107]
 v_mfma_f32_16x16x32_bf16 v[104:107], a[132:135], a[20:23], v[104:107]
 ds_read_b64_tr_b16 a[116:117], v6 offset:16384
 v_mfma_f32_16x16x32_bf16 v[136:139], a[128:131], a[24:27], v[136:139]
 v_mfma_f32_16x16x32_bf16 v[136:139], a[132:135], a[28:31], v[136:139]
 ds_read_b64_tr_b16 a[118:119], v6 offset:18432
 v_mfma_f32_16x16x32_bf16 v[168:171], a[128:131], a[32:35], v[168:171]
 v_mfma_f32_16x16x32_bf16 v[168:171], a[132:135], a[36:39], v[168:171]
 v_mfma_f32_16x16x32_bf16 v[200:203], a[128:131], a[40:43], v[200:203]
 v_mfma_f32_16x16x32_bf16 v[200:203], a[132:135], a[44:47], v[200:203]
 v_mfma_f32_16x16x32_bf16 v[232:235], a[128:131], a[48:51], v[232:235]
 v_mfma_f32_16x16x32_bf16 v[232:235], a[132:135], a[52:55], v[232:235]
 s_waitcnt lgkmcnt(4)
 v_mfma_f32_16x16x32_bf16 v[44:47], a[136:139], a[0:3], v[44:47]
 v_mfma_f32_16x16x32_bf16 v[44:47], a[140:143], a[4:7], v[44:47]
 ds_read_b64_tr_b16 a[120:121], v6 offset:8
 v_mfma_f32_16x16x32_bf16 v[76:79], a[136:139], a[8:11], v[76:79]
 v_mfma_f32_16x16x32_bf16 v[76:79], a[140:143], a[12:15], v[76:79]
 ds_read_b64_tr_b16 a[122:123], v6 offset:2056
 v_mfma_f32_16x16x32_bf16 v[108:111], a[136:139], a[16:19], v[108:111]
 v_mfma_f32_16x16x32_bf16 v[108:111], a[140:143], a[20:23], v[108:111]
 ds_read_b64_tr_b16 a[124:125], v6 offset:16392
 v_mfma_f32_16x16x32_bf16 v[140:143], a[136:139], a[24:27], v[140:143]
 v_mfma_f32_16x16x32_bf16 v[140:143], a[140:143], a[28:31], v[140:143]
 ds_read_b64_tr_b16 a[126:127], v6 offset:18440
 v_mfma_f32_16x16x32_bf16 v[172:175], a[136:139], a[32:35], v[172:175]
 v_mfma_f32_16x16x32_bf16 v[172:175], a[140:143], a[36:39], v[172:175]
 v_mfma_f32_16x16x32_bf16 v[204:207], a[136:139], a[40:43], v[204:207]
 v_mfma_f32_16x16x32_bf16 v[204:207], a[140:143], a[44:47], v[204:207]
 v_mfma_f32_16x16x32_bf16 v[236:239], a[136:139], a[48:51], v[236:239]
 v_mfma_f32_16x16x32_bf16 v[236:239], a[140:143], a[52:55], v[236:239]
 s_waitcnt lgkmcnt(4)
 v_mfma_f32_16x16x32_bf16 v[48:51], a[112:115], a[0:3], v[48:51]
 v_mfma_f32_16x16x32_bf16 v[48:51], a[116:119], a[4:7], v[48:51]
 ds_read_b64_tr_b16 a[128:129], v7 offset:0
 v_mfma_f32_16x16x32_bf16 v[80:83], a[112:115], a[8:11], v[80:83]
 v_mfma_f32_16x16x32_bf16 v[80:83], a[116:119], a[12:15], v[80:83]
 ds_read_b64_tr_b16 a[130:131], v7 offset:2048
 v_mfma_f32_16x16x32_bf16 v[112:115], a[112:115], a[16:19], v[112:115]
 v_mfma_f32_16x16x32_bf16 v[112:115], a[116:119], a[20:23], v[112:115]
 ds_read_b64_tr_b16 a[132:133], v7 offset:16384
 v_mfma_f32_16x16x32_bf16 v[144:147], a[112:115], a[24:27], v[144:147]
 v_mfma_f32_16x16x32_bf16 v[144:147], a[116:119], a[28:31], v[144:147]
 ds_read_b64_tr_b16 a[134:135], v7 offset:18432
 v_mfma_f32_16x16x32_bf16 v[176:179], a[112:115], a[32:35], v[176:179]
 v_mfma_f32_16x16x32_bf16 v[176:179], a[116:119], a[36:39], v[176:179]
 v_mfma_f32_16x16x32_bf16 v[208:211], a[112:115], a[40:43], v[208:211]
 v_mfma_f32_16x16x32_bf16 v[208:211], a[116:119], a[44:47], v[208:211]
 v_mfma_f32_16x16x32_bf16 v[240:243], a[112:115], a[48:51], v[240:243]
 v_mfma_f32_16x16x32_bf16 v[240:243], a[116:119], a[52:55], v[240:243]
 s_waitcnt lgkmcnt(4)
 v_mfma_f32_16x16x32_bf16 v[52:55], a[120:123], a[0:3], v[52:55]
 v_mfma_f32_16x16x32_bf16 v[52:55], a[124:127], a[4:7], v[52:55]
 ds_read_b64_tr_b16 a[136:137], v7 offset:8
 v_mfma_f32_16x16x32_bf16 v[84:87], a[120:123], a[8:11], v[84:87]
 v_mfma_f32_16x16x32_bf16 v[84:87], a[124:127], a[12:15], v[84:87]
 ds_read_b64_tr_b16 a[138:139], v7 offset:2056
 v_mfma_f32_16x16x32_bf16 v[116:119], a[120:123], a[16:19], v[116:119]
 v_mfma_f32_16x16x32_bf16 v[116:119], a[124:127], a[20:23], v[116:119]
 ds_read_b64_tr_b16 a[140:141], v7 offset:16392
 v_mfma_f32_16x16x32_bf16 v[148:151], a[120:123], a[24:27], v[148:151]
 v_mfma_f32_16x16x32_bf16 v[148:151], a[124:127], a[28:31], v[148:151]
 ds_read_b64_tr_b16 a[142:143], v7 offset:18440
 v_mfma_f32_16x16x32_bf16 v[180:183], a[120:123], a[32:35], v[180:183]
 s_branch SK734
C1_0:
PG734:
 s_branch PG2904
SK734:
 v_mfma_f32_16x16x32_bf16 v[180:183], a[124:127], a[36:39], v[180:183]
 v_mfma_f32_16x16x32_bf16 v[212:215], a[120:123], a[40:43], v[212:215]
 v_mfma_f32_16x16x32_bf16 v[212:215], a[124:127], a[44:47], v[212:215]
 v_mfma_f32_16x16x32_bf16 v[244:247], a[120:123], a[48:51], v[244:247]
 v_mfma_f32_16x16x32_bf16 v[244:247], a[124:127], a[52:55], v[244:247]
 s_waitcnt vmcnt(1) lgkmcnt(0)
 s_barrier
 v_mfma_f32_16x16x32_bf16 v[56:59], a[128:131], a[0:3], v[56:59]
 buffer_load_dwordx4 v8, s[4:7], s40 offen lds
 v_mfma_f32_16x16x32_bf16 v[56:59], a[132:135], a[4:7], v[56:59]
 s_add_u32 m0, s44, 45056
 ds_read_b64_tr_b16 a[112:113], v4 offset:32768
 v_mfma_f32_16x16x32_bf16 v[88:91], a[128:131], a[8:11], v[88:91]
 s_add_u32 s40, s92, 40960
 ds_read_b64_tr_b16 a[114:115], v4 offset:34816
 v_mfma_f32_16x16x32_bf16 v[88:91], a[132:135], a[12:15], v[88:91]
 ds_read_b64_tr_b16 a[116:117], v4 offset:49152
 v_mfma_f32_16x16x32_bf16 v[120:123], a[128:131], a[16:19], v[120:123]
 ds_read_b64_tr_b16 a[118:119], v4 offset:51200
 v_mfma_f32_16x16x32_bf16 v[120:123], a[132:135], a[20:23], v[120:123]
 buffer_load_dwordx4 v8, s[4:7], s40 offen lds
 v_mfma_f32_16x16x32_bf16 v[152:155], a[128:131], a[24:27], v[152:155]
 s_add_u32 m0, s44, 49152
 ds_read_b128 a[56:59], v2 offset:28672
 v_mfma_f32_16x16x32_bf16 v[152:155], a[132:135], a[28:31], v[152:155]
 s_add_u32 s40, s92, 81920
 ds_read_b128 a[60:63], v3 offset:28672
 v_mfma_f32_16x16x32_bf16 v[184:187], a[128:131], a[32:35], v[184:187]
 ds_read_b128 a[64:67], v2 offset:30720
 v_mfma_f32_16x16x32_bf16 v[184:187], a[132:135], a[36:39], v[184:187]
 ds_read_b128 a[68:71], v3 offset:30720
 v_mfma_f32_16x16x32_bf16 v[216:219], a[128:131], a[40:43], v[216:219]
 buffer_load_dwordx4 v8, s[4:7], s40 offen lds
 v_mfma_f32_16x16x32_bf16 v[216:219], a[132:135], a[44:47], v[216:219]
 s_add_u32 m0, s44, 53248
 ds_read_b128 a[72:75], v2 offset:32768
 v_mfma_f32_16x16x32_bf16 v[248:251], a[128:131], a[48:51], v[248:251]
 s_add_u32 s40, s92, 122880
 ds_read_b128 a[76:79], v3 offset:32768
 v_mfma_f32_16x16x32_bf16 v[248:251], a[132:135], a[52:55], v[248:251]
 s_waitcnt lgkmcnt(10)
 ds_read_b128 a[80:83], v2 offset:34816
 v_mfma_f32_16x16x32_bf16 v[60:63], a[136:139], a[0:3], v[60:63]
 ds_read_b128 a[84:87], v3 offset:34816
 v_mfma_f32_16x16x32_bf16 v[60:63], a[140:143], a[4:7], v[60:63]
 buffer_load_dwordx4 v8, s[4:7], s40 offen lds
 v_mfma_f32_16x16x32_bf16 v[92:95], a[136:139], a[8:11], v[92:95]
 s_add_u32 m0, s44, 57344
 ds_read_b128 a[88:91], v2 offset:36864
 v_mfma_f32_16x16x32_bf16 v[92:95], a[140:143], a[12:15], v[92:95]
 s_add_u32 s40, s92, 163840
 ds_read_b128 a[92:95], v3 offset:36864
 v_mfma_f32_16x16x32_bf16 v[124:127], a[136:139], a[16:19], v[124:127]
 ds_read_b128 a[96:99], v2 offset:38912
 v_mfma_f32_16x16x32_bf16 v[124:127], a[140:143], a[20:23], v[124:127]
 ds_read_b128 a[100:103], v3 offset:38912
 v_mfma_f32_16x16x32_bf16 v[156:159], a[136:139], a[24:27], v[156:159]
 buffer_load_dwordx4 v8, s[4:7], s40 offen lds
 v_mfma_f32_16x16x32_bf16 v[156:159], a[140:143], a[28:31], v[156:159]
 s_add_u32 m0, s44, 61440
 ds_read_b128 a[104:107], v2 offset:40960
 v_mfma_f32_16x16x32_bf16 v[188:191], a[136:139], a[32:35], v[188:191]
 s_add_u32 s40, s92, 204800
 ds_read_b128 a[108:111], v3 offset:40960
 v_mfma_f32_16x16x32_bf16 v[188:191], a[140:143], a[36:39], v[188:191]
 ds_read_b64_tr_b16 a[120:121], v4 offset:32776
 v_mfma_f32_16x16x32_bf16 v[220:223], a[136:139], a[40:43], v[220:223]
 ds_read_b64_tr_b16 a[122:123], v4 offset:34824
 v_mfma_f32_16x16x32_bf16 v[220:223], a[140:143], a[44:47], v[220:223]
 buffer_load_dwordx4 v8, s[4:7], s40 offen lds
 v_mfma_f32_16x16x32_bf16 v[252:255], a[136:139], a[48:51], v[252:255]
 s_add_u32 m0, s44, 65536
 ds_read_b64_tr_b16 a[124:125], v4 offset:49160
 v_mfma_f32_16x16x32_bf16 v[252:255], a[140:143], a[52:55], v[252:255]
 s_waitcnt lgkmcnt(15)
 ds_read_b64_tr_b16 a[126:127], v4 offset:51208
 v_mfma_f32_16x16x32_bf16 v[32:35], a[112:115], a[56:59], v[32:35]
 s_add_u32 s40, s92, 245760
 buffer_load_dwordx4 v8, s[4:7], s40 offen lds
 v_mfma_f32_16x16x32_bf16 v[32:35], a[116:119], a[60:63], v[32:35]
 s_waitcnt lgkmcnt(14)
 ds_read_b64_tr_b16 a[128:129], v5 offset:32768
 v_mfma_f32_16x16x32_bf16 v[64:67], a[112:115], a[64:67], v[64:67]
 s_add_u32 m0, s44, 98304
 s_add_u32 s40, s93, 0
 buffer_load_dwordx4 v9, s[8:11], s40 offen lds
 v_mfma_f32_16x16x32_bf16 v[64:67], a[116:119], a[68:71], v[64:67]
 s_waitcnt lgkmcnt(13)
 ds_read_b64_tr_b16 a[130:131], v5 offset:34816
 v_mfma_f32_16x16x32_bf16 v[96:99], a[112:115], a[72:75], v[96:99]
 s_add_u32 m0, s44, 102400
 s_add_u32 s40, s93, 65536
 buffer_load_dwordx4 v9, s[8:11], s40 offen lds
 v_mfma_f32_16x16x32_bf16 v[96:99], a[116:119], a[76:79], v[96:99]
 s_waitcnt lgkmcnt(12)
 ds_read_b64_tr_b16 a[132:133], v5 offset:49152
 v_mfma_f32_16x16x32_bf16 v[128:131], a[112:115], a[80:83], v[128:131]
 s_add_u32 m0, s44, 106496
 s_add_u32 s40, s93, 131072
 buffer_load_dwordx4 v9, s[8:11], s40 offen lds
 v_mfma_f32_16x16x32_bf16 v[128:131], a[116:119], a[84:87], v[128:131]
 s_waitcnt lgkmcnt(11)
 ds_read_b64_tr_b16 a[134:135], v5 offset:51200
 v_mfma_f32_16x16x32_bf16 v[160:163], a[112:115], a[88:91], v[160:163]
 s_add_u32 m0, s44, 110592
 s_add_u32 s40, s93, 196608
 buffer_load_dwordx4 v9, s[8:11], s40 offen lds
 v_mfma_f32_16x16x32_bf16 v[160:163], a[116:119], a[92:95], v[160:163]
 s_waitcnt lgkmcnt(10)
 s_add_u32 m0, s44, 114688
 s_add_u32 s40, s93, 262144
 buffer_load_dwordx4 v9, s[8:11], s40 offen lds
 v_mfma_f32_16x16x32_bf16 v[192:195], a[112:115], a[96:99], v[192:195]
 s_add_u32 m0, s44, 118784
 s_add_u32 s40, s93, 327680
 buffer_load_dwordx4 v9, s[8:11], s40 offen lds
 v_mfma_f32_16x16x32_bf16 v[192:195], a[116:119], a[100:103], v[192:195]
 s_waitcnt lgkmcnt(8)
 s_add_u32 m0, s44, 122880
 s_add_u32 s40, s93, 393216
 buffer_load_dwordx4 v9, s[8:11], s40 offen lds
 v_mfma_f32_16x16x32_bf16 v[224:227], a[112:115], a[104:107], v[224:227]
 s_add_u32 m0, s44, 126976
 s_add_u32 s40, s93, 458752
 buffer_load_dwordx4 v9, s[8:11], s40 offen lds
 v_mfma_f32_16x16x32_bf16 v[224:227], a[116:119], a[108:111], v[224:227]
 s_waitcnt lgkmcnt(4)
 v_mfma_f32_16x16x32_bf16 v[36:39], a[120:123], a[56:59], v[36:39]
 s_add_u32 s94, s94, 1
 v_mfma_f32_16x16x32_bf16 v[36:39], a[124:127], a[60:63], v[36:39]
 s_cmp_eq_u32 s94, 10
 s_cselect_b32 s94, 0, s94
 ds_read_b64_tr_b16 a[136:137], v5 offset:32776
 v_mfma_f32_16x16x32_bf16 v[68:71], a[120:123], a[64:67], v[68:71]
 s_lshl_b32 s92, s94, 7
 v_mfma_f32_16x16x32_bf16 v[68:71], a[124:127], a[68:71], v[68:71]
 s_lshl_b32 s93, s94, 19
 ds_read_b64_tr_b16 a[138:139], v5 offset:34824
 v_mfma_f32_16x16x32_bf16 v[100:103], a[120:123], a[72:75], v[100:103]
 s_add_u32 m0, s44, 69632
 v_mfma_f32_16x16x32_bf16 v[100:103], a[124:127], a[76:79], v[100:103]
 s_add_u32 s40, s92, 0
 ds_read_b64_tr_b16 a[140:141], v5 offset:49160
 v_mfma_f32_16x16x32_bf16 v[132:135], a[120:123], a[80:83], v[132:135]
 v_mfma_f32_16x16x32_bf16 v[132:135], a[124:127], a[84:87], v[132:135]
 ds_read_b64_tr_b16 a[142:143], v5 offset:51208
 v_mfma_f32_16x16x32_bf16 v[164:167], a[120:123], a[88:91], v[164:167]
 v_mfma_f32_16x16x32_bf16 v[164:167], a[124:127], a[92:95], v[164:167]
 v_mfma_f32_16x16x32_bf16 v[196:199], a[120:123], a[96:99], v[196:199]
 v_mfma_f32_16x16x32_bf16 v[196:199], a[124:127], a[100:103], v[196:199]
 v_mfma_f32_16x16x32_bf16 v[228:231], a[120:123], a[104:107], v[228:231]
 v_mfma_f32_16x16x32_bf16 v[228:231], a[124:127], a[108:111], v[228:231]
 s_waitcnt lgkmcnt(4)
 v_mfma_f32_16x16x32_bf16 v[40:43], a[128:131], a[56:59], v[40:43]
 v_mfma_f32_16x16x32_bf16 v[40:43], a[132:135], a[60:63], v[40:43]
 ds_read_b64_tr_b16 a[112:113], v6 offset:32768
 v_mfma_f32_16x16x32_bf16 v[72:75], a[128:131], a[64:67], v[72:75]
 v_mfma_f32_16x16x32_bf16 v[72:75], a[132:135], a[68:71], v[72:75]
 ds_read_b64_tr_b16 a[114:115], v6 offset:34816
 v_mfma_f32_16x16x32_bf16 v[104:107], a[128:131], a[72:75], v[104:107]
 v_mfma_f32_16x16x32_bf16 v[104:107], a[132:135], a[76:79], v[104:107]
 ds_read_b64_tr_b16 a[116:117], v6 offset:49152
 v_mfma_f32_16x16x32_bf16 v[136:139], a[128:131], a[80:83], v[136:139]
 v_mfma_f32_16x16x32_bf16 v[136:139], a[132:135], a[84:87], v[136:139]
 ds_read_b64_tr_b16 a[118:119], v6 offset:51200
 v_mfma_f32_16x16x32_bf16 v[168:171], a[128:131], a[88:91], v[168:171]
 v_mfma_f32_16x16x32_bf16 v[168:171], a[132:135], a[92:95], v[168:171]
 v_mfma_f32_16x16x32_bf16 v[200:203], a[128:131], a[96:99], v[200:203]
 v_mfma_f32_16x16x32_bf16 v[200:203], a[132:135], a[100:103], v[200:203]
 v_mfma_f32_16x16x32_bf16 v[232:235], a[128:131], a[104:107], v[232:235]
 v_mfma_f32_16x16x32_bf16 v[232:235], a[132:135], a[108:111], v[232:235]
 s_waitcnt lgkmcnt(4)
 v_mfma_f32_16x16x32_bf16 v[44:47], a[136:139], a[56:59], v[44:47]
 v_mfma_f32_16x16x32_bf16 v[44:47], a[140:143], a[60:63], v[44:47]
 ds_read_b64_tr_b16 a[120:121], v6 offset:32776
 v_mfma_f32_16x16x32_bf16 v[76:79], a[136:139], a[64:67], v[76:79]
 v_mfma_f32_16x16x32_bf16 v[76:79], a[140:143], a[68:71], v[76:79]
 ds_read_b64_tr_b16 a[122:123], v6 offset:34824
 v_mfma_f32_16x16x32_bf16 v[108:111], a[136:139], a[72:75], v[108:111]
 v_mfma_f32_16x16x32_bf16 v[108:111], a[140:143], a[76:79], v[108:111]
 ds_read_b64_tr_b16 a[124:125], v6 offset:49160
 v_mfma_f32_16x16x32_bf16 v[140:143], a[136:139], a[80:83], v[140:143]
 v_mfma_f32_16x16x32_bf16 v[140:143], a[140:143], a[84:87], v[140:143]
 ds_read_b64_tr_b16 a[126:127], v6 offset:51208
 v_mfma_f32_16x16x32_bf16 v[172:175], a[136:139], a[88:91], v[172:175]
 v_mfma_f32_16x16x32_bf16 v[172:175], a[140:143], a[92:95], v[172:175]
 v_mfma_f32_16x16x32_bf16 v[204:207], a[136:139], a[96:99], v[204:207]
 v_mfma_f32_16x16x32_bf16 v[204:207], a[140:143], a[100:103], v[204:207]
 v_mfma_f32_16x16x32_bf16 v[236:239], a[136:139], a[104:107], v[236:239]
 v_mfma_f32_16x16x32_bf16 v[236:239], a[140:143], a[108:111], v[236:239]
 s_waitcnt lgkmcnt(4)
 v_mfma_f32_16x16x32_bf16 v[48:51], a[112:115], a[56:59], v[48:51]
 v_mfma_f32_16x16x32_bf16 v[48:51], a[116:119], a[60:63], v[48:51]
 ds_read_b64_tr_b16 a[128:129], v7 offset:32768
 v_mfma_f32_16x16x32_bf16 v[80:83], a[112:115], a[64:67], v[80:83]
 v_mfma_f32_16x16x32_bf16 v[80:83], a[116:119], a[68:71], v[80:83]
 ds_read_b64_tr_b16 a[130:131], v7 offset:34816
 v_mfma_f32_16x16x32_bf16 v[112:115], a[112:115], a[72:75], v[112:115]
 v_mfma_f32_16x16x32_bf16 v[112:115], a[116:119], a[76:79], v[112:115]
 ds_read_b64_tr_b16 a[132:133], v7 offset:49152
 v_mfma_f32_16x16x32_bf16 v[144:147], a[112:115], a[80:83], v[144:147]
 v_mfma_f32_16x16x32_bf16 v[144:147], a[116:119], a[84:87], v[144:147]
 ds_read_b64_tr_b16 a[134:135], v7 offset:51200
 v_mfma_f32_16x16x32_bf16 v[176:179], a[112:115], a[88:91], v[176:179]
 v_mfma_f32_16x16x32_bf16 v[176:179], a[116:119], a[92:95], v[176:179]
 v_mfma_f32_16x16x32_bf16 v[208:211], a[112:115], a[96:99], v[208:211]
 v_mfma_f32_16x16x32_bf16 v[208:211], a[116:119], a[100:103], v[208:211]
 v_mfma_f32_16x16x32_bf16 v[240:243], a[112:115], a[104:107], v[240:243]
 v_mfma_f32_16x16x32_bf16 v[240:243], a[116:119], a[108:111], v[240:243]
 s_waitcnt lgkmcnt(4)
 v_mfma_f32_16x16x32_bf16 v[52:55], a[120:123], a[56:59], v[52:55]
 v_mfma_f32_16x16x32_bf16 v[52:55], a[124:127], a[60:63], v[52:55]
 ds_read_b64_tr_b16 a[136:137], v7 offset:32776
 v_mfma_f32_16x16x32_bf16 v[84:87], a[120:123], a[64:67], v[84:87]
 v_mfma_f32_16x16x32_bf16 v[84:87], a[124:127], a[68:71], v[84:87]
 ds_read_b64_tr_b16 a[138:139], v7 offset:34824
 v_mfma_f32_16x16x32_bf16 v[116:119], a[120:123], a[72:75], v[116:119]
 v_mfma_f32_16x16x32_bf16 v[116:119], a[124:127], a[76:79], v[116:119]
 ds_read_b64_tr_b16 a[140:141], v7 offset:49160
 v_mfma_f32_16x16x32_bf16 v[148:151], a[120:123], a[80:83], v[148:151]
 v_mfma_f32_16x16x32_bf16 v[148:151], a[124:127], a[84:87], v[148:151]
 ds_read_b64_tr_b16 a[142:143], v7 offset:51208
 v_mfma_f32_16x16x32_bf16 v[180:183], a[120:123], a[88:91], v[180:183]
 v_mfma_f32_16x16x32_bf16 v[180:183], a[124:127], a[92:95], v[180:183]
 v_mfma_f32_16x16x32_bf16 v[212:215], a[120:123], a[96:99], v[212:215]
 v_mfma_f32_16x16x32_bf16 v[212:215], a[124:127], a[100:103], v[212:215]
 v_mfma_f32_16x16x32_bf16 v[244:247], a[120:123], a[104:107], v[244:247]
 v_mfma_f32_16x16x32_bf16 v[244:247], a[124:127], a[108:111], v[244:247]
 s_waitcnt vmcnt(0) lgkmcnt(0)
 s_barrier
 v_mfma_f32_16x16x32_bf16 v[56:59], a[128:131], a[56:59], v[56:59]
 buffer_load_dwordx4 v8, s[4:7], s40 offen lds
 v_mfma_f32_16x16x32_bf16 v[56:59], a[132:135], a[60:63], v[56:59]
 s_add_u32 m0, s44, 73728
 ds_read_b64_tr_b16 a[112:113], v4 offset:0
 v_mfma_f32_16x16x32_bf16 v[88:91], a[128:131], a[64:67], v[88:91]
 s_add_u32 s40, s92, 40960
 ds_read_b64_tr_b16 a[114:115], v4 offset:2048
 v_mfma_f32_16x16x32_bf16 v[88:91], a[132:135], a[68:71], v[88:91]
 ds_read_b64_tr_b16 a[116:117], v4 offset:16384
 v_mfma_f32_16x16x32_bf16 v[120:123], a[128:131], a[72:75], v[120:123]
 ds_read_b64_tr_b16 a[118:119], v4 offset:18432
 v_mfma_f32_16x16x32_bf16 v[120:123], a[132:135], a[76:79], v[120:123]
 buffer_load_dwordx4 v8, s[4:7], s40 offen lds
 v_mfma_f32_16x16x32_bf16 v[152:155], a[128:131], a[80:83], v[152:155]
 s_add_u32 m0, s44, 77824
 ds_read_b128 a[0:3], v2 offset:0
 v_mfma_f32_16x16x32_bf16 v[152:155], a[132:135], a[84:87], v[152:155]
 s_add_u32 s40, s92, 81920
 ds_read_b128 a[4:7], v3 offset:0
 v_mfma_f32_16x16x32_bf16 v[184:187], a[128:131], a[88:91], v[184:187]
 ds_read_b128 a[8:11], v2 offset:2048
 v_mfma_f32_16x16x32_bf16 v[184:187], a[132:135], a[92:95], v[184:187]
 ds_read_b128 a[12:15], v3 offset:2048
 v_mfma_f32_16x16x32_bf16 v[216:219], a[128:131], a[96:99], v[216:219]
 buffer_load_dwordx4 v8, s[4:7], s40 offen lds
 v_mfma_f32_16x16x32_bf16 v[216:219], a[132:135], a[100:103], v[216:219]
 s_add_u32 m0, s44, 81920
 ds_read_b128 a[16:19], v2 offset:4096
 v_mfma_f32_16x16x32_bf16 v[248:251], a[128:131], a[104:107], v[248:251]
 s_add_u32 s40, s92, 122880
 ds_read_b128 a[20:23], v3 offset:4096
 v_mfma_f32_16x16x32_bf16 v[248:251], a[132:135], a[108:111], v[248:251]
 s_waitcnt lgkmcnt(10)
 ds_read_b128 a[24:27], v2 offset:6144
 v_mfma_f32_16x16x32_bf16 v[60:63], a[136:139], a[56:59], v[60:63]
 ds_read_b128 a[28:31], v3 offset:6144
 v_mfma_f32_16x16x32_bf16 v[60:63], a[140:143], a[60:63], v[60:63]
 buffer_load_dwordx4 v8, s[4:7], s40 offen lds
 v_mfma_f32_16x16x32_bf16 v[92:95], a[136:139], a[64:67], v[92:95]
 s_add_u32 m0, s44, 86016
 ds_read_b128 a[32:35], v2 offset:8192
 v_mfma_f32_16x16x32_bf16 v[92:95], a[140:143], a[68:71], v[92:95]
 s_add_u32 s40, s92, 163840
 ds_read_b128 a[36:39], v3 offset:8192
 v_mfma_f32_16x16x32_bf16 v[124:127], a[136:139], a[72:75], v[124:127]
 ds_read_b128 a[40:43], v2 offset:10240
 v_mfma_f32_16x16x32_bf16 v[124:127], a[140:143], a[76:79], v[124:127]
 ds_read_b128 a[44:47], v3 offset:10240
 v_mfma_f32_16x16x32_bf16 v[156:159], a[136:139], a[80:83], v[156:159]
 buffer_load_dwordx4 v8, s[4:7], s40 offen lds
 v_mfma_f32_16x16x32_bf16 v[156:159], a[140:143], a[84:87], v[156:159]
 s_add_u32 m0, s44, 90112
 ds_read_b128 a[48:51], v2 offset:12288
 v_mfma_f32_16x16x32_bf16 v[188:191], a[136:139], a[88:91], v[188:191]
 s_add_u32 s40, s92, 204800
 ds_read_b128 a[52:55], v3 offset:12288
 v_mfma_f32_16x16x32_bf16 v[188:191], a[140:143], a[92:95], v[188:191]
 ds_read_b64_tr_b16 a[120:121], v4 offset:8
 v_mfma_f32_16x16x32_bf16 v[220:223], a[136:139], a[96:99], v[220:223]
 ds_read_b64_tr_b16 a[122:123], v4 offset:2056
 v_mfma_f32_16x16x32_bf16 v[220:223], a[140:143], a[100:103], v[220:223]
 buffer_load_dwordx4 v8, s[4:7], s40 offen lds
 v_mfma_f32_16x16x32_bf16 v[252:255], a[136:139], a[104:107], v[252:255]
 s_add_u32 m0, s44, 94208
 ds_read_b64_tr_b16 a[124:125], v4 offset:16392
 v_mfma_f32_16x16x32_bf16 v[252:255], a[140:143], a[108:111], v[252:255]
 s_waitcnt lgkmcnt(15)
 ds_read_b64_tr_b16 a[126:127], v4 offset:18440
 v_mfma_f32_16x16x32_bf16 v[32:35], a[112:115], a[0:3], v[32:35]
 s_add_u32 s40, s92, 245760
 buffer_load_dwordx4 v8, s[4:7], s40 offen lds
 v_mfma_f32_16x16x32_bf16 v[32:35], a[116:119], a[4:7], v[32:35]
 s_waitcnt lgkmcnt(14)
 ds_read_b64_tr_b16 a[128:129], v5 offset:0
 v_mfma_f32_16x16x32_bf16 v[64:67], a[112:115], a[8:11], v[64:67]
 s_add_u32 m0, s44, 131072
 s_add_u32 s40, s93, 0
 buffer_load_dwordx4 v9, s[8:11], s40 offen lds
 v_mfma_f32_16x16x32_bf16 v[64:67], a[116:119], a[12:15], v[64:67]
 s_waitcnt lgkmcnt(13)
 ds_read_b64_tr_b16 a[130:131], v5 offset:2048
 v_mfma_f32_16x16x32_bf16 v[96:99], a[112:115], a[16:19], v[96:99]
 s_add_u32 m0, s44, 135168
 s_add_u32 s40, s93, 65536
 buffer_load_dwordx4 v9, s[8:11], s40 offen lds
 v_mfma_f32_16x16x32_bf16 v[96:99], a[116:119], a[20:23], v[96:99]
 s_waitcnt lgkmcnt(12)
 ds_read_b64_tr_b16 a[132:133], v5 offset:16384
 v_mfma_f32_16x16x32_bf16 v[128:131], a[112:115], a[24:27], v[128:131]
 s_add_u32 m0, s44, 139264
 s_add_u32 s40, s93, 131072
 buffer_load_dwordx4 v9, s[8:11], s40 offen lds
 v_mfma_f32_16x16x32_bf16 v[128:131], a[116:119], a[28:31], v[128:131]
 s_waitcnt lgkmcnt(11)
 ds_read_b64_tr_b16 a[134:135], v5 offset:18432
 v_mfma_f32_16x16x32_bf16 v[160:163], a[112:115], a[32:35], v[160:163]
 s_add_u32 m0, s44, 143360
 s_add_u32 s40, s93, 196608
 buffer_load_dwordx4 v9, s[8:11], s40 offen lds
 v_mfma_f32_16x16x32_bf16 v[160:163], a[116:119], a[36:39], v[160:163]
 s_waitcnt lgkmcnt(10)
 s_add_u32 m0, s44, 147456
 s_add_u32 s40, s93, 262144
 buffer_load_dwordx4 v9, s[8:11], s40 offen lds
 v_mfma_f32_16x16x32_bf16 v[192:195], a[112:115], a[40:43], v[192:195]
 s_add_u32 m0, s44, 151552
 s_add_u32 s40, s93, 327680
 buffer_load_dwordx4 v9, s[8:11], s40 offen lds
 v_mfma_f32_16x16x32_bf16 v[192:195], a[116:119], a[44:47], v[192:195]
 s_waitcnt lgkmcnt(8)
 s_add_u32 m0, s44, 155648
 s_add_u32 s40, s93, 393216
 buffer_load_dwordx4 v9, s[8:11], s40 offen lds
 v_mfma_f32_16x16x32_bf16 v[224:227], a[112:115], a[48:51], v[224:227]
 s_add_u32 m0, s44, 159744
 s_add_u32 s40, s93, 458752
 buffer_load_dwordx4 v9, s[8:11], s40 offen lds
 v_mfma_f32_16x16x32_bf16 v[224:227], a[116:119], a[52:55], v[224:227]
 s_waitcnt lgkmcnt(4)
 v_mfma_f32_16x16x32_bf16 v[36:39], a[120:123], a[0:3], v[36:39]
 s_add_u32 s94, s94, 1
 v_mfma_f32_16x16x32_bf16 v[36:39], a[124:127], a[4:7], v[36:39]
 s_cmp_eq_u32 s94, 10
 s_cselect_b32 s94, 0, s94
 ds_read_b64_tr_b16 a[136:137], v5 offset:8
 v_mfma_f32_16x16x32_bf16 v[68:71], a[120:123], a[8:11], v[68:71]
 s_lshl_b32 s92, s94, 7
 s_lshl_b32 s93, s94, 19
 s_add_u32 m0, s44, 0
 s_add_u32 s40, s44, 0
 buffer_load_dwordx4 v0, s[20:23], s40 offen nt lds
 v_mfma_f32_16x16x32_bf16 v[68:71], a[124:127], a[12:15], v[68:71]
 s_add_u32 m0, s44, 4096
 ds_read_b64_tr_b16 a[138:139], v5 offset:2056
 v_mfma_f32_16x16x32_bf16 v[100:103], a[120:123], a[16:19], v[100:103]
 s_add_u32 s40, s44, 4096
 v_mfma_f32_16x16x32_bf16 v[100:103], a[124:127], a[20:23], v[100:103]
 ds_read_b64_tr_b16 a[140:141], v5 offset:16392
 v_mfma_f32_16x16x32_bf16 v[132:135], a[120:123], a[24:27], v[132:135]
 v_mfma_f32_16x16x32_bf16 v[132:135], a[124:127], a[28:31], v[132:135]
 ds_read_b64_tr_b16 a[142:143], v5 offset:18440
 v_mfma_f32_16x16x32_bf16 v[164:167], a[120:123], a[32:35], v[164:167]
 v_mfma_f32_16x16x32_bf16 v[164:167], a[124:127], a[36:39], v[164:167]
 v_mfma_f32_16x16x32_bf16 v[196:199], a[120:123], a[40:43], v[196:199]
 v_mfma_f32_16x16x32_bf16 v[196:199], a[124:127], a[44:47], v[196:199]
 v_mfma_f32_16x16x32_bf16 v[228:231], a[120:123], a[48:51], v[228:231]
 buffer_load_dwordx4 v0, s[20:23], s40 offen nt lds
 v_mfma_f32_16x16x32_bf16 v[228:231], a[124:127], a[52:55], v[228:231]
 s_waitcnt lgkmcnt(4)
 v_mfma_f32_16x16x32_bf16 v[40:43], a[128:131], a[0:3], v[40:43]
 s_add_u32 m0, s44, 8192
 v_mfma_f32_16x16x32_bf16 v[40:43], a[132:135], a[4:7], v[40:43]
 s_add_u32 s40, s44, 8192
 ds_read_b64_tr_b16 a[112:113], v6 offset:0
 v_mfma_f32_16x16x32_bf16 v[72:75], a[128:131], a[8:11], v[72:75]
 v_mfma_f32_16x16x32_bf16 v[72:75], a[132:135], a[12:15], v[72:75]
 ds_read_b64_tr_b16 a[114:115], v6 offset:2048
 v_mfma_f32_16x16x32_bf16 v[104:107], a[128:131], a[16:19], v[104:107]
 v_mfma_f32_16x16x32_bf16 v[104:107], a[132:135], a[20:23], v[104:107]
 ds_read_b64_tr_b16 a[116:117], v6 offset:16384
 v_mfma_f32_16x16x32_bf16 v[136:139], a[128:131], a[24:27], v[136:139]
 v_mfma_f32_16x16x32_bf16 v[136:139], a[132:135], a[28:31], v[136:139]
 ds_read_b64_tr_b16 a[118:119], v6 offset:18432
 v_mfma_f32_16x16x32_bf16 v[168:171], a[128:131], a[32:35], v[168:171]
 v_mfma_f32_16x16x32_bf16 v[168:171], a[132:135], a[36:39], v[168:171]
 buffer_load_dwordx4 v0, s[20:23], s40 offen nt lds
 v_mfma_f32_16x16x32_bf16 v[200:203], a[128:131], a[40:43], v[200:203]
 s_add_u32 m0, s44, 12288
 v_mfma_f32_16x16x32_bf16 v[200:203], a[132:135], a[44:47], v[200:203]
 s_add_u32 s40, s44, 12288
 v_mfma_f32_16x16x32_bf16 v[232:235], a[128:131], a[48:51], v[232:235]
 v_mfma_f32_16x16x32_bf16 v[232:235], a[132:135], a[52:55], v[232:235]
 s_waitcnt lgkmcnt(4)
 v_mfma_f32_16x16x32_bf16 v[44:47], a[136:139], a[0:3], v[44:47]
 v_mfma_f32_16x16x32_bf16 v[44:47], a[140:143], a[4:7], v[44:47]
 ds_read_b64_tr_b16 a[120:121], v6 offset:8
 v_mfma_f32_16x16x32_bf16 v[76:79], a[136:139], a[8:11], v[76:79]
 v_mfma_f32_16x16x32_bf16 v[76:79], a[140:143], a[12:15], v[76:79]
 ds_read_b64_tr_b16 a[122:123], v6 offset:2056
 v_mfma_f32_16x16x32_bf16 v[108:111], a[136:139], a[16:19], v[108:111]
 v_mfma_f32_16x16x32_bf16 v[108:111], a[140:143], a[20:23], v[108:111]
 ds_read_b64_tr_b16 a[124:125], v6 offset:16392
 v_mfma_f32_16x16x32_bf16 v[140:143], a[136:139], a[24:27], v[140:143]
 buffer_load_dwordx4 v0, s[20:23], s40 offen nt lds
 v_mfma_f32_16x16x32_bf16 v[140:143], a[140:143], a[28:31], v[140:143]
 s_add_u32 m0, s44, 16384
 ds_read_b64_tr_b16 a[126:127], v6 offset:18440
 v_mfma_f32_16x16x32_bf16 v[172:175], a[136:139], a[32:35], v[172:175]
 s_add_u32 s40, s44, 16384
 v_mfma_f32_16x16x32_bf16 v[172:175], a[140:143], a[36:39], v[172:175]
 v_mfma_f32_16x16x32_bf16 v[204:207], a[136:139], a[40:43], v[204:207]
 v_mfma_f32_16x16x32_bf16 v[204:207], a[140:143], a[44:47], v[204:207]
 v_mfma_f32_16x16x32_bf16 v[236:239], a[136:139], a[48:51], v[236:239]
 v_mfma_f32_16x16x32_bf16 v[236:239], a[140:143], a[52:55], v[236:239]
 s_waitcnt lgkmcnt(4)
 v_mfma_f32_16x16x32_bf16 v[48:51], a[112:115], a[0:3], v[48:51]
 v_mfma_f32_16x16x32_bf16 v[48:51], a[116:119], a[4:7], v[48:51]
 ds_read_b64_tr_b16 a[128:129], v7 offset:0
 v_mfma_f32_16x16x32_bf16 v[80:83], a[112:115], a[8:11], v[80:83]
 v_mfma_f32_16x16x32_bf16 v[80:83], a[116:119], a[12:15], v[80:83]
 ds_read_b64_tr_b16 a[130:131], v7 offset:2048
 v_mfma_f32_16x16x32_bf16 v[112:115], a[112:115], a[16:19], v[112:115]
 buffer_load_dwordx4 v0, s[20:23], s40 offen nt lds
 v_mfma_f32_16x16x32_bf16 v[112:115], a[116:119], a[20:23], v[112:115]
 s_add_u32 m0, s44, 40960
 ds_read_b64_tr_b16 a[132:133], v7 offset:16384
 v_mfma_f32_16x16x32_bf16 v[144:147], a[112:115], a[24:27], v[144:147]
 s_add_u32 s40, s92, 0
 v_mfma_f32_16x16x32_bf16 v[144:147], a[116:119], a[28:31], v[144:147]
 ds_read_b64_tr_b16 a[134:135], v7 offset:18432
 v_mfma_f32_16x16x32_bf16 v[176:179], a[112:115], a[32:35], v[176:179]
 v_mfma_f32_16x16x32_bf16 v[176:179], a[116:119], a[36:39], v[176:179]
 v_mfma_f32_16x16x32_bf16 v[208:211], a[112:115], a[40:43], v[208:211]
 v_mfma_f32_16x16x32_bf16 v[208:211], a[116:119], a[44:47], v[208:211]
 v_mfma_f32_16x16x32_bf16 v[240:243], a[112:115], a[48:51], v[240:243]
 v_mfma_f32_16x16x32_bf16 v[240:243], a[116:119], a[52:55], v[240:243]
 s_waitcnt lgkmcnt(4)
 v_mfma_f32_16x16x32_bf16 v[52:55], a[120:123], a[0:3], v[52:55]
 v_mfma_f32_16x16x32_bf16 v[52:55], a[124:127], a[4:7], v[52:55]
 ds_read_b64_tr_b16 a[136:137], v7 offset:8
 v_mfma_f32_16x16x32_bf16 v[84:87], a[120:123], a[8:11], v[84:87]
 v_mfma_f32_16x16x32_bf16 v[84:87], a[124:127], a[12:15], v[84:87]
 ds_read_b64_tr_b16 a[138:139], v7 offset:2056
 v_mfma_f32_16x16x32_bf16 v[116:119], a[120:123], a[16:19], v[116:119]
 v_mfma_f32_16x16x32_bf16 v[116:119], a[124:127], a[20:23], v[116:119]
 ds_read_b64_tr_b16 a[140:141], v7 offset:16392
 v_mfma_f32_16x16x32_bf16 v[148:151], a[120:123], a[24:27], v[148:151]
 v_mfma_f32_16x16x32_bf16 v[148:151], a[124:127], a[28:31], v[148:151]
 ds_read_b64_tr_b16 a[142:143], v7 offset:18440
 v_mfma_f32_16x16x32_bf16 v[180:183], a[120:123], a[32:35], v[180:183]
 v_mfma_f32_16x16x32_bf16 v[180:183], a[124:127], a[36:39], v[180:183]
 v_mfma_f32_16x16x32_bf16 v[212:215], a[120:123], a[40:43], v[212:215]
 v_mfma_f32_16x16x32_bf16 v[212:215], a[124:127], a[44:47], v[212:215]
 v_mfma_f32_16x16x32_bf16 v[244:247], a[120:123], a[48:51], v[244:247]
 v_mfma_f32_16x16x32_bf16 v[244:247], a[124:127], a[52:55], v[244:247]
 s_waitcnt vmcnt(5) lgkmcnt(0)
 s_barrier
 v_mfma_f32_16x16x32_bf16 v[56:59], a[128:131], a[0:3], v[56:59]
 buffer_load_dwordx4 v8, s[4:7], s40 offen lds
 v_mfma_f32_16x16x32_bf16 v[56:59], a[132:135], a[4:7], v[56:59]
 s_add_u32 m0, s44, 45056
 ds_read_b64_tr_b16 a[112:113], v4 offset:32768
 v_mfma_f32_16x16x32_bf16 v[88:91], a[128:131], a[8:11], v[88:91]
 s_add_u32 s40, s92, 40960
 ds_read_b64_tr_b16 a[114:115], v4 offset:34816
 v_mfma_f32_16x16x32_bf16 v[88:91], a[132:135], a[12:15], v[88:91]
 ds_read_b64_tr_b16 a[116:117], v4 offset:49152
 v_mfma_f32_16x16x32_bf16 v[120:123], a[128:131], a[16:19], v[120:123]
 ds_read_b64_tr_b16 a[118:119], v4 offset:51200
 v_mfma_f32_16x16x32_bf16 v[120:123], a[132:135], a[20:23], v[120:123]
 buffer_load_dwordx4 v8, s[4:7], s40 offen lds
 v_mfma_f32_16x16x32_bf16 v[152:155], a[128:131], a[24:27], v[152:155]
 s_add_u32 m0, s44, 49152
 ds_read_b128 a[56:59], v2 offset:28672
 v_mfma_f32_16x16x32_bf16 v[152:155], a[132:135], a[28:31], v[152:155]
 s_add_u32 s40, s92, 81920
 ds_read_b128 a[60:63], v3 offset:28672
 v_mfma_f32_16x16x32_bf16 v[184:187], a[128:131], a[32:35], v[184:187]
 ds_read_b128 a[64:67], v2 offset:30720
 v_mfma_f32_16x16x32_bf16 v[184:187], a[132:135], a[36:39], v[184:187]
 ds_read_b128 a[68:71], v3 offset:30720
 v_mfma_f32_16x16x32_bf16 v[216:219], a[128:131], a[40:43], v[216:219]
 buffer_load_dwordx4 v8, s[4:7], s40 offen lds
 v_mfma_f32_16x16x32_bf16 v[216:219], a[132:135], a[44:47], v[216:219]
 s_add_u32 m0, s44, 53248
 ds_read_b128 a[72:75], v2 offset:32768
 v_mfma_f32_16x16x32_bf16 v[248:251], a[128:131], a[48:51], v[248:251]
 s_add_u32 s40, s92, 122880
 ds_read_b128 a[76:79], v3 offset:32768
 v_mfma_f32_16x16x32_bf16 v[248:251], a[132:135], a[52:55], v[248:251]
 s_waitcnt lgkmcnt(10)
 ds_read_b128 a[80:83], v2 offset:34816
 v_mfma_f32_16x16x32_bf16 v[60:63], a[136:139], a[0:3], v[60:63]
 ds_read_b128 a[84:87], v3 offset:34816
 v_mfma_f32_16x16x32_bf16 v[60:63], a[140:143], a[4:7], v[60:63]
 buffer_load_dwordx4 v8, s[4:7], s40 offen lds
 v_mfma_f32_16x16x32_bf16 v[92:95], a[136:139], a[8:11], v[92:95]
 s_add_u32 m0, s44, 57344
 ds_read_b128 a[88:91], v2 offset:36864
 v_mfma_f32_16x16x32_bf16 v[92:95], a[140:143], a[12:15], v[92:95]
 s_add_u32 s40, s92, 163840
 ds_read_b128 a[92:95], v3 offset:36864
 v_mfma_f32_16x16x32_bf16 v[124:127], a[136:139], a[16:19], v[124:127]
 ds_read_b128 a[96:99], v2 offset:38912
 v_mfma_f32_16x16x32_bf16 v[124:127], a[140:143], a[20:23], v[124:127]
 ds_read_b128 a[100:103], v3 offset:38912
 v_mfma_f32_16x16x32_bf16 v[156:159], a[136:139], a[24:27], v[156:159]
 buffer_load_dwordx4 v8, s[4:7], s40 offen lds
 v_mfma_f32_16x16x32_bf16 v[156:159], a[140:143], a[28:31], v[156:159]
 s_add_u32 m0, s44, 61440
 ds_read_b128 a[104:107], v2 offset:40960
 v_mfma_f32_16x16x32_bf16 v[188:191], a[136:139], a[32:35], v[188:191]
 s_add_u32 s40, s92, 204800
 ds_read_b128 a[108:111], v3 offset:40960
 v_mfma_f32_16x16x32_bf16 v[188:191], a[140:143], a[36:39], v[188:191]
 ds_read_b64_tr_b16 a[120:121], v4 offset:32776
 v_mfma_f32_16x16x32_bf16 v[220:223], a[136:139], a[40:43], v[220:223]
 ds_read_b64_tr_b16 a[122:123], v4 offset:34824
 v_mfma_f32_16x16x32_bf16 v[220:223], a[140:143], a[44:47], v[220:223]
 buffer_load_dwordx4 v8, s[4:7], s40 offen lds
 v_mfma_f32_16x16x32_bf16 v[252:255], a[136:139], a[48:51], v[252:255]
 s_add_u32 m0, s44, 65536
 ds_read_b64_tr_b16 a[124:125], v4 offset:49160
 v_mfma_f32_16x16x32_bf16 v[252:255], a[140:143], a[52:55], v[252:255]
 s_branch SK1270
C1_1:
PG1270:
 s_branch PG3489
SK1270:
 s_waitcnt lgkmcnt(15)
 ds_read_b64_tr_b16 a[126:127], v4 offset:51208
 v_mfma_f32_16x16x32_bf16 v[32:35], a[112:115], a[56:59], v[32:35]
 s_add_u32 s40, s92, 245760
 buffer_load_dwordx4 v8, s[4:7], s40 offen lds
 v_mfma_f32_16x16x32_bf16 v[32:35], a[116:119], a[60:63], v[32:35]
 s_waitcnt lgkmcnt(14)
 ds_read_b64_tr_b16 a[128:129], v5 offset:32768
 v_mfma_f32_16x16x32_bf16 v[64:67], a[112:115], a[64:67], v[64:67]
 s_add_u32 m0, s44, 98304
 s_add_u32 s40, s93, 0
 buffer_load_dwordx4 v9, s[8:11], s40 offen lds
 v_mfma_f32_16x16x32_bf16 v[64:67], a[116:119], a[68:71], v[64:67]
 s_waitcnt lgkmcnt(13)
 ds_read_b64_tr_b16 a[130:131], v5 offset:34816
 v_mfma_f32_16x16x32_bf16 v[96:99], a[112:115], a[72:75], v[96:99]
 s_add_u32 m0, s44, 102400
 s_add_u32 s40, s93, 65536
 buffer_load_dwordx4 v9, s[8:11], s40 offen lds
 v_mfma_f32_16x16x32_bf16 v[96:99], a[116:119], a[76:79], v[96:99]
 s_waitcnt lgkmcnt(12)
 ds_read_b64_tr_b16 a[132:133], v5 offset:49152
 v_mfma_f32_16x16x32_bf16 v[128:131], a[112:115], a[80:83], v[128:131]
 s_add_u32 m0, s44, 106496
 s_add_u32 s40, s93, 131072
 buffer_load_dwordx4 v9, s[8:11], s40 offen lds
 v_mfma_f32_16x16x32_bf16 v[128:131], a[116:119], a[84:87], v[128:131]
 s_waitcnt lgkmcnt(11)
 ds_read_b64_tr_b16 a[134:135], v5 offset:51200
 v_mfma_f32_16x16x32_bf16 v[160:163], a[112:115], a[88:91], v[160:163]
 s_add_u32 m0, s44, 110592
 s_add_u32 s40, s93, 196608
 buffer_load_dwordx4 v9, s[8:11], s40 offen lds
 v_mfma_f32_16x16x32_bf16 v[160:163], a[116:119], a[92:95], v[160:163]
 s_waitcnt lgkmcnt(10)
 s_add_u32 m0, s44, 114688
 s_add_u32 s40, s93, 262144
 buffer_load_dwordx4 v9, s[8:11], s40 offen lds
 v_mfma_f32_16x16x32_bf16 v[192:195], a[112:115], a[96:99], v[192:195]
 s_add_u32 m0, s44, 118784
 s_add_u32 s40, s93, 327680
 buffer_load_dwordx4 v9, s[8:11], s40 offen lds
 v_mfma_f32_16x16x32_bf16 v[192:195], a[116:119], a[100:103], v[192:195]
 s_waitcnt lgkmcnt(8)
 s_add_u32 m0, s44, 122880
 s_add_u32 s40, s93, 393216
 buffer_load_dwordx4 v9, s[8:11], s40 offen lds
 v_mfma_f32_16x16x32_bf16 v[224:227], a[112:115], a[104:107], v[224:227]
 s_add_u32 m0, s44, 126976
 s_add_u32 s40, s93, 458752
 buffer_load_dwordx4 v9, s[8:11], s40 offen lds
 v_mfma_f32_16x16x32_bf16 v[224:227], a[116:119], a[108:111], v[224:227]
 s_waitcnt lgkmcnt(4)
 v_mfma_f32_16x16x32_bf16 v[36:39], a[120:123], a[56:59], v[36:39]
 s_add_u32 s94, s94, 1
 v_mfma_f32_16x16x32_bf16 v[36:39], a[124:127], a[60:63], v[36:39]
 s_cmp_eq_u32 s94, 10
 s_cselect_b32 s94, 0, s94
 ds_read_b64_tr_b16 a[136:137], v5 offset:32776
 v_mfma_f32_16x16x32_bf16 v[68:71], a[120:123], a[64:67], v[68:71]
 s_lshl_b32 s92, s94, 7
 s_lshl_b32 s93, s94, 19
 s_add_u32 m0, s44, 20480
 s_add_u32 s40, s44, 20480
 buffer_load_dwordx4 v0, s[20:23], s40 offen nt lds
 v_mfma_f32_16x16x32_bf16 v[68:71], a[124:127], a[68:71], v[68:71]
 s_add_u32 m0, s44, 24576
 ds_read_b64_tr_b16 a[138:139], v5 offset:34824
 v_mfma_f32_16x16x32_bf16 v[100:103], a[120:123], a[72:75], v[100:103]
 s_add_u32 s40, s44, 24576
 v_mfma_f32_16x16x32_bf16 v[100:103], a[124:127], a[76:79], v[100:103]
 ds_read_b64_tr_b16 a[140:141], v5 offset:49160
 v_mfma_f32_16x16x32_bf16 v[132:135], a[120:123], a[80:83], v[132:135]
 v_mfma_f32_16x16x32_bf16 v[132:135], a[124:127], a[84:87], v[132:135]
 ds_read_b64_tr_b16 a[142:143], v5 offset:51208
 v_mfma_f32_16x16x32_bf16 v[164:167], a[120:123], a[88:91], v[164:167]
 v_mfma_f32_16x16x32_bf16 v[164:167], a[124:127], a[92:95], v[164:167]
 v_mfma_f32_16x16x32_bf16 v[196:199], a[120:123], a[96:99], v[196:199]
 v_mfma_f32_16x16x32_bf16 v[196:199], a[124:127], a[100:103], v[196:199]
 v_mfma_f32_16x16x32_bf16 v[228:231], a[120:123], a[104:107], v[228:231]
 buffer_load_dwordx4 v0, s[20:23], s40 offen nt lds
 v_mfma_f32_16x16x32_bf16 v[228:231], a[124:127], a[108:111], v[228:231]
 s_waitcnt lgkmcnt(4)
 v_mfma_f32_16x16x32_bf16 v[40:43], a[128:131], a[56:59], v[40:43]
 s_add_u32 m0, s44, 28672
 v_mfma_f32_16x16x32_bf16 v[40:43], a[132:135], a[60:63], v[40:43]
 s_add_u32 s40, s44, 28672
 ds_read_b64_tr_b16 a[112:113], v6 offset:32768
 v_mfma_f32_16x16x32_bf16 v[72:75], a[128:131], a[64:67], v[72:75]
 v_mfma_f32_16x16x32_bf16 v[72:75], a[132:135], a[68:71], v[72:75]
 ds_read_b64_tr_b16 a[114:115], v6 offset:34816
 v_mfma_f32_16x16x32_bf16 v[104:107], a[128:131], a[72:75], v[104:107]
 v_mfma_f32_16x16x32_bf16 v[104:107], a[132:135], a[76:79], v[104:107]
 ds_read_b64_tr_b16 a[116:117], v6 offset:49152
 v_mfma_f32_16x16x32_bf16 v[136:139], a[128:131], a[80:83], v[136:139]
 v_mfma_f32_16x16x32_bf16 v[136:139], a[132:135], a[84:87], v[136:139]
 ds_read_b64_tr_b16 a[118:119], v6 offset:51200
 v_mfma_f32_16x16x32_bf16 v[168:171], a[128:131], a[88:91], v[168:171]
 v_mfma_f32_16x16x32_bf16 v[168:171], a[132:135], a[92:95], v[168:171]
 buffer_load_dwordx4 v0, s[20:23], s40 offen nt lds
 v_mfma_f32_16x16x32_bf16 v[200:203], a[128:131], a[96:99], v[200:203]
 s_add_u32 m0, s44, 32768
 v_mfma_f32_16x16x32_bf16 v[200:203], a[132:135], a[100:103], v[200:203]
 s_add_u32 s40, s44, 32768
 v_mfma_f32_16x16x32_bf16 v[232:235], a[128:131], a[104:107], v[232:235]
 v_mfma_f32_16x16x32_bf16 v[232:235], a[132:135], a[108:111], v[232:235]
 s_waitcnt lgkmcnt(4)
 v_mfma_f32_16x16x32_bf16 v[44:47], a[136:139], a[56:59], v[44:47]
 v_mfma_f32_16x16x32_bf16 v[44:47], a[140:143], a[60:63], v[44:47]
 ds_read_b64_tr_b16 a[120:121], v6 offset:32776
 v_mfma_f32_16x16x32_bf16 v[76:79], a[136:139], a[64:67], v[76:79]
 v_mfma_f32_16x16x32_bf16 v[76:79], a[140:143], a[68:71], v[76:79]
 ds_read_b64_tr_b16 a[122:123], v6 offset:34824
 v_mfma_f32_16x16x32_bf16 v[108:111], a[136:139], a[72:75], v[108:111]
 v_mfma_f32_16x16x32_bf16 v[108:111], a[140:143], a[76:79], v[108:111]
 ds_read_b64_tr_b16 a[124:125], v6 offset:49160
 v_mfma_f32_16x16x32_bf16 v[140:143], a[136:139], a[80:83], v[140:143]
 buffer_load_dwordx4 v0, s[20:23], s40 offen nt lds
 v_mfma_f32_16x16x32_bf16 v[140:143], a[140:143], a[84:87], v[140:143]
 s_add_u32 m0, s44, 36864
 ds_read_b64_tr_b16 a[126:127], v6 offset:51208
 v_mfma_f32_16x16x32_bf16 v[172:175], a[136:139], a[88:91], v[172:175]
 s_add_u32 s40, s44, 36864
 v_mfma_f32_16x16x32_bf16 v[172:175], a[140:143], a[92:95], v[172:175]
 v_mfma_f32_16x16x32_bf16 v[204:207], a[136:139], a[96:99], v[204:207]
 v_mfma_f32_16x16x32_bf16 v[204:207], a[140:143], a[100:103], v[204:207]
 v_mfma_f32_16x16x32_bf16 v[236:239], a[136:139], a[104:107], v[236:239]
 v_mfma_f32_16x16x32_bf16 v[236:239], a[140:143], a[108:111], v[236:239]
 s_waitcnt lgkmcnt(4)
 v_mfma_f32_16x16x32_bf16 v[48:51], a[112:115], a[56:59], v[48:51]
 v_mfma_f32_16x16x32_bf16 v[48:51], a[116:119], a[60:63], v[48:51]
 ds_read_b64_tr_b16 a[128:129], v7 offset:32768
 v_mfma_f32_16x16x32_bf16 v[80:83], a[112:115], a[64:67], v[80:83]
 v_mfma_f32_16x16x32_bf16 v[80:83], a[116:119], a[68:71], v[80:83]
 ds_read_b64_tr_b16 a[130:131], v7 offset:34816
 v_mfma_f32_16x16x32_bf16 v[112:115], a[112:115], a[72:75], v[112:115]
 buffer_load_dwordx4 v0, s[20:23], s40 offen nt lds
 v_mfma_f32_16x16x32_bf16 v[112:115], a[116:119], a[76:79], v[112:115]
 s_add_u32 m0, s44, 69632
 ds_read_b64_tr_b16 a[132:133], v7 offset:49152
 v_mfma_f32_16x16x32_bf16 v[144:147], a[112:115], a[80:83], v[144:147]
 s_add_u32 s40, s92, 0
 v_mfma_f32_16x16x32_bf16 v[144:147], a[116:119], a[84:87], v[144:147]
 ds_read_b64_tr_b16 a[134:135], v7 offset:51200
 v_mfma_f32_16x16x32_bf16 v[176:179], a[112:115], a[88:91], v[176:179]
 v_mfma_f32_16x16x32_bf16 v[176:179], a[116:119], a[92:95], v[176:179]
 v_mfma_f32_16x16x32_bf16 v[208:211], a[112:115], a[96:99], v[208:211]
 v_mfma_f32_16x16x32_bf16 v[208:211], a[116:119], a[100:103], v[208:211]
 v_mfma_f32_16x16x32_bf16 v[240:243], a[112:115], a[104:107], v[240:243]
 v_mfma_f32_16x16x32_bf16 v[240:243], a[116:119], a[108:111], v[240:243]
 s_waitcnt lgkmcnt(4)
 v_mfma_f32_16x16x32_bf16 v[52:55], a[120:123], a[56:59], v[52:55]
 v_mfma_f32_16x16x32_bf16 v[52:55], a[124:127], a[60:63], v[52:55]
 ds_read_b64_tr_b16 a[136:137], v7 offset:32776
 v_mfma_f32_16x16x32_bf16 v[84:87], a[120:123], a[64:67], v[84:87]
 v_mfma_f32_16x16x32_bf16 v[84:87], a[124:127], a[68:71], v[84:87]
 ds_read_b64_tr_b16 a[138:139], v7 offset:34824
 v_mfma_f32_16x16x32_bf16 v[116:119], a[120:123], a[72:75], v[116:119]
 v_mfma_f32_16x16x32_bf16 v[116:119], a[124:127], a[76:79], v[116:119]
 ds_read_b64_tr_b16 a[140:141], v7 offset:49160
 v_mfma_f32_16x16x32_bf16 v[148:151], a[120:123], a[80:83], v[148:151]
 v_mfma_f32_16x16x32_bf16 v[148:151], a[124:127], a[84:87], v[148:151]
 ds_read_b64_tr_b16 a[142:143], v7 offset:51208
 v_mfma_f32_16x16x32_bf16 v[180:183], a[120:123], a[88:91], v[180:183]
 v_mfma_f32_16x16x32_bf16 v[180:183], a[124:127], a[92:95], v[180:183]
 v_mfma_f32_16x16x32_bf16 v[212:215], a[120:123], a[96:99], v[212:215]
 v_mfma_f32_16x16x32_bf16 v[212:215], a[124:127], a[100:103], v[212:215]
 v_mfma_f32_16x16x32_bf16 v[244:247], a[120:123], a[104:107], v[244:247]
 v_mfma_f32_16x16x32_bf16 v[244:247], a[124:127], a[108:111], v[244:247]
 s_waitcnt vmcnt(5) lgkmcnt(0)
 s_barrier
 v_mfma_f32_16x16x32_bf16 v[56:59], a[128:131], a[56:59], v[56:59]
 buffer_load_dwordx4 v8, s[4:7], s40 offen lds
 v_mfma_f32_16x16x32_bf16 v[56:59], a[132:135], a[60:63], v[56:59]
 s_add_u32 m0, s44, 73728
 ds_read_b64_tr_b16 a[112:113], v4 offset:0
 v_mfma_f32_16x16x32_bf16 v[88:91], a[128:131], a[64:67], v[88:91]
 s_add_u32 s40, s92, 40960
 ds_read_b64_tr_b16 a[114:115], v4 offset:2048
 v_mfma_f32_16x16x32_bf16 v[88:91], a[132:135], a[68:71], v[88:91]
 ds_read_b64_tr_b16 a[116:117], v4 offset:16384
 v_mfma_f32_16x16x32_bf16 v[120:123], a[128:131], a[72:75], v[120:123]
 ds_read_b64_tr_b16 a[118:119], v4 offset:18432
 v_mfma_f32_16x16x32_bf16 v[120:123], a[132:135], a[76:79], v[120:123]
 buffer_load_dwordx4 v8, s[4:7], s40 offen lds
 v_mfma_f32_16x16x32_bf16 v[152:155], a[128:131], a[80:83], v[152:155]
 s_add_u32 m0, s44, 77824
 ds_read_b128 a[0:3], v2 offset:0
 v_mfma_f32_16x16x32_bf16 v[152:155], a[132:135], a[84:87], v[152:155]
 s_add_u32 s40, s92, 81920
 ds_read_b128 a[4:7], v3 offset:0
 v_mfma_f32_16x16x32_bf16 v[184:187], a[128:131], a[88:91], v[184:187]
 ds_read_b128 a[8:11], v2 offset:2048
 v_mfma_f32_16x16x32_bf16 v[184:187], a[132:135], a[92:95], v[184:187]
 ds_read_b128 a[12:15], v3 offset:2048
 v_mfma_f32_16x16x32_bf16 v[216:219], a[128:131], a[96:99], v[216:219]
 buffer_load_dwordx4 v8, s[4:7], s40 offen lds
 v_mfma_f32_16x16x32_bf16 v[216:219], a[132:135], a[100:103], v[216:219]
 s_add_u32 m0, s44, 81920
 ds_read_b128 a[16:19], v2 offset:4096
 v_mfma_f32_16x16x32_bf16 v[248:251], a[128:131], a[104:107], v[248:251]
 s_add_u32 s40, s92, 122880
 ds_read_b128 a[20:23], v3 offset:4096
 v_mfma_f32_16x16x32_bf16 v[248:251], a[132:135], a[108:111], v[248:251]
 s_waitcnt lgkmcnt(10)
 ds_read_b128 a[24:27], v2 offset:6144
 v_mfma_f32_16x16x32_bf16 v[60:63], a[136:139], a[56:59], v[60:63]
 ds_read_b128 a[28:31], v3 offset:6144
 v_mfma_f32_16x16x32_bf16 v[60:63], a[140:143], a[60:63], v[60:63]
 buffer_load_dwordx4 v8, s[4:7], s40 offen lds
 v_mfma_f32_16x16x32_bf16 v[92:95], a[136:139], a[64:67], v[92:95]
 s_add_u32 m0, s44, 86016
 ds_read_b128 a[32:35], v2 offset:8192
 v_mfma_f32_16x16x32_bf16 v[92:95], a[140:143], a[68:71], v[92:95]
 s_add_u32 s40, s92, 163840
 ds_read_b128 a[36:39], v3 offset:8192
 v_mfma_f32_16x16x32_bf16 v[124:127], a[136:139], a[72:75], v[124:127]
 ds_read_b128 a[40:43], v2 offset:10240
 v_mfma_f32_16x16x32_bf16 v[124:127], a[140:143], a[76:79], v[124:127]
 ds_read_b128 a[44:47], v3 offset:10240
 v_mfma_f32_16x16x32_bf16 v[156:159], a[136:139], a[80:83], v[156:159]
 buffer_load_dwordx4 v8, s[4:7], s40 offen lds
 v_mfma_f32_16x16x32_bf16 v[156:159], a[140:143], a[84:87], v[156:159]
 s_add_u32 m0, s44, 90112
 ds_read_b128 a[48:51], v2 offset:12288
 v_mfma_f32_16x16x32_bf16 v[188:191], a[136:139], a[88:91], v[188:191]
 s_add_u32 s40, s92, 204800
 ds_read_b128 a[52:55], v3 offset:12288
 v_mfma_f32_16x16x32_bf16 v[188:191], a[140:143], a[92:95], v[188:191]
 ds_read_b64_tr_b16 a[120:121], v4 offset:8
 v_mfma_f32_16x16x32_bf16 v[220:223], a[136:139], a[96:99], v[220:223]
 ds_read_b64_tr_b16 a[122:123], v4 offset:2056
 v_mfma_f32_16x16x32_bf16 v[220:223], a[140:143], a[100:103], v[220:223]
 buffer_load_dwordx4 v8, s[4:7], s40 offen lds
 v_mfma_f32_16x16x32_bf16 v[252:255], a[136:139], a[104:107], v[252:255]
 s_add_u32 m0, s44, 94208
 ds_read_b64_tr_b16 a[124:125], v4 offset:16392
 v_mfma_f32_16x16x32_bf16 v[252:255], a[140:143], a[108:111], v[252:255]
 s_waitcnt lgkmcnt(15)
 ds_read_b64_tr_b16 a[126:127], v4 offset:18440
 v_mfma_f32_16x16x32_bf16 v[32:35], a[112:115], a[0:3], v[32:35]
 s_add_u32 s40, s92, 245760
 buffer_load_dwordx4 v8, s[4:7], s40 offen lds
 v_mfma_f32_16x16x32_bf16 v[32:35], a[116:119], a[4:7], v[32:35]
 s_waitcnt lgkmcnt(14)
 ds_read_b64_tr_b16 a[128:129], v5 offset:0
 v_mfma_f32_16x16x32_bf16 v[64:67], a[112:115], a[8:11], v[64:67]
 s_add_u32 m0, s44, 131072
 s_add_u32 s40, s93, 0
 buffer_load_dwordx4 v9, s[8:11], s40 offen lds
 v_mfma_f32_16x16x32_bf16 v[64:67], a[116:119], a[12:15], v[64:67]
 s_waitcnt lgkmcnt(13)
 ds_read_b64_tr_b16 a[130:131], v5 offset:2048
 v_mfma_f32_16x16x32_bf16 v[96:99], a[112:115], a[16:19], v[96:99]
 s_add_u32 m0, s44, 135168
 s_add_u32 s40, s93, 65536
 buffer_load_dwordx4 v9, s[8:11], s40 offen lds
 v_mfma_f32_16x16x32_bf16 v[96:99], a[116:119], a[20:23], v[96:99]
 s_waitcnt lgkmcnt(12)
 ds_read_b64_tr_b16 a[132:133], v5 offset:16384
 v_mfma_f32_16x16x32_bf16 v[128:131], a[112:115], a[24:27], v[128:131]
 s_add_u32 m0, s44, 139264
 s_add_u32 s40, s93, 131072
 buffer_load_dwordx4 v9, s[8:11], s40 offen lds
 v_mfma_f32_16x16x32_bf16 v[128:131], a[116:119], a[28:31], v[128:131]
 s_waitcnt lgkmcnt(11)
 ds_read_b64_tr_b16 a[134:135], v5 offset:18432
 v_mfma_f32_16x16x32_bf16 v[160:163], a[112:115], a[32:35], v[160:163]
 s_add_u32 m0, s44, 143360
 s_add_u32 s40, s93, 196608
 buffer_load_dwordx4 v9, s[8:11], s40 offen lds
 v_mfma_f32_16x16x32_bf16 v[160:163], a[116:119], a[36:39], v[160:163]
 s_waitcnt lgkmcnt(10)
 s_add_u32 m0, s44, 147456
 s_add_u32 s40, s93, 262144
 buffer_load_dwordx4 v9, s[8:11], s40 offen lds
 v_mfma_f32_16x16x32_bf16 v[192:195], a[112:115], a[40:43], v[192:195]
 s_add_u32 m0, s44, 151552
 s_add_u32 s40, s93, 327680
 buffer_load_dwordx4 v9, s[8:11], s40 offen lds
 v_mfma_f32_16x16x32_bf16 v[192:195], a[116:119], a[44:47], v[192:195]
 s_waitcnt lgkmcnt(8)
 s_add_u32 m0, s44, 155648
 s_add_u32 s40, s93, 393216
 buffer_load_dwordx4 v9, s[8:11], s40 offen lds
 v_mfma_f32_16x16x32_bf16 v[224:227], a[112:115], a[48:51], v[224:227]
 s_add_u32 m0, s44, 159744
 s_add_u32 s40, s93, 458752
 buffer_load_dwordx4 v9, s[8:11], s40 offen lds
 v_mfma_f32_16x16x32_bf16 v[224:227], a[116:119], a[52:55], v[224:227]
 s_waitcnt lgkmcnt(4)
 v_mfma_f32_16x16x32_bf16 v[36:39], a[120:123], a[0:3], v[36:39]
 s_add_u32 s94, s94, 1
 v_mfma_f32_16x16x32_bf16 v[36:39], a[124:127], a[4:7], v[36:39]
 s_cmp_eq_u32 s94, 10
 s_cselect_b32 s94, 0, s94
 ds_read_b64_tr_b16 a[136:137], v5 offset:8
 v_mfma_f32_16x16x32_bf16 v[68:71], a[120:123], a[8:11], v[68:71]
 s_xor_b32 s88, s101, 2048
 buffer_load_dwordx4 a[144:147], v22, s[12:15], s88 offen nt
 v_mfma_f32_16x16x32_bf16 v[68:71], a[124:127], a[12:15], v[68:71]
 s_lshl_b32 s92, s94, 7
 ds_read_b64_tr_b16 a[138:139], v5 offset:2056
 v_mfma_f32_16x16x32_bf16 v[100:103], a[120:123], a[16:19], v[100:103]
 s_lshl_b32 s93, s94, 19
 v_mfma_f32_16x16x32_bf16 v[100:103], a[124:127], a[20:23], v[100:103]
 s_add_u32 m0, s44, 40960
 ds_read_b64_tr_b16 a[140:141], v5 offset:16392
 v_mfma_f32_16x16x32_bf16 v[132:135], a[120:123], a[24:27], v[132:135]
 s_add_u32 s40, s92, 0
 v_mfma_f32_16x16x32_bf16 v[132:135], a[124:127], a[28:31], v[132:135]
 ds_read_b64_tr_b16 a[142:143], v5 offset:18440
 v_mfma_f32_16x16x32_bf16 v[164:167], a[120:123], a[32:35], v[164:167]
 v_mfma_f32_16x16x32_bf16 v[164:167], a[124:127], a[36:39], v[164:167]
 v_mfma_f32_16x16x32_bf16 v[196:199], a[120:123], a[40:43], v[196:199]
 buffer_load_dwordx4 a[148:151], v23, s[12:15], s88 offen offset:2048 nt
 v_mfma_f32_16x16x32_bf16 v[196:199], a[124:127], a[44:47], v[196:199]
 v_mfma_f32_16x16x32_bf16 v[228:231], a[120:123], a[48:51], v[228:231]
 v_mfma_f32_16x16x32_bf16 v[228:231], a[124:127], a[52:55], v[228:231]
 s_waitcnt lgkmcnt(4)
 v_mfma_f32_16x16x32_bf16 v[40:43], a[128:131], a[0:3], v[40:43]
 v_mfma_f32_16x16x32_bf16 v[40:43], a[132:135], a[4:7], v[40:43]
 ds_read_b64_tr_b16 a[112:113], v6 offset:0
 v_mfma_f32_16x16x32_bf16 v[72:75], a[128:131], a[8:11], v[72:75]
 v_mfma_f32_16x16x32_bf16 v[72:75], a[132:135], a[12:15], v[72:75]
 ds_read_b64_tr_b16 a[114:115], v6 offset:2048
 v_mfma_f32_16x16x32_bf16 v[104:107], a[128:131], a[16:19], v[104:107]
 v_mfma_f32_16x16x32_bf16 v[104:107], a[132:135], a[20:23], v[104:107]
 ds_read_b64_tr_b16 a[116:117], v6 offset:16384
 v_mfma_f32_16x16x32_bf16 v[136:139], a[128:131], a[24:27], v[136:139]
 s_xor_b32 s88, s101, 18432
 buffer_load_dwordx4 a[152:155], v22, s[12:15], s88 offen nt
 v_mfma_f32_16x16x32_bf16 v[136:139], a[132:135], a[28:31], v[136:139]
 ds_read_b64_tr_b16 a[118:119], v6 offset:18432
 v_mfma_f32_16x16x32_bf16 v[168:171], a[128:131], a[32:35], v[168:171]
 v_mfma_f32_16x16x32_bf16 v[168:171], a[132:135], a[36:39], v[168:171]
 v_mfma_f32_16x16x32_bf16 v[200:203], a[128:131], a[40:43], v[200:203]
 v_mfma_f32_16x16x32_bf16 v[200:203], a[132:135], a[44:47], v[200:203]
 v_mfma_f32_16x16x32_bf16 v[232:235], a[128:131], a[48:51], v[232:235]
 v_mfma_f32_16x16x32_bf16 v[232:235], a[132:135], a[52:55], v[232:235]
 s_waitcnt lgkmcnt(4)
 v_mfma_f32_16x16x32_bf16 v[44:47], a[136:139], a[0:3], v[44:47]
 buffer_load_dwordx4 a[156:159], v23, s[12:15], s88 offen offset:2048 nt
 v_mfma_f32_16x16x32_bf16 v[44:47], a[140:143], a[4:7], v[44:47]
 ds_read_b64_tr_b16 a[120:121], v6 offset:8
 v_mfma_f32_16x16x32_bf16 v[76:79], a[136:139], a[8:11], v[76:79]
 v_mfma_f32_16x16x32_bf16 v[76:79], a[140:143], a[12:15], v[76:79]
 ds_read_b64_tr_b16 a[122:123], v6 offset:2056
 v_mfma_f32_16x16x32_bf16 v[108:111], a[136:139], a[16:19], v[108:111]
 v_mfma_f32_16x16x32_bf16 v[108:111], a[140:143], a[20:23], v[108:111]
 ds_read_b64_tr_b16 a[124:125], v6 offset:16392
 v_mfma_f32_16x16x32_bf16 v[140:143], a[136:139], a[24:27], v[140:143]
 v_mfma_f32_16x16x32_bf16 v[140:143], a[140:143], a[28:31], v[140:143]
 ds_read_b64_tr_b16 a[126:127], v6 offset:18440
 v_mfma_f32_16x16x32_bf16 v[172:175], a[136:139], a[32:35], v[172:175]
 v_mfma_f32_16x16x32_bf16 v[172:175], a[140:143], a[36:39], v[172:175]
 s_xor_b32 s88, s101, 0
 buffer_load_dwordx4 a[160:163], v24, s[16:19], s88 offen nt
 v_mfma_f32_16x16x32_bf16 v[204:207], a[136:139], a[40:43], v[204:207]
 v_mfma_f32_16x16x32_bf16 v[204:207], a[140:143], a[44:47], v[204:207]
 v_mfma_f32_16x16x32_bf16 v[236:239], a[136:139], a[48:51], v[236:239]
 v_mfma_f32_16x16x32_bf16 v[236:239], a[140:143], a[52:55], v[236:239]
 s_waitcnt lgkmcnt(4)
 v_mfma_f32_16x16x32_bf16 v[48:51], a[112:115], a[0:3], v[48:51]
 v_mfma_f32_16x16x32_bf16 v[48:51], a[116:119], a[4:7], v[48:51]
 ds_read_b64_tr_b16 a[128:129], v7 offset:0
 v_mfma_f32_16x16x32_bf16 v[80:83], a[112:115], a[8:11], v[80:83]
 v_mfma_f32_16x16x32_bf16 v[80:83], a[116:119], a[12:15], v[80:83]
 ds_read_b64_tr_b16 a[130:131], v7 offset:2048
 v_mfma_f32_16x16x32_bf16 v[112:115], a[112:115], a[16:19], v[112:115]
 s_xor_b32 s88, s101, 65536
 buffer_load_dwordx4 a[164:167], v24, s[16:19], s88 offen nt
 v_mfma_f32_16x16x32_bf16 v[112:115], a[116:119], a[20:23], v[112:115]
 ds_read_b64_tr_b16 a[132:133], v7 offset:16384
 v_mfma_f32_16x16x32_bf16 v[144:147], a[112:115], a[24:27], v[144:147]
 v_mfma_f32_16x16x32_bf16 v[144:147], a[116:119], a[28:31], v[144:147]
 ds_read_b64_tr_b16 a[134:135], v7 offset:18432
 v_mfma_f32_16x16x32_bf16 v[176:179], a[112:115], a[32:35], v[176:179]
 v_mfma_f32_16x16x32_bf16 v[176:179], a[116:119], a[36:39], v[176:179]
 v_mfma_f32_16x16x32_bf16 v[208:211], a[112:115], a[40:43], v[208:211]
 v_mfma_f32_16x16x32_bf16 v[208:211], a[116:119], a[44:47], v[208:211]
 v_mfma_f32_16x16x32_bf16 v[240:243], a[112:115], a[48:51], v[240:243]
 v_mfma_f32_16x16x32_bf16 v[240:243], a[116:119], a[52:55], v[240:243]
 s_waitcnt lgkmcnt(4)
 v_mfma_f32_16x16x32_bf16 v[52:55], a[120:123], a[0:3], v[52:55]
 v_mfma_f32_16x16x32_bf16 v[52:55], a[124:127], a[4:7], v[52:55]
 ds_read_b64_tr_b16 a[136:137], v7 offset:8
 v_mfma_f32_16x16x32_bf16 v[84:87], a[120:123], a[8:11], v[84:87]
 v_mfma_f32_16x16x32_bf16 v[84:87], a[124:127], a[12:15], v[84:87]
 ds_read_b64_tr_b16 a[138:139], v7 offset:2056
 v_mfma_f32_16x16x32_bf16 v[116:119], a[120:123], a[16:19], v[116:119]
 v_mfma_f32_16x16x32_bf16 v[116:119], a[124:127], a[20:23], v[116:119]
 ds_read_b64_tr_b16 a[140:141], v7 offset:16392
 v_mfma_f32_16x16x32_bf16 v[148:151], a[120:123], a[24:27], v[148:151]
 v_mfma_f32_16x16x32_bf16 v[148:151], a[124:127], a[28:31], v[148:151]
 ds_read_b64_tr_b16 a[142:143], v7 offset:18440
 v_mfma_f32_16x16x32_bf16 v[180:183], a[120:123], a[32:35], v[180:183]
 v_mfma_f32_16x16x32_bf16 v[180:183], a[124:127], a[36:39], v[180:183]
 v_mfma_f32_16x16x32_bf16 v[212:215], a[120:123], a[40:43], v[212:215]
 v_mfma_f32_16x16x32_bf16 v[212:215], a[124:127], a[44:47], v[212:215]
 v_mfma_f32_16x16x32_bf16 v[244:247], a[120:123], a[48:51], v[244:247]
 v_mfma_f32_16x16x32_bf16 v[244:247], a[124:127], a[52:55], v[244:247]
 s_waitcnt vmcnt(6) lgkmcnt(0)
 s_barrier
 v_mfma_f32_16x16x32_bf16 v[56:59], a[128:131], a[0:3], v[56:59]
 buffer_load_dwordx4 v8, s[4:7], s40 offen lds
 v_mfma_f32_16x16x32_bf16 v[56:59], a[132:135], a[4:7], v[56:59]
 s_add_u32 m0, s44, 45056
 ds_read_b64_tr_b16 a[112:113], v4 offset:32768
 v_mfma_f32_16x16x32_bf16 v[88:91], a[128:131], a[8:11], v[88:91]
 s_add_u32 s40, s92, 40960
 ds_read_b64_tr_b16 a[114:115], v4 offset:34816
 v_mfma_f32_16x16x32_bf16 v[88:91], a[132:135], a[12:15], v[88:91]
 ds_read_b64_tr_b16 a[116:117], v4 offset:49152
 v_mfma_f32_16x16x32_bf16 v[120:123], a[128:131], a[16:19], v[120:123]
 ds_read_b64_tr_b16 a[118:119], v4 offset:51200
 v_mfma_f32_16x16x32_bf16 v[120:123], a[132:135], a[20:23], v[120:123]
 buffer_load_dwordx4 v8, s[4:7], s40 offen lds
 v_mfma_f32_16x16x32_bf16 v[152:155], a[128:131], a[24:27], v[152:155]
 s_add_u32 m0, s44, 49152
 ds_read_b128 a[56:59], v2 offset:28672
 v_mfma_f32_16x16x32_bf16 v[152:155], a[132:135], a[28:31], v[152:155]
 s_add_u32 s40, s92, 81920
 ds_read_b128 a[60:63], v3 offset:28672
 v_mfma_f32_16x16x32_bf16 v[184:187], a[128:131], a[32:35], v[184:187]
 ds_read_b128 a[64:67], v2 offset:30720
 v_mfma_f32_16x16x32_bf16 v[184:187], a[132:135], a[36:39], v[184:187]
 ds_read_b128 a[68:71], v3 offset:30720
 v_mfma_f32_16x16x32_bf16 v[216:219], a[128:131], a[40:43], v[216:219]
 buffer_load_dwordx4 v8, s[4:7], s40 offen lds
 v_mfma_f32_16x16x32_bf16 v[216:219], a[132:135], a[44:47], v[216:219]
 s_add_u32 m0, s44, 53248
 ds_read_b128 a[72:75], v2 offset:32768
 v_mfma_f32_16x16x32_bf16 v[248:251], a[128:131], a[48:51], v[248:251]
 s_add_u32 s40, s92, 122880
 ds_read_b128 a[76:79], v3 offset:32768
 v_mfma_f32_16x16x32_bf16 v[248:251], a[132:135], a[52:55], v[248:251]
 s_waitcnt lgkmcnt(10)
 ds_read_b128 a[80:83], v2 offset:34816
 v_mfma_f32_16x16x32_bf16 v[60:63], a[136:139], a[0:3], v[60:63]
 ds_read_b128 a[84:87], v3 offset:34816
 v_mfma_f32_16x16x32_bf16 v[60:63], a[140:143], a[4:7], v[60:63]
 buffer_load_dwordx4 v8, s[4:7], s40 offen lds
 v_mfma_f32_16x16x32_bf16 v[92:95], a[136:139], a[8:11], v[92:95]
 s_add_u32 m0, s44, 57344
 ds_read_b128 a[88:91], v2 offset:36864
 v_mfma_f32_16x16x32_bf16 v[92:95], a[140:143], a[12:15], v[92:95]
 s_add_u32 s40, s92, 163840
 ds_read_b128 a[92:95], v3 offset:36864
 v_mfma_f32_16x16x32_bf16 v[124:127], a[136:139], a[16:19], v[124:127]
 ds_read_b128 a[96:99], v2 offset:38912
 v_mfma_f32_16x16x32_bf16 v[124:127], a[140:143], a[20:23], v[124:127]
 ds_read_b128 a[100:103], v3 offset:38912
 v_mfma_f32_16x16x32_bf16 v[156:159], a[136:139], a[24:27], v[156:159]
 buffer_load_dwordx4 v8, s[4:7], s40 offen lds
 v_mfma_f32_16x16x32_bf16 v[156:159], a[140:143], a[28:31], v[156:159]
 s_add_u32 m0, s44, 61440
 ds_read_b128 a[104:107], v2 offset:40960
 v_mfma_f32_16x16x32_bf16 v[188:191], a[136:139], a[32:35], v[188:191]
 s_add_u32 s40, s92, 204800
 ds_read_b128 a[108:111], v3 offset:40960
 v_mfma_f32_16x16x32_bf16 v[188:191], a[140:143], a[36:39], v[188:191]
 ds_read_b64_tr_b16 a[120:121], v4 offset:32776
 v_mfma_f32_16x16x32_bf16 v[220:223], a[136:139], a[40:43], v[220:223]
 ds_read_b64_tr_b16 a[122:123], v4 offset:34824
 v_mfma_f32_16x16x32_bf16 v[220:223], a[140:143], a[44:47], v[220:223]
 buffer_load_dwordx4 v8, s[4:7], s40 offen lds
 v_mfma_f32_16x16x32_bf16 v[252:255], a[136:139], a[48:51], v[252:255]
 s_add_u32 m0, s44, 65536
 ds_read_b64_tr_b16 a[124:125], v4 offset:49160
 v_mfma_f32_16x16x32_bf16 v[252:255], a[140:143], a[52:55], v[252:255]
 s_waitcnt lgkmcnt(15)
 ds_read_b64_tr_b16 a[126:127], v4 offset:51208
 v_mfma_f32_16x16x32_bf16 v[32:35], a[112:115], a[56:59], v[32:35]
 s_add_u32 s40, s92, 245760
 buffer_load_dwordx4 v8, s[4:7], s40 offen lds
 v_mfma_f32_16x16x32_bf16 v[32:35], a[116:119], a[60:63], v[32:35]
 s_waitcnt lgkmcnt(14)
 ds_read_b64_tr_b16 a[128:129], v5 offset:32768
 v_mfma_f32_16x16x32_bf16 v[64:67], a[112:115], a[64:67], v[64:67]
 s_add_u32 m0, s44, 98304
 s_add_u32 s40, s93, 0
 buffer_load_dwordx4 v9, s[8:11], s40 offen lds
 v_mfma_f32_16x16x32_bf16 v[64:67], a[116:119], a[68:71], v[64:67]
 s_waitcnt lgkmcnt(13)
 ds_read_b64_tr_b16 a[130:131], v5 offset:34816
 v_mfma_f32_16x16x32_bf16 v[96:99], a[112:115], a[72:75], v[96:99]
 s_add_u32 m0, s44, 102400
 s_add_u32 s40, s93, 65536
 buffer_load_dwordx4 v9, s[8:11], s40 offen lds
 v_mfma_f32_16x16x32_bf16 v[96:99], a[116:119], a[76:79], v[96:99]
 s_waitcnt lgkmcnt(12)
 ds_read_b64_tr_b16 a[132:133], v5 offset:49152
 v_mfma_f32_16x16x32_bf16 v[128:131], a[112:115], a[80:83], v[128:131]
 s_add_u32 m0, s44, 106496
 s_add_u32 s40, s93, 131072
 buffer_load_dwordx4 v9, s[8:11], s40 offen lds
 v_mfma_f32_16x16x32_bf16 v[128:131], a[116:119], a[84:87], v[128:131]
 s_waitcnt lgkmcnt(11)
 ds_read_b64_tr_b16 a[134:135], v5 offset:51200
 v_mfma_f32_16x16x32_bf16 v[160:163], a[112:115], a[88:91], v[160:163]
 s_add_u32 m0, s44, 110592
 s_add_u32 s40, s93, 196608
 buffer_load_dwordx4 v9, s[8:11], s40 offen lds
 v_mfma_f32_16x16x32_bf16 v[160:163], a[116:119], a[92:95], v[160:163]
 s_waitcnt lgkmcnt(10)
 s_add_u32 m0, s44, 114688
 s_add_u32 s40, s93, 262144
 buffer_load_dwordx4 v9, s[8:11], s40 offen lds
 v_mfma_f32_16x16x32_bf16 v[192:195], a[112:115], a[96:99], v[192:195]
 s_add_u32 m0, s44, 118784
 s_add_u32 s40, s93, 327680
 buffer_load_dwordx4 v9, s[8:11], s40 offen lds
 v_mfma_f32_16x16x32_bf16 v[192:195], a[116:119], a[100:103], v[192:195]
 s_waitcnt lgkmcnt(8)
 s_add_u32 m0, s44, 122880
 s_add_u32 s40, s93, 393216
 buffer_load_dwordx4 v9, s[8:11], s40 offen lds
 v_mfma_f32_16x16x32_bf16 v[224:227], a[112:115], a[104:107], v[224:227]
 s_add_u32 m0, s44, 126976
 s_add_u32 s40, s93, 458752
 buffer_load_dwordx4 v9, s[8:11], s40 offen lds
 v_mfma_f32_16x16x32_bf16 v[224:227], a[116:119], a[108:111], v[224:227]
 s_waitcnt lgkmcnt(4)
 v_mfma_f32_16x16x32_bf16 v[36:39], a[120:123], a[56:59], v[36:39]
 s_add_u32 s94, s94, 1
 ds_read_b64_tr_b16 a[208:209], v28 offset:0
 v_mfma_f32_16x16x32_bf16 v[36:39], a[124:127], a[60:63], v[36:39]
 s_cmp_eq_u32 s94, 10
 s_cselect_b32 s94, 0, s94
 ds_read_b64_tr_b16 a[136:137], v5 offset:32776
 v_mfma_f32_16x16x32_bf16 v[68:71], a[120:123], a[64:67], v[68:71]
 s_xor_b32 s88, s101, 16384
 buffer_load_dwordx4 a[168:171], v24, s[16:19], s88 offen nt
 v_mfma_f32_16x16x32_bf16 v[68:71], a[124:127], a[68:71], v[68:71]
 s_lshl_b32 s92, s94, 7
 ds_read_b64_tr_b16 a[138:139], v5 offset:34824
 v_mfma_f32_16x16x32_bf16 v[100:103], a[120:123], a[72:75], v[100:103]
 s_lshl_b32 s93, s94, 19
 v_mfma_f32_16x16x32_bf16 v[100:103], a[124:127], a[76:79], v[100:103]
 s_branch SK1811
C1_2:
PG1811:
 s_branch PG4086
SK1811:
 s_add_u32 m0, s44, 69632
 ds_read_b64_tr_b16 a[140:141], v5 offset:49160
 v_mfma_f32_16x16x32_bf16 v[132:135], a[120:123], a[80:83], v[132:135]
 s_add_u32 s40, s92, 0
 v_mfma_f32_16x16x32_bf16 v[132:135], a[124:127], a[84:87], v[132:135]
 ds_read_b64_tr_b16 a[142:143], v5 offset:51208
 v_mfma_f32_16x16x32_bf16 v[164:167], a[120:123], a[88:91], v[164:167]
 ds_read_b64_tr_b16 a[210:211], v28 offset:20480
 v_mfma_f32_16x16x32_bf16 v[164:167], a[124:127], a[92:95], v[164:167]
 v_mfma_f32_16x16x32_bf16 v[196:199], a[120:123], a[96:99], v[196:199]
 s_xor_b32 s88, s101, 81920
 buffer_load_dwordx4 a[172:175], v24, s[16:19], s88 offen nt
 v_mfma_f32_16x16x32_bf16 v[196:199], a[124:127], a[100:103], v[196:199]
 v_mfma_f32_16x16x32_bf16 v[228:231], a[120:123], a[104:107], v[228:231]
 v_mfma_f32_16x16x32_bf16 v[228:231], a[124:127], a[108:111], v[228:231]
 s_waitcnt lgkmcnt(6)
 v_mfma_f32_16x16x32_bf16 v[40:43], a[128:131], a[56:59], v[40:43]
 ds_read_b64_tr_b16 a[212:213], v28 offset:8
 v_mfma_f32_16x16x32_bf16 v[40:43], a[132:135], a[60:63], v[40:43]
 ds_read_b64_tr_b16 a[112:113], v6 offset:32768
 v_mfma_f32_16x16x32_bf16 v[72:75], a[128:131], a[64:67], v[72:75]
 v_mfma_f32_16x16x32_bf16 v[72:75], a[132:135], a[68:71], v[72:75]
 ds_read_b64_tr_b16 a[114:115], v6 offset:34816
 v_mfma_f32_16x16x32_bf16 v[104:107], a[128:131], a[72:75], v[104:107]
 v_mfma_f32_16x16x32_bf16 v[104:107], a[132:135], a[76:79], v[104:107]
 ds_read_b64_tr_b16 a[116:117], v6 offset:49152
 v_mfma_f32_16x16x32_bf16 v[136:139], a[128:131], a[80:83], v[136:139]
 s_xor_b32 s88, s101, 3072
 buffer_load_dwordx4 a[176:179], v22, s[12:15], s88 offen nt
 v_mfma_f32_16x16x32_bf16 v[136:139], a[132:135], a[84:87], v[136:139]
 ds_read_b64_tr_b16 a[118:119], v6 offset:51200
 v_mfma_f32_16x16x32_bf16 v[168:171], a[128:131], a[88:91], v[168:171]
 ds_read_b64_tr_b16 a[214:215], v28 offset:20488
 v_mfma_f32_16x16x32_bf16 v[168:171], a[132:135], a[92:95], v[168:171]
 v_mfma_f32_16x16x32_bf16 v[200:203], a[128:131], a[96:99], v[200:203]
 v_mfma_f32_16x16x32_bf16 v[200:203], a[132:135], a[100:103], v[200:203]
 v_mfma_f32_16x16x32_bf16 v[232:235], a[128:131], a[104:107], v[232:235]
 ds_read_b64_tr_b16 a[216:217], v28 offset:64
 v_mfma_f32_16x16x32_bf16 v[232:235], a[132:135], a[108:111], v[232:235]
 s_waitcnt lgkmcnt(8)
 v_mfma_f32_16x16x32_bf16 v[44:47], a[136:139], a[56:59], v[44:47]
 buffer_load_dwordx4 a[180:183], v23, s[12:15], s88 offen offset:2048 nt
 v_mfma_f32_16x16x32_bf16 v[44:47], a[140:143], a[60:63], v[44:47]
 ds_read_b64_tr_b16 a[120:121], v6 offset:32776
 v_mfma_f32_16x16x32_bf16 v[76:79], a[136:139], a[64:67], v[76:79]
 v_mfma_f32_16x16x32_bf16 v[76:79], a[140:143], a[68:71], v[76:79]
 ds_read_b64_tr_b16 a[122:123], v6 offset:34824
 v_mfma_f32_16x16x32_bf16 v[108:111], a[136:139], a[72:75], v[108:111]
 v_mfma_f32_16x16x32_bf16 v[108:111], a[140:143], a[76:79], v[108:111]
 ds_read_b64_tr_b16 a[124:125], v6 offset:49160
 v_mfma_f32_16x16x32_bf16 v[140:143], a[136:139], a[80:83], v[140:143]
 v_mfma_f32_16x16x32_bf16 v[140:143], a[140:143], a[84:87], v[140:143]
 ds_read_b64_tr_b16 a[126:127], v6 offset:51208
 v_mfma_f32_16x16x32_bf16 v[172:175], a[136:139], a[88:91], v[172:175]
 ds_read_b64_tr_b16 a[218:219], v28 offset:20544
 v_mfma_f32_16x16x32_bf16 v[172:175], a[140:143], a[92:95], v[172:175]
 s_xor_b32 s88, s101, 19456
 buffer_load_dwordx4 a[184:187], v22, s[12:15], s88 offen nt
 v_mfma_f32_16x16x32_bf16 v[204:207], a[136:139], a[96:99], v[204:207]
 v_mfma_f32_16x16x32_bf16 v[204:207], a[140:143], a[100:103], v[204:207]
 v_mfma_f32_16x16x32_bf16 v[236:239], a[136:139], a[104:107], v[236:239]
 ds_read_b64_tr_b16 a[220:221], v28 offset:72
 v_mfma_f32_16x16x32_bf16 v[236:239], a[140:143], a[108:111], v[236:239]
 s_waitcnt lgkmcnt(8)
 v_mfma_f32_16x16x32_bf16 v[48:51], a[112:115], a[56:59], v[48:51]
 v_mfma_f32_16x16x32_bf16 v[48:51], a[116:119], a[60:63], v[48:51]
 ds_read_b64_tr_b16 a[128:129], v7 offset:32768
 v_mfma_f32_16x16x32_bf16 v[80:83], a[112:115], a[64:67], v[80:83]
 v_mfma_f32_16x16x32_bf16 v[80:83], a[116:119], a[68:71], v[80:83]
 ds_read_b64_tr_b16 a[130:131], v7 offset:34816
 v_mfma_f32_16x16x32_bf16 v[112:115], a[112:115], a[72:75], v[112:115]
 buffer_load_dwordx4 a[188:191], v23, s[12:15], s88 offen offset:2048 nt
 v_mfma_f32_16x16x32_bf16 v[112:115], a[116:119], a[76:79], v[112:115]
 ds_read_b64_tr_b16 a[132:133], v7 offset:49152
 v_mfma_f32_16x16x32_bf16 v[144:147], a[112:115], a[80:83], v[144:147]
 v_mfma_f32_16x16x32_bf16 v[144:147], a[116:119], a[84:87], v[144:147]
 ds_read_b64_tr_b16 a[134:135], v7 offset:51200
 v_mfma_f32_16x16x32_bf16 v[176:179], a[112:115], a[88:91], v[176:179]
 ds_read_b64_tr_b16 a[222:223], v28 offset:20552
 v_mfma_f32_16x16x32_bf16 v[176:179], a[116:119], a[92:95], v[176:179]
 v_mfma_f32_16x16x32_bf16 v[208:211], a[112:115], a[96:99], v[208:211]
 v_mfma_f32_16x16x32_bf16 v[208:211], a[116:119], a[100:103], v[208:211]
 ds_read_b64_tr_b16 a[224:225], v29 offset:128
 v_mfma_f32_16x16x32_bf16 v[240:243], a[112:115], a[104:107], v[240:243]
 v_mfma_f32_16x16x32_bf16 v[240:243], a[116:119], a[108:111], v[240:243]
 s_waitcnt lgkmcnt(8)
 v_mfma_f32_16x16x32_bf16 v[52:55], a[120:123], a[56:59], v[52:55]
 v_mfma_f32_16x16x32_bf16 v[52:55], a[124:127], a[60:63], v[52:55]
 ds_read_b64_tr_b16 a[136:137], v7 offset:32776
 v_mfma_f32_16x16x32_bf16 v[84:87], a[120:123], a[64:67], v[84:87]
 v_mfma_f32_16x16x32_bf16 v[84:87], a[124:127], a[68:71], v[84:87]
 ds_read_b64_tr_b16 a[138:139], v7 offset:34824
 v_mfma_f32_16x16x32_bf16 v[116:119], a[120:123], a[72:75], v[116:119]
 ds_read_b64_tr_b16 a[226:227], v29 offset:20608
 v_mfma_f32_16x16x32_bf16 v[116:119], a[124:127], a[76:79], v[116:119]
 ds_read_b64_tr_b16 a[140:141], v7 offset:49160
 v_mfma_f32_16x16x32_bf16 v[148:151], a[120:123], a[80:83], v[148:151]
 v_mfma_f32_16x16x32_bf16 v[148:151], a[124:127], a[84:87], v[148:151]
 ds_read_b64_tr_b16 a[142:143], v7 offset:51208
 v_mfma_f32_16x16x32_bf16 v[180:183], a[120:123], a[88:91], v[180:183]
 v_mfma_f32_16x16x32_bf16 v[180:183], a[124:127], a[92:95], v[180:183]
 v_mfma_f32_16x16x32_bf16 v[212:215], a[120:123], a[96:99], v[212:215]
 v_mfma_f32_16x16x32_bf16 v[212:215], a[124:127], a[100:103], v[212:215]
 v_mfma_f32_16x16x32_bf16 v[244:247], a[120:123], a[104:107], v[244:247]
 v_mfma_f32_16x16x32_bf16 v[244:247], a[124:127], a[108:111], v[244:247]
 s_waitcnt vmcnt(6) lgkmcnt(0)
 s_barrier
 v_mfma_f32_16x16x32_bf16 v[56:59], a[128:131], a[56:59], v[56:59]
 buffer_load_dwordx4 v8, s[4:7], s40 offen lds
 v_mfma_f32_16x16x32_bf16 v[56:59], a[132:135], a[60:63], v[56:59]
 s_add_u32 m0, s44, 73728
 ds_read_b64_tr_b16 a[112:113], v4 offset:0
 v_mfma_f32_16x16x32_bf16 v[88:91], a[128:131], a[64:67], v[88:91]
 s_add_u32 s40, s92, 40960
 ds_read_b64_tr_b16 a[114:115], v4 offset:2048
 v_mfma_f32_16x16x32_bf16 v[88:91], a[132:135], a[68:71], v[88:91]
 ds_read_b64_tr_b16 a[116:117], v4 offset:16384
 v_mfma_f32_16x16x32_bf16 v[120:123], a[128:131], a[72:75], v[120:123]
 ds_read_b64_tr_b16 a[118:119], v4 offset:18432
 v_mfma_f32_16x16x32_bf16 v[120:123], a[132:135], a[76:79], v[120:123]
 buffer_load_dwordx4 v8, s[4:7], s40 offen lds
 v_mfma_f32_16x16x32_bf16 v[152:155], a[128:131], a[80:83], v[152:155]
 s_add_u32 m0, s44, 77824
 ds_read_b128 a[0:3], v2 offset:0
 v_mfma_f32_16x16x32_bf16 v[152:155], a[132:135], a[84:87], v[152:155]
 s_add_u32 s40, s92, 81920
 ds_read_b128 a[4:7], v3 offset:0
 v_mfma_f32_16x16x32_bf16 v[184:187], a[128:131], a[88:91], v[184:187]
 ds_read_b128 a[8:11], v2 offset:2048
 v_mfma_f32_16x16x32_bf16 v[184:187], a[132:135], a[92:95], v[184:187]
 ds_read_b128 a[12:15], v3 offset:2048
 v_mfma_f32_16x16x32_bf16 v[216:219], a[128:131], a[96:99], v[216:219]
 buffer_load_dwordx4 v8, s[4:7], s40 offen lds
 v_mfma_f32_16x16x32_bf16 v[216:219], a[132:135], a[100:103], v[216:219]
 s_add_u32 m0, s44, 81920
 ds_read_b128 a[16:19], v2 offset:4096
 v_mfma_f32_16x16x32_bf16 v[248:251], a[128:131], a[104:107], v[248:251]
 s_add_u32 s40, s92, 122880
 ds_read_b128 a[20:23], v3 offset:4096
 v_mfma_f32_16x16x32_bf16 v[248:251], a[132:135], a[108:111], v[248:251]
 s_waitcnt lgkmcnt(10)
 ds_read_b128 a[24:27], v2 offset:6144
 v_mfma_f32_16x16x32_bf16 v[60:63], a[136:139], a[56:59], v[60:63]
 ds_read_b128 a[28:31], v3 offset:6144
 v_mfma_f32_16x16x32_bf16 v[60:63], a[140:143], a[60:63], v[60:63]
 buffer_load_dwordx4 v8, s[4:7], s40 offen lds
 v_mfma_f32_16x16x32_bf16 v[92:95], a[136:139], a[64:67], v[92:95]
 s_add_u32 m0, s44, 86016
 ds_read_b128 a[32:35], v2 offset:8192
 v_mfma_f32_16x16x32_bf16 v[92:95], a[140:143], a[68:71], v[92:95]
 s_add_u32 s40, s92, 163840
 ds_read_b128 a[36:39], v3 offset:8192
 v_mfma_f32_16x16x32_bf16 v[124:127], a[136:139], a[72:75], v[124:127]
 ds_read_b128 a[40:43], v2 offset:10240
 v_mfma_f32_16x16x32_bf16 v[124:127], a[140:143], a[76:79], v[124:127]
 ds_read_b128 a[44:47], v3 offset:10240
 v_mfma_f32_16x16x32_bf16 v[156:159], a[136:139], a[80:83], v[156:159]
 buffer_load_dwordx4 v8, s[4:7], s40 offen lds
 v_mfma_f32_16x16x32_bf16 v[156:159], a[140:143], a[84:87], v[156:159]
 s_add_u32 m0, s44, 90112
 ds_read_b128 a[48:51], v2 offset:12288
 v_mfma_f32_16x16x32_bf16 v[188:191], a[136:139], a[88:91], v[188:191]
 s_add_u32 s40, s92, 204800
 ds_read_b128 a[52:55], v3 offset:12288
 v_mfma_f32_16x16x32_bf16 v[188:191], a[140:143], a[92:95], v[188:191]
 ds_read_b64_tr_b16 a[120:121], v4 offset:8
 v_mfma_f32_16x16x32_bf16 v[220:223], a[136:139], a[96:99], v[220:223]
 ds_read_b64_tr_b16 a[122:123], v4 offset:2056
 v_mfma_f32_16x16x32_bf16 v[220:223], a[140:143], a[100:103], v[220:223]
 buffer_load_dwordx4 v8, s[4:7], s40 offen lds
 v_mfma_f32_16x16x32_bf16 v[252:255], a[136:139], a[104:107], v[252:255]
 s_add_u32 m0, s44, 94208
 ds_read_b64_tr_b16 a[124:125], v4 offset:16392
 v_mfma_f32_16x16x32_bf16 v[252:255], a[140:143], a[108:111], v[252:255]
 s_waitcnt lgkmcnt(15)
 ds_read_b64_tr_b16 a[126:127], v4 offset:18440
 v_mfma_f32_16x16x32_bf16 v[32:35], a[112:115], a[0:3], v[32:35]
 s_add_u32 s40, s92, 245760
 buffer_load_dwordx4 v8, s[4:7], s40 offen lds
 v_mfma_f32_16x16x32_bf16 v[32:35], a[116:119], a[4:7], v[32:35]
 s_waitcnt lgkmcnt(14)
 ds_read_b64_tr_b16 a[128:129], v5 offset:0
 v_mfma_f32_16x16x32_bf16 v[64:67], a[112:115], a[8:11], v[64:67]
 s_add_u32 m0, s44, 131072
 s_add_u32 s40, s93, 0
 buffer_load_dwordx4 v9, s[8:11], s40 offen lds
 v_mfma_f32_16x16x32_bf16 v[64:67], a[116:119], a[12:15], v[64:67]
 s_waitcnt lgkmcnt(13)
 ds_read_b64_tr_b16 a[130:131], v5 offset:2048
 v_mfma_f32_16x16x32_bf16 v[96:99], a[112:115], a[16:19], v[96:99]
 s_add_u32 m0, s44, 135168
 s_add_u32 s40, s93, 65536
 buffer_load_dwordx4 v9, s[8:11], s40 offen lds
 v_mfma_f32_16x16x32_bf16 v[96:99], a[116:119], a[20:23], v[96:99]
 s_waitcnt lgkmcnt(12)
 ds_read_b64_tr_b16 a[132:133], v5 offset:16384
 v_mfma_f32_16x16x32_bf16 v[128:131], a[112:115], a[24:27], v[128:131]
 s_add_u32 m0, s44, 139264
 s_add_u32 s40, s93, 131072
 buffer_load_dwordx4 v9, s[8:11], s40 offen lds
 v_mfma_f32_16x16x32_bf16 v[128:131], a[116:119], a[28:31], v[128:131]
 s_waitcnt lgkmcnt(11)
 ds_read_b64_tr_b16 a[134:135], v5 offset:18432
 v_mfma_f32_16x16x32_bf16 v[160:163], a[112:115], a[32:35], v[160:163]
 s_add_u32 m0, s44, 143360
 s_add_u32 s40, s93, 196608
 buffer_load_dwordx4 v9, s[8:11], s40 offen lds
 v_mfma_f32_16x16x32_bf16 v[160:163], a[116:119], a[36:39], v[160:163]
 s_waitcnt lgkmcnt(10)
 s_add_u32 m0, s44, 147456
 s_add_u32 s40, s93, 262144
 buffer_load_dwordx4 v9, s[8:11], s40 offen lds
 v_mfma_f32_16x16x32_bf16 v[192:195], a[112:115], a[40:43], v[192:195]
 s_add_u32 m0, s44, 151552
 s_add_u32 s40, s93, 327680
 buffer_load_dwordx4 v9, s[8:11], s40 offen lds
 v_mfma_f32_16x16x32_bf16 v[192:195], a[116:119], a[44:47], v[192:195]
 s_waitcnt lgkmcnt(8)
 s_add_u32 m0, s44, 155648
 s_add_u32 s40, s93, 393216
 buffer_load_dwordx4 v9, s[8:11], s40 offen lds
 v_mfma_f32_16x16x32_bf16 v[224:227], a[112:115], a[48:51], v[224:227]
 s_add_u32 m0, s44, 159744
 s_add_u32 s40, s93, 458752
 buffer_load_dwordx4 v9, s[8:11], s40 offen lds
 v_mfma_f32_16x16x32_bf16 v[224:227], a[116:119], a[52:55], v[224:227]
 s_waitcnt lgkmcnt(4)
 v_mfma_f32_16x16x32_bf16 v[36:39], a[120:123], a[0:3], v[36:39]
 s_add_u32 s94, s94, 1
 ds_read_b64_tr_b16 a[228:229], v28 offset:192
 v_mfma_f32_16x16x32_bf16 v[36:39], a[124:127], a[4:7], v[36:39]
 s_cmp_eq_u32 s94, 10
 s_cselect_b32 s94, 0, s94
 ds_read_b64_tr_b16 a[136:137], v5 offset:8
 v_mfma_f32_16x16x32_bf16 v[68:71], a[120:123], a[8:11], v[68:71]
 s_xor_b32 s88, s101, 1024
 buffer_load_dwordx4 a[192:195], v24, s[16:19], s88 offen nt
 v_mfma_f32_16x16x32_bf16 v[68:71], a[124:127], a[12:15], v[68:71]
 s_lshl_b32 s92, s94, 7
 ds_read_b64_tr_b16 a[138:139], v5 offset:2056
 v_mfma_f32_16x16x32_bf16 v[100:103], a[120:123], a[16:19], v[100:103]
 s_lshl_b32 s93, s94, 19
 v_mfma_f32_16x16x32_bf16 v[100:103], a[124:127], a[20:23], v[100:103]
 s_add_u32 m0, s44, 40960
 ds_read_b64_tr_b16 a[140:141], v5 offset:16392
 v_mfma_f32_16x16x32_bf16 v[132:135], a[120:123], a[24:27], v[132:135]
 s_add_u32 s40, s92, 0
 v_mfma_f32_16x16x32_bf16 v[132:135], a[124:127], a[28:31], v[132:135]
 ds_read_b64_tr_b16 a[142:143], v5 offset:18440
 v_mfma_f32_16x16x32_bf16 v[164:167], a[120:123], a[32:35], v[164:167]
 ds_read_b64_tr_b16 a[230:231], v28 offset:20672
 v_mfma_f32_16x16x32_bf16 v[164:167], a[124:127], a[36:39], v[164:167]
 v_mfma_f32_16x16x32_bf16 v[196:199], a[120:123], a[40:43], v[196:199]
 v_mfma_f32_16x16x32_bf16 v[196:199], a[124:127], a[44:47], v[196:199]
 v_mfma_f32_16x16x32_bf16 v[228:231], a[120:123], a[48:51], v[228:231]
 s_xor_b32 s88, s101, 66560
 buffer_load_dwordx4 a[196:199], v24, s[16:19], s88 offen nt
 v_mfma_f32_16x16x32_bf16 v[228:231], a[124:127], a[52:55], v[228:231]
 s_waitcnt lgkmcnt(6)
 v_mfma_f32_16x16x32_bf16 v[40:43], a[128:131], a[0:3], v[40:43]
 ds_read_b64_tr_b16 a[232:233], v28 offset:200
 v_mfma_f32_16x16x32_bf16 v[40:43], a[132:135], a[4:7], v[40:43]
 ds_read_b64_tr_b16 a[112:113], v6 offset:0
 v_mfma_f32_16x16x32_bf16 v[72:75], a[128:131], a[8:11], v[72:75]
 v_mfma_f32_16x16x32_bf16 v[72:75], a[132:135], a[12:15], v[72:75]
 ds_read_b64_tr_b16 a[114:115], v6 offset:2048
 v_mfma_f32_16x16x32_bf16 v[104:107], a[128:131], a[16:19], v[104:107]
 v_mfma_f32_16x16x32_bf16 v[104:107], a[132:135], a[20:23], v[104:107]
 ds_read_b64_tr_b16 a[116:117], v6 offset:16384
 v_mfma_f32_16x16x32_bf16 v[136:139], a[128:131], a[24:27], v[136:139]
 v_mfma_f32_16x16x32_bf16 v[136:139], a[132:135], a[28:31], v[136:139]
 ds_read_b64_tr_b16 a[118:119], v6 offset:18432
 v_mfma_f32_16x16x32_bf16 v[168:171], a[128:131], a[32:35], v[168:171]
 ds_read_b64_tr_b16 a[234:235], v28 offset:20680
 v_mfma_f32_16x16x32_bf16 v[168:171], a[132:135], a[36:39], v[168:171]
 s_xor_b32 s88, s101, 17408
 buffer_load_dwordx4 a[200:203], v24, s[16:19], s88 offen nt
 v_mfma_f32_16x16x32_bf16 v[200:203], a[128:131], a[40:43], v[200:203]
 v_mfma_f32_16x16x32_bf16 v[200:203], a[132:135], a[44:47], v[200:203]
 v_mfma_f32_16x16x32_bf16 v[232:235], a[128:131], a[48:51], v[232:235]
 ds_read_b64_tr_b16 a[236:237], v28 offset:256
 v_mfma_f32_16x16x32_bf16 v[232:235], a[132:135], a[52:55], v[232:235]
 s_waitcnt lgkmcnt(8)
 v_mfma_f32_16x16x32_bf16 v[44:47], a[136:139], a[0:3], v[44:47]
 v_mfma_f32_16x16x32_bf16 v[44:47], a[140:143], a[4:7], v[44:47]
 ds_read_b64_tr_b16 a[120:121], v6 offset:8
 v_mfma_f32_16x16x32_bf16 v[76:79], a[136:139], a[8:11], v[76:79]
 v_mfma_f32_16x16x32_bf16 v[76:79], a[140:143], a[12:15], v[76:79]
 ds_read_b64_tr_b16 a[122:123], v6 offset:2056
 v_mfma_f32_16x16x32_bf16 v[108:111], a[136:139], a[16:19], v[108:111]
 v_mfma_f32_16x16x32_bf16 v[108:111], a[140:143], a[20:23], v[108:111]
 ds_read_b64_tr_b16 a[124:125], v6 offset:16392
 v_mfma_f32_16x16x32_bf16 v[140:143], a[136:139], a[24:27], v[140:143]
 s_xor_b32 s88, s101, 82944
 buffer_load_dwordx4 a[204:207], v24, s[16:19], s88 offen nt
 v_mfma_f32_16x16x32_bf16 v[140:143], a[140:143], a[28:31], v[140:143]
 ds_read_b64_tr_b16 a[126:127], v6 offset:18440
 v_mfma_f32_16x16x32_bf16 v[172:175], a[136:139], a[32:35], v[172:175]
 ds_read_b64_tr_b16 a[238:239], v28 offset:20736
 v_mfma_f32_16x16x32_bf16 v[172:175], a[140:143], a[36:39], v[172:175]
 v_mfma_f32_16x16x32_bf16 v[204:207], a[136:139], a[40:43], v[204:207]
 v_mfma_f32_16x16x32_bf16 v[204:207], a[140:143], a[44:47], v[204:207]
 v_mfma_f32_16x16x32_bf16 v[236:239], a[136:139], a[48:51], v[236:239]
 ds_read_b64_tr_b16 a[240:241], v28 offset:264
 v_mfma_f32_16x16x32_bf16 v[236:239], a[140:143], a[52:55], v[236:239]
 s_waitcnt lgkmcnt(8)
 v_mfma_f32_16x16x32_bf16 v[48:51], a[112:115], a[0:3], v[48:51]
 v_mfma_f32_16x16x32_bf16 v[48:51], a[116:119], a[4:7], v[48:51]
 ds_read_b64_tr_b16 a[128:129], v7 offset:0
 v_mfma_f32_16x16x32_bf16 v[80:83], a[112:115], a[8:11], v[80:83]
 v_mfma_f32_16x16x32_bf16 v[80:83], a[116:119], a[12:15], v[80:83]
 ds_read_b64_tr_b16 a[130:131], v7 offset:2048
 v_mfma_f32_16x16x32_bf16 v[112:115], a[112:115], a[16:19], v[112:115]
CPF3:
 s_mov_b32 s75, CPF3-K1_BASE+2048
 buffer_load_dword a255, v25, s[96:99], s75 offen
 v_mfma_f32_16x16x32_bf16 v[112:115], a[116:119], a[20:23], v[112:115]
 ds_read_b64_tr_b16 a[132:133], v7 offset:16384
 v_mfma_f32_16x16x32_bf16 v[144:147], a[112:115], a[24:27], v[144:147]
 ds_read_b64_tr_b16 a[242:243], v28 offset:20744
 v_mfma_f32_16x16x32_bf16 v[144:147], a[116:119], a[28:31], v[144:147]
 ds_read_b64_tr_b16 a[134:135], v7 offset:18432
 v_mfma_f32_16x16x32_bf16 v[176:179], a[112:115], a[32:35], v[176:179]
 v_mfma_f32_16x16x32_bf16 v[176:179], a[116:119], a[36:39], v[176:179]
 v_mfma_f32_16x16x32_bf16 v[208:211], a[112:115], a[40:43], v[208:211]
 v_mfma_f32_16x16x32_bf16 v[208:211], a[116:119], a[44:47], v[208:211]
 ds_read_b64_tr_b16 a[244:245], v29 offset:160
 v_mfma_f32_16x16x32_bf16 v[240:243], a[112:115], a[48:51], v[240:243]
 v_mfma_f32_16x16x32_bf16 v[240:243], a[116:119], a[52:55], v[240:243]
 s_waitcnt lgkmcnt(8)
 v_mfma_f32_16x16x32_bf16 v[52:55], a[120:123], a[0:3], v[52:55]
 v_mfma_f32_16x16x32_bf16 v[52:55], a[124:127], a[4:7], v[52:55]
 ds_read_b64_tr_b16 a[136:137], v7 offset:8
 v_mfma_f32_16x16x32_bf16 v[84:87], a[120:123], a[8:11], v[84:87]
 v_mfma_f32_16x16x32_bf16 v[84:87], a[124:127], a[12:15], v[84:87]
 ds_read_b64_tr_b16 a[138:139], v7 offset:2056
 v_mfma_f32_16x16x32_bf16 v[116:119], a[120:123], a[16:19], v[116:119]
 ds_read_b64_tr_b16 a[246:247], v29 offset:20640
 v_mfma_f32_16x16x32_bf16 v[116:119], a[124:127], a[20:23], v[116:119]
 ds_read_b64_tr_b16 a[140:141], v7 offset:16392
 v_mfma_f32_16x16x32_bf16 v[148:151], a[120:123], a[24:27], v[148:151]
 v_mfma_f32_16x16x32_bf16 v[148:151], a[124:127], a[28:31], v[148:151]
 ds_read_b64_tr_b16 a[142:143], v7 offset:18440
 v_mfma_f32_16x16x32_bf16 v[180:183], a[120:123], a[32:35], v[180:183]
 v_mfma_f32_16x16x32_bf16 v[180:183], a[124:127], a[36:39], v[180:183]
 v_mfma_f32_16x16x32_bf16 v[212:215], a[120:123], a[40:43], v[212:215]
 v_mfma_f32_16x16x32_bf16 v[212:215], a[124:127], a[44:47], v[212:215]
 v_mfma_f32_16x16x32_bf16 v[244:247], a[120:123], a[48:51], v[244:247]
 v_mfma_f32_16x16x32_bf16 v[244:247], a[124:127], a[52:55], v[244:247]
 s_waitcnt vmcnt(5) lgkmcnt(0)
 s_barrier
 v_mfma_f32_16x16x32_bf16 v[56:59], a[128:131], a[0:3], v[56:59]
 buffer_load_dwordx4 v8, s[4:7], s40 offen lds
 v_mfma_f32_16x16x32_bf16 v[56:59], a[132:135], a[4:7], v[56:59]
 s_add_u32 m0, s44, 45056
 ds_read_b64_tr_b16 a[112:113], v4 offset:32768
 v_mfma_f32_16x16x32_bf16 v[88:91], a[128:131], a[8:11], v[88:91]
 s_add_u32 s40, s92, 40960
 ds_read_b64_tr_b16 a[114:115], v4 offset:34816
 v_mfma_f32_16x16x32_bf16 v[88:91], a[132:135], a[12:15], v[88:91]
 ds_read_b64_tr_b16 a[116:117], v4 offset:49152
 v_mfma_f32_16x16x32_bf16 v[120:123], a[128:131], a[16:19], v[120:123]
 ds_read_b64_tr_b16 a[118:119], v4 offset:51200
 v_mfma_f32_16x16x32_bf16 v[120:123], a[132:135], a[20:23], v[120:123]
 buffer_load_dwordx4 v8, s[4:7], s40 offen lds
 v_mfma_f32_16x16x32_bf16 v[152:155], a[128:131], a[24:27], v[152:155]
 s_add_u32 m0, s44, 49152
 ds_read_b128 a[56:59], v2 offset:28672
 v_mfma_f32_16x16x32_bf16 v[152:155], a[132:135], a[28:31], v[152:155]
 s_add_u32 s40, s92, 81920
 ds_read_b128 a[60:63], v3 offset:28672
 v_mfma_f32_16x16x32_bf16 v[184:187], a[128:131], a[32:35], v[184:187]
 ds_read_b128 a[64:67], v2 offset:30720
 v_mfma_f32_16x16x32_bf16 v[184:187], a[132:135], a[36:39], v[184:187]
 ds_read_b128 a[68:71], v3 offset:30720
 v_mfma_f32_16x16x32_bf16 v[216:219], a[128:131], a[40:43], v[216:219]
 buffer_load_dwordx4 v8, s[4:7], s40 offen lds
 v_mfma_f32_16x16x32_bf16 v[216:219], a[132:135], a[44:47], v[216:219]
 s_add_u32 m0, s44, 53248
 ds_read_b128 a[72:75], v2 offset:32768
 v_mfma_f32_16x16x32_bf16 v[248:251], a[128:131], a[48:51], v[248:251]
 s_add_u32 s40, s92, 122880
 ds_read_b128 a[76:79], v3 offset:32768
 v_mfma_f32_16x16x32_bf16 v[248:251], a[132:135], a[52:55], v[248:251]
 s_waitcnt lgkmcnt(10)
 ds_read_b128 a[80:83], v2 offset:34816
 v_mfma_f32_16x16x32_bf16 v[60:63], a[136:139], a[0:3], v[60:63]
 ds_read_b128 a[84:87], v3 offset:34816
 v_mfma_f32_16x16x32_bf16 v[60:63], a[140:143], a[4:7], v[60:63]
 buffer_load_dwordx4 v8, s[4:7], s40 offen lds
 v_mfma_f32_16x16x32_bf16 v[92:95], a[136:139], a[8:11], v[92:95]
 s_add_u32 m0, s44, 57344
 ds_read_b128 a[88:91], v2 offset:36864
 v_mfma_f32_16x16x32_bf16 v[92:95], a[140:143], a[12:15], v[92:95]
 s_add_u32 s40, s92, 163840
 ds_read_b128 a[92:95], v3 offset:36864
 v_mfma_f32_16x16x32_bf16 v[124:127], a[136:139], a[16:19], v[124:127]
 ds_read_b128 a[96:99], v2 offset:38912
 v_mfma_f32_16x16x32_bf16 v[124:127], a[140:143], a[20:23], v[124:127]
 ds_read_b128 a[100:103], v3 offset:38912
 v_mfma_f32_16x16x32_bf16 v[156:159], a[136:139], a[24:27], v[156:159]
 buffer_load_dwordx4 v8, s[4:7], s40 offen lds
 v_mfma_f32_16x16x32_bf16 v[156:159], a[140:143], a[28:31], v[156:159]
 s_add_u32 m0, s44, 61440
 ds_read_b128 a[104:107], v2 offset:40960
 v_mfma_f32_16x16x32_bf16 v[188:191], a[136:139], a[32:35], v[188:191]
 s_add_u32 s40, s92, 204800
 ds_read_b128 a[108:111], v3 offset:40960
 v_mfma_f32_16x16x32_bf16 v[188:191], a[140:143], a[36:39], v[188:191]
 ds_read_b64_tr_b16 a[120:121], v4 offset:32776
 v_mfma_f32_16x16x32_bf16 v[220:223], a[136:139], a[40:43], v[220:223]
 ds_read_b64_tr_b16 a[122:123], v4 offset:34824
 v_mfma_f32_16x16x32_bf16 v[220:223], a[140:143], a[44:47], v[220:223]
 buffer_load_dwordx4 v8, s[4:7], s40 offen lds
 v_mfma_f32_16x16x32_bf16 v[252:255], a[136:139], a[48:51], v[252:255]
 s_add_u32 m0, s44, 65536
 ds_read_b64_tr_b16 a[124:125], v4 offset:49160
 v_mfma_f32_16x16x32_bf16 v[252:255], a[140:143], a[52:55], v[252:255]
 s_waitcnt lgkmcnt(15)
 ds_read_b64_tr_b16 a[126:127], v4 offset:51208
 v_mfma_f32_16x16x32_bf16 v[32:35], a[112:115], a[56:59], v[32:35]
 s_add_u32 s40, s92, 245760
 buffer_load_dwordx4 v8, s[4:7], s40 offen lds
 v_mfma_f32_16x16x32_bf16 v[32:35], a[116:119], a[60:63], v[32:35]
 s_waitcnt lgkmcnt(14)
 ds_read_b64_tr_b16 a[128:129], v5 offset:32768
 v_mfma_f32_16x16x32_bf16 v[64:67], a[112:115], a[64:67], v[64:67]
 s_add_u32 m0, s44, 98304
 s_add_u32 s40, s93, 0
 buffer_load_dwordx4 v9, s[8:11], s40 offen lds
 v_mfma_f32_16x16x32_bf16 v[64:67], a[116:119], a[68:71], v[64:67]
 s_waitcnt lgkmcnt(13)
 ds_read_b64_tr_b16 a[130:131], v5 offset:34816
 v_mfma_f32_16x16x32_bf16 v[96:99], a[112:115], a[72:75], v[96:99]
 s_add_u32 m0, s44, 102400
 s_add_u32 s40, s93, 65536
 buffer_load_dwordx4 v9, s[8:11], s40 offen lds
 v_mfma_f32_16x16x32_bf16 v[96:99], a[116:119], a[76:79], v[96:99]
 s_waitcnt lgkmcnt(12)
 ds_read_b64_tr_b16 a[132:133], v5 offset:49152
 v_mfma_f32_16x16x32_bf16 v[128:131], a[112:115], a[80:83], v[128:131]
 s_add_u32 m0, s44, 106496
 s_add_u32 s40, s93, 131072
 buffer_load_dwordx4 v9, s[8:11], s40 offen lds
 v_mfma_f32_16x16x32_bf16 v[128:131], a[116:119], a[84:87], v[128:131]
 s_waitcnt lgkmcnt(11)
 ds_read_b64_tr_b16 a[134:135], v5 offset:51200
 v_mfma_f32_16x16x32_bf16 v[160:163], a[112:115], a[88:91], v[160:163]
 s_add_u32 m0, s44, 110592
 s_add_u32 s40, s93, 196608
 buffer_load_dwordx4 v9, s[8:11], s40 offen lds
 v_mfma_f32_16x16x32_bf16 v[160:163], a[116:119], a[92:95], v[160:163]
 s_waitcnt lgkmcnt(10)
 s_add_u32 m0, s44, 114688
 s_add_u32 s40, s93, 262144
 buffer_load_dwordx4 v9, s[8:11], s40 offen lds
 v_mfma_f32_16x16x32_bf16 v[192:195], a[112:115], a[96:99], v[192:195]
 s_add_u32 m0, s44, 118784
 s_add_u32 s40, s93, 327680
 buffer_load_dwordx4 v9, s[8:11], s40 offen lds
 v_mfma_f32_16x16x32_bf16 v[192:195], a[116:119], a[100:103], v[192:195]
 s_waitcnt lgkmcnt(8)
 s_add_u32 m0, s44, 122880
 s_add_u32 s40, s93, 393216
 buffer_load_dwordx4 v9, s[8:11], s40 offen lds
 v_mfma_f32_16x16x32_bf16 v[224:227], a[112:115], a[104:107], v[224:227]
 s_add_u32 m0, s44, 126976
 s_add_u32 s40, s93, 458752
 buffer_load_dwordx4 v9, s[8:11], s40 offen lds
 v_mfma_f32_16x16x32_bf16 v[224:227], a[116:119], a[108:111], v[224:227]
 s_waitcnt lgkmcnt(4)
 v_mfma_f32_16x16x32_bf16 v[36:39], a[120:123], a[56:59], v[36:39]
 s_add_u32 s94, s94, 1
 v_mfma_f32_16x16x32_bf16 v[36:39], a[124:127], a[60:63], v[36:39]
 s_cmp_eq_u32 s94, 10
 s_cselect_b32 s94, 0, s94
 ds_read_b64_tr_b16 a[136:137], v5 offset:32776
 v_mfma_f32_16x16x32_bf16 v[68:71], a[120:123], a[64:67], v[68:71]
 s_lshl_b32 s92, s94, 7
 s_lshl_b32 s93, s94, 19
 s_add_u32 m0, s45, 0
 s_xor_b32 s40, s101, 0
 buffer_load_dwordx4 v22, s[12:15], s40 offen nt lds
 v_mfma_f32_16x16x32_bf16 v[68:71], a[124:127], a[68:71], v[68:71]
 ds_read_b64_tr_b16 a[138:139], v5 offset:34824
 v_mfma_f32_16x16x32_bf16 v[100:103], a[120:123], a[72:75], v[100:103]
 v_mfma_f32_16x16x32_bf16 v[100:103], a[124:127], a[76:79], v[100:103]
 ds_read_b64_tr_b16 a[140:141], v5 offset:49160
 v_mfma_f32_16x16x32_bf16 v[132:135], a[120:123], a[80:83], v[132:135]
 v_mfma_f32_16x16x32_bf16 v[132:135], a[124:127], a[84:87], v[132:135]
 ds_read_b64_tr_b16 a[142:143], v5 offset:51208
 v_mfma_f32_16x16x32_bf16 v[164:167], a[120:123], a[88:91], v[164:167]
 buffer_load_dwordx4 v23, s[12:15], s40 offen offset:2048 nt lds
 v_mfma_f32_16x16x32_bf16 v[164:167], a[124:127], a[92:95], v[164:167]
 s_add_u32 m0, s45, 4096
 v_mfma_f32_16x16x32_bf16 v[196:199], a[120:123], a[96:99], v[196:199]
 s_xor_b32 s40, s101, 16384
 v_mfma_f32_16x16x32_bf16 v[196:199], a[124:127], a[100:103], v[196:199]
 v_mfma_f32_16x16x32_bf16 v[228:231], a[120:123], a[104:107], v[228:231]
 v_mfma_f32_16x16x32_bf16 v[228:231], a[124:127], a[108:111], v[228:231]
 s_waitcnt lgkmcnt(4)
 buffer_load_dwordx4 v22, s[12:15], s40 offen nt lds
 v_mfma_f32_16x16x32_bf16 v[40:43], a[128:131], a[56:59], v[40:43]
 v_mfma_f32_16x16x32_bf16 v[40:43], a[132:135], a[60:63], v[40:43]
 ds_read_b64_tr_b16 a[112:113], v6 offset:32768
 v_mfma_f32_16x16x32_bf16 v[72:75], a[128:131], a[64:67], v[72:75]
 v_mfma_f32_16x16x32_bf16 v[72:75], a[132:135], a[68:71], v[72:75]
 ds_read_b64_tr_b16 a[114:115], v6 offset:34816
 v_mfma_f32_16x16x32_bf16 v[104:107], a[128:131], a[72:75], v[104:107]
 v_mfma_f32_16x16x32_bf16 v[104:107], a[132:135], a[76:79], v[104:107]
 ds_read_b64_tr_b16 a[116:117], v6 offset:49152
 v_mfma_f32_16x16x32_bf16 v[136:139], a[128:131], a[80:83], v[136:139]
 buffer_load_dwordx4 v23, s[12:15], s40 offen offset:2048 nt lds
 v_mfma_f32_16x16x32_bf16 v[136:139], a[132:135], a[84:87], v[136:139]
 s_add_u32 m0, s45, 8192
 ds_read_b64_tr_b16 a[118:119], v6 offset:51200
 v_mfma_f32_16x16x32_bf16 v[168:171], a[128:131], a[88:91], v[168:171]
 s_xor_b32 s40, s101, 1024
 v_mfma_f32_16x16x32_bf16 v[168:171], a[132:135], a[92:95], v[168:171]
 v_mfma_f32_16x16x32_bf16 v[200:203], a[128:131], a[96:99], v[200:203]
 v_mfma_f32_16x16x32_bf16 v[200:203], a[132:135], a[100:103], v[200:203]
 v_mfma_f32_16x16x32_bf16 v[232:235], a[128:131], a[104:107], v[232:235]
 buffer_load_dwordx4 v22, s[12:15], s40 offen nt lds
 v_mfma_f32_16x16x32_bf16 v[232:235], a[132:135], a[108:111], v[232:235]
 s_waitcnt lgkmcnt(4)
 v_mfma_f32_16x16x32_bf16 v[44:47], a[136:139], a[56:59], v[44:47]
 v_mfma_f32_16x16x32_bf16 v[44:47], a[140:143], a[60:63], v[44:47]
 ds_read_b64_tr_b16 a[120:121], v6 offset:32776
 v_mfma_f32_16x16x32_bf16 v[76:79], a[136:139], a[64:67], v[76:79]
 v_mfma_f32_16x16x32_bf16 v[76:79], a[140:143], a[68:71], v[76:79]
 ds_read_b64_tr_b16 a[122:123], v6 offset:34824
 v_mfma_f32_16x16x32_bf16 v[108:111], a[136:139], a[72:75], v[108:111]
 v_mfma_f32_16x16x32_bf16 v[108:111], a[140:143], a[76:79], v[108:111]
 ds_read_b64_tr_b16 a[124:125], v6 offset:49160
 v_mfma_f32_16x16x32_bf16 v[140:143], a[136:139], a[80:83], v[140:143]
 buffer_load_dwordx4 v23, s[12:15], s40 offen offset:2048 nt lds
 v_mfma_f32_16x16x32_bf16 v[140:143], a[140:143], a[84:87], v[140:143]
 s_branch SK2349
C1_3:
PG2349:
 s_branch PG4670
SK2349:
 s_add_u32 m0, s45, 12288
 ds_read_b64_tr_b16 a[126:127], v6 offset:51208
 v_mfma_f32_16x16x32_bf16 v[172:175], a[136:139], a[88:91], v[172:175]
 s_xor_b32 s40, s101, 17408
 v_mfma_f32_16x16x32_bf16 v[172:175], a[140:143], a[92:95], v[172:175]
 v_mfma_f32_16x16x32_bf16 v[204:207], a[136:139], a[96:99], v[204:207]
 v_mfma_f32_16x16x32_bf16 v[204:207], a[140:143], a[100:103], v[204:207]
 buffer_load_dwordx4 v22, s[12:15], s40 offen nt lds
 v_mfma_f32_16x16x32_bf16 v[236:239], a[136:139], a[104:107], v[236:239]
 v_mfma_f32_16x16x32_bf16 v[236:239], a[140:143], a[108:111], v[236:239]
 s_waitcnt lgkmcnt(4)
 v_mfma_f32_16x16x32_bf16 v[48:51], a[112:115], a[56:59], v[48:51]
 v_mfma_f32_16x16x32_bf16 v[48:51], a[116:119], a[60:63], v[48:51]
 ds_read_b64_tr_b16 a[128:129], v7 offset:32768
 v_mfma_f32_16x16x32_bf16 v[80:83], a[112:115], a[64:67], v[80:83]
 v_mfma_f32_16x16x32_bf16 v[80:83], a[116:119], a[68:71], v[80:83]
 ds_read_b64_tr_b16 a[130:131], v7 offset:34816
 v_mfma_f32_16x16x32_bf16 v[112:115], a[112:115], a[72:75], v[112:115]
 buffer_load_dwordx4 v23, s[12:15], s40 offen offset:2048 nt lds
 v_mfma_f32_16x16x32_bf16 v[112:115], a[116:119], a[76:79], v[112:115]
 s_add_u32 m0, s44, 69632
 ds_read_b64_tr_b16 a[132:133], v7 offset:49152
 v_mfma_f32_16x16x32_bf16 v[144:147], a[112:115], a[80:83], v[144:147]
 s_add_u32 s40, s92, 0
 v_mfma_f32_16x16x32_bf16 v[144:147], a[116:119], a[84:87], v[144:147]
 ds_read_b64_tr_b16 a[134:135], v7 offset:51200
 v_mfma_f32_16x16x32_bf16 v[176:179], a[112:115], a[88:91], v[176:179]
 v_mfma_f32_16x16x32_bf16 v[176:179], a[116:119], a[92:95], v[176:179]
 v_mfma_f32_16x16x32_bf16 v[208:211], a[112:115], a[96:99], v[208:211]
 v_mfma_f32_16x16x32_bf16 v[208:211], a[116:119], a[100:103], v[208:211]
 v_mfma_f32_16x16x32_bf16 v[240:243], a[112:115], a[104:107], v[240:243]
 v_mfma_f32_16x16x32_bf16 v[240:243], a[116:119], a[108:111], v[240:243]
 s_waitcnt lgkmcnt(4)
 v_mfma_f32_16x16x32_bf16 v[52:55], a[120:123], a[56:59], v[52:55]
 v_mfma_f32_16x16x32_bf16 v[52:55], a[124:127], a[60:63], v[52:55]
 ds_read_b64_tr_b16 a[136:137], v7 offset:32776
 v_mfma_f32_16x16x32_bf16 v[84:87], a[120:123], a[64:67], v[84:87]
 v_mfma_f32_16x16x32_bf16 v[84:87], a[124:127], a[68:71], v[84:87]
 ds_read_b64_tr_b16 a[138:139], v7 offset:34824
 v_mfma_f32_16x16x32_bf16 v[116:119], a[120:123], a[72:75], v[116:119]
 v_mfma_f32_16x16x32_bf16 v[116:119], a[124:127], a[76:79], v[116:119]
 ds_read_b64_tr_b16 a[140:141], v7 offset:49160
 v_mfma_f32_16x16x32_bf16 v[148:151], a[120:123], a[80:83], v[148:151]
 v_mfma_f32_16x16x32_bf16 v[148:151], a[124:127], a[84:87], v[148:151]
 ds_read_b64_tr_b16 a[142:143], v7 offset:51208
 v_mfma_f32_16x16x32_bf16 v[180:183], a[120:123], a[88:91], v[180:183]
 v_mfma_f32_16x16x32_bf16 v[180:183], a[124:127], a[92:95], v[180:183]
 v_mfma_f32_16x16x32_bf16 v[212:215], a[120:123], a[96:99], v[212:215]
 v_mfma_f32_16x16x32_bf16 v[212:215], a[124:127], a[100:103], v[212:215]
 v_mfma_f32_16x16x32_bf16 v[244:247], a[120:123], a[104:107], v[244:247]
 v_mfma_f32_16x16x32_bf16 v[244:247], a[124:127], a[108:111], v[244:247]
 s_waitcnt vmcnt(8) lgkmcnt(0)
 s_barrier
 v_mfma_f32_16x16x32_bf16 v[56:59], a[128:131], a[56:59], v[56:59]
 buffer_load_dwordx4 v8, s[4:7], s40 offen lds
 v_mfma_f32_16x16x32_bf16 v[56:59], a[132:135], a[60:63], v[56:59]
 s_add_u32 m0, s44, 73728
 ds_read_b64_tr_b16 a[112:113], v4 offset:0
 v_mfma_f32_16x16x32_bf16 v[88:91], a[128:131], a[64:67], v[88:91]
 s_add_u32 s40, s92, 40960
 ds_read_b64_tr_b16 a[114:115], v4 offset:2048
 v_mfma_f32_16x16x32_bf16 v[88:91], a[132:135], a[68:71], v[88:91]
 ds_read_b64_tr_b16 a[116:117], v4 offset:16384
 v_mfma_f32_16x16x32_bf16 v[120:123], a[128:131], a[72:75], v[120:123]
 ds_read_b64_tr_b16 a[118:119], v4 offset:18432
 v_mfma_f32_16x16x32_bf16 v[120:123], a[132:135], a[76:79], v[120:123]
 buffer_load_dwordx4 v8, s[4:7], s40 offen lds
 v_mfma_f32_16x16x32_bf16 v[152:155], a[128:131], a[80:83], v[152:155]
 s_add_u32 m0, s44, 77824
 ds_read_b128 a[0:3], v2 offset:0
 v_mfma_f32_16x16x32_bf16 v[152:155], a[132:135], a[84:87], v[152:155]
 s_add_u32 s40, s92, 81920
 ds_read_b128 a[4:7], v3 offset:0
 v_mfma_f32_16x16x32_bf16 v[184:187], a[128:131], a[88:91], v[184:187]
 ds_read_b128 a[8:11], v2 offset:2048
 v_mfma_f32_16x16x32_bf16 v[184:187], a[132:135], a[92:95], v[184:187]
 ds_read_b128 a[12:15], v3 offset:2048
 v_mfma_f32_16x16x32_bf16 v[216:219], a[128:131], a[96:99], v[216:219]
 buffer_load_dwordx4 v8, s[4:7], s40 offen lds
 v_mfma_f32_16x16x32_bf16 v[216:219], a[132:135], a[100:103], v[216:219]
 s_add_u32 m0, s44, 81920
 ds_read_b128 a[16:19], v2 offset:4096
 v_mfma_f32_16x16x32_bf16 v[248:251], a[128:131], a[104:107], v[248:251]
 s_add_u32 s40, s92, 122880
 ds_read_b128 a[20:23], v3 offset:4096
 v_mfma_f32_16x16x32_bf16 v[248:251], a[132:135], a[108:111], v[248:251]
 s_waitcnt lgkmcnt(10)
 ds_read_b128 a[24:27], v2 offset:6144
 v_mfma_f32_16x16x32_bf16 v[60:63], a[136:139], a[56:59], v[60:63]
 ds_read_b128 a[28:31], v3 offset:6144
 v_mfma_f32_16x16x32_bf16 v[60:63], a[140:143], a[60:63], v[60:63]
 buffer_load_dwordx4 v8, s[4:7], s40 offen lds
 v_mfma_f32_16x16x32_bf16 v[92:95], a[136:139], a[64:67], v[92:95]
 s_add_u32 m0, s44, 86016
 ds_read_b128 a[32:35], v2 offset:8192
 v_mfma_f32_16x16x32_bf16 v[92:95], a[140:143], a[68:71], v[92:95]
 s_add_u32 s40, s92, 163840
 ds_read_b128 a[36:39], v3 offset:8192
 v_mfma_f32_16x16x32_bf16 v[124:127], a[136:139], a[72:75], v[124:127]
 ds_read_b128 a[40:43], v2 offset:10240
 v_mfma_f32_16x16x32_bf16 v[124:127], a[140:143], a[76:79], v[124:127]
 ds_read_b128 a[44:47], v3 offset:10240
 v_mfma_f32_16x16x32_bf16 v[156:159], a[136:139], a[80:83], v[156:159]
 buffer_load_dwordx4 v8, s[4:7], s40 offen lds
 v_mfma_f32_16x16x32_bf16 v[156:159], a[140:143], a[84:87], v[156:159]
 s_add_u32 m0, s44, 90112
 ds_read_b128 a[48:51], v2 offset:12288
 v_mfma_f32_16x16x32_bf16 v[188:191], a[136:139], a[88:91], v[188:191]
 s_add_u32 s40, s92, 204800
 ds_read_b128 a[52:55], v3 offset:12288
 v_mfma_f32_16x16x32_bf16 v[188:191], a[140:143], a[92:95], v[188:191]
 ds_read_b64_tr_b16 a[120:121], v4 offset:8
 v_mfma_f32_16x16x32_bf16 v[220:223], a[136:139], a[96:99], v[220:223]
 ds_read_b64_tr_b16 a[122:123], v4 offset:2056
 v_mfma_f32_16x16x32_bf16 v[220:223], a[140:143], a[100:103], v[220:223]
 buffer_load_dwordx4 v8, s[4:7], s40 offen lds
 v_mfma_f32_16x16x32_bf16 v[252:255], a[136:139], a[104:107], v[252:255]
 s_add_u32 m0, s44, 94208
 ds_read_b64_tr_b16 a[124:125], v4 offset:16392
 v_mfma_f32_16x16x32_bf16 v[252:255], a[140:143], a[108:111], v[252:255]
 s_waitcnt lgkmcnt(15)
 ds_read_b64_tr_b16 a[126:127], v4 offset:18440
 v_mfma_f32_16x16x32_bf16 v[32:35], a[112:115], a[0:3], v[32:35]
 s_add_u32 s40, s92, 245760
 buffer_load_dwordx4 v8, s[4:7], s40 offen lds
 v_mfma_f32_16x16x32_bf16 v[32:35], a[116:119], a[4:7], v[32:35]
 s_waitcnt lgkmcnt(14)
 ds_read_b64_tr_b16 a[128:129], v5 offset:0
 v_mfma_f32_16x16x32_bf16 v[64:67], a[112:115], a[8:11], v[64:67]
 s_add_u32 m0, s44, 131072
 s_add_u32 s40, s93, 0
 buffer_load_dwordx4 v9, s[8:11], s40 offen lds
 v_mfma_f32_16x16x32_bf16 v[64:67], a[116:119], a[12:15], v[64:67]
 s_waitcnt lgkmcnt(13)
 ds_read_b64_tr_b16 a[130:131], v5 offset:2048
 v_mfma_f32_16x16x32_bf16 v[96:99], a[112:115], a[16:19], v[96:99]
 s_add_u32 m0, s44, 135168
 s_add_u32 s40, s93, 65536
 buffer_load_dwordx4 v9, s[8:11], s40 offen lds
 v_mfma_f32_16x16x32_bf16 v[96:99], a[116:119], a[20:23], v[96:99]
 s_waitcnt lgkmcnt(12)
 ds_read_b64_tr_b16 a[132:133], v5 offset:16384
 v_mfma_f32_16x16x32_bf16 v[128:131], a[112:115], a[24:27], v[128:131]
 s_add_u32 m0, s44, 139264
 s_add_u32 s40, s93, 131072
 buffer_load_dwordx4 v9, s[8:11], s40 offen lds
 v_mfma_f32_16x16x32_bf16 v[128:131], a[116:119], a[28:31], v[128:131]
 s_waitcnt lgkmcnt(11)
 ds_read_b64_tr_b16 a[134:135], v5 offset:18432
 v_mfma_f32_16x16x32_bf16 v[160:163], a[112:115], a[32:35], v[160:163]
 s_add_u32 m0, s44, 143360
 s_add_u32 s40, s93, 196608
 buffer_load_dwordx4 v9, s[8:11], s40 offen lds
 v_mfma_f32_16x16x32_bf16 v[160:163], a[116:119], a[36:39], v[160:163]
 s_waitcnt lgkmcnt(10)
 s_add_u32 m0, s44, 147456
 s_add_u32 s40, s93, 262144
 buffer_load_dwordx4 v9, s[8:11], s40 offen lds
 v_mfma_f32_16x16x32_bf16 v[192:195], a[112:115], a[40:43], v[192:195]
 s_add_u32 m0, s44, 151552
 s_add_u32 s40, s93, 327680
 buffer_load_dwordx4 v9, s[8:11], s40 offen lds
 v_mfma_f32_16x16x32_bf16 v[192:195], a[116:119], a[44:47], v[192:195]
 s_waitcnt lgkmcnt(8)
 s_add_u32 m0, s44, 155648
 s_add_u32 s40, s93, 393216
 buffer_load_dwordx4 v9, s[8:11], s40 offen lds
 v_mfma_f32_16x16x32_bf16 v[224:227], a[112:115], a[48:51], v[224:227]
 s_add_u32 m0, s44, 159744
 s_add_u32 s40, s93, 458752
 buffer_load_dwordx4 v9, s[8:11], s40 offen lds
 v_mfma_f32_16x16x32_bf16 v[224:227], a[116:119], a[52:55], v[224:227]
 s_waitcnt lgkmcnt(4)
 v_mfma_f32_16x16x32_bf16 v[36:39], a[120:123], a[0:3], v[36:39]
 s_add_u32 s94, s94, 1
 v_mfma_f32_16x16x32_bf16 v[36:39], a[124:127], a[4:7], v[36:39]
 s_cmp_eq_u32 s94, 10
 s_cselect_b32 s94, 0, s94
 ds_read_b64_tr_b16 a[136:137], v5 offset:8
 v_mfma_f32_16x16x32_bf16 v[68:71], a[120:123], a[8:11], v[68:71]
 s_mov_b32 s41, 0
 buffer_store_dwordx4 a[208:211], v0, s[28:31], s41 offen sc1
 v_mfma_f32_16x16x32_bf16 v[68:71], a[124:127], a[12:15], v[68:71]
 s_lshl_b32 s92, s94, 7
 ds_read_b64_tr_b16 a[138:139], v5 offset:2056
 v_mfma_f32_16x16x32_bf16 v[100:103], a[120:123], a[16:19], v[100:103]
 s_lshl_b32 s93, s94, 19
 v_mfma_f32_16x16x32_bf16 v[100:103], a[124:127], a[20:23], v[100:103]
 s_add_u32 m0, s45, 131072
 ds_read_b64_tr_b16 a[140:141], v5 offset:16392
 v_mfma_f32_16x16x32_bf16 v[132:135], a[120:123], a[24:27], v[132:135]
 s_xor_b32 s40, s101, 4096
 v_mfma_f32_16x16x32_bf16 v[132:135], a[124:127], a[28:31], v[132:135]
 ds_read_b64_tr_b16 a[142:143], v5 offset:18440
 v_mfma_f32_16x16x32_bf16 v[164:167], a[120:123], a[32:35], v[164:167]
 v_mfma_f32_16x16x32_bf16 v[164:167], a[124:127], a[36:39], v[164:167]
 v_mfma_f32_16x16x32_bf16 v[196:199], a[120:123], a[40:43], v[196:199]
 v_mfma_f32_16x16x32_bf16 v[196:199], a[124:127], a[44:47], v[196:199]
 v_mfma_f32_16x16x32_bf16 v[228:231], a[120:123], a[48:51], v[228:231]
 s_mov_b32 s41, 1024
 buffer_store_dwordx4 a[212:215], v0, s[28:31], s41 offen sc1
 v_mfma_f32_16x16x32_bf16 v[228:231], a[124:127], a[52:55], v[228:231]
 s_waitcnt lgkmcnt(4)
 v_mfma_f32_16x16x32_bf16 v[40:43], a[128:131], a[0:3], v[40:43]
 v_mfma_f32_16x16x32_bf16 v[40:43], a[132:135], a[4:7], v[40:43]
 ds_read_b64_tr_b16 a[112:113], v6 offset:0
 v_mfma_f32_16x16x32_bf16 v[72:75], a[128:131], a[8:11], v[72:75]
 v_mfma_f32_16x16x32_bf16 v[72:75], a[132:135], a[12:15], v[72:75]
 ds_read_b64_tr_b16 a[114:115], v6 offset:2048
 v_mfma_f32_16x16x32_bf16 v[104:107], a[128:131], a[16:19], v[104:107]
 v_mfma_f32_16x16x32_bf16 v[104:107], a[132:135], a[20:23], v[104:107]
 ds_read_b64_tr_b16 a[116:117], v6 offset:16384
 v_mfma_f32_16x16x32_bf16 v[136:139], a[128:131], a[24:27], v[136:139]
 v_mfma_f32_16x16x32_bf16 v[136:139], a[132:135], a[28:31], v[136:139]
 ds_read_b64_tr_b16 a[118:119], v6 offset:18432
 v_mfma_f32_16x16x32_bf16 v[168:171], a[128:131], a[32:35], v[168:171]
 s_mov_b32 s41, 2048
 buffer_store_dwordx4 a[216:219], v0, s[28:31], s41 offen sc1
 v_mfma_f32_16x16x32_bf16 v[168:171], a[132:135], a[36:39], v[168:171]
 v_mfma_f32_16x16x32_bf16 v[200:203], a[128:131], a[40:43], v[200:203]
 v_mfma_f32_16x16x32_bf16 v[200:203], a[132:135], a[44:47], v[200:203]
 v_mfma_f32_16x16x32_bf16 v[232:235], a[128:131], a[48:51], v[232:235]
 v_mfma_f32_16x16x32_bf16 v[232:235], a[132:135], a[52:55], v[232:235]
 s_waitcnt lgkmcnt(4)
 v_mfma_f32_16x16x32_bf16 v[44:47], a[136:139], a[0:3], v[44:47]
 v_mfma_f32_16x16x32_bf16 v[44:47], a[140:143], a[4:7], v[44:47]
 ds_read_b64_tr_b16 a[120:121], v6 offset:8
 v_mfma_f32_16x16x32_bf16 v[76:79], a[136:139], a[8:11], v[76:79]
 v_mfma_f32_16x16x32_bf16 v[76:79], a[140:143], a[12:15], v[76:79]
 ds_read_b64_tr_b16 a[122:123], v6 offset:2056
 v_mfma_f32_16x16x32_bf16 v[108:111], a[136:139], a[16:19], v[108:111]
 s_xor_b32 s88, s101, 2048
 buffer_load_dwordx4 a[208:211], v24, s[16:19], s88 offen nt
 v_mfma_f32_16x16x32_bf16 v[108:111], a[140:143], a[20:23], v[108:111]
 ds_read_b64_tr_b16 a[124:125], v6 offset:16392
 v_mfma_f32_16x16x32_bf16 v[140:143], a[136:139], a[24:27], v[140:143]
 v_mfma_f32_16x16x32_bf16 v[140:143], a[140:143], a[28:31], v[140:143]
 ds_read_b64_tr_b16 a[126:127], v6 offset:18440
 v_mfma_f32_16x16x32_bf16 v[172:175], a[136:139], a[32:35], v[172:175]
 v_mfma_f32_16x16x32_bf16 v[172:175], a[140:143], a[36:39], v[172:175]
 v_mfma_f32_16x16x32_bf16 v[204:207], a[136:139], a[40:43], v[204:207]
 v_mfma_f32_16x16x32_bf16 v[204:207], a[140:143], a[44:47], v[204:207]
 v_mfma_f32_16x16x32_bf16 v[236:239], a[136:139], a[48:51], v[236:239]
 v_mfma_f32_16x16x32_bf16 v[236:239], a[140:143], a[52:55], v[236:239]
 s_waitcnt lgkmcnt(4)
 v_mfma_f32_16x16x32_bf16 v[48:51], a[112:115], a[0:3], v[48:51]
 s_mov_b32 s41, 3072
 buffer_store_dwordx4 a[220:223], v0, s[28:31], s41 offen sc1
 v_mfma_f32_16x16x32_bf16 v[48:51], a[116:119], a[4:7], v[48:51]
 ds_read_b64_tr_b16 a[128:129], v7 offset:0
 v_mfma_f32_16x16x32_bf16 v[80:83], a[112:115], a[8:11], v[80:83]
 v_mfma_f32_16x16x32_bf16 v[80:83], a[116:119], a[12:15], v[80:83]
 ds_read_b64_tr_b16 a[130:131], v7 offset:2048
 v_mfma_f32_16x16x32_bf16 v[112:115], a[112:115], a[16:19], v[112:115]
 v_mfma_f32_16x16x32_bf16 v[112:115], a[116:119], a[20:23], v[112:115]
 ds_read_b64_tr_b16 a[132:133], v7 offset:16384
 v_mfma_f32_16x16x32_bf16 v[144:147], a[112:115], a[24:27], v[144:147]
 v_mfma_f32_16x16x32_bf16 v[144:147], a[116:119], a[28:31], v[144:147]
 ds_read_b64_tr_b16 a[134:135], v7 offset:18432
 v_mfma_f32_16x16x32_bf16 v[176:179], a[112:115], a[32:35], v[176:179]
 v_mfma_f32_16x16x32_bf16 v[176:179], a[116:119], a[36:39], v[176:179]
 v_mfma_f32_16x16x32_bf16 v[208:211], a[112:115], a[40:43], v[208:211]
 s_xor_b32 s88, s101, 67584
 buffer_load_dwordx4 a[212:215], v24, s[16:19], s88 offen nt
 v_mfma_f32_16x16x32_bf16 v[208:211], a[116:119], a[44:47], v[208:211]
 v_mfma_f32_16x16x32_bf16 v[240:243], a[112:115], a[48:51], v[240:243]
 v_mfma_f32_16x16x32_bf16 v[240:243], a[116:119], a[52:55], v[240:243]
 s_waitcnt lgkmcnt(4)
 v_mfma_f32_16x16x32_bf16 v[52:55], a[120:123], a[0:3], v[52:55]
 v_mfma_f32_16x16x32_bf16 v[52:55], a[124:127], a[4:7], v[52:55]
 ds_read_b64_tr_b16 a[136:137], v7 offset:8
 v_mfma_f32_16x16x32_bf16 v[84:87], a[120:123], a[8:11], v[84:87]
 v_mfma_f32_16x16x32_bf16 v[84:87], a[124:127], a[12:15], v[84:87]
 ds_read_b64_tr_b16 a[138:139], v7 offset:2056
 v_mfma_f32_16x16x32_bf16 v[116:119], a[120:123], a[16:19], v[116:119]
 v_mfma_f32_16x16x32_bf16 v[116:119], a[124:127], a[20:23], v[116:119]
 ds_read_b64_tr_b16 a[140:141], v7 offset:16392
 v_mfma_f32_16x16x32_bf16 v[148:151], a[120:123], a[24:27], v[148:151]
 s_mov_b32 s41, 4096
 buffer_store_dwordx4 a[224:227], v0, s[28:31], s41 offen sc1
 v_mfma_f32_16x16x32_bf16 v[148:151], a[124:127], a[28:31], v[148:151]
 ds_read_b64_tr_b16 a[142:143], v7 offset:18440
 v_mfma_f32_16x16x32_bf16 v[180:183], a[120:123], a[32:35], v[180:183]
 v_mfma_f32_16x16x32_bf16 v[180:183], a[124:127], a[36:39], v[180:183]
 v_mfma_f32_16x16x32_bf16 v[212:215], a[120:123], a[40:43], v[212:215]
 v_mfma_f32_16x16x32_bf16 v[212:215], a[124:127], a[44:47], v[212:215]
 v_mfma_f32_16x16x32_bf16 v[244:247], a[120:123], a[48:51], v[244:247]
 v_mfma_f32_16x16x32_bf16 v[244:247], a[124:127], a[52:55], v[244:247]
 s_waitcnt vmcnt(7) lgkmcnt(0)
 s_barrier
 v_mfma_f32_16x16x32_bf16 v[56:59], a[128:131], a[0:3], v[56:59]
 v_mfma_f32_16x16x32_bf16 v[56:59], a[132:135], a[4:7], v[56:59]
 ds_read_b64_tr_b16 a[112:113], v4 offset:32768
 v_mfma_f32_16x16x32_bf16 v[88:91], a[128:131], a[8:11], v[88:91]
 ds_read_b64_tr_b16 a[114:115], v4 offset:34816
 v_mfma_f32_16x16x32_bf16 v[88:91], a[132:135], a[12:15], v[88:91]
 ds_read_b64_tr_b16 a[116:117], v4 offset:49152
 v_mfma_f32_16x16x32_bf16 v[120:123], a[128:131], a[16:19], v[120:123]
 ds_read_b64_tr_b16 a[118:119], v4 offset:51200
 v_mfma_f32_16x16x32_bf16 v[120:123], a[132:135], a[20:23], v[120:123]
 s_xor_b32 s88, s101, 18432
 buffer_load_dwordx4 a[216:219], v24, s[16:19], s88 offen nt
 v_mfma_f32_16x16x32_bf16 v[152:155], a[128:131], a[24:27], v[152:155]
 ds_read_b128 a[56:59], v2 offset:28672
 v_mfma_f32_16x16x32_bf16 v[152:155], a[132:135], a[28:31], v[152:155]
 ds_read_b128 a[60:63], v3 offset:28672
 v_mfma_f32_16x16x32_bf16 v[184:187], a[128:131], a[32:35], v[184:187]
 ds_read_b128 a[64:67], v2 offset:30720
 v_mfma_f32_16x16x32_bf16 v[184:187], a[132:135], a[36:39], v[184:187]
 ds_read_b128 a[68:71], v3 offset:30720
 v_mfma_f32_16x16x32_bf16 v[216:219], a[128:131], a[40:43], v[216:219]
 v_mfma_f32_16x16x32_bf16 v[216:219], a[132:135], a[44:47], v[216:219]
 ds_read_b128 a[72:75], v2 offset:32768
 v_mfma_f32_16x16x32_bf16 v[248:251], a[128:131], a[48:51], v[248:251]
 ds_read_b128 a[76:79], v3 offset:32768
 v_mfma_f32_16x16x32_bf16 v[248:251], a[132:135], a[52:55], v[248:251]
 s_waitcnt lgkmcnt(10)
 ds_read_b128 a[80:83], v2 offset:34816
 v_mfma_f32_16x16x32_bf16 v[60:63], a[136:139], a[0:3], v[60:63]
 ds_read_b128 a[84:87], v3 offset:34816
 v_mfma_f32_16x16x32_bf16 v[60:63], a[140:143], a[4:7], v[60:63]
 s_mov_b32 s41, 655360
 buffer_store_dwordx4 a[228:231], v0, s[28:31], s41 offen sc1
 v_mfma_f32_16x16x32_bf16 v[92:95], a[136:139], a[8:11], v[92:95]
 ds_read_b128 a[88:91], v2 offset:36864
 v_mfma_f32_16x16x32_bf16 v[92:95], a[140:143], a[12:15], v[92:95]
 ds_read_b128 a[92:95], v3 offset:36864
 v_mfma_f32_16x16x32_bf16 v[124:127], a[136:139], a[16:19], v[124:127]
 ds_read_b128 a[96:99], v2 offset:38912
 v_mfma_f32_16x16x32_bf16 v[124:127], a[140:143], a[20:23], v[124:127]
 ds_read_b128 a[100:103], v3 offset:38912
 v_mfma_f32_16x16x32_bf16 v[156:159], a[136:139], a[24:27], v[156:159]
 v_mfma_f32_16x16x32_bf16 v[156:159], a[140:143], a[28:31], v[156:159]
 ds_read_b128 a[104:107], v2 offset:40960
 v_mfma_f32_16x16x32_bf16 v[188:191], a[136:139], a[32:35], v[188:191]
 ds_read_b128 a[108:111], v3 offset:40960
 v_mfma_f32_16x16x32_bf16 v[188:191], a[140:143], a[36:39], v[188:191]
 ds_read_b64_tr_b16 a[120:121], v4 offset:32776
 v_mfma_f32_16x16x32_bf16 v[220:223], a[136:139], a[40:43], v[220:223]
 ds_read_b64_tr_b16 a[122:123], v4 offset:34824
 v_mfma_f32_16x16x32_bf16 v[220:223], a[140:143], a[44:47], v[220:223]
 s_xor_b32 s88, s101, 83968
 buffer_load_dwordx4 a[220:223], v24, s[16:19], s88 offen nt
 v_mfma_f32_16x16x32_bf16 v[252:255], a[136:139], a[48:51], v[252:255]
 ds_read_b64_tr_b16 a[124:125], v4 offset:49160
 v_mfma_f32_16x16x32_bf16 v[252:255], a[140:143], a[52:55], v[252:255]
 s_waitcnt lgkmcnt(15)
 ds_read_b64_tr_b16 a[126:127], v4 offset:51208
 v_mfma_f32_16x16x32_bf16 v[32:35], a[112:115], a[56:59], v[32:35]
 v_mfma_f32_16x16x32_bf16 v[32:35], a[116:119], a[60:63], v[32:35]
 s_waitcnt lgkmcnt(14)
 ds_read_b64_tr_b16 a[128:129], v5 offset:32768
 v_mfma_f32_16x16x32_bf16 v[64:67], a[112:115], a[64:67], v[64:67]
 s_mov_b32 s41, 656384
 buffer_store_dwordx4 a[232:235], v0, s[28:31], s41 offen sc1
 v_mfma_f32_16x16x32_bf16 v[64:67], a[116:119], a[68:71], v[64:67]
 s_waitcnt lgkmcnt(13)
 ds_read_b64_tr_b16 a[130:131], v5 offset:34816
 v_mfma_f32_16x16x32_bf16 v[96:99], a[112:115], a[72:75], v[96:99]
 v_mfma_f32_16x16x32_bf16 v[96:99], a[116:119], a[76:79], v[96:99]
 s_waitcnt lgkmcnt(12)
 ds_read_b64_tr_b16 a[132:133], v5 offset:49152
 v_mfma_f32_16x16x32_bf16 v[128:131], a[112:115], a[80:83], v[128:131]
 v_mfma_f32_16x16x32_bf16 v[128:131], a[116:119], a[84:87], v[128:131]
 s_waitcnt lgkmcnt(11)
 ds_read_b64_tr_b16 a[134:135], v5 offset:51200
 v_mfma_f32_16x16x32_bf16 v[160:163], a[112:115], a[88:91], v[160:163]
 s_waitcnt vmcnt(50)
 v_mfma_f32_16x16x32_bf16 v[160:163], a[116:119], a[92:95], v[160:163]
 s_waitcnt lgkmcnt(10)
 ds_write_b128 v27, a[160:163] offset:32768
 v_mfma_f32_16x16x32_bf16 v[192:195], a[112:115], a[96:99], v[192:195]
 ds_write_b128 v27, a[164:167] offset:34816
 v_mfma_f32_16x16x32_bf16 v[192:195], a[116:119], a[100:103], v[192:195]
 s_waitcnt lgkmcnt(10)
 ds_write_b128 v27, a[168:171] offset:36864
 v_mfma_f32_16x16x32_bf16 v[224:227], a[112:115], a[104:107], v[224:227]
 ds_write_b128 v27, a[172:175] offset:38912
 v_mfma_f32_16x16x32_bf16 v[224:227], a[116:119], a[108:111], v[224:227]
 s_waitcnt lgkmcnt(8)
 v_mfma_f32_16x16x32_bf16 v[36:39], a[120:123], a[56:59], v[36:39]
 s_xor_b32 s88, s101, 3072
 buffer_load_dwordx4 a[224:227], v24, s[16:19], s88 offen nt
 v_mfma_f32_16x16x32_bf16 v[36:39], a[124:127], a[60:63], v[36:39]
 ds_read_b64_tr_b16 a[136:137], v5 offset:32776
 v_mfma_f32_16x16x32_bf16 v[68:71], a[120:123], a[64:67], v[68:71]
 v_add_u32 v2, 63488, v24
 v_mfma_f32_16x16x32_bf16 v[68:71], a[124:127], a[68:71], v[68:71]
 ds_read_b64_tr_b16 a[138:139], v5 offset:34824
 v_mfma_f32_16x16x32_bf16 v[100:103], a[120:123], a[72:75], v[100:103]
 v_mfma_f32_16x16x32_bf16 v[100:103], a[124:127], a[76:79], v[100:103]
 ds_read_b64_tr_b16 a[140:141], v5 offset:49160
 v_mfma_f32_16x16x32_bf16 v[132:135], a[120:123], a[80:83], v[132:135]
 v_mfma_f32_16x16x32_bf16 v[132:135], a[124:127], a[84:87], v[132:135]
 ds_read_b64_tr_b16 a[142:143], v5 offset:51208
 v_mfma_f32_16x16x32_bf16 v[164:167], a[120:123], a[88:91], v[164:167]
 v_mfma_f32_16x16x32_bf16 v[164:167], a[124:127], a[92:95], v[164:167]
 ds_write_b128 v26, a[144:147] offset:32768
 v_mul_f32 v32, s42, v32
 v_mfma_f32_16x16x32_bf16 v[196:199], a[120:123], a[96:99], v[196:199]
 ds_write_b128 v26, a[148:151] offset:34816
 v_mul_f32 v33, s42, v33
 v_mfma_f32_16x16x32_bf16 v[196:199], a[124:127], a[100:103], v[196:199]
 ds_write_b128 v26, a[152:155] offset:36864
 v_mul_f32 v34, s42, v34
 v_mfma_f32_16x16x32_bf16 v[228:231], a[120:123], a[104:107], v[228:231]
 ds_write_b128 v26, a[156:159] offset:38912
 v_mul_f32 v35, s42, v35
 v_mfma_f32_16x16x32_bf16 v[228:231], a[124:127], a[108:111], v[228:231]
 s_waitcnt lgkmcnt(12)
 v_mul_f32 v36, s42, v36
 v_mul_f32 v37, s42, v37
 v_mfma_f32_16x16x32_bf16 v[40:43], a[128:131], a[56:59], v[40:43]
 s_mov_b32 s41, 657408
 buffer_store_dwordx4 a[236:239], v0, s[28:31], s41 offen sc1
 v_mfma_f32_16x16x32_bf16 v[40:43], a[132:135], a[60:63], v[40:43]
 ds_read_b64_tr_b16 a[112:113], v6 offset:32768
 v_mul_f32 v38, s42, v38
 v_mfma_f32_16x16x32_bf16 v[72:75], a[128:131], a[64:67], v[72:75]
 v_mul_f32 v39, s42, v39
 v_cvt_pk_bf16_f32 v32, v32, v33
 v_mfma_f32_16x16x32_bf16 v[72:75], a[132:135], a[68:71], v[72:75]
 ds_read_b64_tr_b16 a[114:115], v6 offset:34816
 v_cvt_pk_bf16_f32 v33, v34, v35
 v_mfma_f32_16x16x32_bf16 v[104:107], a[128:131], a[72:75], v[104:107]
 v_cvt_pk_bf16_f32 v34, v36, v37
 v_cvt_pk_bf16_f32 v35, v38, v39
 v_mfma_f32_16x16x32_bf16 v[104:107], a[132:135], a[76:79], v[104:107]
 ds_read_b64_tr_b16 a[116:117], v6 offset:49152
 v_mul_f32 v64, s42, v64
 v_mfma_f32_16x16x32_bf16 v[136:139], a[128:131], a[80:83], v[136:139]
 v_mul_f32 v65, s42, v65
 v_mul_f32 v66, s42, v66
 v_mfma_f32_16x16x32_bf16 v[136:139], a[132:135], a[84:87], v[136:139]
 ds_read_b64_tr_b16 a[118:119], v6 offset:51200
 v_mul_f32 v67, s42, v67
 v_mfma_f32_16x16x32_bf16 v[168:171], a[128:131], a[88:91], v[168:171]
 v_mul_f32 v68, s42, v68
 v_mul_f32 v69, s42, v69
 v_mfma_f32_16x16x32_bf16 v[168:171], a[132:135], a[92:95], v[168:171]
 ds_write_b128 v27, a[192:195] offset:40960
 v_mul_f32 v70, s42, v70
 v_mfma_f32_16x16x32_bf16 v[200:203], a[128:131], a[96:99], v[200:203]
 ds_write_b128 v27, a[196:199] offset:43008
 v_mul_f32 v71, s42, v71
 v_mfma_f32_16x16x32_bf16 v[200:203], a[132:135], a[100:103], v[200:203]
 ds_write_b128 v27, a[200:203] offset:45056
 v_cvt_pk_bf16_f32 v64, v64, v65
 v_mfma_f32_16x16x32_bf16 v[232:235], a[128:131], a[104:107], v[232:235]
 ds_write_b128 v27, a[204:207] offset:47104
 v_cvt_pk_bf16_f32 v65, v66, v67
 v_mfma_f32_16x16x32_bf16 v[232:235], a[132:135], a[108:111], v[232:235]
 s_waitcnt lgkmcnt(12)
 v_cvt_pk_bf16_f32 v66, v68, v69
 v_cvt_pk_bf16_f32 v67, v70, v71
 v_mfma_f32_16x16x32_bf16 v[44:47], a[136:139], a[56:59], v[44:47]
 s_xor_b32 s88, s101, 68608
 buffer_load_dwordx4 a[228:231], v24, s[16:19], s88 offen nt
 v_mfma_f32_16x16x32_bf16 v[44:47], a[140:143], a[60:63], v[44:47]
 ds_read_b64_tr_b16 a[120:121], v6 offset:32776
 v_mul_f32 v96, s42, v96
 v_mfma_f32_16x16x32_bf16 v[76:79], a[136:139], a[64:67], v[76:79]
 v_mul_f32 v97, s42, v97
 v_mul_f32 v98, s42, v98
 v_mfma_f32_16x16x32_bf16 v[76:79], a[140:143], a[68:71], v[76:79]
 ds_read_b64_tr_b16 a[122:123], v6 offset:34824
 v_mul_f32 v99, s42, v99
 v_mfma_f32_16x16x32_bf16 v[108:111], a[136:139], a[72:75], v[108:111]
 v_mul_f32 v100, s42, v100
 v_mul_f32 v101, s42, v101
 v_mfma_f32_16x16x32_bf16 v[108:111], a[140:143], a[76:79], v[108:111]
 ds_read_b64_tr_b16 a[124:125], v6 offset:49160
 v_mul_f32 v102, s42, v102
 v_mfma_f32_16x16x32_bf16 v[140:143], a[136:139], a[80:83], v[140:143]
 v_mul_f32 v103, s42, v103
 v_cvt_pk_bf16_f32 v96, v96, v97
 v_mfma_f32_16x16x32_bf16 v[140:143], a[140:143], a[84:87], v[140:143]
 ds_read_b64_tr_b16 a[126:127], v6 offset:51208
 v_cvt_pk_bf16_f32 v97, v98, v99
 v_mfma_f32_16x16x32_bf16 v[172:175], a[136:139], a[88:91], v[172:175]
 v_cvt_pk_bf16_f32 v98, v100, v101
 v_cvt_pk_bf16_f32 v99, v102, v103
 v_mfma_f32_16x16x32_bf16 v[172:175], a[140:143], a[92:95], v[172:175]
 ds_write_b128 v26, a[176:179] offset:40960
 v_mul_f32 v128, s42, v128
 v_mfma_f32_16x16x32_bf16 v[204:207], a[136:139], a[96:99], v[204:207]
 ds_write_b128 v26, a[180:183] offset:43008
 v_mul_f32 v129, s42, v129
 v_mfma_f32_16x16x32_bf16 v[204:207], a[140:143], a[100:103], v[204:207]
 ds_write_b128 v26, a[184:187] offset:45056
 v_mul_f32 v130, s42, v130
 v_mfma_f32_16x16x32_bf16 v[236:239], a[136:139], a[104:107], v[236:239]
 ds_write_b128 v26, a[188:191] offset:47104
 v_mul_f32 v131, s42, v131
 v_mfma_f32_16x16x32_bf16 v[236:239], a[140:143], a[108:111], v[236:239]
 s_waitcnt lgkmcnt(12)
 v_mul_f32 v132, s42, v132
 v_mul_f32 v133, s42, v133
 v_mfma_f32_16x16x32_bf16 v[48:51], a[112:115], a[56:59], v[48:51]
 s_mov_b32 s41, 658432
 buffer_store_dwordx4 a[240:243], v0, s[28:31], s41 offen sc1
 v_mfma_f32_16x16x32_bf16 v[48:51], a[116:119], a[60:63], v[48:51]
 ds_read_b64_tr_b16 a[128:129], v7 offset:32768
 v_mul_f32 v134, s42, v134
 v_mfma_f32_16x16x32_bf16 v[80:83], a[112:115], a[64:67], v[80:83]
 v_mul_f32 v135, s42, v135
 v_cvt_pk_bf16_f32 v128, v128, v129
 v_mfma_f32_16x16x32_bf16 v[80:83], a[116:119], a[68:71], v[80:83]
 ds_read_b64_tr_b16 a[130:131], v7 offset:34816
 v_cvt_pk_bf16_f32 v129, v130, v131
 v_mfma_f32_16x16x32_bf16 v[112:115], a[112:115], a[72:75], v[112:115]
 v_cvt_pk_bf16_f32 v130, v132, v133
 v_cvt_pk_bf16_f32 v131, v134, v135
 v_mfma_f32_16x16x32_bf16 v[112:115], a[116:119], a[76:79], v[112:115]
 ds_read_b64_tr_b16 a[132:133], v7 offset:49152
 v_mul_f32 v160, s42, v160
 v_mfma_f32_16x16x32_bf16 v[144:147], a[112:115], a[80:83], v[144:147]
 s_xor_b32 s88, s101, 19456
 buffer_load_dwordx4 a[232:235], v24, s[16:19], s88 offen nt
 v_mfma_f32_16x16x32_bf16 v[144:147], a[116:119], a[84:87], v[144:147]
 ds_read_b64_tr_b16 a[134:135], v7 offset:51200
 v_mul_f32 v161, s42, v161
 v_mfma_f32_16x16x32_bf16 v[176:179], a[112:115], a[88:91], v[176:179]
 v_mul_f32 v162, s42, v162
 v_mul_f32 v163, s42, v163
 v_mfma_f32_16x16x32_bf16 v[176:179], a[116:119], a[92:95], v[176:179]
 v_mul_f32 v164, s42, v164
 v_mul_f32 v165, s42, v165
 v_mfma_f32_16x16x32_bf16 v[208:211], a[112:115], a[96:99], v[208:211]
 v_mul_f32 v166, s42, v166
 v_mul_f32 v167, s42, v167
 v_mfma_f32_16x16x32_bf16 v[208:211], a[116:119], a[100:103], v[208:211]
 v_cvt_pk_bf16_f32 v160, v160, v161
 v_cvt_pk_bf16_f32 v161, v162, v163
 v_mfma_f32_16x16x32_bf16 v[240:243], a[112:115], a[104:107], v[240:243]
 s_mov_b32 s41, 659456
 buffer_store_dwordx4 a[244:247], v0, s[28:31], s41 offen sc1
 v_mfma_f32_16x16x32_bf16 v[240:243], a[116:119], a[108:111], v[240:243]
 s_waitcnt lgkmcnt(8)
 v_cvt_pk_bf16_f32 v162, v164, v165
 v_cvt_pk_bf16_f32 v163, v166, v167
 v_mfma_f32_16x16x32_bf16 v[52:55], a[120:123], a[56:59], v[52:55]
 v_mul_f32 v192, s42, v192
 v_mul_f32 v193, s42, v193
 v_mfma_f32_16x16x32_bf16 v[52:55], a[124:127], a[60:63], v[52:55]
 ds_read_b64_tr_b16 a[136:137], v7 offset:32776
 v_mul_f32 v194, s42, v194
 v_mfma_f32_16x16x32_bf16 v[84:87], a[120:123], a[64:67], v[84:87]
 v_mul_f32 v195, s42, v195
 v_mul_f32 v196, s42, v196
 v_mfma_f32_16x16x32_bf16 v[84:87], a[124:127], a[68:71], v[84:87]
 ds_read_b64_tr_b16 a[138:139], v7 offset:34824
 v_mul_f32 v197, s42, v197
 v_mfma_f32_16x16x32_bf16 v[116:119], a[120:123], a[72:75], v[116:119]
 s_branch SK2904
PG2904:
 s_branch PG5263
SK2904:
 s_xor_b32 s88, s101, 84992
 buffer_load_dwordx4 a[236:239], v24, s[16:19], s88 offen nt
 v_mfma_f32_16x16x32_bf16 v[116:119], a[124:127], a[76:79], v[116:119]
 ds_read_b64_tr_b16 a[140:141], v7 offset:49160
 v_mul_f32 v198, s42, v198
 v_mfma_f32_16x16x32_bf16 v[148:151], a[120:123], a[80:83], v[148:151]
 v_mul_f32 v199, s42, v199
 v_cvt_pk_bf16_f32 v192, v192, v193
 v_mfma_f32_16x16x32_bf16 v[148:151], a[124:127], a[84:87], v[148:151]
 ds_read_b64_tr_b16 a[142:143], v7 offset:51208
 v_cvt_pk_bf16_f32 v193, v194, v195
 v_mfma_f32_16x16x32_bf16 v[180:183], a[120:123], a[88:91], v[180:183]
 v_cvt_pk_bf16_f32 v194, v196, v197
 v_cvt_pk_bf16_f32 v195, v198, v199
 v_mfma_f32_16x16x32_bf16 v[180:183], a[124:127], a[92:95], v[180:183]
 v_mul_f32 v224, s42, v224
 v_mul_f32 v225, s42, v225
 v_mfma_f32_16x16x32_bf16 v[212:215], a[120:123], a[96:99], v[212:215]
 v_mul_f32 v226, s42, v226
 v_mul_f32 v227, s42, v227
 v_mfma_f32_16x16x32_bf16 v[212:215], a[124:127], a[100:103], v[212:215]
 v_mul_f32 v228, s42, v228
 v_mul_f32 v229, s42, v229
 v_mfma_f32_16x16x32_bf16 v[244:247], a[120:123], a[104:107], v[244:247]
 v_mul_f32 v230, s42, v230
 v_mul_f32 v231, s42, v231
 v_mfma_f32_16x16x32_bf16 v[244:247], a[124:127], a[108:111], v[244:247]
 s_waitcnt vmcnt(37) lgkmcnt(0)
 s_barrier
 v_cvt_pk_bf16_f32 v224, v224, v225
 v_cvt_pk_bf16_f32 v225, v226, v227
 v_mfma_f32_16x16x32_bf16 v[56:59], a[128:131], a[56:59], v[56:59]
 buffer_load_dwordx4 v22, s[12:15], s40 offen nt lds
 v_mfma_f32_16x16x32_bf16 v[56:59], a[132:135], a[60:63], v[56:59]
 v_cvt_pk_bf16_f32 v226, v228, v229
 v_cvt_pk_bf16_f32 v227, v230, v231
 v_mfma_f32_16x16x32_bf16 v[88:91], a[128:131], a[64:67], v[88:91]
 buffer_load_dwordx4 v23, s[12:15], s40 offen offset:2048 nt lds
 v_mfma_f32_16x16x32_bf16 v[88:91], a[132:135], a[68:71], v[88:91]
 s_add_u32 m0, s45, 135168
 v_mul_f32 v40, s42, v40
 v_mul_f32 v41, s42, v41
 v_mfma_f32_16x16x32_bf16 v[120:123], a[128:131], a[72:75], v[120:123]
 s_xor_b32 s40, s101, 20480
 buffer_load_dwordx4 v22, s[12:15], s40 offen nt lds
 v_mfma_f32_16x16x32_bf16 v[120:123], a[132:135], a[76:79], v[120:123]
 v_mul_f32 v42, s42, v42
 v_mul_f32 v43, s42, v43
 v_mfma_f32_16x16x32_bf16 v[152:155], a[128:131], a[80:83], v[152:155]
 buffer_load_dwordx4 v23, s[12:15], s40 offen offset:2048 nt lds
 v_mfma_f32_16x16x32_bf16 v[152:155], a[132:135], a[84:87], v[152:155]
 s_add_u32 m0, s45, 0
 v_mul_f32 v44, s42, v44
 v_mul_f32 v45, s42, v45
 v_mfma_f32_16x16x32_bf16 v[184:187], a[128:131], a[88:91], v[184:187]
 s_xor_b32 s40, s101, 5120
 v_mul_f32 v46, s42, v46
 v_mul_f32 v47, s42, v47
 v_mfma_f32_16x16x32_bf16 v[184:187], a[132:135], a[92:95], v[184:187]
 v_cvt_pk_bf16_f32 v40, v40, v41
 v_cvt_pk_bf16_f32 v41, v42, v43
 v_mfma_f32_16x16x32_bf16 v[216:219], a[128:131], a[96:99], v[216:219]
 v_cvt_pk_bf16_f32 v42, v44, v45
 v_cvt_pk_bf16_f32 v43, v46, v47
 v_mfma_f32_16x16x32_bf16 v[216:219], a[132:135], a[100:103], v[216:219]
 v_mul_f32 v72, s42, v72
 v_mul_f32 v73, s42, v73
 v_mfma_f32_16x16x32_bf16 v[248:251], a[128:131], a[104:107], v[248:251]
 v_mul_f32 v74, s42, v74
 v_mul_f32 v75, s42, v75
 v_mfma_f32_16x16x32_bf16 v[248:251], a[132:135], a[108:111], v[248:251]
 s_waitcnt lgkmcnt(0)
 v_mul_f32 v76, s42, v76
 v_mul_f32 v77, s42, v77
 v_mfma_f32_16x16x32_bf16 v[60:63], a[136:139], a[56:59], v[60:63]
 v_mul_f32 v78, s42, v78
 v_mul_f32 v79, s42, v79
 v_mfma_f32_16x16x32_bf16 v[60:63], a[140:143], a[60:63], v[60:63]
 v_cvt_pk_bf16_f32 v72, v72, v73
 v_cvt_pk_bf16_f32 v73, v74, v75
 v_mfma_f32_16x16x32_bf16 v[92:95], a[136:139], a[64:67], v[92:95]
 v_cvt_pk_bf16_f32 v74, v76, v77
 v_cvt_pk_bf16_f32 v75, v78, v79
 v_mfma_f32_16x16x32_bf16 v[92:95], a[140:143], a[68:71], v[92:95]
 ds_read_b128 v[36:39], v10 offset:0
 v_mul_f32 v104, s42, v104
 v_mfma_f32_16x16x32_bf16 v[124:127], a[136:139], a[72:75], v[124:127]
 v_mul_f32 v105, s42, v105
 v_mul_f32 v106, s42, v106
 v_mfma_f32_16x16x32_bf16 v[124:127], a[140:143], a[76:79], v[124:127]
 ds_read_b128 v[68:71], v11 offset:0
 v_mul_f32 v107, s42, v107
 v_mfma_f32_16x16x32_bf16 v[156:159], a[136:139], a[80:83], v[156:159]
 v_mul_f32 v108, s42, v108
 v_mul_f32 v109, s42, v109
 v_mfma_f32_16x16x32_bf16 v[156:159], a[140:143], a[84:87], v[156:159]
 ds_read_b128 v[100:103], v12 offset:0
 v_mul_f32 v110, s42, v110
 v_mfma_f32_16x16x32_bf16 v[188:191], a[136:139], a[88:91], v[188:191]
 v_mul_f32 v111, s42, v111
 v_cvt_pk_bf16_f32 v104, v104, v105
 v_mfma_f32_16x16x32_bf16 v[188:191], a[140:143], a[92:95], v[188:191]
 ds_read_b128 v[132:135], v13 offset:0
 v_cvt_pk_bf16_f32 v105, v106, v107
 v_mfma_f32_16x16x32_bf16 v[220:223], a[136:139], a[96:99], v[220:223]
 v_cvt_pk_bf16_f32 v106, v108, v109
 v_cvt_pk_bf16_f32 v107, v110, v111
 v_mfma_f32_16x16x32_bf16 v[220:223], a[140:143], a[100:103], v[220:223]
 v_mul_f32 v136, s42, v136
 v_mul_f32 v137, s42, v137
 v_mfma_f32_16x16x32_bf16 v[252:255], a[136:139], a[104:107], v[252:255]
 v_mul_f32 v138, s42, v138
 v_mul_f32 v139, s42, v139
 v_mfma_f32_16x16x32_bf16 v[252:255], a[140:143], a[108:111], v[252:255]
 v_mul_f32 v140, s42, v140
 v_mul_f32 v141, s42, v141
 s_nop 7
 v_pk_mul_f32 v[142:143], s[42:43], v[142:143] op_sel_hi:[0,1]
 v_cvt_pk_bf16_f32 v136, v136, v137
 v_cvt_pk_bf16_f32 v137, v138, v139
 v_cvt_pk_bf16_f32 v138, v140, v141
 v_cvt_pk_bf16_f32 v139, v142, v143
 v_pk_mul_f32 v[168:169], s[42:43], v[168:169] op_sel_hi:[0,1]
 v_pk_mul_f32 v[170:171], s[42:43], v[170:171] op_sel_hi:[0,1]
 v_pk_mul_f32 v[172:173], s[42:43], v[172:173] op_sel_hi:[0,1]
 v_pk_mul_f32 v[174:175], s[42:43], v[174:175] op_sel_hi:[0,1]
 v_cvt_pk_bf16_f32 v168, v168, v169
 v_cvt_pk_bf16_f32 v169, v170, v171
 v_cvt_pk_bf16_f32 v170, v172, v173
 v_cvt_pk_bf16_f32 v171, v174, v175
 v_pk_mul_f32 v[200:201], s[42:43], v[200:201] op_sel_hi:[0,1]
 v_pk_mul_f32 v[202:203], s[42:43], v[202:203] op_sel_hi:[0,1]
 v_pk_mul_f32 v[204:205], s[42:43], v[204:205] op_sel_hi:[0,1]
 v_pk_mul_f32 v[206:207], s[42:43], v[206:207] op_sel_hi:[0,1]
 v_cvt_pk_bf16_f32 v200, v200, v201
 v_cvt_pk_bf16_f32 v201, v202, v203
 v_cvt_pk_bf16_f32 v202, v204, v205
 v_cvt_pk_bf16_f32 v203, v206, v207
 v_pk_mul_f32 v[232:233], s[42:43], v[232:233] op_sel_hi:[0,1]
 v_pk_mul_f32 v[234:235], s[42:43], v[234:235] op_sel_hi:[0,1]
 v_pk_mul_f32 v[236:237], s[42:43], v[236:237] op_sel_hi:[0,1]
 v_pk_mul_f32 v[238:239], s[42:43], v[238:239] op_sel_hi:[0,1]
 v_cvt_pk_bf16_f32 v232, v232, v233
 v_cvt_pk_bf16_f32 v233, v234, v235
 v_cvt_pk_bf16_f32 v234, v236, v237
 v_cvt_pk_bf16_f32 v235, v238, v239
 v_pk_mul_f32 v[48:49], s[42:43], v[48:49] op_sel_hi:[0,1]
 v_pk_mul_f32 v[50:51], s[42:43], v[50:51] op_sel_hi:[0,1]
 v_pk_mul_f32 v[52:53], s[42:43], v[52:53] op_sel_hi:[0,1]
 v_pk_mul_f32 v[54:55], s[42:43], v[54:55] op_sel_hi:[0,1]
 v_cvt_pk_bf16_f32 v48, v48, v49
 v_cvt_pk_bf16_f32 v49, v50, v51
 v_cvt_pk_bf16_f32 v50, v52, v53
 v_cvt_pk_bf16_f32 v51, v54, v55
 v_pk_mul_f32 v[80:81], s[42:43], v[80:81] op_sel_hi:[0,1]
 v_pk_mul_f32 v[82:83], s[42:43], v[82:83] op_sel_hi:[0,1]
 v_pk_mul_f32 v[84:85], s[42:43], v[84:85] op_sel_hi:[0,1]
 v_pk_mul_f32 v[86:87], s[42:43], v[86:87] op_sel_hi:[0,1]
 v_cvt_pk_bf16_f32 v80, v80, v81
 v_cvt_pk_bf16_f32 v81, v82, v83
 v_cvt_pk_bf16_f32 v82, v84, v85
 v_cvt_pk_bf16_f32 v83, v86, v87
 v_pk_mul_f32 v[112:113], s[42:43], v[112:113] op_sel_hi:[0,1]
 v_pk_mul_f32 v[114:115], s[42:43], v[114:115] op_sel_hi:[0,1]
 v_pk_mul_f32 v[116:117], s[42:43], v[116:117] op_sel_hi:[0,1]
 v_pk_mul_f32 v[118:119], s[42:43], v[118:119] op_sel_hi:[0,1]
 v_cvt_pk_bf16_f32 v112, v112, v113
 v_cvt_pk_bf16_f32 v113, v114, v115
 v_cvt_pk_bf16_f32 v114, v116, v117
 v_cvt_pk_bf16_f32 v115, v118, v119
 v_pk_mul_f32 v[144:145], s[42:43], v[144:145] op_sel_hi:[0,1]
 v_pk_mul_f32 v[146:147], s[42:43], v[146:147] op_sel_hi:[0,1]
 v_pk_mul_f32 v[148:149], s[42:43], v[148:149] op_sel_hi:[0,1]
 v_pk_mul_f32 v[150:151], s[42:43], v[150:151] op_sel_hi:[0,1]
 v_cvt_pk_bf16_f32 v144, v144, v145
 v_cvt_pk_bf16_f32 v145, v146, v147
 v_cvt_pk_bf16_f32 v146, v148, v149
 v_cvt_pk_bf16_f32 v147, v150, v151
 v_pk_mul_f32 v[176:177], s[42:43], v[176:177] op_sel_hi:[0,1]
 v_pk_mul_f32 v[178:179], s[42:43], v[178:179] op_sel_hi:[0,1]
 v_pk_mul_f32 v[180:181], s[42:43], v[180:181] op_sel_hi:[0,1]
 v_pk_mul_f32 v[182:183], s[42:43], v[182:183] op_sel_hi:[0,1]
 v_cvt_pk_bf16_f32 v176, v176, v177
 v_cvt_pk_bf16_f32 v177, v178, v179
 v_cvt_pk_bf16_f32 v178, v180, v181
 v_cvt_pk_bf16_f32 v179, v182, v183
 v_pk_mul_f32 v[208:209], s[42:43], v[208:209] op_sel_hi:[0,1]
 v_pk_mul_f32 v[210:211], s[42:43], v[210:211] op_sel_hi:[0,1]
 v_pk_mul_f32 v[212:213], s[42:43], v[212:213] op_sel_hi:[0,1]
 v_pk_mul_f32 v[214:215], s[42:43], v[214:215] op_sel_hi:[0,1]
 v_cvt_pk_bf16_f32 v208, v208, v209
 v_cvt_pk_bf16_f32 v209, v210, v211
 v_cvt_pk_bf16_f32 v210, v212, v213
 v_cvt_pk_bf16_f32 v211, v214, v215
 v_pk_mul_f32 v[240:241], s[42:43], v[240:241] op_sel_hi:[0,1]
 v_pk_mul_f32 v[242:243], s[42:43], v[242:243] op_sel_hi:[0,1]
 v_pk_mul_f32 v[244:245], s[42:43], v[244:245] op_sel_hi:[0,1]
 v_pk_mul_f32 v[246:247], s[42:43], v[246:247] op_sel_hi:[0,1]
 v_cvt_pk_bf16_f32 v240, v240, v241
 v_cvt_pk_bf16_f32 v241, v242, v243
 v_cvt_pk_bf16_f32 v242, v244, v245
 v_cvt_pk_bf16_f32 v243, v246, v247
 v_pk_mul_f32 v[56:57], s[42:43], v[56:57] op_sel_hi:[0,1]
 v_pk_mul_f32 v[58:59], s[42:43], v[58:59] op_sel_hi:[0,1]
 v_pk_mul_f32 v[60:61], s[42:43], v[60:61] op_sel_hi:[0,1]
 v_pk_mul_f32 v[62:63], s[42:43], v[62:63] op_sel_hi:[0,1]
 v_cvt_pk_bf16_f32 v56, v56, v57
 v_cvt_pk_bf16_f32 v57, v58, v59
 v_cvt_pk_bf16_f32 v58, v60, v61
 v_cvt_pk_bf16_f32 v59, v62, v63
 v_pk_mul_f32 v[88:89], s[42:43], v[88:89] op_sel_hi:[0,1]
 v_pk_mul_f32 v[90:91], s[42:43], v[90:91] op_sel_hi:[0,1]
 v_pk_mul_f32 v[92:93], s[42:43], v[92:93] op_sel_hi:[0,1]
 v_pk_mul_f32 v[94:95], s[42:43], v[94:95] op_sel_hi:[0,1]
 v_cvt_pk_bf16_f32 v88, v88, v89
 v_cvt_pk_bf16_f32 v89, v90, v91
 v_cvt_pk_bf16_f32 v90, v92, v93
 v_cvt_pk_bf16_f32 v91, v94, v95
 v_pk_mul_f32 v[120:121], s[42:43], v[120:121] op_sel_hi:[0,1]
 v_pk_mul_f32 v[122:123], s[42:43], v[122:123] op_sel_hi:[0,1]
 v_pk_mul_f32 v[124:125], s[42:43], v[124:125] op_sel_hi:[0,1]
 v_pk_mul_f32 v[126:127], s[42:43], v[126:127] op_sel_hi:[0,1]
 v_cvt_pk_bf16_f32 v120, v120, v121
 v_cvt_pk_bf16_f32 v121, v122, v123
 v_cvt_pk_bf16_f32 v122, v124, v125
 v_cvt_pk_bf16_f32 v123, v126, v127
 v_pk_mul_f32 v[152:153], s[42:43], v[152:153] op_sel_hi:[0,1]
 v_pk_mul_f32 v[154:155], s[42:43], v[154:155] op_sel_hi:[0,1]
 v_pk_mul_f32 v[156:157], s[42:43], v[156:157] op_sel_hi:[0,1]
 v_pk_mul_f32 v[158:159], s[42:43], v[158:159] op_sel_hi:[0,1]
 v_cvt_pk_bf16_f32 v152, v152, v153
 v_cvt_pk_bf16_f32 v153, v154, v155
 v_cvt_pk_bf16_f32 v154, v156, v157
 v_cvt_pk_bf16_f32 v155, v158, v159
 v_pk_mul_f32 v[184:185], s[42:43], v[184:185] op_sel_hi:[0,1]
 v_pk_mul_f32 v[186:187], s[42:43], v[186:187] op_sel_hi:[0,1]
 v_pk_mul_f32 v[188:189], s[42:43], v[188:189] op_sel_hi:[0,1]
 v_pk_mul_f32 v[190:191], s[42:43], v[190:191] op_sel_hi:[0,1]
 v_cvt_pk_bf16_f32 v184, v184, v185
 v_cvt_pk_bf16_f32 v185, v186, v187
 v_cvt_pk_bf16_f32 v186, v188, v189
 v_cvt_pk_bf16_f32 v187, v190, v191
 v_pk_mul_f32 v[216:217], s[42:43], v[216:217] op_sel_hi:[0,1]
 v_pk_mul_f32 v[218:219], s[42:43], v[218:219] op_sel_hi:[0,1]
 v_pk_mul_f32 v[220:221], s[42:43], v[220:221] op_sel_hi:[0,1]
 v_pk_mul_f32 v[222:223], s[42:43], v[222:223] op_sel_hi:[0,1]
 v_cvt_pk_bf16_f32 v216, v216, v217
 v_cvt_pk_bf16_f32 v217, v218, v219
 v_cvt_pk_bf16_f32 v218, v220, v221
 v_cvt_pk_bf16_f32 v219, v222, v223
 v_pk_mul_f32 v[248:249], s[42:43], v[248:249] op_sel_hi:[0,1]
 v_pk_mul_f32 v[250:251], s[42:43], v[250:251] op_sel_hi:[0,1]
 v_pk_mul_f32 v[252:253], s[42:43], v[252:253] op_sel_hi:[0,1]
 v_pk_mul_f32 v[254:255], s[42:43], v[254:255] op_sel_hi:[0,1]
 v_cvt_pk_bf16_f32 v248, v248, v249
 v_cvt_pk_bf16_f32 v249, v250, v251
 v_cvt_pk_bf16_f32 v250, v252, v253
 v_cvt_pk_bf16_f32 v251, v254, v255
 v_mov_b32 v9, v25
 v_mov_b32 v8, v27
 v_mov_b32 v28, 0x3f803f80
 v_mov_b32 v29, 0x3f803f80
 v_mov_b32 v30, 0x3f803f80
 v_mov_b32 v31, 0x3f803f80
 s_waitcnt lgkmcnt(0)
 v_mfma_f32_16x16x32_bf16 v[76:79], v[36:39], v[32:35], 0
 v_mfma_f32_16x16x32_bf16 v[76:79], v[68:71], v[40:43], v[76:79]
 v_mfma_f32_16x16x32_bf16 v[76:79], v[100:103], v[48:51], v[76:79]
 v_mfma_f32_16x16x32_bf16 v[76:79], v[132:135], v[56:59], v[76:79]
 v_mfma_f32_16x16x32_bf16 v[108:111], v[36:39], v[64:67], 0
 ds_read_b128 v[164:167], v10 offset:4096
 ds_read_b128 v[196:199], v11 offset:4096
 v_mfma_f32_16x16x32_bf16 v[108:111], v[68:71], v[72:75], v[108:111]
 v_mfma_f32_16x16x32_bf16 v[108:111], v[100:103], v[80:83], v[108:111]
 v_mfma_f32_16x16x32_bf16 v[108:111], v[132:135], v[88:91], v[108:111]
 s_nop 3
 v_mfma_f32_16x16x32_bf16 v[252:255], v[36:39], v[96:99], 0
 v_exp_f32 v76, v76
 v_mfma_f32_16x16x32_bf16 v[252:255], v[68:71], v[104:107], v[252:255]
 v_exp_f32 v77, v77
 v_mfma_f32_16x16x32_bf16 v[252:255], v[100:103], v[112:115], v[252:255]
 v_exp_f32 v78, v78
 v_mfma_f32_16x16x32_bf16 v[252:255], v[132:135], v[120:123], v[252:255]
 v_exp_f32 v79, v79
 v_mfma_f32_16x16x32_bf16 v[4:7], v[36:39], v[128:131], 0
 ds_read_b128 v[228:231], v12 offset:4096
 ds_read_b128 v[44:47], v13 offset:4096
 v_exp_f32 v108, v108
 v_mfma_f32_16x16x32_bf16 v[4:7], v[68:71], v[136:139], v[4:7]
 v_exp_f32 v109, v109
 v_mfma_f32_16x16x32_bf16 v[4:7], v[100:103], v[144:147], v[4:7]
 v_exp_f32 v110, v110
 v_mfma_f32_16x16x32_bf16 v[4:7], v[132:135], v[152:155], v[4:7]
 v_exp_f32 v111, v111
 v_cvt_pk_bf16_f32 v140, v76, v77
 v_cvt_pk_bf16_f32 v141, v78, v79
 v_cvt_pk_bf16_f32 v172, v108, v109
 v_cvt_pk_bf16_f32 v173, v110, v111
 v_mfma_f32_16x16x32_bf16 v[76:79], v[36:39], v[160:163], 0
 v_exp_f32 v252, v252
 v_mfma_f32_16x16x32_bf16 v[76:79], v[68:71], v[168:171], v[76:79]
 v_exp_f32 v253, v253
 v_mfma_f32_16x16x32_bf16 v[76:79], v[100:103], v[176:179], v[76:79]
 v_exp_f32 v254, v254
 v_mfma_f32_16x16x32_bf16 v[76:79], v[132:135], v[184:187], v[76:79]
 v_exp_f32 v255, v255
 v_mfma_f32_16x16x32_bf16 v[108:111], v[36:39], v[192:195], 0
 v_exp_f32 v4, v4
 v_mfma_f32_16x16x32_bf16 v[108:111], v[68:71], v[200:203], v[108:111]
 v_exp_f32 v5, v5
 v_mfma_f32_16x16x32_bf16 v[108:111], v[100:103], v[208:211], v[108:111]
 v_exp_f32 v6, v6
 v_mfma_f32_16x16x32_bf16 v[108:111], v[132:135], v[216:219], v[108:111]
 v_exp_f32 v7, v7
 v_cvt_pk_bf16_f32 v204, v252, v253
 v_cvt_pk_bf16_f32 v205, v254, v255
 v_cvt_pk_bf16_f32 v236, v4, v5
 v_cvt_pk_bf16_f32 v237, v6, v7
 s_waitcnt vmcnt(37) lgkmcnt(0)
 s_barrier
 v_mfma_f32_16x16x32_bf16 v[252:255], v[36:39], v[224:227], 0
 buffer_load_dwordx4 v22, s[12:15], s40 offen nt lds
 buffer_load_dwordx4 v23, s[12:15], s40 offen offset:2048 nt lds
 v_exp_f32 v76, v76
 v_mfma_f32_16x16x32_bf16 v[252:255], v[68:71], v[232:235], v[252:255]
 s_add_u32 m0, s45, 4096
 v_exp_f32 v77, v77
 v_mfma_f32_16x16x32_bf16 v[252:255], v[100:103], v[240:243], v[252:255]
 s_xor_b32 s40, s101, 21504
 v_exp_f32 v78, v78
 v_mfma_f32_16x16x32_bf16 v[252:255], v[132:135], v[248:251], v[252:255]
 v_exp_f32 v79, v79
 v_mfma_f32_16x16x32_bf16 v[4:7], v[164:167], v[32:35], 0
 ds_read_b128 v[36:39], v10 offset:8192
 ds_read_b128 v[68:71], v11 offset:8192
 v_exp_f32 v108, v108
 v_mfma_f32_16x16x32_bf16 v[4:7], v[196:199], v[40:43], v[4:7]
 v_exp_f32 v109, v109
 v_mfma_f32_16x16x32_bf16 v[4:7], v[228:231], v[48:51], v[4:7]
 v_exp_f32 v110, v110
 v_mfma_f32_16x16x32_bf16 v[4:7], v[44:47], v[56:59], v[4:7]
 v_exp_f32 v111, v111
 v_cvt_pk_bf16_f32 v52, v76, v77
 v_cvt_pk_bf16_f32 v53, v78, v79
 v_cvt_pk_bf16_f32 v84, v108, v109
 v_cvt_pk_bf16_f32 v85, v110, v111
 v_mfma_f32_16x16x32_bf16 v[76:79], v[164:167], v[64:67], 0
 v_exp_f32 v252, v252
 v_mfma_f32_16x16x32_bf16 v[76:79], v[196:199], v[72:75], v[76:79]
 v_exp_f32 v253, v253
 v_mfma_f32_16x16x32_bf16 v[76:79], v[228:231], v[80:83], v[76:79]
 v_exp_f32 v254, v254
 v_mfma_f32_16x16x32_bf16 v[76:79], v[44:47], v[88:91], v[76:79]
 v_exp_f32 v255, v255
 v_mfma_f32_16x16x32_bf16 v[108:111], v[164:167], v[96:99], 0
 ds_read_b128 v[100:103], v12 offset:8192
 ds_read_b128 v[132:135], v13 offset:8192
 s_waitcnt vmcnt(6)
 ds_write_b128 v8, a[208:211] offset:0
 ds_write_b128 v8, a[212:215] offset:2048
 v_exp_f32 v4, v4
 v_mfma_f32_16x16x32_bf16 v[108:111], v[196:199], v[104:107], v[108:111]
 v_exp_f32 v5, v5
 v_mfma_f32_16x16x32_bf16 v[108:111], v[228:231], v[112:115], v[108:111]
 v_exp_f32 v6, v6
 v_mfma_f32_16x16x32_bf16 v[108:111], v[44:47], v[120:123], v[108:111]
 v_exp_f32 v7, v7
 v_cvt_pk_bf16_f32 v116, v252, v253
 v_cvt_pk_bf16_f32 v117, v254, v255
 v_cvt_pk_bf16_f32 v142, v4, v5
 v_cvt_pk_bf16_f32 v143, v6, v7
 v_mfma_f32_16x16x32_bf16 v[252:255], v[164:167], v[128:131], 0
 buffer_load_dwordx4 v22, s[12:15], s40 offen nt lds
 buffer_load_dwordx4 v23, s[12:15], s40 offen offset:2048 nt lds
 v_exp_f32 v76, v76
 v_mfma_f32_16x16x32_bf16 v[252:255], v[196:199], v[136:139], v[252:255]
 s_add_u32 m0, s46, 73728
 v_exp_f32 v77, v77
 v_mfma_f32_16x16x32_bf16 v[252:255], v[228:231], v[144:147], v[252:255]
 s_xor_b32 s40, s101, 4096
 v_exp_f32 v78, v78
 v_mfma_f32_16x16x32_bf16 v[252:255], v[44:47], v[152:155], v[252:255]
 v_exp_f32 v79, v79
 v_mfma_f32_16x16x32_bf16 v[4:7], v[164:167], v[160:163], 0
 ds_write_b128 v8, a[216:219] offset:4096
 ds_write_b128 v8, a[220:223] offset:6144
 ds_write_b128 v8, a[224:227] offset:8192
 ds_write_b128 v8, a[228:231] offset:10240
 ds_write_b128 v8, a[232:235] offset:12288
 ds_write_b128 v8, a[236:239] offset:14336
 v_exp_f32 v108, v108
 v_mfma_f32_16x16x32_bf16 v[4:7], v[196:199], v[168:171], v[4:7]
 v_exp_f32 v109, v109
 v_mfma_f32_16x16x32_bf16 v[4:7], v[228:231], v[176:179], v[4:7]
 v_exp_f32 v110, v110
 v_mfma_f32_16x16x32_bf16 v[4:7], v[44:47], v[184:187], v[4:7]
 v_exp_f32 v111, v111
 v_cvt_pk_bf16_f32 v174, v76, v77
 v_cvt_pk_bf16_f32 v175, v78, v79
 v_cvt_pk_bf16_f32 v206, v108, v109
 v_cvt_pk_bf16_f32 v207, v110, v111
 v_mfma_f32_16x16x32_bf16 v[76:79], v[164:167], v[192:195], 0
 v_exp_f32 v252, v252
 v_mfma_f32_16x16x32_bf16 v[76:79], v[196:199], v[200:203], v[76:79]
 v_exp_f32 v253, v253
 v_mfma_f32_16x16x32_bf16 v[76:79], v[228:231], v[208:211], v[76:79]
 v_exp_f32 v254, v254
 v_mfma_f32_16x16x32_bf16 v[76:79], v[44:47], v[216:219], v[76:79]
 v_exp_f32 v255, v255
 v_mfma_f32_16x16x32_bf16 v[108:111], v[164:167], v[224:227], 0
 ds_read_b64_tr_b16 v[148:149], v14 offset:32768
 ds_read_b64_tr_b16 v[150:151], v14 offset:36864
 ds_read_b64_tr_b16 v[180:181], v15 offset:32768
 ds_read_b64_tr_b16 v[182:183], v15 offset:36864
 v_exp_f32 v4, v4
 v_mfma_f32_16x16x32_bf16 v[108:111], v[196:199], v[232:235], v[108:111]
 v_exp_f32 v5, v5
 v_mfma_f32_16x16x32_bf16 v[108:111], v[228:231], v[240:243], v[108:111]
 v_exp_f32 v6, v6
 v_mfma_f32_16x16x32_bf16 v[108:111], v[44:47], v[248:251], v[108:111]
 s_waitcnt lgkmcnt(12)
 v_exp_f32 v7, v7
 v_cvt_pk_bf16_f32 v238, v252, v253
 v_cvt_pk_bf16_f32 v239, v254, v255
 v_cvt_pk_bf16_f32 v54, v4, v5
 v_cvt_pk_bf16_f32 v55, v6, v7
 v_mfma_f32_16x16x32_bf16 v[252:255], v[36:39], v[32:35], 0
 v_exp_f32 v76, v76
 v_mfma_f32_16x16x32_bf16 v[252:255], v[68:71], v[40:43], v[252:255]
 v_exp_f32 v77, v77
 v_mfma_f32_16x16x32_bf16 v[252:255], v[100:103], v[48:51], v[252:255]
 v_exp_f32 v78, v78
 v_mfma_f32_16x16x32_bf16 v[252:255], v[132:135], v[56:59], v[252:255]
 v_exp_f32 v79, v79
 v_mfma_f32_16x16x32_bf16 v[4:7], v[36:39], v[64:67], 0
 v_exp_f32 v108, v108
 v_mfma_f32_16x16x32_bf16 v[4:7], v[68:71], v[72:75], v[4:7]
 v_exp_f32 v109, v109
 v_mfma_f32_16x16x32_bf16 v[4:7], v[100:103], v[80:83], v[4:7]
 v_exp_f32 v110, v110
 v_mfma_f32_16x16x32_bf16 v[4:7], v[132:135], v[88:91], v[4:7]
 s_waitcnt lgkmcnt(2)
 v_exp_f32 v111, v111
 v_mfma_f32_16x16x32_bf16 a[0:3], v[148:151], v[140:143], 0
 ds_read_b64_tr_b16 v[212:213], v16 offset:32768
 v_cvt_pk_bf16_f32 v86, v76, v77
 v_mfma_f32_16x16x32_bf16 a[4:7], v[148:151], v[172:175], 0
 v_cvt_pk_bf16_f32 v87, v78, v79
 v_mfma_f32_16x16x32_bf16 a[8:11], v[148:151], v[204:207], 0
 ds_read_b64_tr_b16 v[214:215], v16 offset:36864
 v_cvt_pk_bf16_f32 v118, v108, v109
 v_mfma_f32_16x16x32_bf16 a[12:15], v[148:151], v[236:239], 0
 v_cvt_pk_bf16_f32 v119, v110, v111
 v_mfma_f32_16x16x32_bf16 a[16:19], v[148:151], v[52:55], 0
 ds_read_b128 v[164:167], v10 offset:12288
 v_mfma_f32_16x16x32_bf16 a[20:23], v[148:151], v[84:87], 0
 v_mfma_f32_16x16x32_bf16 a[24:27], v[148:151], v[116:119], 0
 s_waitcnt lgkmcnt(3)
 ds_read_b128 v[196:199], v11 offset:12288
 v_mfma_f32_16x16x32_bf16 a[28:31], v[180:183], v[140:143], 0
 buffer_load_dwordx4 v24, s[16:19], s40 offen nt lds
 v_mfma_f32_16x16x32_bf16 a[224:227], v[28:31], v[140:143], 0
 buffer_load_dwordx4 v2, s[16:19], s40 offen offset:2048 nt lds
 v_mfma_f32_16x16x32_bf16 v[76:79], v[36:39], v[96:99], 0
 s_add_u32 m0, s46, 77824
 v_exp_f32 v252, v252
 v_mfma_f32_16x16x32_bf16 v[76:79], v[68:71], v[104:107], v[76:79]
 s_xor_b32 s40, s101, 20480
 v_exp_f32 v253, v253
 v_mfma_f32_16x16x32_bf16 v[76:79], v[100:103], v[112:115], v[76:79]
 v_exp_f32 v254, v254
 v_mfma_f32_16x16x32_bf16 v[76:79], v[132:135], v[120:123], v[76:79]
 v_exp_f32 v255, v255
 v_mfma_f32_16x16x32_bf16 v[108:111], v[36:39], v[128:131], 0
 v_exp_f32 v4, v4
 v_mfma_f32_16x16x32_bf16 v[108:111], v[68:71], v[136:139], v[108:111]
 v_exp_f32 v5, v5
 v_mfma_f32_16x16x32_bf16 v[108:111], v[100:103], v[144:147], v[108:111]
 v_exp_f32 v6, v6
 v_mfma_f32_16x16x32_bf16 v[108:111], v[132:135], v[152:155], v[108:111]
 v_exp_f32 v7, v7
 v_mfma_f32_16x16x32_bf16 a[32:35], v[180:183], v[172:175], 0
 ds_read_b64_tr_b16 v[148:149], v17 offset:32768
 v_cvt_pk_bf16_f32 v244, v252, v253
 v_mfma_f32_16x16x32_bf16 a[36:39], v[180:183], v[204:207], 0
 v_cvt_pk_bf16_f32 v245, v254, v255
 v_mfma_f32_16x16x32_bf16 a[40:43], v[180:183], v[236:239], 0
 ds_read_b64_tr_b16 v[150:151], v17 offset:36864
 v_cvt_pk_bf16_f32 v60, v4, v5
 v_mfma_f32_16x16x32_bf16 a[44:47], v[180:183], v[52:55], 0
 v_cvt_pk_bf16_f32 v61, v6, v7
 v_mfma_f32_16x16x32_bf16 a[48:51], v[180:183], v[84:87], 0
 ds_read_b128 v[228:231], v12 offset:12288
 v_mfma_f32_16x16x32_bf16 a[52:55], v[180:183], v[116:119], 0
 s_waitcnt lgkmcnt(5)
 v_mfma_f32_16x16x32_bf16 a[56:59], v[212:215], v[140:143], 0
 ds_read_b128 v[44:47], v13 offset:12288
 v_mfma_f32_16x16x32_bf16 a[60:63], v[212:215], v[172:175], 0
 v_mfma_f32_16x16x32_bf16 a[228:231], v[28:31], v[172:175], 0
 v_mfma_f32_16x16x32_bf16 v[252:255], v[36:39], v[160:163], 0
 v_exp_f32 v76, v76
 v_mfma_f32_16x16x32_bf16 v[252:255], v[68:71], v[168:171], v[252:255]
 v_exp_f32 v77, v77
 v_mfma_f32_16x16x32_bf16 v[252:255], v[100:103], v[176:179], v[252:255]
 v_exp_f32 v78, v78
 v_mfma_f32_16x16x32_bf16 v[252:255], v[132:135], v[184:187], v[252:255]
 v_exp_f32 v79, v79
 v_mfma_f32_16x16x32_bf16 v[4:7], v[36:39], v[192:195], 0
 v_exp_f32 v108, v108
 v_mfma_f32_16x16x32_bf16 v[4:7], v[68:71], v[200:203], v[4:7]
 v_exp_f32 v109, v109
 v_mfma_f32_16x16x32_bf16 v[4:7], v[100:103], v[208:211], v[4:7]
 v_exp_f32 v110, v110
 v_mfma_f32_16x16x32_bf16 v[4:7], v[132:135], v[216:219], v[4:7]
 v_exp_f32 v111, v111
 v_mfma_f32_16x16x32_bf16 a[64:67], v[212:215], v[204:207], 0
 ds_read_b64_tr_b16 v[180:181], v18 offset:32768
 v_cvt_pk_bf16_f32 v92, v76, v77
 v_mfma_f32_16x16x32_bf16 a[68:71], v[212:215], v[236:239], 0
 v_cvt_pk_bf16_f32 v93, v78, v79
 v_mfma_f32_16x16x32_bf16 a[72:75], v[212:215], v[52:55], 0
 ds_read_b64_tr_b16 v[182:183], v18 offset:36864
 v_cvt_pk_bf16_f32 v124, v108, v109
 v_mfma_f32_16x16x32_bf16 a[76:79], v[212:215], v[84:87], 0
 v_cvt_pk_bf16_f32 v125, v110, v111
 v_mfma_f32_16x16x32_bf16 a[80:83], v[212:215], v[116:119], 0
 s_waitcnt lgkmcnt(4)
 v_mfma_f32_16x16x32_bf16 a[84:87], v[148:151], v[140:143], 0
 v_mfma_f32_16x16x32_bf16 a[88:91], v[148:151], v[172:175], 0
 v_mfma_f32_16x16x32_bf16 a[92:95], v[148:151], v[204:207], 0
 buffer_load_dwordx4 v24, s[16:19], s40 offen nt lds
 v_mfma_f32_16x16x32_bf16 a[232:235], v[28:31], v[204:207], 0
 buffer_load_dwordx4 v2, s[16:19], s40 offen offset:2048 nt lds
 s_waitcnt lgkmcnt(2)
 s_barrier
 v_mfma_f32_16x16x32_bf16 v[76:79], v[36:39], v[224:227], 0
 s_add_u32 m0, s45, 8192
 v_exp_f32 v252, v252
 v_mfma_f32_16x16x32_bf16 v[76:79], v[68:71], v[232:235], v[76:79]
 s_xor_b32 s40, s101, 6144
 v_exp_f32 v253, v253
 v_mfma_f32_16x16x32_bf16 v[76:79], v[100:103], v[240:243], v[76:79]
 v_exp_f32 v254, v254
 v_mfma_f32_16x16x32_bf16 v[76:79], v[132:135], v[248:251], v[76:79]
 v_exp_f32 v255, v255
 v_mfma_f32_16x16x32_bf16 v[108:111], v[164:167], v[32:35], 0
 v_exp_f32 v4, v4
 v_mfma_f32_16x16x32_bf16 v[108:111], v[196:199], v[40:43], v[108:111]
 v_exp_f32 v5, v5
 v_mfma_f32_16x16x32_bf16 v[108:111], v[228:231], v[48:51], v[108:111]
 v_exp_f32 v6, v6
 v_mfma_f32_16x16x32_bf16 v[108:111], v[44:47], v[56:59], v[108:111]
 v_exp_f32 v7, v7
 v_mfma_f32_16x16x32_bf16 a[96:99], v[148:151], v[236:239], 0
 ds_read_b64_tr_b16 v[212:213], v19 offset:32768
 v_cvt_pk_bf16_f32 v156, v252, v253
 v_mfma_f32_16x16x32_bf16 a[100:103], v[148:151], v[52:55], 0
 v_cvt_pk_bf16_f32 v157, v254, v255
 v_mfma_f32_16x16x32_bf16 a[104:107], v[148:151], v[84:87], 0
 ds_read_b64_tr_b16 v[214:215], v19 offset:36864
 v_cvt_pk_bf16_f32 v188, v4, v5
 v_mfma_f32_16x16x32_bf16 a[108:111], v[148:151], v[116:119], 0
 s_waitcnt lgkmcnt(2)
 v_cvt_pk_bf16_f32 v189, v6, v7
 v_mfma_f32_16x16x32_bf16 a[112:115], v[180:183], v[140:143], 0
 ds_read_b128 v[36:39], v10 offset:32768
 v_mfma_f32_16x16x32_bf16 a[116:119], v[180:183], v[172:175], 0
 v_mfma_f32_16x16x32_bf16 a[120:123], v[180:183], v[204:207], 0
 ds_read_b128 v[68:71], v11 offset:32768
 v_mfma_f32_16x16x32_bf16 a[124:127], v[180:183], v[236:239], 0
 v_mfma_f32_16x16x32_bf16 a[236:239], v[28:31], v[236:239], 0
 v_mfma_f32_16x16x32_bf16 v[252:255], v[164:167], v[64:67], 0
 v_exp_f32 v76, v76
 v_mfma_f32_16x16x32_bf16 v[252:255], v[196:199], v[72:75], v[252:255]
 v_exp_f32 v77, v77
 v_mfma_f32_16x16x32_bf16 v[252:255], v[228:231], v[80:83], v[252:255]
 v_exp_f32 v78, v78
 v_mfma_f32_16x16x32_bf16 v[252:255], v[44:47], v[88:91], v[252:255]
 v_exp_f32 v79, v79
 v_mfma_f32_16x16x32_bf16 v[4:7], v[164:167], v[96:99], 0
 v_exp_f32 v108, v108
 v_mfma_f32_16x16x32_bf16 v[4:7], v[196:199], v[104:107], v[4:7]
 v_exp_f32 v109, v109
 v_mfma_f32_16x16x32_bf16 v[4:7], v[228:231], v[112:115], v[4:7]
 s_branch SK3489
PG3489:
 s_branch PG5860
SK3489:
 v_exp_f32 v110, v110
 v_mfma_f32_16x16x32_bf16 v[4:7], v[44:47], v[120:123], v[4:7]
 v_exp_f32 v111, v111
 v_mfma_f32_16x16x32_bf16 a[128:131], v[180:183], v[52:55], 0
 ds_read_b64_tr_b16 v[148:149], v20 offset:32768
 v_cvt_pk_bf16_f32 v220, v76, v77
 v_mfma_f32_16x16x32_bf16 a[132:135], v[180:183], v[84:87], 0
 v_cvt_pk_bf16_f32 v221, v78, v79
 v_mfma_f32_16x16x32_bf16 a[136:139], v[180:183], v[116:119], 0
 s_waitcnt lgkmcnt(3)
 ds_read_b64_tr_b16 v[150:151], v20 offset:36864
 v_cvt_pk_bf16_f32 v246, v108, v109
 v_mfma_f32_16x16x32_bf16 a[140:143], v[212:215], v[140:143], 0
 v_cvt_pk_bf16_f32 v247, v110, v111
 v_mfma_f32_16x16x32_bf16 a[144:147], v[212:215], v[172:175], 0
 ds_read_b128 v[100:103], v12 offset:32768
 v_mfma_f32_16x16x32_bf16 a[148:151], v[212:215], v[204:207], 0
 v_mfma_f32_16x16x32_bf16 a[152:155], v[212:215], v[236:239], 0
 ds_read_b128 v[132:135], v13 offset:32768
 v_mfma_f32_16x16x32_bf16 a[156:159], v[212:215], v[52:55], 0
 buffer_load_dwordx4 v22, s[12:15], s40 offen nt lds
 v_mfma_f32_16x16x32_bf16 a[240:243], v[28:31], v[52:55], 0
 buffer_load_dwordx4 v23, s[12:15], s40 offen offset:2048 nt lds
 v_mfma_f32_16x16x32_bf16 v[76:79], v[164:167], v[128:131], 0
 s_add_u32 m0, s45, 12288
 v_exp_f32 v252, v252
 v_mfma_f32_16x16x32_bf16 v[76:79], v[196:199], v[136:139], v[76:79]
 s_xor_b32 s40, s101, 22528
 v_exp_f32 v253, v253
 v_mfma_f32_16x16x32_bf16 v[76:79], v[228:231], v[144:147], v[76:79]
 v_exp_f32 v254, v254
 v_mfma_f32_16x16x32_bf16 v[76:79], v[44:47], v[152:155], v[76:79]
 v_exp_f32 v255, v255
 v_mfma_f32_16x16x32_bf16 v[108:111], v[164:167], v[160:163], 0
 v_exp_f32 v4, v4
 v_mfma_f32_16x16x32_bf16 v[108:111], v[196:199], v[168:171], v[108:111]
 v_exp_f32 v5, v5
 v_mfma_f32_16x16x32_bf16 v[108:111], v[228:231], v[176:179], v[108:111]
 v_exp_f32 v6, v6
 v_mfma_f32_16x16x32_bf16 v[108:111], v[44:47], v[184:187], v[108:111]
 v_exp_f32 v7, v7
 v_mfma_f32_16x16x32_bf16 a[160:163], v[212:215], v[84:87], 0
 ds_read_b64_tr_b16 v[180:181], v21 offset:32768
 v_cvt_pk_bf16_f32 v62, v252, v253
 v_mfma_f32_16x16x32_bf16 a[164:167], v[212:215], v[116:119], 0
 s_waitcnt lgkmcnt(3)
 v_cvt_pk_bf16_f32 v63, v254, v255
 v_mfma_f32_16x16x32_bf16 a[168:171], v[148:151], v[140:143], 0
 ds_read_b64_tr_b16 v[182:183], v21 offset:36864
 v_cvt_pk_bf16_f32 v94, v4, v5
 v_mfma_f32_16x16x32_bf16 a[172:175], v[148:151], v[172:175], 0
 v_cvt_pk_bf16_f32 v95, v6, v7
 v_mfma_f32_16x16x32_bf16 a[176:179], v[148:151], v[204:207], 0
 v_mfma_f32_16x16x32_bf16 a[180:183], v[148:151], v[236:239], 0
 v_mfma_f32_16x16x32_bf16 a[184:187], v[148:151], v[52:55], 0
 v_mfma_f32_16x16x32_bf16 a[188:191], v[148:151], v[84:87], 0
CPF4:
 s_mov_b32 s88, CPF4-K1_BASE+2048
 buffer_load_dword v8, v9, s[96:99], s88 offen
 v_mfma_f32_16x16x32_bf16 a[244:247], v[28:31], v[84:87], 0
 v_mfma_f32_16x16x32_bf16 v[252:255], v[164:167], v[192:195], 0
 v_exp_f32 v76, v76
 v_mfma_f32_16x16x32_bf16 v[252:255], v[196:199], v[200:203], v[252:255]
 v_exp_f32 v77, v77
 v_mfma_f32_16x16x32_bf16 v[252:255], v[228:231], v[208:211], v[252:255]
 v_exp_f32 v78, v78
 v_mfma_f32_16x16x32_bf16 v[252:255], v[44:47], v[216:219], v[252:255]
 v_exp_f32 v79, v79
 v_mfma_f32_16x16x32_bf16 v[4:7], v[164:167], v[224:227], 0
 v_exp_f32 v108, v108
 v_mfma_f32_16x16x32_bf16 v[4:7], v[196:199], v[232:235], v[4:7]
 v_exp_f32 v109, v109
 v_mfma_f32_16x16x32_bf16 v[4:7], v[228:231], v[240:243], v[4:7]
 v_exp_f32 v110, v110
 v_mfma_f32_16x16x32_bf16 v[4:7], v[44:47], v[248:251], v[4:7]
 v_exp_f32 v111, v111
 v_mfma_f32_16x16x32_bf16 a[192:195], v[148:151], v[116:119], 0
 s_waitcnt lgkmcnt(0)
 ds_read_b64_tr_b16 v[212:213], v14 offset:40960
 v_cvt_pk_bf16_f32 v126, v76, v77
 v_mfma_f32_16x16x32_bf16 a[196:199], v[180:183], v[140:143], 0
 v_cvt_pk_bf16_f32 v127, v78, v79
 v_mfma_f32_16x16x32_bf16 a[200:203], v[180:183], v[172:175], 0
 ds_read_b64_tr_b16 v[214:215], v14 offset:45056
 v_cvt_pk_bf16_f32 v158, v108, v109
 v_mfma_f32_16x16x32_bf16 a[204:207], v[180:183], v[204:207], 0
 v_cvt_pk_bf16_f32 v159, v110, v111
 v_mfma_f32_16x16x32_bf16 a[208:211], v[180:183], v[236:239], 0
 ds_read_b64_tr_b16 v[148:149], v15 offset:40960
 v_mfma_f32_16x16x32_bf16 a[212:215], v[180:183], v[52:55], 0
 v_mfma_f32_16x16x32_bf16 a[216:219], v[180:183], v[84:87], 0
 ds_read_b64_tr_b16 v[150:151], v15 offset:45056
 v_mfma_f32_16x16x32_bf16 a[220:223], v[180:183], v[116:119], 0
 buffer_load_dwordx4 v22, s[12:15], s40 offen nt lds
 v_mfma_f32_16x16x32_bf16 a[248:251], v[28:31], v[116:119], 0
 s_waitcnt lgkmcnt(6)
 buffer_load_dwordx4 v23, s[12:15], s40 offen offset:2048 nt lds
 v_mfma_f32_16x16x32_bf16 v[76:79], v[36:39], v[32:35], 0
 s_add_u32 m0, s46, 32768
 v_exp_f32 v252, v252
 v_mfma_f32_16x16x32_bf16 v[76:79], v[68:71], v[40:43], v[76:79]
 s_xor_b32 s40, s101, 5120
 v_exp_f32 v253, v253
 v_mfma_f32_16x16x32_bf16 v[76:79], v[100:103], v[48:51], v[76:79]
 v_exp_f32 v254, v254
 v_mfma_f32_16x16x32_bf16 v[76:79], v[132:135], v[56:59], v[76:79]
 v_exp_f32 v255, v255
 v_mfma_f32_16x16x32_bf16 v[108:111], v[36:39], v[64:67], 0
 v_exp_f32 v4, v4
 v_mfma_f32_16x16x32_bf16 v[108:111], v[68:71], v[72:75], v[108:111]
 v_exp_f32 v5, v5
 v_mfma_f32_16x16x32_bf16 v[108:111], v[100:103], v[80:83], v[108:111]
 v_exp_f32 v6, v6
 v_mfma_f32_16x16x32_bf16 v[108:111], v[132:135], v[88:91], v[108:111]
 s_waitcnt lgkmcnt(2)
 v_exp_f32 v7, v7
 v_mfma_f32_16x16x32_bf16 a[0:3], v[212:215], v[244:247], a[0:3]
 ds_read_b64_tr_b16 v[180:181], v16 offset:40960
 v_cvt_pk_bf16_f32 v190, v252, v253
 v_mfma_f32_16x16x32_bf16 a[4:7], v[212:215], v[60:63], a[4:7]
 v_cvt_pk_bf16_f32 v191, v254, v255
 v_mfma_f32_16x16x32_bf16 a[8:11], v[212:215], v[92:95], a[8:11]
 ds_read_b64_tr_b16 v[182:183], v16 offset:45056
 v_cvt_pk_bf16_f32 v222, v4, v5
 v_mfma_f32_16x16x32_bf16 a[12:15], v[212:215], v[124:127], a[12:15]
 v_cvt_pk_bf16_f32 v223, v6, v7
 v_mfma_f32_16x16x32_bf16 a[16:19], v[212:215], v[156:159], a[16:19]
 ds_read_b128 v[164:167], v10 offset:36864
 v_mfma_f32_16x16x32_bf16 a[20:23], v[212:215], v[188:191], a[20:23]
 v_mfma_f32_16x16x32_bf16 a[24:27], v[212:215], v[220:223], a[24:27]
 s_waitcnt lgkmcnt(3)
 ds_read_b128 v[196:199], v11 offset:36864
 v_mfma_f32_16x16x32_bf16 a[28:31], v[148:151], v[244:247], a[28:31]
 v_mfma_f32_16x16x32_bf16 a[224:227], v[28:31], v[244:247], a[224:227]
 v_mfma_f32_16x16x32_bf16 v[252:255], v[36:39], v[96:99], 0
 v_exp_f32 v76, v76
 v_mfma_f32_16x16x32_bf16 v[252:255], v[68:71], v[104:107], v[252:255]
 v_exp_f32 v77, v77
 v_mfma_f32_16x16x32_bf16 v[252:255], v[100:103], v[112:115], v[252:255]
 v_exp_f32 v78, v78
 v_mfma_f32_16x16x32_bf16 v[252:255], v[132:135], v[120:123], v[252:255]
 v_exp_f32 v79, v79
 v_mfma_f32_16x16x32_bf16 v[4:7], v[36:39], v[128:131], 0
 v_exp_f32 v108, v108
 v_mfma_f32_16x16x32_bf16 v[4:7], v[68:71], v[136:139], v[4:7]
 v_exp_f32 v109, v109
 v_mfma_f32_16x16x32_bf16 v[4:7], v[100:103], v[144:147], v[4:7]
 v_exp_f32 v110, v110
 v_mfma_f32_16x16x32_bf16 v[4:7], v[132:135], v[152:155], v[4:7]
 v_exp_f32 v111, v111
 v_mfma_f32_16x16x32_bf16 a[32:35], v[148:151], v[60:63], a[32:35]
 ds_read_b64_tr_b16 v[212:213], v17 offset:40960
 v_cvt_pk_bf16_f32 v140, v76, v77
 v_mfma_f32_16x16x32_bf16 a[36:39], v[148:151], v[92:95], a[36:39]
 v_cvt_pk_bf16_f32 v141, v78, v79
 v_mfma_f32_16x16x32_bf16 a[40:43], v[148:151], v[124:127], a[40:43]
 ds_read_b64_tr_b16 v[214:215], v17 offset:45056
 v_cvt_pk_bf16_f32 v172, v108, v109
 v_mfma_f32_16x16x32_bf16 a[44:47], v[148:151], v[156:159], a[44:47]
 v_cvt_pk_bf16_f32 v173, v110, v111
 v_mfma_f32_16x16x32_bf16 a[48:51], v[148:151], v[188:191], a[48:51]
 ds_read_b128 v[228:231], v12 offset:36864
 v_mfma_f32_16x16x32_bf16 a[52:55], v[148:151], v[220:223], a[52:55]
 s_waitcnt lgkmcnt(5)
 v_mfma_f32_16x16x32_bf16 a[56:59], v[180:183], v[244:247], a[56:59]
 ds_read_b128 v[44:47], v13 offset:36864
 v_mfma_f32_16x16x32_bf16 a[60:63], v[180:183], v[60:63], a[60:63]
 v_mfma_f32_16x16x32_bf16 a[228:231], v[28:31], v[60:63], a[228:231]
 v_mfma_f32_16x16x32_bf16 v[76:79], v[36:39], v[160:163], 0
 v_exp_f32 v252, v252
 v_mfma_f32_16x16x32_bf16 v[76:79], v[68:71], v[168:171], v[76:79]
 v_exp_f32 v253, v253
 v_mfma_f32_16x16x32_bf16 v[76:79], v[100:103], v[176:179], v[76:79]
 v_exp_f32 v254, v254
 v_mfma_f32_16x16x32_bf16 v[76:79], v[132:135], v[184:187], v[76:79]
 v_exp_f32 v255, v255
 v_mfma_f32_16x16x32_bf16 v[108:111], v[36:39], v[192:195], 0
 v_exp_f32 v4, v4
 v_mfma_f32_16x16x32_bf16 v[108:111], v[68:71], v[200:203], v[108:111]
 v_exp_f32 v5, v5
 v_mfma_f32_16x16x32_bf16 v[108:111], v[100:103], v[208:211], v[108:111]
 v_exp_f32 v6, v6
 v_mfma_f32_16x16x32_bf16 v[108:111], v[132:135], v[216:219], v[108:111]
 v_exp_f32 v7, v7
 v_mfma_f32_16x16x32_bf16 a[64:67], v[180:183], v[92:95], a[64:67]
 ds_read_b64_tr_b16 v[148:149], v18 offset:40960
 v_cvt_pk_bf16_f32 v204, v252, v253
 v_mfma_f32_16x16x32_bf16 a[68:71], v[180:183], v[124:127], a[68:71]
 v_cvt_pk_bf16_f32 v205, v254, v255
 v_mfma_f32_16x16x32_bf16 a[72:75], v[180:183], v[156:159], a[72:75]
 ds_read_b64_tr_b16 v[150:151], v18 offset:45056
 v_cvt_pk_bf16_f32 v236, v4, v5
 v_mfma_f32_16x16x32_bf16 a[76:79], v[180:183], v[188:191], a[76:79]
 v_cvt_pk_bf16_f32 v237, v6, v7
 v_mfma_f32_16x16x32_bf16 a[80:83], v[180:183], v[220:223], a[80:83]
 s_waitcnt lgkmcnt(4)
 v_mfma_f32_16x16x32_bf16 a[84:87], v[212:215], v[244:247], a[84:87]
 v_mfma_f32_16x16x32_bf16 a[88:91], v[212:215], v[60:63], a[88:91]
 v_mfma_f32_16x16x32_bf16 a[92:95], v[212:215], v[92:95], a[92:95]
 v_mfma_f32_16x16x32_bf16 a[232:235], v[28:31], v[92:95], a[232:235]
 s_waitcnt lgkmcnt(2)
 s_barrier
 v_mfma_f32_16x16x32_bf16 v[252:255], v[36:39], v[224:227], 0
 v_exp_f32 v76, v76
 v_mfma_f32_16x16x32_bf16 v[252:255], v[68:71], v[232:235], v[252:255]
 v_exp_f32 v77, v77
 v_mfma_f32_16x16x32_bf16 v[252:255], v[100:103], v[240:243], v[252:255]
 v_exp_f32 v78, v78
 v_mfma_f32_16x16x32_bf16 v[252:255], v[132:135], v[248:251], v[252:255]
 v_exp_f32 v79, v79
 v_mfma_f32_16x16x32_bf16 v[4:7], v[164:167], v[32:35], 0
 v_exp_f32 v108, v108
 v_mfma_f32_16x16x32_bf16 v[4:7], v[196:199], v[40:43], v[4:7]
 v_exp_f32 v109, v109
 v_mfma_f32_16x16x32_bf16 v[4:7], v[228:231], v[48:51], v[4:7]
 v_exp_f32 v110, v110
 v_mfma_f32_16x16x32_bf16 v[4:7], v[44:47], v[56:59], v[4:7]
 v_exp_f32 v111, v111
 v_mfma_f32_16x16x32_bf16 a[96:99], v[212:215], v[124:127], a[96:99]
 ds_read_b64_tr_b16 v[180:181], v19 offset:40960
 v_cvt_pk_bf16_f32 v52, v76, v77
 v_mfma_f32_16x16x32_bf16 a[100:103], v[212:215], v[156:159], a[100:103]
 v_cvt_pk_bf16_f32 v53, v78, v79
 v_mfma_f32_16x16x32_bf16 a[104:107], v[212:215], v[188:191], a[104:107]
 ds_read_b64_tr_b16 v[182:183], v19 offset:45056
 v_cvt_pk_bf16_f32 v84, v108, v109
 v_mfma_f32_16x16x32_bf16 a[108:111], v[212:215], v[220:223], a[108:111]
 s_waitcnt lgkmcnt(2)
 v_cvt_pk_bf16_f32 v85, v110, v111
 v_mfma_f32_16x16x32_bf16 a[112:115], v[148:151], v[244:247], a[112:115]
 ds_read_b128 v[36:39], v10 offset:40960
 v_mfma_f32_16x16x32_bf16 a[116:119], v[148:151], v[60:63], a[116:119]
 v_mfma_f32_16x16x32_bf16 a[120:123], v[148:151], v[92:95], a[120:123]
 ds_read_b128 v[68:71], v11 offset:40960
 v_mfma_f32_16x16x32_bf16 a[124:127], v[148:151], v[124:127], a[124:127]
 buffer_load_dwordx4 v24, s[16:19], s40 offen nt lds
 v_mfma_f32_16x16x32_bf16 a[236:239], v[28:31], v[124:127], a[236:239]
 buffer_load_dwordx4 v2, s[16:19], s40 offen offset:2048 nt lds
 v_mfma_f32_16x16x32_bf16 v[76:79], v[164:167], v[64:67], 0
 s_add_u32 m0, s46, 36864
 v_exp_f32 v252, v252
 v_mfma_f32_16x16x32_bf16 v[76:79], v[196:199], v[72:75], v[76:79]
 s_xor_b32 s40, s101, 21504
 v_exp_f32 v253, v253
 v_mfma_f32_16x16x32_bf16 v[76:79], v[228:231], v[80:83], v[76:79]
 v_exp_f32 v254, v254
 v_mfma_f32_16x16x32_bf16 v[76:79], v[44:47], v[88:91], v[76:79]
 v_exp_f32 v255, v255
 v_mfma_f32_16x16x32_bf16 v[108:111], v[164:167], v[96:99], 0
 v_exp_f32 v4, v4
 v_mfma_f32_16x16x32_bf16 v[108:111], v[196:199], v[104:107], v[108:111]
 v_exp_f32 v5, v5
 v_mfma_f32_16x16x32_bf16 v[108:111], v[228:231], v[112:115], v[108:111]
 v_exp_f32 v6, v6
 v_mfma_f32_16x16x32_bf16 v[108:111], v[44:47], v[120:123], v[108:111]
 v_exp_f32 v7, v7
 v_mfma_f32_16x16x32_bf16 a[128:131], v[148:151], v[156:159], a[128:131]
 ds_read_b64_tr_b16 v[212:213], v20 offset:40960
 v_cvt_pk_bf16_f32 v116, v252, v253
 v_mfma_f32_16x16x32_bf16 a[132:135], v[148:151], v[188:191], a[132:135]
 v_cvt_pk_bf16_f32 v117, v254, v255
 v_mfma_f32_16x16x32_bf16 a[136:139], v[148:151], v[220:223], a[136:139]
 s_waitcnt lgkmcnt(3)
 ds_read_b64_tr_b16 v[214:215], v20 offset:45056
 v_cvt_pk_bf16_f32 v142, v4, v5
 v_mfma_f32_16x16x32_bf16 a[140:143], v[180:183], v[244:247], a[140:143]
 v_cvt_pk_bf16_f32 v143, v6, v7
 v_mfma_f32_16x16x32_bf16 a[144:147], v[180:183], v[60:63], a[144:147]
 ds_read_b128 v[100:103], v12 offset:40960
 v_mfma_f32_16x16x32_bf16 a[148:151], v[180:183], v[92:95], a[148:151]
 v_mfma_f32_16x16x32_bf16 a[152:155], v[180:183], v[124:127], a[152:155]
 ds_read_b128 v[132:135], v13 offset:40960
 v_mfma_f32_16x16x32_bf16 a[156:159], v[180:183], v[156:159], a[156:159]
 v_mfma_f32_16x16x32_bf16 a[240:243], v[28:31], v[156:159], a[240:243]
 v_mfma_f32_16x16x32_bf16 v[252:255], v[164:167], v[128:131], 0
 v_exp_f32 v76, v76
 v_mfma_f32_16x16x32_bf16 v[252:255], v[196:199], v[136:139], v[252:255]
 v_exp_f32 v77, v77
 v_mfma_f32_16x16x32_bf16 v[252:255], v[228:231], v[144:147], v[252:255]
 v_exp_f32 v78, v78
 v_mfma_f32_16x16x32_bf16 v[252:255], v[44:47], v[152:155], v[252:255]
 v_exp_f32 v79, v79
 v_mfma_f32_16x16x32_bf16 v[4:7], v[164:167], v[160:163], 0
 v_exp_f32 v108, v108
 v_mfma_f32_16x16x32_bf16 v[4:7], v[196:199], v[168:171], v[4:7]
 v_exp_f32 v109, v109
 v_mfma_f32_16x16x32_bf16 v[4:7], v[228:231], v[176:179], v[4:7]
 v_exp_f32 v110, v110
 v_mfma_f32_16x16x32_bf16 v[4:7], v[44:47], v[184:187], v[4:7]
 v_exp_f32 v111, v111
 v_mfma_f32_16x16x32_bf16 a[160:163], v[180:183], v[188:191], a[160:163]
 ds_read_b64_tr_b16 v[148:149], v21 offset:40960
 v_cvt_pk_bf16_f32 v174, v76, v77
 v_mfma_f32_16x16x32_bf16 a[164:167], v[180:183], v[220:223], a[164:167]
 s_waitcnt lgkmcnt(3)
 v_cvt_pk_bf16_f32 v175, v78, v79
 v_mfma_f32_16x16x32_bf16 a[168:171], v[212:215], v[244:247], a[168:171]
 ds_read_b64_tr_b16 v[150:151], v21 offset:45056
 v_cvt_pk_bf16_f32 v206, v108, v109
 v_mfma_f32_16x16x32_bf16 a[172:175], v[212:215], v[60:63], a[172:175]
 v_cvt_pk_bf16_f32 v207, v110, v111
 v_mfma_f32_16x16x32_bf16 a[176:179], v[212:215], v[92:95], a[176:179]
 v_mfma_f32_16x16x32_bf16 a[180:183], v[212:215], v[124:127], a[180:183]
 v_mfma_f32_16x16x32_bf16 a[184:187], v[212:215], v[156:159], a[184:187]
 v_mfma_f32_16x16x32_bf16 a[188:191], v[212:215], v[188:191], a[188:191]
 buffer_load_dwordx4 v24, s[16:19], s40 offen nt lds
 v_mfma_f32_16x16x32_bf16 a[244:247], v[28:31], v[188:191], a[244:247]
 buffer_load_dwordx4 v2, s[16:19], s40 offen offset:2048 nt lds
 v_mfma_f32_16x16x32_bf16 v[76:79], v[164:167], v[192:195], 0
 s_add_u32 m0, s45, 32768
 v_exp_f32 v252, v252
 v_mfma_f32_16x16x32_bf16 v[76:79], v[196:199], v[200:203], v[76:79]
 s_xor_b32 s40, s101, 7168
 v_exp_f32 v253, v253
 v_mfma_f32_16x16x32_bf16 v[76:79], v[228:231], v[208:211], v[76:79]
 v_exp_f32 v254, v254
 v_mfma_f32_16x16x32_bf16 v[76:79], v[44:47], v[216:219], v[76:79]
 v_exp_f32 v255, v255
 v_mfma_f32_16x16x32_bf16 v[108:111], v[164:167], v[224:227], 0
 v_exp_f32 v4, v4
 v_mfma_f32_16x16x32_bf16 v[108:111], v[196:199], v[232:235], v[108:111]
 v_exp_f32 v5, v5
 v_mfma_f32_16x16x32_bf16 v[108:111], v[228:231], v[240:243], v[108:111]
 v_exp_f32 v6, v6
 v_mfma_f32_16x16x32_bf16 v[108:111], v[44:47], v[248:251], v[108:111]
 v_exp_f32 v7, v7
 v_mfma_f32_16x16x32_bf16 a[192:195], v[212:215], v[220:223], a[192:195]
 s_waitcnt lgkmcnt(0)
 ds_read_b64_tr_b16 v[180:181], v14 offset:0
 v_cvt_pk_bf16_f32 v238, v252, v253
 v_mfma_f32_16x16x32_bf16 a[196:199], v[148:151], v[244:247], a[196:199]
 v_cvt_pk_bf16_f32 v239, v254, v255
 v_mfma_f32_16x16x32_bf16 a[200:203], v[148:151], v[60:63], a[200:203]
 ds_read_b64_tr_b16 v[182:183], v14 offset:4096
 v_cvt_pk_bf16_f32 v54, v4, v5
 v_mfma_f32_16x16x32_bf16 a[204:207], v[148:151], v[92:95], a[204:207]
 v_cvt_pk_bf16_f32 v55, v6, v7
 v_mfma_f32_16x16x32_bf16 a[208:211], v[148:151], v[124:127], a[208:211]
 ds_read_b64_tr_b16 v[212:213], v15 offset:0
 v_mfma_f32_16x16x32_bf16 a[212:215], v[148:151], v[156:159], a[212:215]
 v_mfma_f32_16x16x32_bf16 a[216:219], v[148:151], v[188:191], a[216:219]
 ds_read_b64_tr_b16 v[214:215], v15 offset:4096
 v_mfma_f32_16x16x32_bf16 a[220:223], v[148:151], v[220:223], a[220:223]
 v_mfma_f32_16x16x32_bf16 a[248:251], v[28:31], v[220:223], a[248:251]
 s_waitcnt lgkmcnt(6)
 v_mfma_f32_16x16x32_bf16 v[252:255], v[36:39], v[32:35], 0
 v_exp_f32 v76, v76
 v_mfma_f32_16x16x32_bf16 v[252:255], v[68:71], v[40:43], v[252:255]
 v_exp_f32 v77, v77
 v_mfma_f32_16x16x32_bf16 v[252:255], v[100:103], v[48:51], v[252:255]
 v_exp_f32 v78, v78
 v_mfma_f32_16x16x32_bf16 v[252:255], v[132:135], v[56:59], v[252:255]
 v_exp_f32 v79, v79
 v_mfma_f32_16x16x32_bf16 v[4:7], v[36:39], v[64:67], 0
 v_exp_f32 v108, v108
 v_mfma_f32_16x16x32_bf16 v[4:7], v[68:71], v[72:75], v[4:7]
 v_exp_f32 v109, v109
 v_mfma_f32_16x16x32_bf16 v[4:7], v[100:103], v[80:83], v[4:7]
 v_exp_f32 v110, v110
 v_mfma_f32_16x16x32_bf16 v[4:7], v[132:135], v[88:91], v[4:7]
 s_waitcnt lgkmcnt(2)
 v_exp_f32 v111, v111
 v_mfma_f32_16x16x32_bf16 a[0:3], v[180:183], v[140:143], a[0:3]
 ds_read_b64_tr_b16 v[148:149], v16 offset:0
 v_cvt_pk_bf16_f32 v86, v76, v77
 v_mfma_f32_16x16x32_bf16 a[4:7], v[180:183], v[172:175], a[4:7]
 v_cvt_pk_bf16_f32 v87, v78, v79
 v_mfma_f32_16x16x32_bf16 a[8:11], v[180:183], v[204:207], a[8:11]
 ds_read_b64_tr_b16 v[150:151], v16 offset:4096
 v_cvt_pk_bf16_f32 v118, v108, v109
 v_mfma_f32_16x16x32_bf16 a[12:15], v[180:183], v[236:239], a[12:15]
 v_cvt_pk_bf16_f32 v119, v110, v111
 v_mfma_f32_16x16x32_bf16 a[16:19], v[180:183], v[52:55], a[16:19]
 ds_read_b128 v[164:167], v10 offset:45056
 v_add_u32 v10, 131072, v10
 v_mfma_f32_16x16x32_bf16 a[20:23], v[180:183], v[84:87], a[20:23]
 v_mfma_f32_16x16x32_bf16 a[24:27], v[180:183], v[116:119], a[24:27]
 s_waitcnt lgkmcnt(3)
 ds_read_b128 v[196:199], v11 offset:45056
 v_add_u32 v11, 131072, v11
 v_mfma_f32_16x16x32_bf16 a[28:31], v[212:215], v[140:143], a[28:31]
 buffer_load_dwordx4 v22, s[12:15], s40 offen nt lds
 v_mfma_f32_16x16x32_bf16 a[224:227], v[28:31], v[140:143], a[224:227]
 buffer_load_dwordx4 v23, s[12:15], s40 offen offset:2048 nt lds
 v_mfma_f32_16x16x32_bf16 v[76:79], v[36:39], v[96:99], 0
 s_add_u32 m0, s45, 36864
 v_exp_f32 v252, v252
 v_mfma_f32_16x16x32_bf16 v[76:79], v[68:71], v[104:107], v[76:79]
 s_xor_b32 s40, s101, 23552
 v_exp_f32 v253, v253
 v_mfma_f32_16x16x32_bf16 v[76:79], v[100:103], v[112:115], v[76:79]
 v_exp_f32 v254, v254
 v_mfma_f32_16x16x32_bf16 v[76:79], v[132:135], v[120:123], v[76:79]
 v_exp_f32 v255, v255
 v_mfma_f32_16x16x32_bf16 v[108:111], v[36:39], v[128:131], 0
 v_exp_f32 v4, v4
 v_mfma_f32_16x16x32_bf16 v[108:111], v[68:71], v[136:139], v[108:111]
 v_exp_f32 v5, v5
 v_mfma_f32_16x16x32_bf16 v[108:111], v[100:103], v[144:147], v[108:111]
 v_exp_f32 v6, v6
 v_mfma_f32_16x16x32_bf16 v[108:111], v[132:135], v[152:155], v[108:111]
 v_exp_f32 v7, v7
 v_mfma_f32_16x16x32_bf16 a[32:35], v[212:215], v[172:175], a[32:35]
 ds_read_b64_tr_b16 v[180:181], v17 offset:0
 v_cvt_pk_bf16_f32 v244, v252, v253
 v_mfma_f32_16x16x32_bf16 a[36:39], v[212:215], v[204:207], a[36:39]
 v_cvt_pk_bf16_f32 v245, v254, v255
 v_mfma_f32_16x16x32_bf16 a[40:43], v[212:215], v[236:239], a[40:43]
 ds_read_b64_tr_b16 v[182:183], v17 offset:4096
 v_cvt_pk_bf16_f32 v60, v4, v5
 v_mfma_f32_16x16x32_bf16 a[44:47], v[212:215], v[52:55], a[44:47]
 v_cvt_pk_bf16_f32 v61, v6, v7
 v_mfma_f32_16x16x32_bf16 a[48:51], v[212:215], v[84:87], a[48:51]
 ds_read_b128 v[228:231], v12 offset:45056
 v_add_u32 v12, 131072, v12
 v_mfma_f32_16x16x32_bf16 a[52:55], v[212:215], v[116:119], a[52:55]
 s_waitcnt lgkmcnt(5)
 v_mfma_f32_16x16x32_bf16 a[56:59], v[148:151], v[140:143], a[56:59]
 ds_read_b128 v[44:47], v13 offset:45056
 v_add_u32 v13, 131072, v13
 v_mfma_f32_16x16x32_bf16 a[60:63], v[148:151], v[172:175], a[60:63]
 v_mfma_f32_16x16x32_bf16 a[228:231], v[28:31], v[172:175], a[228:231]
 v_mfma_f32_16x16x32_bf16 v[252:255], v[36:39], v[160:163], 0
 v_exp_f32 v76, v76
 v_mfma_f32_16x16x32_bf16 v[252:255], v[68:71], v[168:171], v[252:255]
 v_exp_f32 v77, v77
 v_mfma_f32_16x16x32_bf16 v[252:255], v[100:103], v[176:179], v[252:255]
 v_exp_f32 v78, v78
 v_mfma_f32_16x16x32_bf16 v[252:255], v[132:135], v[184:187], v[252:255]
 v_exp_f32 v79, v79
 v_mfma_f32_16x16x32_bf16 v[4:7], v[36:39], v[192:195], 0
 v_exp_f32 v108, v108
 v_mfma_f32_16x16x32_bf16 v[4:7], v[68:71], v[200:203], v[4:7]
 v_exp_f32 v109, v109
 v_mfma_f32_16x16x32_bf16 v[4:7], v[100:103], v[208:211], v[4:7]
 v_exp_f32 v110, v110
 v_mfma_f32_16x16x32_bf16 v[4:7], v[132:135], v[216:219], v[4:7]
 v_exp_f32 v111, v111
 v_mfma_f32_16x16x32_bf16 a[64:67], v[148:151], v[204:207], a[64:67]
 ds_read_b64_tr_b16 v[212:213], v18 offset:0
 v_cvt_pk_bf16_f32 v92, v76, v77
 v_mfma_f32_16x16x32_bf16 a[68:71], v[148:151], v[236:239], a[68:71]
 v_cvt_pk_bf16_f32 v93, v78, v79
 v_mfma_f32_16x16x32_bf16 a[72:75], v[148:151], v[52:55], a[72:75]
 ds_read_b64_tr_b16 v[214:215], v18 offset:4096
 v_cvt_pk_bf16_f32 v124, v108, v109
 v_mfma_f32_16x16x32_bf16 a[76:79], v[148:151], v[84:87], a[76:79]
 v_cvt_pk_bf16_f32 v125, v110, v111
 v_mfma_f32_16x16x32_bf16 a[80:83], v[148:151], v[116:119], a[80:83]
 s_waitcnt lgkmcnt(4)
 v_mfma_f32_16x16x32_bf16 a[84:87], v[180:183], v[140:143], a[84:87]
 v_mfma_f32_16x16x32_bf16 a[88:91], v[180:183], v[172:175], a[88:91]
 v_mfma_f32_16x16x32_bf16 a[92:95], v[180:183], v[204:207], a[92:95]
 buffer_load_dwordx4 v22, s[12:15], s40 offen nt lds
 v_mfma_f32_16x16x32_bf16 a[232:235], v[28:31], v[204:207], a[232:235]
 buffer_load_dwordx4 v23, s[12:15], s40 offen offset:2048 nt lds
 s_waitcnt vmcnt(21) lgkmcnt(2)
 s_barrier
 v_mfma_f32_16x16x32_bf16 v[76:79], v[36:39], v[224:227], 0
 s_waitcnt vmcnt(26)
 v_exp_f32 v252, v252
 v_mfma_f32_16x16x32_bf16 v[76:79], v[68:71], v[232:235], v[76:79]
 s_add_u32 m0, s46, 40960
 v_exp_f32 v253, v253
 v_mfma_f32_16x16x32_bf16 v[76:79], v[100:103], v[240:243], v[76:79]
 s_xor_b32 s40, s101, 6144
 v_exp_f32 v254, v254
 v_mfma_f32_16x16x32_bf16 v[76:79], v[132:135], v[248:251], v[76:79]
 v_exp_f32 v255, v255
 v_mfma_f32_16x16x32_bf16 v[108:111], v[164:167], v[32:35], 0
 v_exp_f32 v4, v4
 v_mfma_f32_16x16x32_bf16 v[108:111], v[196:199], v[40:43], v[108:111]
 v_exp_f32 v5, v5
 v_mfma_f32_16x16x32_bf16 v[108:111], v[228:231], v[48:51], v[108:111]
 v_exp_f32 v6, v6
 v_mfma_f32_16x16x32_bf16 v[108:111], v[44:47], v[56:59], v[108:111]
 v_exp_f32 v7, v7
 v_mfma_f32_16x16x32_bf16 a[96:99], v[180:183], v[236:239], a[96:99]
 ds_read_b64_tr_b16 v[148:149], v19 offset:0
 v_cvt_pk_bf16_f32 v156, v252, v253
 v_mfma_f32_16x16x32_bf16 a[100:103], v[180:183], v[52:55], a[100:103]
 v_cvt_pk_bf16_f32 v157, v254, v255
 v_mfma_f32_16x16x32_bf16 a[104:107], v[180:183], v[84:87], a[104:107]
 ds_read_b64_tr_b16 v[150:151], v19 offset:4096
 v_cvt_pk_bf16_f32 v188, v4, v5
 v_mfma_f32_16x16x32_bf16 a[108:111], v[180:183], v[116:119], a[108:111]
 s_waitcnt lgkmcnt(2)
 v_cvt_pk_bf16_f32 v189, v6, v7
 v_mfma_f32_16x16x32_bf16 a[112:115], v[212:215], v[140:143], a[112:115]
 ds_read_b128 v[36:39], v10 offset:0
 v_mfma_f32_16x16x32_bf16 a[116:119], v[212:215], v[172:175], a[116:119]
 v_mfma_f32_16x16x32_bf16 a[120:123], v[212:215], v[204:207], a[120:123]
 ds_read_b128 v[68:71], v11 offset:0
 v_mfma_f32_16x16x32_bf16 a[124:127], v[212:215], v[236:239], a[124:127]
 v_mfma_f32_16x16x32_bf16 a[236:239], v[28:31], v[236:239], a[236:239]
 v_mfma_f32_16x16x32_bf16 v[252:255], v[164:167], v[64:67], 0
 s_lshl_b32 s74, s43, 4
 v_exp_f32 v76, v76
 v_mfma_f32_16x16x32_bf16 v[252:255], v[196:199], v[72:75], v[252:255]
 s_add_u32 s74, s74, s39
 v_exp_f32 v77, v77
 v_mfma_f32_16x16x32_bf16 v[252:255], v[228:231], v[80:83], v[252:255]
 s_lshl_b32 s75, s36, 7
 v_exp_f32 v78, v78
 v_mfma_f32_16x16x32_bf16 v[252:255], v[44:47], v[88:91], v[252:255]
 s_add_u32 s74, s74, s75
 v_exp_f32 v79, v79
 v_mfma_f32_16x16x32_bf16 v[4:7], v[164:167], v[96:99], 0
 v_exp_f32 v108, v108
 v_mfma_f32_16x16x32_bf16 v[4:7], v[196:199], v[104:107], v[4:7]
 v_exp_f32 v109, v109
 v_mfma_f32_16x16x32_bf16 v[4:7], v[228:231], v[112:115], v[4:7]
 v_exp_f32 v110, v110
 v_mfma_f32_16x16x32_bf16 v[4:7], v[44:47], v[120:123], v[4:7]
 v_exp_f32 v111, v111
 v_mfma_f32_16x16x32_bf16 a[128:131], v[212:215], v[52:55], a[128:131]
 ds_read_b64_tr_b16 v[180:181], v20 offset:0
 v_cvt_pk_bf16_f32 v220, v76, v77
 v_mfma_f32_16x16x32_bf16 a[132:135], v[212:215], v[84:87], a[132:135]
 v_cvt_pk_bf16_f32 v221, v78, v79
 v_mfma_f32_16x16x32_bf16 a[136:139], v[212:215], v[116:119], a[136:139]
 s_waitcnt lgkmcnt(3)
 ds_read_b64_tr_b16 v[182:183], v20 offset:4096
 v_cvt_pk_bf16_f32 v246, v108, v109
 v_mfma_f32_16x16x32_bf16 a[140:143], v[148:151], v[140:143], a[140:143]
 v_cvt_pk_bf16_f32 v247, v110, v111
 v_mov_b32 v26, 1
 v_mov_b32 v25, 0
 v_mfma_f32_16x16x32_bf16 a[144:147], v[148:151], v[172:175], a[144:147]
 ds_read_b128 v[100:103], v12 offset:0
 v_mfma_f32_16x16x32_bf16 a[148:151], v[148:151], v[204:207], a[148:151]
 v_mfma_f32_16x16x32_bf16 a[152:155], v[148:151], v[236:239], a[152:155]
 ds_read_b128 v[132:135], v13 offset:0
 v_mfma_f32_16x16x32_bf16 a[156:159], v[148:151], v[52:55], a[156:159]
 buffer_load_dwordx4 v24, s[16:19], s40 offen nt lds
 v_mfma_f32_16x16x32_bf16 a[240:243], v[28:31], v[52:55], a[240:243]
 buffer_load_dwordx4 v2, s[16:19], s40 offen offset:2048 nt lds
 v_mfma_f32_16x16x32_bf16 v[76:79], v[164:167], v[128:131], 0
 s_add_u32 m0, s46, 45056
 v_exp_f32 v252, v252
 v_mfma_f32_16x16x32_bf16 v[76:79], v[196:199], v[136:139], v[76:79]
 s_xor_b32 s40, s101, 22528
 v_exp_f32 v253, v253
 v_mfma_f32_16x16x32_bf16 v[76:79], v[228:231], v[144:147], v[76:79]
 v_exp_f32 v254, v254
 v_mfma_f32_16x16x32_bf16 v[76:79], v[44:47], v[152:155], v[76:79]
 v_exp_f32 v255, v255
 v_mfma_f32_16x16x32_bf16 v[108:111], v[164:167], v[160:163], 0
 v_exp_f32 v4, v4
 v_mfma_f32_16x16x32_bf16 v[108:111], v[196:199], v[168:171], v[108:111]
 v_exp_f32 v5, v5
 v_mfma_f32_16x16x32_bf16 v[108:111], v[228:231], v[176:179], v[108:111]
 v_exp_f32 v6, v6
 v_mfma_f32_16x16x32_bf16 v[108:111], v[44:47], v[184:187], v[108:111]
 v_exp_f32 v7, v7
 v_mfma_f32_16x16x32_bf16 a[160:163], v[148:151], v[84:87], a[160:163]
 ds_read_b64_tr_b16 v[212:213], v21 offset:0
 v_cvt_pk_bf16_f32 v62, v252, v253
 v_mfma_f32_16x16x32_bf16 a[164:167], v[148:151], v[116:119], a[164:167]
 s_waitcnt lgkmcnt(3)
 v_cvt_pk_bf16_f32 v63, v254, v255
 v_mfma_f32_16x16x32_bf16 a[168:171], v[180:183], v[140:143], a[168:171]
 ds_read_b64_tr_b16 v[214:215], v21 offset:4096
 v_cvt_pk_bf16_f32 v94, v4, v5
 v_mfma_f32_16x16x32_bf16 a[172:175], v[180:183], v[172:175], a[172:175]
 v_cvt_pk_bf16_f32 v95, v6, v7
 v_mfma_f32_16x16x32_bf16 a[176:179], v[180:183], v[204:207], a[176:179]
 v_mfma_f32_16x16x32_bf16 a[180:183], v[180:183], v[236:239], a[180:183]
 v_mfma_f32_16x16x32_bf16 a[184:187], v[180:183], v[52:55], a[184:187]
 v_mfma_f32_16x16x32_bf16 a[188:191], v[180:183], v[84:87], a[188:191]
 v_mfma_f32_16x16x32_bf16 a[244:247], v[28:31], v[84:87], a[244:247]
 v_mfma_f32_16x16x32_bf16 v[252:255], v[164:167], v[192:195], 0
 s_mov_b64 exec, 1
 buffer_store_byte v26, v25, s[84:87], s74 offen sc1
 s_mov_b64 exec, -1
 s_nop 3
 v_exp_f32 v76, v76
 v_mfma_f32_16x16x32_bf16 v[252:255], v[196:199], v[200:203], v[252:255]
 v_exp_f32 v77, v77
 v_mfma_f32_16x16x32_bf16 v[252:255], v[228:231], v[208:211], v[252:255]
 v_exp_f32 v78, v78
 v_mfma_f32_16x16x32_bf16 v[252:255], v[44:47], v[216:219], v[252:255]
 v_exp_f32 v79, v79
 v_mfma_f32_16x16x32_bf16 v[4:7], v[164:167], v[224:227], 0
 v_exp_f32 v108, v108
 v_mfma_f32_16x16x32_bf16 v[4:7], v[196:199], v[232:235], v[4:7]
 v_exp_f32 v109, v109
 v_mfma_f32_16x16x32_bf16 v[4:7], v[228:231], v[240:243], v[4:7]
 v_exp_f32 v110, v110
 v_mfma_f32_16x16x32_bf16 v[4:7], v[44:47], v[248:251], v[4:7]
 v_exp_f32 v111, v111
 v_mfma_f32_16x16x32_bf16 a[192:195], v[180:183], v[116:119], a[192:195]
 s_waitcnt lgkmcnt(0)
 ds_read_b64_tr_b16 v[148:149], v14 offset:8192
 v_cvt_pk_bf16_f32 v126, v76, v77
 v_mfma_f32_16x16x32_bf16 a[196:199], v[212:215], v[140:143], a[196:199]
 s_branch SK4086
PG4086:
 s_branch PG6452
SK4086:
 v_cvt_pk_bf16_f32 v127, v78, v79
 v_mfma_f32_16x16x32_bf16 a[200:203], v[212:215], v[172:175], a[200:203]
 ds_read_b64_tr_b16 v[150:151], v14 offset:12288
 v_add_u32 v14, 73728, v14
 v_cvt_pk_bf16_f32 v158, v108, v109
 v_mfma_f32_16x16x32_bf16 a[204:207], v[212:215], v[204:207], a[204:207]
 v_cvt_pk_bf16_f32 v159, v110, v111
 v_mfma_f32_16x16x32_bf16 a[208:211], v[212:215], v[236:239], a[208:211]
 ds_read_b64_tr_b16 v[180:181], v15 offset:8192
 v_mfma_f32_16x16x32_bf16 a[212:215], v[212:215], v[52:55], a[212:215]
 v_mfma_f32_16x16x32_bf16 a[216:219], v[212:215], v[84:87], a[216:219]
 ds_read_b64_tr_b16 v[182:183], v15 offset:12288
 v_add_u32 v15, 73728, v15
 v_mfma_f32_16x16x32_bf16 a[220:223], v[212:215], v[116:119], a[220:223]
 buffer_load_dwordx4 v24, s[16:19], s40 offen nt lds
 v_mfma_f32_16x16x32_bf16 a[248:251], v[28:31], v[116:119], a[248:251]
 s_waitcnt lgkmcnt(6)
 buffer_load_dwordx4 v2, s[16:19], s40 offen offset:2048 nt lds
 v_mfma_f32_16x16x32_bf16 v[76:79], v[36:39], v[32:35], 0
 s_add_u32 m0, s45, 40960
 v_exp_f32 v252, v252
 v_mfma_f32_16x16x32_bf16 v[76:79], v[68:71], v[40:43], v[76:79]
 s_xor_b32 s40, s101, 8192
 v_exp_f32 v253, v253
 v_mfma_f32_16x16x32_bf16 v[76:79], v[100:103], v[48:51], v[76:79]
 v_exp_f32 v254, v254
 v_mfma_f32_16x16x32_bf16 v[76:79], v[132:135], v[56:59], v[76:79]
 v_exp_f32 v255, v255
 v_mfma_f32_16x16x32_bf16 v[108:111], v[36:39], v[64:67], 0
 v_exp_f32 v4, v4
 v_mfma_f32_16x16x32_bf16 v[108:111], v[68:71], v[72:75], v[108:111]
 v_exp_f32 v5, v5
 v_mfma_f32_16x16x32_bf16 v[108:111], v[100:103], v[80:83], v[108:111]
 v_exp_f32 v6, v6
 v_mfma_f32_16x16x32_bf16 v[108:111], v[132:135], v[88:91], v[108:111]
 s_waitcnt lgkmcnt(2)
 v_exp_f32 v7, v7
 v_mfma_f32_16x16x32_bf16 a[0:3], v[148:151], v[244:247], a[0:3]
 ds_read_b64_tr_b16 v[212:213], v16 offset:8192
 v_cvt_pk_bf16_f32 v190, v252, v253
 v_mfma_f32_16x16x32_bf16 a[4:7], v[148:151], v[60:63], a[4:7]
 v_cvt_pk_bf16_f32 v191, v254, v255
 v_mfma_f32_16x16x32_bf16 a[8:11], v[148:151], v[92:95], a[8:11]
 ds_read_b64_tr_b16 v[214:215], v16 offset:12288
 v_add_u32 v16, 73728, v16
 v_cvt_pk_bf16_f32 v222, v4, v5
 v_mfma_f32_16x16x32_bf16 a[12:15], v[148:151], v[124:127], a[12:15]
 v_cvt_pk_bf16_f32 v223, v6, v7
 v_mfma_f32_16x16x32_bf16 a[16:19], v[148:151], v[156:159], a[16:19]
 ds_read_b128 v[164:167], v10 offset:4096
 v_add_u32 v10, 0xfffe0000, v10
 v_mfma_f32_16x16x32_bf16 a[20:23], v[148:151], v[188:191], a[20:23]
 v_mfma_f32_16x16x32_bf16 a[24:27], v[148:151], v[220:223], a[24:27]
 s_waitcnt lgkmcnt(3)
 ds_read_b128 v[196:199], v11 offset:4096
 v_add_u32 v11, 0xfffe0000, v11
 v_mfma_f32_16x16x32_bf16 a[28:31], v[180:183], v[244:247], a[28:31]
 v_mfma_f32_16x16x32_bf16 a[224:227], v[28:31], v[244:247], a[224:227]
 v_mfma_f32_16x16x32_bf16 v[252:255], v[36:39], v[96:99], 0
 v_exp_f32 v76, v76
 v_mfma_f32_16x16x32_bf16 v[252:255], v[68:71], v[104:107], v[252:255]
 v_exp_f32 v77, v77
 v_mfma_f32_16x16x32_bf16 v[252:255], v[100:103], v[112:115], v[252:255]
 v_exp_f32 v78, v78
 v_mfma_f32_16x16x32_bf16 v[252:255], v[132:135], v[120:123], v[252:255]
 v_exp_f32 v79, v79
 v_mfma_f32_16x16x32_bf16 v[4:7], v[36:39], v[128:131], 0
 v_exp_f32 v108, v108
 v_mfma_f32_16x16x32_bf16 v[4:7], v[68:71], v[136:139], v[4:7]
 v_exp_f32 v109, v109
 v_mfma_f32_16x16x32_bf16 v[4:7], v[100:103], v[144:147], v[4:7]
 v_exp_f32 v110, v110
 v_mfma_f32_16x16x32_bf16 v[4:7], v[132:135], v[152:155], v[4:7]
 v_exp_f32 v111, v111
 v_mfma_f32_16x16x32_bf16 a[32:35], v[180:183], v[60:63], a[32:35]
 ds_read_b64_tr_b16 v[148:149], v17 offset:8192
 v_cvt_pk_bf16_f32 v140, v76, v77
 v_mfma_f32_16x16x32_bf16 a[36:39], v[180:183], v[92:95], a[36:39]
 v_cvt_pk_bf16_f32 v141, v78, v79
 v_mfma_f32_16x16x32_bf16 a[40:43], v[180:183], v[124:127], a[40:43]
 ds_read_b64_tr_b16 v[150:151], v17 offset:12288
 v_add_u32 v17, 73728, v17
 v_cvt_pk_bf16_f32 v172, v108, v109
 v_mfma_f32_16x16x32_bf16 a[44:47], v[180:183], v[156:159], a[44:47]
 v_cvt_pk_bf16_f32 v173, v110, v111
 v_mfma_f32_16x16x32_bf16 a[48:51], v[180:183], v[188:191], a[48:51]
 ds_read_b128 v[228:231], v12 offset:4096
 v_add_u32 v12, 0xfffe0000, v12
 v_mfma_f32_16x16x32_bf16 a[52:55], v[180:183], v[220:223], a[52:55]
 s_waitcnt lgkmcnt(5)
 v_mfma_f32_16x16x32_bf16 a[56:59], v[212:215], v[244:247], a[56:59]
 ds_read_b128 v[44:47], v13 offset:4096
 v_add_u32 v13, 0xfffe0000, v13
 v_mfma_f32_16x16x32_bf16 a[60:63], v[212:215], v[60:63], a[60:63]
 buffer_load_dwordx4 v22, s[12:15], s40 offen nt lds
 v_mfma_f32_16x16x32_bf16 a[228:231], v[28:31], v[60:63], a[228:231]
 buffer_load_dwordx4 v23, s[12:15], s40 offen offset:2048 nt lds
 v_mfma_f32_16x16x32_bf16 v[76:79], v[36:39], v[160:163], 0
 s_add_u32 m0, s45, 45056
 v_exp_f32 v252, v252
 v_mfma_f32_16x16x32_bf16 v[76:79], v[68:71], v[168:171], v[76:79]
 s_xor_b32 s40, s101, 24576
 v_exp_f32 v253, v253
 v_mfma_f32_16x16x32_bf16 v[76:79], v[100:103], v[176:179], v[76:79]
 v_exp_f32 v254, v254
 v_mfma_f32_16x16x32_bf16 v[76:79], v[132:135], v[184:187], v[76:79]
 v_exp_f32 v255, v255
 v_mfma_f32_16x16x32_bf16 v[108:111], v[36:39], v[192:195], 0
 v_exp_f32 v4, v4
 v_mfma_f32_16x16x32_bf16 v[108:111], v[68:71], v[200:203], v[108:111]
 v_exp_f32 v5, v5
 v_mfma_f32_16x16x32_bf16 v[108:111], v[100:103], v[208:211], v[108:111]
 v_exp_f32 v6, v6
 v_mfma_f32_16x16x32_bf16 v[108:111], v[132:135], v[216:219], v[108:111]
 v_exp_f32 v7, v7
 v_mfma_f32_16x16x32_bf16 a[64:67], v[212:215], v[92:95], a[64:67]
 ds_read_b64_tr_b16 v[180:181], v18 offset:8192
 v_cvt_pk_bf16_f32 v204, v252, v253
 v_mfma_f32_16x16x32_bf16 a[68:71], v[212:215], v[124:127], a[68:71]
 v_cvt_pk_bf16_f32 v205, v254, v255
 v_mfma_f32_16x16x32_bf16 a[72:75], v[212:215], v[156:159], a[72:75]
 ds_read_b64_tr_b16 v[182:183], v18 offset:12288
 v_add_u32 v18, 73728, v18
 v_cvt_pk_bf16_f32 v236, v4, v5
 v_mfma_f32_16x16x32_bf16 a[76:79], v[212:215], v[188:191], a[76:79]
 v_cvt_pk_bf16_f32 v237, v6, v7
 v_mfma_f32_16x16x32_bf16 a[80:83], v[212:215], v[220:223], a[80:83]
 s_waitcnt lgkmcnt(4)
 v_mfma_f32_16x16x32_bf16 a[84:87], v[148:151], v[244:247], a[84:87]
 v_mfma_f32_16x16x32_bf16 a[88:91], v[148:151], v[60:63], a[88:91]
 v_mfma_f32_16x16x32_bf16 a[92:95], v[148:151], v[92:95], a[92:95]
 v_mfma_f32_16x16x32_bf16 a[232:235], v[28:31], v[92:95], a[232:235]
 s_waitcnt vmcnt(20) lgkmcnt(2)
 s_barrier
 v_mfma_f32_16x16x32_bf16 v[252:255], v[36:39], v[224:227], 0
 v_exp_f32 v76, v76
 v_mfma_f32_16x16x32_bf16 v[252:255], v[68:71], v[232:235], v[252:255]
 v_exp_f32 v77, v77
 v_mfma_f32_16x16x32_bf16 v[252:255], v[100:103], v[240:243], v[252:255]
 v_exp_f32 v78, v78
 v_mfma_f32_16x16x32_bf16 v[252:255], v[132:135], v[248:251], v[252:255]
 v_exp_f32 v79, v79
 v_mfma_f32_16x16x32_bf16 v[4:7], v[164:167], v[32:35], 0
 v_exp_f32 v108, v108
 v_mfma_f32_16x16x32_bf16 v[4:7], v[196:199], v[40:43], v[4:7]
 v_exp_f32 v109, v109
 v_mfma_f32_16x16x32_bf16 v[4:7], v[228:231], v[48:51], v[4:7]
 v_exp_f32 v110, v110
 v_mfma_f32_16x16x32_bf16 v[4:7], v[44:47], v[56:59], v[4:7]
 v_exp_f32 v111, v111
 v_mfma_f32_16x16x32_bf16 a[96:99], v[148:151], v[124:127], a[96:99]
 ds_read_b64_tr_b16 v[212:213], v19 offset:8192
 v_cvt_pk_bf16_f32 v52, v76, v77
 v_mfma_f32_16x16x32_bf16 a[100:103], v[148:151], v[156:159], a[100:103]
 v_cvt_pk_bf16_f32 v53, v78, v79
 v_mfma_f32_16x16x32_bf16 a[104:107], v[148:151], v[188:191], a[104:107]
 ds_read_b64_tr_b16 v[214:215], v19 offset:12288
 v_add_u32 v19, 73728, v19
 v_cvt_pk_bf16_f32 v84, v108, v109
 v_mfma_f32_16x16x32_bf16 a[108:111], v[148:151], v[220:223], a[108:111]
 s_waitcnt lgkmcnt(2)
 v_cvt_pk_bf16_f32 v85, v110, v111
 v_mfma_f32_16x16x32_bf16 a[112:115], v[180:183], v[244:247], a[112:115]
 ds_read_b128 v[36:39], v10 offset:0
 v_mfma_f32_16x16x32_bf16 a[116:119], v[180:183], v[60:63], a[116:119]
 v_mfma_f32_16x16x32_bf16 a[120:123], v[180:183], v[92:95], a[120:123]
 ds_read_b128 v[68:71], v11 offset:0
 v_mfma_f32_16x16x32_bf16 a[124:127], v[180:183], v[124:127], a[124:127]
 buffer_load_dwordx4 v22, s[12:15], s40 offen nt lds
 v_mfma_f32_16x16x32_bf16 a[236:239], v[28:31], v[124:127], a[236:239]
 buffer_load_dwordx4 v23, s[12:15], s40 offen offset:2048 nt lds
 v_mfma_f32_16x16x32_bf16 v[76:79], v[164:167], v[64:67], 0
 s_add_u32 m0, s46, 0
 v_exp_f32 v252, v252
 v_mfma_f32_16x16x32_bf16 v[76:79], v[196:199], v[72:75], v[76:79]
 s_xor_b32 s40, s101, 7168
 v_exp_f32 v253, v253
 v_mfma_f32_16x16x32_bf16 v[76:79], v[228:231], v[80:83], v[76:79]
 v_exp_f32 v254, v254
 v_mfma_f32_16x16x32_bf16 v[76:79], v[44:47], v[88:91], v[76:79]
 v_exp_f32 v255, v255
 v_mfma_f32_16x16x32_bf16 v[108:111], v[164:167], v[96:99], 0
 v_exp_f32 v4, v4
 v_mfma_f32_16x16x32_bf16 v[108:111], v[196:199], v[104:107], v[108:111]
 v_exp_f32 v5, v5
 v_mfma_f32_16x16x32_bf16 v[108:111], v[228:231], v[112:115], v[108:111]
 v_exp_f32 v6, v6
 v_mfma_f32_16x16x32_bf16 v[108:111], v[44:47], v[120:123], v[108:111]
 v_exp_f32 v7, v7
 v_mfma_f32_16x16x32_bf16 a[128:131], v[180:183], v[156:159], a[128:131]
 ds_read_b64_tr_b16 v[148:149], v20 offset:8192
 v_cvt_pk_bf16_f32 v116, v252, v253
 v_mfma_f32_16x16x32_bf16 a[132:135], v[180:183], v[188:191], a[132:135]
 v_cvt_pk_bf16_f32 v117, v254, v255
 v_mfma_f32_16x16x32_bf16 a[136:139], v[180:183], v[220:223], a[136:139]
 s_waitcnt lgkmcnt(3)
 ds_read_b64_tr_b16 v[150:151], v20 offset:12288
 v_add_u32 v20, 73728, v20
 v_cvt_pk_bf16_f32 v142, v4, v5
 v_mfma_f32_16x16x32_bf16 a[140:143], v[212:215], v[244:247], a[140:143]
 v_cvt_pk_bf16_f32 v143, v6, v7
 v_mfma_f32_16x16x32_bf16 a[144:147], v[212:215], v[60:63], a[144:147]
 ds_read_b128 v[100:103], v12 offset:0
 v_mfma_f32_16x16x32_bf16 a[148:151], v[212:215], v[92:95], a[148:151]
 v_mfma_f32_16x16x32_bf16 a[152:155], v[212:215], v[124:127], a[152:155]
 ds_read_b128 v[132:135], v13 offset:0
 v_mfma_f32_16x16x32_bf16 a[156:159], v[212:215], v[156:159], a[156:159]
 v_mfma_f32_16x16x32_bf16 a[240:243], v[28:31], v[156:159], a[240:243]
 v_mfma_f32_16x16x32_bf16 v[252:255], v[164:167], v[128:131], 0
 v_exp_f32 v76, v76
 v_mfma_f32_16x16x32_bf16 v[252:255], v[196:199], v[136:139], v[252:255]
 v_exp_f32 v77, v77
 v_mfma_f32_16x16x32_bf16 v[252:255], v[228:231], v[144:147], v[252:255]
 v_exp_f32 v78, v78
 v_mfma_f32_16x16x32_bf16 v[252:255], v[44:47], v[152:155], v[252:255]
 v_exp_f32 v79, v79
 v_mfma_f32_16x16x32_bf16 v[4:7], v[164:167], v[160:163], 0
 v_exp_f32 v108, v108
 v_mfma_f32_16x16x32_bf16 v[4:7], v[196:199], v[168:171], v[4:7]
 v_exp_f32 v109, v109
 v_mfma_f32_16x16x32_bf16 v[4:7], v[228:231], v[176:179], v[4:7]
 v_exp_f32 v110, v110
 v_mfma_f32_16x16x32_bf16 v[4:7], v[44:47], v[184:187], v[4:7]
 v_exp_f32 v111, v111
 v_mfma_f32_16x16x32_bf16 a[160:163], v[212:215], v[188:191], a[160:163]
 ds_read_b64_tr_b16 v[180:181], v21 offset:8192
 v_cvt_pk_bf16_f32 v174, v76, v77
 v_mfma_f32_16x16x32_bf16 a[164:167], v[212:215], v[220:223], a[164:167]
 s_waitcnt lgkmcnt(3)
 v_cvt_pk_bf16_f32 v175, v78, v79
 v_mfma_f32_16x16x32_bf16 a[168:171], v[148:151], v[244:247], a[168:171]
 ds_read_b64_tr_b16 v[182:183], v21 offset:12288
 v_add_u32 v21, 73728, v21
 v_cvt_pk_bf16_f32 v206, v108, v109
 v_mfma_f32_16x16x32_bf16 a[172:175], v[148:151], v[60:63], a[172:175]
 v_cvt_pk_bf16_f32 v207, v110, v111
 v_mfma_f32_16x16x32_bf16 a[176:179], v[148:151], v[92:95], a[176:179]
 v_mfma_f32_16x16x32_bf16 a[180:183], v[148:151], v[124:127], a[180:183]
 v_mfma_f32_16x16x32_bf16 a[184:187], v[148:151], v[156:159], a[184:187]
 v_mfma_f32_16x16x32_bf16 a[188:191], v[148:151], v[188:191], a[188:191]
 buffer_load_dwordx4 v24, s[16:19], s40 offen nt lds
 v_mfma_f32_16x16x32_bf16 a[244:247], v[28:31], v[188:191], a[244:247]
 buffer_load_dwordx4 v2, s[16:19], s40 offen offset:2048 nt lds
 v_mfma_f32_16x16x32_bf16 v[76:79], v[164:167], v[192:195], 0
 s_add_u32 m0, s46, 4096
 v_exp_f32 v252, v252
 v_mfma_f32_16x16x32_bf16 v[76:79], v[196:199], v[200:203], v[76:79]
 s_xor_b32 s40, s101, 23552
 v_exp_f32 v253, v253
 v_mfma_f32_16x16x32_bf16 v[76:79], v[228:231], v[208:211], v[76:79]
 v_exp_f32 v254, v254
 v_mfma_f32_16x16x32_bf16 v[76:79], v[44:47], v[216:219], v[76:79]
 v_exp_f32 v255, v255
 v_mfma_f32_16x16x32_bf16 v[108:111], v[164:167], v[224:227], 0
 v_exp_f32 v4, v4
 v_mfma_f32_16x16x32_bf16 v[108:111], v[196:199], v[232:235], v[108:111]
 v_exp_f32 v5, v5
 v_mfma_f32_16x16x32_bf16 v[108:111], v[228:231], v[240:243], v[108:111]
 v_exp_f32 v6, v6
 v_mfma_f32_16x16x32_bf16 v[108:111], v[44:47], v[248:251], v[108:111]
 v_exp_f32 v7, v7
 v_mfma_f32_16x16x32_bf16 a[192:195], v[148:151], v[220:223], a[192:195]
 s_waitcnt lgkmcnt(0)
 ds_read_b64_tr_b16 v[212:213], v14 offset:0
 v_cvt_pk_bf16_f32 v238, v252, v253
 v_mfma_f32_16x16x32_bf16 a[196:199], v[180:183], v[244:247], a[196:199]
 v_cvt_pk_bf16_f32 v239, v254, v255
 v_mfma_f32_16x16x32_bf16 a[200:203], v[180:183], v[60:63], a[200:203]
 ds_read_b64_tr_b16 v[214:215], v14 offset:4096
 v_add_u32 v14, 0xfffee000, v14
 v_cvt_pk_bf16_f32 v54, v4, v5
 v_mfma_f32_16x16x32_bf16 a[204:207], v[180:183], v[92:95], a[204:207]
 v_cvt_pk_bf16_f32 v55, v6, v7
 v_mfma_f32_16x16x32_bf16 a[208:211], v[180:183], v[124:127], a[208:211]
 ds_read_b64_tr_b16 v[148:149], v15 offset:0
 v_mfma_f32_16x16x32_bf16 a[212:215], v[180:183], v[156:159], a[212:215]
 v_mfma_f32_16x16x32_bf16 a[216:219], v[180:183], v[188:191], a[216:219]
 ds_read_b64_tr_b16 v[150:151], v15 offset:4096
 v_add_u32 v15, 0xfffee000, v15
 v_mfma_f32_16x16x32_bf16 a[220:223], v[180:183], v[220:223], a[220:223]
 v_mfma_f32_16x16x32_bf16 a[248:251], v[28:31], v[220:223], a[248:251]
 s_waitcnt lgkmcnt(6)
 v_mfma_f32_16x16x32_bf16 v[252:255], v[36:39], v[32:35], 0
 v_exp_f32 v76, v76
 v_mfma_f32_16x16x32_bf16 v[252:255], v[68:71], v[40:43], v[252:255]
 v_exp_f32 v77, v77
 v_mfma_f32_16x16x32_bf16 v[252:255], v[100:103], v[48:51], v[252:255]
 v_exp_f32 v78, v78
 v_mfma_f32_16x16x32_bf16 v[252:255], v[132:135], v[56:59], v[252:255]
 v_exp_f32 v79, v79
 v_mfma_f32_16x16x32_bf16 v[4:7], v[36:39], v[64:67], 0
 v_exp_f32 v108, v108
 v_mfma_f32_16x16x32_bf16 v[4:7], v[68:71], v[72:75], v[4:7]
 v_exp_f32 v109, v109
 v_mfma_f32_16x16x32_bf16 v[4:7], v[100:103], v[80:83], v[4:7]
 v_exp_f32 v110, v110
 v_mfma_f32_16x16x32_bf16 v[4:7], v[132:135], v[88:91], v[4:7]
 s_waitcnt lgkmcnt(2)
 v_exp_f32 v111, v111
 v_mfma_f32_16x16x32_bf16 a[0:3], v[212:215], v[140:143], a[0:3]
 ds_read_b64_tr_b16 v[180:181], v16 offset:0
 v_cvt_pk_bf16_f32 v86, v76, v77
 v_mfma_f32_16x16x32_bf16 a[4:7], v[212:215], v[172:175], a[4:7]
 v_cvt_pk_bf16_f32 v87, v78, v79
 v_mfma_f32_16x16x32_bf16 a[8:11], v[212:215], v[204:207], a[8:11]
 ds_read_b64_tr_b16 v[182:183], v16 offset:4096
 v_add_u32 v16, 0xfffee000, v16
 v_cvt_pk_bf16_f32 v118, v108, v109
 v_mfma_f32_16x16x32_bf16 a[12:15], v[212:215], v[236:239], a[12:15]
 v_cvt_pk_bf16_f32 v119, v110, v111
 v_mfma_f32_16x16x32_bf16 a[16:19], v[212:215], v[52:55], a[16:19]
 ds_read_b128 v[164:167], v10 offset:4096
 v_mfma_f32_16x16x32_bf16 a[20:23], v[212:215], v[84:87], a[20:23]
 v_mfma_f32_16x16x32_bf16 a[24:27], v[212:215], v[116:119], a[24:27]
 s_waitcnt lgkmcnt(3)
 ds_read_b128 v[196:199], v11 offset:4096
 v_mfma_f32_16x16x32_bf16 a[28:31], v[148:151], v[140:143], a[28:31]
 buffer_load_dwordx4 v24, s[16:19], s40 offen nt lds
 v_mfma_f32_16x16x32_bf16 a[224:227], v[28:31], v[140:143], a[224:227]
 buffer_load_dwordx4 v2, s[16:19], s40 offen offset:2048 nt lds
 v_mfma_f32_16x16x32_bf16 v[76:79], v[36:39], v[96:99], 0
 s_add_u32 m0, s45, 131072
 v_exp_f32 v252, v252
 v_mfma_f32_16x16x32_bf16 v[76:79], v[68:71], v[104:107], v[76:79]
 s_xor_b32 s40, s101, 9216
 v_exp_f32 v253, v253
 v_mfma_f32_16x16x32_bf16 v[76:79], v[100:103], v[112:115], v[76:79]
 v_exp_f32 v254, v254
 v_mfma_f32_16x16x32_bf16 v[76:79], v[132:135], v[120:123], v[76:79]
 v_exp_f32 v255, v255
 v_mfma_f32_16x16x32_bf16 v[108:111], v[36:39], v[128:131], 0
 v_exp_f32 v4, v4
 v_mfma_f32_16x16x32_bf16 v[108:111], v[68:71], v[136:139], v[108:111]
 v_exp_f32 v5, v5
 v_mfma_f32_16x16x32_bf16 v[108:111], v[100:103], v[144:147], v[108:111]
 v_exp_f32 v6, v6
 v_mfma_f32_16x16x32_bf16 v[108:111], v[132:135], v[152:155], v[108:111]
 v_exp_f32 v7, v7
 v_mfma_f32_16x16x32_bf16 a[32:35], v[148:151], v[172:175], a[32:35]
 ds_read_b64_tr_b16 v[212:213], v17 offset:0
 v_cvt_pk_bf16_f32 v244, v252, v253
 v_mfma_f32_16x16x32_bf16 a[36:39], v[148:151], v[204:207], a[36:39]
 v_cvt_pk_bf16_f32 v245, v254, v255
 v_mfma_f32_16x16x32_bf16 a[40:43], v[148:151], v[236:239], a[40:43]
 ds_read_b64_tr_b16 v[214:215], v17 offset:4096
 v_add_u32 v17, 0xfffee000, v17
 v_cvt_pk_bf16_f32 v60, v4, v5
 v_mfma_f32_16x16x32_bf16 a[44:47], v[148:151], v[52:55], a[44:47]
 v_cvt_pk_bf16_f32 v61, v6, v7
 v_mfma_f32_16x16x32_bf16 a[48:51], v[148:151], v[84:87], a[48:51]
 ds_read_b128 v[228:231], v12 offset:4096
 v_mfma_f32_16x16x32_bf16 a[52:55], v[148:151], v[116:119], a[52:55]
 s_waitcnt lgkmcnt(5)
 v_mfma_f32_16x16x32_bf16 a[56:59], v[180:183], v[140:143], a[56:59]
 ds_read_b128 v[44:47], v13 offset:4096
 v_mfma_f32_16x16x32_bf16 a[60:63], v[180:183], v[172:175], a[60:63]
 v_mfma_f32_16x16x32_bf16 a[228:231], v[28:31], v[172:175], a[228:231]
 v_mfma_f32_16x16x32_bf16 v[252:255], v[36:39], v[160:163], 0
 v_exp_f32 v76, v76
 v_mfma_f32_16x16x32_bf16 v[252:255], v[68:71], v[168:171], v[252:255]
 v_exp_f32 v77, v77
 v_mfma_f32_16x16x32_bf16 v[252:255], v[100:103], v[176:179], v[252:255]
 v_exp_f32 v78, v78
 v_mfma_f32_16x16x32_bf16 v[252:255], v[132:135], v[184:187], v[252:255]
 v_exp_f32 v79, v79
 v_mfma_f32_16x16x32_bf16 v[4:7], v[36:39], v[192:195], 0
 v_exp_f32 v108, v108
 v_mfma_f32_16x16x32_bf16 v[4:7], v[68:71], v[200:203], v[4:7]
 v_exp_f32 v109, v109
 v_mfma_f32_16x16x32_bf16 v[4:7], v[100:103], v[208:211], v[4:7]
 v_exp_f32 v110, v110
 v_mfma_f32_16x16x32_bf16 v[4:7], v[132:135], v[216:219], v[4:7]
 v_exp_f32 v111, v111
 v_mfma_f32_16x16x32_bf16 a[64:67], v[180:183], v[204:207], a[64:67]
 ds_read_b64_tr_b16 v[148:149], v18 offset:0
 v_cvt_pk_bf16_f32 v92, v76, v77
 v_mfma_f32_16x16x32_bf16 a[68:71], v[180:183], v[236:239], a[68:71]
 v_cvt_pk_bf16_f32 v93, v78, v79
 v_mfma_f32_16x16x32_bf16 a[72:75], v[180:183], v[52:55], a[72:75]
 ds_read_b64_tr_b16 v[150:151], v18 offset:4096
 v_add_u32 v18, 0xfffee000, v18
 v_cvt_pk_bf16_f32 v124, v108, v109
 v_mfma_f32_16x16x32_bf16 a[76:79], v[180:183], v[84:87], a[76:79]
 v_cvt_pk_bf16_f32 v125, v110, v111
 v_mfma_f32_16x16x32_bf16 a[80:83], v[180:183], v[116:119], a[80:83]
 s_waitcnt lgkmcnt(4)
 v_mfma_f32_16x16x32_bf16 a[84:87], v[212:215], v[140:143], a[84:87]
 v_mfma_f32_16x16x32_bf16 a[88:91], v[212:215], v[172:175], a[88:91]
 v_mfma_f32_16x16x32_bf16 a[92:95], v[212:215], v[204:207], a[92:95]
 buffer_load_dwordx4 v22, s[12:15], s40 offen nt lds
 v_mfma_f32_16x16x32_bf16 a[232:235], v[28:31], v[204:207], a[232:235]
 buffer_load_dwordx4 v23, s[12:15], s40 offen offset:2048 nt lds
 s_waitcnt vmcnt(19) lgkmcnt(2)
 s_barrier
 v_mfma_f32_16x16x32_bf16 v[76:79], v[36:39], v[224:227], 0
 s_add_u32 m0, s45, 135168
 v_exp_f32 v252, v252
 v_mfma_f32_16x16x32_bf16 v[76:79], v[68:71], v[232:235], v[76:79]
 s_xor_b32 s40, s101, 25600
 v_exp_f32 v253, v253
 v_mfma_f32_16x16x32_bf16 v[76:79], v[100:103], v[240:243], v[76:79]
 v_exp_f32 v254, v254
 v_mfma_f32_16x16x32_bf16 v[76:79], v[132:135], v[248:251], v[76:79]
 v_exp_f32 v255, v255
 v_mfma_f32_16x16x32_bf16 v[108:111], v[164:167], v[32:35], 0
 v_exp_f32 v4, v4
 v_mfma_f32_16x16x32_bf16 v[108:111], v[196:199], v[40:43], v[108:111]
 v_exp_f32 v5, v5
 v_mfma_f32_16x16x32_bf16 v[108:111], v[228:231], v[48:51], v[108:111]
 v_exp_f32 v6, v6
 v_mfma_f32_16x16x32_bf16 v[108:111], v[44:47], v[56:59], v[108:111]
 v_exp_f32 v7, v7
 v_mfma_f32_16x16x32_bf16 a[96:99], v[212:215], v[236:239], a[96:99]
 ds_read_b64_tr_b16 v[180:181], v19 offset:0
 v_cvt_pk_bf16_f32 v156, v252, v253
 v_mfma_f32_16x16x32_bf16 a[100:103], v[212:215], v[52:55], a[100:103]
 v_cvt_pk_bf16_f32 v157, v254, v255
 v_mfma_f32_16x16x32_bf16 a[104:107], v[212:215], v[84:87], a[104:107]
 ds_read_b64_tr_b16 v[182:183], v19 offset:4096
 v_add_u32 v19, 0xfffee000, v19
 v_cvt_pk_bf16_f32 v188, v4, v5
 v_mfma_f32_16x16x32_bf16 a[108:111], v[212:215], v[116:119], a[108:111]
 s_waitcnt lgkmcnt(2)
 v_cvt_pk_bf16_f32 v189, v6, v7
 v_mfma_f32_16x16x32_bf16 a[112:115], v[148:151], v[140:143], a[112:115]
 ds_read_b128 v[36:39], v10 offset:8192
 v_mfma_f32_16x16x32_bf16 a[116:119], v[148:151], v[172:175], a[116:119]
 v_mfma_f32_16x16x32_bf16 a[120:123], v[148:151], v[204:207], a[120:123]
 ds_read_b128 v[68:71], v11 offset:8192
 v_mfma_f32_16x16x32_bf16 a[124:127], v[148:151], v[236:239], a[124:127]
 v_mfma_f32_16x16x32_bf16 a[236:239], v[28:31], v[236:239], a[236:239]
 v_mfma_f32_16x16x32_bf16 v[252:255], v[164:167], v[64:67], 0
 v_exp_f32 v76, v76
 v_mfma_f32_16x16x32_bf16 v[252:255], v[196:199], v[72:75], v[252:255]
 v_exp_f32 v77, v77
 v_mfma_f32_16x16x32_bf16 v[252:255], v[228:231], v[80:83], v[252:255]
 v_exp_f32 v78, v78
 v_mfma_f32_16x16x32_bf16 v[252:255], v[44:47], v[88:91], v[252:255]
 v_exp_f32 v79, v79
 v_mfma_f32_16x16x32_bf16 v[4:7], v[164:167], v[96:99], 0
 v_exp_f32 v108, v108
 v_mfma_f32_16x16x32_bf16 v[4:7], v[196:199], v[104:107], v[4:7]
 v_exp_f32 v109, v109
 v_mfma_f32_16x16x32_bf16 v[4:7], v[228:231], v[112:115], v[4:7]
 v_exp_f32 v110, v110
 v_mfma_f32_16x16x32_bf16 v[4:7], v[44:47], v[120:123], v[4:7]
 v_exp_f32 v111, v111
 v_mfma_f32_16x16x32_bf16 a[128:131], v[148:151], v[52:55], a[128:131]
 ds_read_b64_tr_b16 v[212:213], v20 offset:0
 v_cvt_pk_bf16_f32 v220, v76, v77
 v_mfma_f32_16x16x32_bf16 a[132:135], v[148:151], v[84:87], a[132:135]
 v_cvt_pk_bf16_f32 v221, v78, v79
 v_mfma_f32_16x16x32_bf16 a[136:139], v[148:151], v[116:119], a[136:139]
 s_waitcnt lgkmcnt(3)
 ds_read_b64_tr_b16 v[214:215], v20 offset:4096
 v_add_u32 v20, 0xfffee000, v20
 v_cvt_pk_bf16_f32 v246, v108, v109
 v_mfma_f32_16x16x32_bf16 a[140:143], v[180:183], v[140:143], a[140:143]
 v_cvt_pk_bf16_f32 v247, v110, v111
 v_mfma_f32_16x16x32_bf16 a[144:147], v[180:183], v[172:175], a[144:147]
 ds_read_b128 v[100:103], v12 offset:8192
 v_mfma_f32_16x16x32_bf16 a[148:151], v[180:183], v[204:207], a[148:151]
 v_mfma_f32_16x16x32_bf16 a[152:155], v[180:183], v[236:239], a[152:155]
 ds_read_b128 v[132:135], v13 offset:8192
 v_mfma_f32_16x16x32_bf16 a[156:159], v[180:183], v[52:55], a[156:159]
 buffer_load_dwordx4 v22, s[12:15], s40 offen nt lds
 v_mfma_f32_16x16x32_bf16 a[240:243], v[28:31], v[52:55], a[240:243]
 buffer_load_dwordx4 v23, s[12:15], s40 offen offset:2048 nt lds
 v_mfma_f32_16x16x32_bf16 v[76:79], v[164:167], v[128:131], 0
 s_add_u32 m0, s46, 8192
 v_exp_f32 v252, v252
 v_mfma_f32_16x16x32_bf16 v[76:79], v[196:199], v[136:139], v[76:79]
 s_xor_b32 s40, s101, 8192
 v_exp_f32 v253, v253
 v_mfma_f32_16x16x32_bf16 v[76:79], v[228:231], v[144:147], v[76:79]
 v_exp_f32 v254, v254
 v_mfma_f32_16x16x32_bf16 v[76:79], v[44:47], v[152:155], v[76:79]
 v_exp_f32 v255, v255
 v_mfma_f32_16x16x32_bf16 v[108:111], v[164:167], v[160:163], 0
 v_exp_f32 v4, v4
 v_mfma_f32_16x16x32_bf16 v[108:111], v[196:199], v[168:171], v[108:111]
 v_exp_f32 v5, v5
 v_mfma_f32_16x16x32_bf16 v[108:111], v[228:231], v[176:179], v[108:111]
 v_exp_f32 v6, v6
 v_mfma_f32_16x16x32_bf16 v[108:111], v[44:47], v[184:187], v[108:111]
 v_exp_f32 v7, v7
 v_mfma_f32_16x16x32_bf16 a[160:163], v[180:183], v[84:87], a[160:163]
 ds_read_b64_tr_b16 v[148:149], v21 offset:0
 v_cvt_pk_bf16_f32 v62, v252, v253
 v_mfma_f32_16x16x32_bf16 a[164:167], v[180:183], v[116:119], a[164:167]
 s_waitcnt lgkmcnt(3)
 v_cvt_pk_bf16_f32 v63, v254, v255
 v_mfma_f32_16x16x32_bf16 a[168:171], v[212:215], v[140:143], a[168:171]
 ds_read_b64_tr_b16 v[150:151], v21 offset:4096
 v_add_u32 v21, 0xfffee000, v21
 v_cvt_pk_bf16_f32 v94, v4, v5
 v_mfma_f32_16x16x32_bf16 a[172:175], v[212:215], v[172:175], a[172:175]
 v_cvt_pk_bf16_f32 v95, v6, v7
 v_mfma_f32_16x16x32_bf16 a[176:179], v[212:215], v[204:207], a[176:179]
 v_mfma_f32_16x16x32_bf16 a[180:183], v[212:215], v[236:239], a[180:183]
 v_mfma_f32_16x16x32_bf16 a[184:187], v[212:215], v[52:55], a[184:187]
 v_mfma_f32_16x16x32_bf16 a[188:191], v[212:215], v[84:87], a[188:191]
CPF5:
 s_mov_b32 s88, CPF5-K1_BASE+2048
 buffer_load_dword v8, v9, s[96:99], s88 offen
 v_mfma_f32_16x16x32_bf16 a[244:247], v[28:31], v[84:87], a[244:247]
 v_mfma_f32_16x16x32_bf16 v[252:255], v[164:167], v[192:195], 0
 v_exp_f32 v76, v76
 v_mfma_f32_16x16x32_bf16 v[252:255], v[196:199], v[200:203], v[252:255]
 v_exp_f32 v77, v77
 v_mfma_f32_16x16x32_bf16 v[252:255], v[228:231], v[208:211], v[252:255]
 v_exp_f32 v78, v78
 v_mfma_f32_16x16x32_bf16 v[252:255], v[44:47], v[216:219], v[252:255]
 v_exp_f32 v79, v79
 v_mfma_f32_16x16x32_bf16 v[4:7], v[164:167], v[224:227], 0
 v_exp_f32 v108, v108
 v_mfma_f32_16x16x32_bf16 v[4:7], v[196:199], v[232:235], v[4:7]
 v_exp_f32 v109, v109
 v_mfma_f32_16x16x32_bf16 v[4:7], v[228:231], v[240:243], v[4:7]
 v_exp_f32 v110, v110
 v_mfma_f32_16x16x32_bf16 v[4:7], v[44:47], v[248:251], v[4:7]
 v_exp_f32 v111, v111
 v_mfma_f32_16x16x32_bf16 a[192:195], v[212:215], v[116:119], a[192:195]
 s_waitcnt lgkmcnt(0)
 ds_read_b64_tr_b16 v[180:181], v14 offset:32768
 v_cvt_pk_bf16_f32 v126, v76, v77
 v_mfma_f32_16x16x32_bf16 a[196:199], v[148:151], v[140:143], a[196:199]
 v_cvt_pk_bf16_f32 v127, v78, v79
 v_mfma_f32_16x16x32_bf16 a[200:203], v[148:151], v[172:175], a[200:203]
 ds_read_b64_tr_b16 v[182:183], v14 offset:36864
 v_cvt_pk_bf16_f32 v158, v108, v109
 v_mfma_f32_16x16x32_bf16 a[204:207], v[148:151], v[204:207], a[204:207]
 v_cvt_pk_bf16_f32 v159, v110, v111
 v_mfma_f32_16x16x32_bf16 a[208:211], v[148:151], v[236:239], a[208:211]
 ds_read_b64_tr_b16 v[212:213], v15 offset:32768
 v_mfma_f32_16x16x32_bf16 a[212:215], v[148:151], v[52:55], a[212:215]
 v_mfma_f32_16x16x32_bf16 a[216:219], v[148:151], v[84:87], a[216:219]
 ds_read_b64_tr_b16 v[214:215], v15 offset:36864
 v_mfma_f32_16x16x32_bf16 a[220:223], v[148:151], v[116:119], a[220:223]
 buffer_load_dwordx4 v24, s[16:19], s40 offen nt lds
 v_mfma_f32_16x16x32_bf16 a[248:251], v[28:31], v[116:119], a[248:251]
 s_waitcnt lgkmcnt(6)
 buffer_load_dwordx4 v2, s[16:19], s40 offen offset:2048 nt lds
 v_mfma_f32_16x16x32_bf16 v[76:79], v[36:39], v[32:35], 0
 s_add_u32 m0, s46, 12288
 v_exp_f32 v252, v252
 v_mfma_f32_16x16x32_bf16 v[76:79], v[68:71], v[40:43], v[76:79]
 s_xor_b32 s40, s101, 24576
 v_exp_f32 v253, v253
 v_mfma_f32_16x16x32_bf16 v[76:79], v[100:103], v[48:51], v[76:79]
 v_exp_f32 v254, v254
 v_mfma_f32_16x16x32_bf16 v[76:79], v[132:135], v[56:59], v[76:79]
 v_exp_f32 v255, v255
 v_mfma_f32_16x16x32_bf16 v[108:111], v[36:39], v[64:67], 0
 v_exp_f32 v4, v4
 v_mfma_f32_16x16x32_bf16 v[108:111], v[68:71], v[72:75], v[108:111]
 v_exp_f32 v5, v5
 v_mfma_f32_16x16x32_bf16 v[108:111], v[100:103], v[80:83], v[108:111]
 v_exp_f32 v6, v6
 v_mfma_f32_16x16x32_bf16 v[108:111], v[132:135], v[88:91], v[108:111]
 s_waitcnt lgkmcnt(2)
 v_exp_f32 v7, v7
 v_mfma_f32_16x16x32_bf16 a[0:3], v[180:183], v[244:247], a[0:3]
 ds_read_b64_tr_b16 v[148:149], v16 offset:32768
 v_cvt_pk_bf16_f32 v190, v252, v253
 v_mfma_f32_16x16x32_bf16 a[4:7], v[180:183], v[60:63], a[4:7]
 v_cvt_pk_bf16_f32 v191, v254, v255
 v_mfma_f32_16x16x32_bf16 a[8:11], v[180:183], v[92:95], a[8:11]
 ds_read_b64_tr_b16 v[150:151], v16 offset:36864
 v_cvt_pk_bf16_f32 v222, v4, v5
 v_mfma_f32_16x16x32_bf16 a[12:15], v[180:183], v[124:127], a[12:15]
 v_cvt_pk_bf16_f32 v223, v6, v7
 v_mfma_f32_16x16x32_bf16 a[16:19], v[180:183], v[156:159], a[16:19]
 ds_read_b128 v[164:167], v10 offset:12288
 v_mfma_f32_16x16x32_bf16 a[20:23], v[180:183], v[188:191], a[20:23]
 v_mfma_f32_16x16x32_bf16 a[24:27], v[180:183], v[220:223], a[24:27]
 s_waitcnt lgkmcnt(3)
 ds_read_b128 v[196:199], v11 offset:12288
 v_mfma_f32_16x16x32_bf16 a[28:31], v[212:215], v[244:247], a[28:31]
 v_mfma_f32_16x16x32_bf16 a[224:227], v[28:31], v[244:247], a[224:227]
 v_mfma_f32_16x16x32_bf16 v[252:255], v[36:39], v[96:99], 0
 v_exp_f32 v76, v76
 v_mfma_f32_16x16x32_bf16 v[252:255], v[68:71], v[104:107], v[252:255]
 s_branch SK4670
PG4670:
 s_branch PG7052
SK4670:
 v_exp_f32 v77, v77
 v_mfma_f32_16x16x32_bf16 v[252:255], v[100:103], v[112:115], v[252:255]
 v_exp_f32 v78, v78
 v_mfma_f32_16x16x32_bf16 v[252:255], v[132:135], v[120:123], v[252:255]
 v_exp_f32 v79, v79
 v_mfma_f32_16x16x32_bf16 v[4:7], v[36:39], v[128:131], 0
 v_exp_f32 v108, v108
 v_mfma_f32_16x16x32_bf16 v[4:7], v[68:71], v[136:139], v[4:7]
 v_exp_f32 v109, v109
 v_mfma_f32_16x16x32_bf16 v[4:7], v[100:103], v[144:147], v[4:7]
 v_exp_f32 v110, v110
 v_mfma_f32_16x16x32_bf16 v[4:7], v[132:135], v[152:155], v[4:7]
 v_exp_f32 v111, v111
 v_mfma_f32_16x16x32_bf16 a[32:35], v[212:215], v[60:63], a[32:35]
 ds_read_b64_tr_b16 v[180:181], v17 offset:32768
 v_cvt_pk_bf16_f32 v140, v76, v77
 v_mfma_f32_16x16x32_bf16 a[36:39], v[212:215], v[92:95], a[36:39]
 v_cvt_pk_bf16_f32 v141, v78, v79
 v_mfma_f32_16x16x32_bf16 a[40:43], v[212:215], v[124:127], a[40:43]
 ds_read_b64_tr_b16 v[182:183], v17 offset:36864
 v_cvt_pk_bf16_f32 v172, v108, v109
 v_mfma_f32_16x16x32_bf16 a[44:47], v[212:215], v[156:159], a[44:47]
 v_cvt_pk_bf16_f32 v173, v110, v111
 v_mfma_f32_16x16x32_bf16 a[48:51], v[212:215], v[188:191], a[48:51]
 ds_read_b128 v[228:231], v12 offset:12288
 v_mfma_f32_16x16x32_bf16 a[52:55], v[212:215], v[220:223], a[52:55]
 s_waitcnt lgkmcnt(5)
 v_mfma_f32_16x16x32_bf16 a[56:59], v[148:151], v[244:247], a[56:59]
 ds_read_b128 v[44:47], v13 offset:12288
 v_mfma_f32_16x16x32_bf16 a[60:63], v[148:151], v[60:63], a[60:63]
 buffer_load_dwordx4 v24, s[16:19], s40 offen nt lds
 v_mfma_f32_16x16x32_bf16 a[228:231], v[28:31], v[60:63], a[228:231]
 buffer_load_dwordx4 v2, s[16:19], s40 offen offset:2048 nt lds
 v_mfma_f32_16x16x32_bf16 v[76:79], v[36:39], v[160:163], 0
 s_add_u32 m0, s45, 0
 v_exp_f32 v252, v252
 v_mfma_f32_16x16x32_bf16 v[76:79], v[68:71], v[168:171], v[76:79]
 s_xor_b32 s40, s101, 10240
 v_exp_f32 v253, v253
 v_mfma_f32_16x16x32_bf16 v[76:79], v[100:103], v[176:179], v[76:79]
 v_exp_f32 v254, v254
 v_mfma_f32_16x16x32_bf16 v[76:79], v[132:135], v[184:187], v[76:79]
 v_exp_f32 v255, v255
 v_mfma_f32_16x16x32_bf16 v[108:111], v[36:39], v[192:195], 0
 v_exp_f32 v4, v4
 v_mfma_f32_16x16x32_bf16 v[108:111], v[68:71], v[200:203], v[108:111]
 v_exp_f32 v5, v5
 v_mfma_f32_16x16x32_bf16 v[108:111], v[100:103], v[208:211], v[108:111]
 v_exp_f32 v6, v6
 v_mfma_f32_16x16x32_bf16 v[108:111], v[132:135], v[216:219], v[108:111]
 v_exp_f32 v7, v7
 v_mfma_f32_16x16x32_bf16 a[64:67], v[148:151], v[92:95], a[64:67]
 ds_read_b64_tr_b16 v[212:213], v18 offset:32768
 v_cvt_pk_bf16_f32 v204, v252, v253
 v_mfma_f32_16x16x32_bf16 a[68:71], v[148:151], v[124:127], a[68:71]
 v_cvt_pk_bf16_f32 v205, v254, v255
 v_mfma_f32_16x16x32_bf16 a[72:75], v[148:151], v[156:159], a[72:75]
 ds_read_b64_tr_b16 v[214:215], v18 offset:36864
 v_cvt_pk_bf16_f32 v236, v4, v5
 v_mfma_f32_16x16x32_bf16 a[76:79], v[148:151], v[188:191], a[76:79]
 v_cvt_pk_bf16_f32 v237, v6, v7
 v_mfma_f32_16x16x32_bf16 a[80:83], v[148:151], v[220:223], a[80:83]
 s_waitcnt lgkmcnt(4)
 v_mfma_f32_16x16x32_bf16 a[84:87], v[180:183], v[244:247], a[84:87]
 v_mfma_f32_16x16x32_bf16 a[88:91], v[180:183], v[60:63], a[88:91]
 v_mfma_f32_16x16x32_bf16 a[92:95], v[180:183], v[92:95], a[92:95]
 v_mfma_f32_16x16x32_bf16 a[232:235], v[28:31], v[92:95], a[232:235]
 s_waitcnt vmcnt(17) lgkmcnt(2)
 s_barrier
 v_mfma_f32_16x16x32_bf16 v[252:255], v[36:39], v[224:227], 0
 v_exp_f32 v76, v76
 v_mfma_f32_16x16x32_bf16 v[252:255], v[68:71], v[232:235], v[252:255]
 v_exp_f32 v77, v77
 v_mfma_f32_16x16x32_bf16 v[252:255], v[100:103], v[240:243], v[252:255]
 v_exp_f32 v78, v78
 v_mfma_f32_16x16x32_bf16 v[252:255], v[132:135], v[248:251], v[252:255]
 v_exp_f32 v79, v79
 v_mfma_f32_16x16x32_bf16 v[4:7], v[164:167], v[32:35], 0
 v_exp_f32 v108, v108
 v_mfma_f32_16x16x32_bf16 v[4:7], v[196:199], v[40:43], v[4:7]
 v_exp_f32 v109, v109
 v_mfma_f32_16x16x32_bf16 v[4:7], v[228:231], v[48:51], v[4:7]
 v_exp_f32 v110, v110
 v_mfma_f32_16x16x32_bf16 v[4:7], v[44:47], v[56:59], v[4:7]
 v_exp_f32 v111, v111
 v_mfma_f32_16x16x32_bf16 a[96:99], v[180:183], v[124:127], a[96:99]
 ds_read_b64_tr_b16 v[148:149], v19 offset:32768
 v_cvt_pk_bf16_f32 v52, v76, v77
 v_mfma_f32_16x16x32_bf16 a[100:103], v[180:183], v[156:159], a[100:103]
 v_cvt_pk_bf16_f32 v53, v78, v79
 v_mfma_f32_16x16x32_bf16 a[104:107], v[180:183], v[188:191], a[104:107]
 ds_read_b64_tr_b16 v[150:151], v19 offset:36864
 v_cvt_pk_bf16_f32 v84, v108, v109
 v_mfma_f32_16x16x32_bf16 a[108:111], v[180:183], v[220:223], a[108:111]
 s_waitcnt lgkmcnt(2)
 v_cvt_pk_bf16_f32 v85, v110, v111
 v_mfma_f32_16x16x32_bf16 a[112:115], v[212:215], v[244:247], a[112:115]
 ds_read_b128 v[36:39], v10 offset:32768
 v_mfma_f32_16x16x32_bf16 a[116:119], v[212:215], v[60:63], a[116:119]
 v_mfma_f32_16x16x32_bf16 a[120:123], v[212:215], v[92:95], a[120:123]
 ds_read_b128 v[68:71], v11 offset:32768
 v_mfma_f32_16x16x32_bf16 a[124:127], v[212:215], v[124:127], a[124:127]
 buffer_load_dwordx4 v22, s[12:15], s40 offen nt lds
 v_mfma_f32_16x16x32_bf16 a[236:239], v[28:31], v[124:127], a[236:239]
 buffer_load_dwordx4 v23, s[12:15], s40 offen offset:2048 nt lds
 v_mfma_f32_16x16x32_bf16 v[76:79], v[164:167], v[64:67], 0
 s_add_u32 m0, s45, 4096
 v_exp_f32 v252, v252
 v_mfma_f32_16x16x32_bf16 v[76:79], v[196:199], v[72:75], v[76:79]
 s_xor_b32 s40, s101, 26624
 v_exp_f32 v253, v253
 v_mfma_f32_16x16x32_bf16 v[76:79], v[228:231], v[80:83], v[76:79]
 v_exp_f32 v254, v254
 v_mfma_f32_16x16x32_bf16 v[76:79], v[44:47], v[88:91], v[76:79]
 v_exp_f32 v255, v255
 v_mfma_f32_16x16x32_bf16 v[108:111], v[164:167], v[96:99], 0
 v_exp_f32 v4, v4
 v_mfma_f32_16x16x32_bf16 v[108:111], v[196:199], v[104:107], v[108:111]
 v_exp_f32 v5, v5
 v_mfma_f32_16x16x32_bf16 v[108:111], v[228:231], v[112:115], v[108:111]
 v_exp_f32 v6, v6
 v_mfma_f32_16x16x32_bf16 v[108:111], v[44:47], v[120:123], v[108:111]
 v_exp_f32 v7, v7
 v_mfma_f32_16x16x32_bf16 a[128:131], v[212:215], v[156:159], a[128:131]
 ds_read_b64_tr_b16 v[180:181], v20 offset:32768
 v_cvt_pk_bf16_f32 v116, v252, v253
 v_mfma_f32_16x16x32_bf16 a[132:135], v[212:215], v[188:191], a[132:135]
 v_cvt_pk_bf16_f32 v117, v254, v255
 v_mfma_f32_16x16x32_bf16 a[136:139], v[212:215], v[220:223], a[136:139]
 s_waitcnt lgkmcnt(3)
 ds_read_b64_tr_b16 v[182:183], v20 offset:36864
 v_cvt_pk_bf16_f32 v142, v4, v5
 v_mfma_f32_16x16x32_bf16 a[140:143], v[148:151], v[244:247], a[140:143]
 v_cvt_pk_bf16_f32 v143, v6, v7
 v_mfma_f32_16x16x32_bf16 a[144:147], v[148:151], v[60:63], a[144:147]
 ds_read_b128 v[100:103], v12 offset:32768
 v_mfma_f32_16x16x32_bf16 a[148:151], v[148:151], v[92:95], a[148:151]
 v_mfma_f32_16x16x32_bf16 a[152:155], v[148:151], v[124:127], a[152:155]
 ds_read_b128 v[132:135], v13 offset:32768
 v_mfma_f32_16x16x32_bf16 a[156:159], v[148:151], v[156:159], a[156:159]
 v_mfma_f32_16x16x32_bf16 a[240:243], v[28:31], v[156:159], a[240:243]
 v_mfma_f32_16x16x32_bf16 v[252:255], v[164:167], v[128:131], 0
 v_exp_f32 v76, v76
 v_mfma_f32_16x16x32_bf16 v[252:255], v[196:199], v[136:139], v[252:255]
 v_exp_f32 v77, v77
 v_mfma_f32_16x16x32_bf16 v[252:255], v[228:231], v[144:147], v[252:255]
 v_exp_f32 v78, v78
 v_mfma_f32_16x16x32_bf16 v[252:255], v[44:47], v[152:155], v[252:255]
 v_exp_f32 v79, v79
 v_mfma_f32_16x16x32_bf16 v[4:7], v[164:167], v[160:163], 0
 v_exp_f32 v108, v108
 v_mfma_f32_16x16x32_bf16 v[4:7], v[196:199], v[168:171], v[4:7]
 v_exp_f32 v109, v109
 v_mfma_f32_16x16x32_bf16 v[4:7], v[228:231], v[176:179], v[4:7]
 v_exp_f32 v110, v110
 v_mfma_f32_16x16x32_bf16 v[4:7], v[44:47], v[184:187], v[4:7]
 v_exp_f32 v111, v111
 v_mfma_f32_16x16x32_bf16 a[160:163], v[148:151], v[188:191], a[160:163]
 ds_read_b64_tr_b16 v[212:213], v21 offset:32768
 v_cvt_pk_bf16_f32 v174, v76, v77
 v_mfma_f32_16x16x32_bf16 a[164:167], v[148:151], v[220:223], a[164:167]
 s_waitcnt lgkmcnt(3)
 v_cvt_pk_bf16_f32 v175, v78, v79
 v_mfma_f32_16x16x32_bf16 a[168:171], v[180:183], v[244:247], a[168:171]
 ds_read_b64_tr_b16 v[214:215], v21 offset:36864
 v_cvt_pk_bf16_f32 v206, v108, v109
 v_mfma_f32_16x16x32_bf16 a[172:175], v[180:183], v[60:63], a[172:175]
 v_cvt_pk_bf16_f32 v207, v110, v111
 v_mfma_f32_16x16x32_bf16 a[176:179], v[180:183], v[92:95], a[176:179]
 v_mfma_f32_16x16x32_bf16 a[180:183], v[180:183], v[124:127], a[180:183]
 v_mfma_f32_16x16x32_bf16 a[184:187], v[180:183], v[156:159], a[184:187]
 v_mfma_f32_16x16x32_bf16 a[188:191], v[180:183], v[188:191], a[188:191]
 buffer_load_dwordx4 v22, s[12:15], s40 offen nt lds
 v_mfma_f32_16x16x32_bf16 a[244:247], v[28:31], v[188:191], a[244:247]
 buffer_load_dwordx4 v23, s[12:15], s40 offen offset:2048 nt lds
 v_mfma_f32_16x16x32_bf16 v[76:79], v[164:167], v[192:195], 0
 s_add_u32 m0, s46, 73728
 v_exp_f32 v252, v252
 v_mfma_f32_16x16x32_bf16 v[76:79], v[196:199], v[200:203], v[76:79]
 s_xor_b32 s40, s101, 9216
 v_exp_f32 v253, v253
 v_mfma_f32_16x16x32_bf16 v[76:79], v[228:231], v[208:211], v[76:79]
 v_exp_f32 v254, v254
 v_mfma_f32_16x16x32_bf16 v[76:79], v[44:47], v[216:219], v[76:79]
 v_exp_f32 v255, v255
 v_mfma_f32_16x16x32_bf16 v[108:111], v[164:167], v[224:227], 0
 v_exp_f32 v4, v4
 v_mfma_f32_16x16x32_bf16 v[108:111], v[196:199], v[232:235], v[108:111]
 v_exp_f32 v5, v5
 v_mfma_f32_16x16x32_bf16 v[108:111], v[228:231], v[240:243], v[108:111]
 v_exp_f32 v6, v6
 v_mfma_f32_16x16x32_bf16 v[108:111], v[44:47], v[248:251], v[108:111]
 v_exp_f32 v7, v7
 v_mfma_f32_16x16x32_bf16 a[192:195], v[180:183], v[220:223], a[192:195]
 s_waitcnt lgkmcnt(0)
 ds_read_b64_tr_b16 v[148:149], v14 offset:40960
 v_cvt_pk_bf16_f32 v238, v252, v253
 v_mfma_f32_16x16x32_bf16 a[196:199], v[212:215], v[244:247], a[196:199]
 v_cvt_pk_bf16_f32 v239, v254, v255
 v_mfma_f32_16x16x32_bf16 a[200:203], v[212:215], v[60:63], a[200:203]
 ds_read_b64_tr_b16 v[150:151], v14 offset:45056
 v_cvt_pk_bf16_f32 v54, v4, v5
 v_mfma_f32_16x16x32_bf16 a[204:207], v[212:215], v[92:95], a[204:207]
 v_cvt_pk_bf16_f32 v55, v6, v7
 v_mfma_f32_16x16x32_bf16 a[208:211], v[212:215], v[124:127], a[208:211]
 ds_read_b64_tr_b16 v[180:181], v15 offset:40960
 v_mfma_f32_16x16x32_bf16 a[212:215], v[212:215], v[156:159], a[212:215]
 v_mfma_f32_16x16x32_bf16 a[216:219], v[212:215], v[188:191], a[216:219]
 ds_read_b64_tr_b16 v[182:183], v15 offset:45056
 v_mfma_f32_16x16x32_bf16 a[220:223], v[212:215], v[220:223], a[220:223]
 v_mfma_f32_16x16x32_bf16 a[248:251], v[28:31], v[220:223], a[248:251]
 s_waitcnt lgkmcnt(6)
 v_mfma_f32_16x16x32_bf16 v[252:255], v[36:39], v[32:35], 0
 v_exp_f32 v76, v76
 v_mfma_f32_16x16x32_bf16 v[252:255], v[68:71], v[40:43], v[252:255]
 v_exp_f32 v77, v77
 v_mfma_f32_16x16x32_bf16 v[252:255], v[100:103], v[48:51], v[252:255]
 v_exp_f32 v78, v78
 v_mfma_f32_16x16x32_bf16 v[252:255], v[132:135], v[56:59], v[252:255]
 v_exp_f32 v79, v79
 v_mfma_f32_16x16x32_bf16 v[4:7], v[36:39], v[64:67], 0
 v_exp_f32 v108, v108
 v_mfma_f32_16x16x32_bf16 v[4:7], v[68:71], v[72:75], v[4:7]
 v_exp_f32 v109, v109
 v_mfma_f32_16x16x32_bf16 v[4:7], v[100:103], v[80:83], v[4:7]
 v_exp_f32 v110, v110
 v_mfma_f32_16x16x32_bf16 v[4:7], v[132:135], v[88:91], v[4:7]
 s_waitcnt lgkmcnt(2)
 v_exp_f32 v111, v111
 v_mfma_f32_16x16x32_bf16 a[0:3], v[148:151], v[140:143], a[0:3]
 ds_read_b64_tr_b16 v[212:213], v16 offset:40960
 v_cvt_pk_bf16_f32 v86, v76, v77
 v_mfma_f32_16x16x32_bf16 a[4:7], v[148:151], v[172:175], a[4:7]
 v_cvt_pk_bf16_f32 v87, v78, v79
 v_mfma_f32_16x16x32_bf16 a[8:11], v[148:151], v[204:207], a[8:11]
 ds_read_b64_tr_b16 v[214:215], v16 offset:45056
 v_cvt_pk_bf16_f32 v118, v108, v109
 v_mfma_f32_16x16x32_bf16 a[12:15], v[148:151], v[236:239], a[12:15]
 v_cvt_pk_bf16_f32 v119, v110, v111
 v_mfma_f32_16x16x32_bf16 a[16:19], v[148:151], v[52:55], a[16:19]
 ds_read_b128 v[164:167], v10 offset:36864
 v_mfma_f32_16x16x32_bf16 a[20:23], v[148:151], v[84:87], a[20:23]
 v_mfma_f32_16x16x32_bf16 a[24:27], v[148:151], v[116:119], a[24:27]
 s_waitcnt lgkmcnt(3)
 ds_read_b128 v[196:199], v11 offset:36864
 v_mfma_f32_16x16x32_bf16 a[28:31], v[180:183], v[140:143], a[28:31]
 buffer_load_dwordx4 v24, s[16:19], s40 offen nt lds
 v_mfma_f32_16x16x32_bf16 a[224:227], v[28:31], v[140:143], a[224:227]
 buffer_load_dwordx4 v2, s[16:19], s40 offen offset:2048 nt lds
 v_mfma_f32_16x16x32_bf16 v[76:79], v[36:39], v[96:99], 0
 s_add_u32 m0, s46, 77824
 v_exp_f32 v252, v252
 v_mfma_f32_16x16x32_bf16 v[76:79], v[68:71], v[104:107], v[76:79]
 s_xor_b32 s40, s101, 25600
 v_exp_f32 v253, v253
 v_mfma_f32_16x16x32_bf16 v[76:79], v[100:103], v[112:115], v[76:79]
 v_exp_f32 v254, v254
 v_mfma_f32_16x16x32_bf16 v[76:79], v[132:135], v[120:123], v[76:79]
 v_exp_f32 v255, v255
 v_mfma_f32_16x16x32_bf16 v[108:111], v[36:39], v[128:131], 0
 v_exp_f32 v4, v4
 v_mfma_f32_16x16x32_bf16 v[108:111], v[68:71], v[136:139], v[108:111]
 v_exp_f32 v5, v5
 v_mfma_f32_16x16x32_bf16 v[108:111], v[100:103], v[144:147], v[108:111]
 v_exp_f32 v6, v6
 v_mfma_f32_16x16x32_bf16 v[108:111], v[132:135], v[152:155], v[108:111]
 v_exp_f32 v7, v7
 v_mfma_f32_16x16x32_bf16 a[32:35], v[180:183], v[172:175], a[32:35]
 ds_read_b64_tr_b16 v[148:149], v17 offset:40960
 v_cvt_pk_bf16_f32 v244, v252, v253
 v_mfma_f32_16x16x32_bf16 a[36:39], v[180:183], v[204:207], a[36:39]
 v_cvt_pk_bf16_f32 v245, v254, v255
 v_mfma_f32_16x16x32_bf16 a[40:43], v[180:183], v[236:239], a[40:43]
 ds_read_b64_tr_b16 v[150:151], v17 offset:45056
 v_cvt_pk_bf16_f32 v60, v4, v5
 v_mfma_f32_16x16x32_bf16 a[44:47], v[180:183], v[52:55], a[44:47]
 v_cvt_pk_bf16_f32 v61, v6, v7
 v_mfma_f32_16x16x32_bf16 a[48:51], v[180:183], v[84:87], a[48:51]
 ds_read_b128 v[228:231], v12 offset:36864
 v_mfma_f32_16x16x32_bf16 a[52:55], v[180:183], v[116:119], a[52:55]
 s_waitcnt lgkmcnt(5)
 v_mfma_f32_16x16x32_bf16 a[56:59], v[212:215], v[140:143], a[56:59]
 ds_read_b128 v[44:47], v13 offset:36864
 v_mfma_f32_16x16x32_bf16 a[60:63], v[212:215], v[172:175], a[60:63]
 v_mfma_f32_16x16x32_bf16 a[228:231], v[28:31], v[172:175], a[228:231]
 v_mfma_f32_16x16x32_bf16 v[252:255], v[36:39], v[160:163], 0
 v_exp_f32 v76, v76
 v_mfma_f32_16x16x32_bf16 v[252:255], v[68:71], v[168:171], v[252:255]
 v_exp_f32 v77, v77
 v_mfma_f32_16x16x32_bf16 v[252:255], v[100:103], v[176:179], v[252:255]
 v_exp_f32 v78, v78
 v_mfma_f32_16x16x32_bf16 v[252:255], v[132:135], v[184:187], v[252:255]
 v_exp_f32 v79, v79
 v_mfma_f32_16x16x32_bf16 v[4:7], v[36:39], v[192:195], 0
 v_exp_f32 v108, v108
 v_mfma_f32_16x16x32_bf16 v[4:7], v[68:71], v[200:203], v[4:7]
 v_exp_f32 v109, v109
 v_mfma_f32_16x16x32_bf16 v[4:7], v[100:103], v[208:211], v[4:7]
 v_exp_f32 v110, v110
 v_mfma_f32_16x16x32_bf16 v[4:7], v[132:135], v[216:219], v[4:7]
 v_exp_f32 v111, v111
 v_mfma_f32_16x16x32_bf16 a[64:67], v[212:215], v[204:207], a[64:67]
 ds_read_b64_tr_b16 v[180:181], v18 offset:40960
 v_cvt_pk_bf16_f32 v92, v76, v77
 v_mfma_f32_16x16x32_bf16 a[68:71], v[212:215], v[236:239], a[68:71]
 v_cvt_pk_bf16_f32 v93, v78, v79
 v_mfma_f32_16x16x32_bf16 a[72:75], v[212:215], v[52:55], a[72:75]
 ds_read_b64_tr_b16 v[182:183], v18 offset:45056
 v_cvt_pk_bf16_f32 v124, v108, v109
 v_mfma_f32_16x16x32_bf16 a[76:79], v[212:215], v[84:87], a[76:79]
 v_cvt_pk_bf16_f32 v125, v110, v111
 v_mfma_f32_16x16x32_bf16 a[80:83], v[212:215], v[116:119], a[80:83]
 s_waitcnt lgkmcnt(4)
 v_mfma_f32_16x16x32_bf16 a[84:87], v[148:151], v[140:143], a[84:87]
 v_mfma_f32_16x16x32_bf16 a[88:91], v[148:151], v[172:175], a[88:91]
 v_mfma_f32_16x16x32_bf16 a[92:95], v[148:151], v[204:207], a[92:95]
 v_mfma_f32_16x16x32_bf16 a[232:235], v[28:31], v[204:207], a[232:235]
 s_waitcnt vmcnt(15) lgkmcnt(2)
 s_barrier
 v_mfma_f32_16x16x32_bf16 v[76:79], v[36:39], v[224:227], 0
 v_exp_f32 v252, v252
 v_mfma_f32_16x16x32_bf16 v[76:79], v[68:71], v[232:235], v[76:79]
 v_exp_f32 v253, v253
 v_mfma_f32_16x16x32_bf16 v[76:79], v[100:103], v[240:243], v[76:79]
 v_exp_f32 v254, v254
 v_mfma_f32_16x16x32_bf16 v[76:79], v[132:135], v[248:251], v[76:79]
 v_exp_f32 v255, v255
 v_mfma_f32_16x16x32_bf16 v[108:111], v[164:167], v[32:35], 0
 v_exp_f32 v4, v4
 v_mfma_f32_16x16x32_bf16 v[108:111], v[196:199], v[40:43], v[108:111]
 v_exp_f32 v5, v5
 v_mfma_f32_16x16x32_bf16 v[108:111], v[228:231], v[48:51], v[108:111]
 v_exp_f32 v6, v6
 v_mfma_f32_16x16x32_bf16 v[108:111], v[44:47], v[56:59], v[108:111]
 v_exp_f32 v7, v7
 v_mfma_f32_16x16x32_bf16 a[96:99], v[148:151], v[236:239], a[96:99]
 ds_read_b64_tr_b16 v[212:213], v19 offset:40960
 v_cvt_pk_bf16_f32 v156, v252, v253
 v_mfma_f32_16x16x32_bf16 a[100:103], v[148:151], v[52:55], a[100:103]
 v_cvt_pk_bf16_f32 v157, v254, v255
 v_mfma_f32_16x16x32_bf16 a[104:107], v[148:151], v[84:87], a[104:107]
 ds_read_b64_tr_b16 v[214:215], v19 offset:45056
 v_cvt_pk_bf16_f32 v188, v4, v5
 v_mfma_f32_16x16x32_bf16 a[108:111], v[148:151], v[116:119], a[108:111]
 s_waitcnt lgkmcnt(2)
 v_cvt_pk_bf16_f32 v189, v6, v7
 v_mfma_f32_16x16x32_bf16 a[112:115], v[180:183], v[140:143], a[112:115]
 ds_read_b128 v[36:39], v10 offset:40960
 v_mfma_f32_16x16x32_bf16 a[116:119], v[180:183], v[172:175], a[116:119]
 v_mfma_f32_16x16x32_bf16 a[120:123], v[180:183], v[204:207], a[120:123]
 ds_read_b128 v[68:71], v11 offset:40960
 v_mfma_f32_16x16x32_bf16 a[124:127], v[180:183], v[236:239], a[124:127]
 buffer_load_dwordx4 v24, s[16:19], s40 offen nt lds
 v_mfma_f32_16x16x32_bf16 a[236:239], v[28:31], v[236:239], a[236:239]
 buffer_load_dwordx4 v2, s[16:19], s40 offen offset:2048 nt lds
 v_mfma_f32_16x16x32_bf16 v[252:255], v[164:167], v[64:67], 0
 s_add_u32 m0, s45, 8192
 v_exp_f32 v76, v76
 v_mfma_f32_16x16x32_bf16 v[252:255], v[196:199], v[72:75], v[252:255]
 s_xor_b32 s40, s101, 11264
 v_exp_f32 v77, v77
 v_mfma_f32_16x16x32_bf16 v[252:255], v[228:231], v[80:83], v[252:255]
 v_exp_f32 v78, v78
 v_mfma_f32_16x16x32_bf16 v[252:255], v[44:47], v[88:91], v[252:255]
 v_exp_f32 v79, v79
 v_mfma_f32_16x16x32_bf16 v[4:7], v[164:167], v[96:99], 0
 v_exp_f32 v108, v108
 v_mfma_f32_16x16x32_bf16 v[4:7], v[196:199], v[104:107], v[4:7]
 v_exp_f32 v109, v109
 v_mfma_f32_16x16x32_bf16 v[4:7], v[228:231], v[112:115], v[4:7]
 v_exp_f32 v110, v110
 v_mfma_f32_16x16x32_bf16 v[4:7], v[44:47], v[120:123], v[4:7]
 v_exp_f32 v111, v111
 v_mfma_f32_16x16x32_bf16 a[128:131], v[180:183], v[52:55], a[128:131]
 ds_read_b64_tr_b16 v[148:149], v20 offset:40960
 v_cvt_pk_bf16_f32 v220, v76, v77
 v_mfma_f32_16x16x32_bf16 a[132:135], v[180:183], v[84:87], a[132:135]
 v_cvt_pk_bf16_f32 v221, v78, v79
 v_mfma_f32_16x16x32_bf16 a[136:139], v[180:183], v[116:119], a[136:139]
 s_waitcnt lgkmcnt(3)
 ds_read_b64_tr_b16 v[150:151], v20 offset:45056
 v_cvt_pk_bf16_f32 v246, v108, v109
 v_mfma_f32_16x16x32_bf16 a[140:143], v[212:215], v[140:143], a[140:143]
 v_cvt_pk_bf16_f32 v247, v110, v111
 v_mfma_f32_16x16x32_bf16 a[144:147], v[212:215], v[172:175], a[144:147]
 ds_read_b128 v[100:103], v12 offset:40960
 v_mfma_f32_16x16x32_bf16 a[148:151], v[212:215], v[204:207], a[148:151]
 v_mfma_f32_16x16x32_bf16 a[152:155], v[212:215], v[236:239], a[152:155]
 ds_read_b128 v[132:135], v13 offset:40960
 v_mfma_f32_16x16x32_bf16 a[156:159], v[212:215], v[52:55], a[156:159]
 v_mfma_f32_16x16x32_bf16 a[240:243], v[28:31], v[52:55], a[240:243]
 v_mfma_f32_16x16x32_bf16 v[76:79], v[164:167], v[128:131], 0
 v_exp_f32 v252, v252
 v_mfma_f32_16x16x32_bf16 v[76:79], v[196:199], v[136:139], v[76:79]
 v_exp_f32 v253, v253
 v_mfma_f32_16x16x32_bf16 v[76:79], v[228:231], v[144:147], v[76:79]
 v_exp_f32 v254, v254
 v_mfma_f32_16x16x32_bf16 v[76:79], v[44:47], v[152:155], v[76:79]
 v_exp_f32 v255, v255
 v_mfma_f32_16x16x32_bf16 v[108:111], v[164:167], v[160:163], 0
 v_exp_f32 v4, v4
 v_mfma_f32_16x16x32_bf16 v[108:111], v[196:199], v[168:171], v[108:111]
 v_exp_f32 v5, v5
 v_mfma_f32_16x16x32_bf16 v[108:111], v[228:231], v[176:179], v[108:111]
 v_exp_f32 v6, v6
 v_mfma_f32_16x16x32_bf16 v[108:111], v[44:47], v[184:187], v[108:111]
 v_exp_f32 v7, v7
 v_mfma_f32_16x16x32_bf16 a[160:163], v[212:215], v[84:87], a[160:163]
 ds_read_b64_tr_b16 v[180:181], v21 offset:40960
 v_cvt_pk_bf16_f32 v62, v252, v253
 v_mfma_f32_16x16x32_bf16 a[164:167], v[212:215], v[116:119], a[164:167]
 s_waitcnt lgkmcnt(3)
 v_cvt_pk_bf16_f32 v63, v254, v255
 v_mfma_f32_16x16x32_bf16 a[168:171], v[148:151], v[140:143], a[168:171]
 ds_read_b64_tr_b16 v[182:183], v21 offset:45056
 v_cvt_pk_bf16_f32 v94, v4, v5
 v_mfma_f32_16x16x32_bf16 a[172:175], v[148:151], v[172:175], a[172:175]
 v_cvt_pk_bf16_f32 v95, v6, v7
 v_mfma_f32_16x16x32_bf16 a[176:179], v[148:151], v[204:207], a[176:179]
 v_mfma_f32_16x16x32_bf16 a[180:183], v[148:151], v[236:239], a[180:183]
 v_mfma_f32_16x16x32_bf16 a[184:187], v[148:151], v[52:55], a[184:187]
 v_mfma_f32_16x16x32_bf16 a[188:191], v[148:151], v[84:87], a[188:191]
 buffer_load_dwordx4 v22, s[12:15], s40 offen nt lds
 v_mfma_f32_16x16x32_bf16 a[244:247], v[28:31], v[84:87], a[244:247]
 buffer_load_dwordx4 v23, s[12:15], s40 offen offset:2048 nt lds
 v_mfma_f32_16x16x32_bf16 v[252:255], v[164:167], v[192:195], 0
 s_add_u32 m0, s45, 12288
 v_exp_f32 v76, v76
 v_mfma_f32_16x16x32_bf16 v[252:255], v[196:199], v[200:203], v[252:255]
 s_xor_b32 s40, s101, 27648
 v_exp_f32 v77, v77
 v_mfma_f32_16x16x32_bf16 v[252:255], v[228:231], v[208:211], v[252:255]
 v_exp_f32 v78, v78
 v_mfma_f32_16x16x32_bf16 v[252:255], v[44:47], v[216:219], v[252:255]
 v_exp_f32 v79, v79
 v_mfma_f32_16x16x32_bf16 v[4:7], v[164:167], v[224:227], 0
 v_exp_f32 v108, v108
 v_mfma_f32_16x16x32_bf16 v[4:7], v[196:199], v[232:235], v[4:7]
 v_exp_f32 v109, v109
 v_mfma_f32_16x16x32_bf16 v[4:7], v[228:231], v[240:243], v[4:7]
 v_exp_f32 v110, v110
 v_mfma_f32_16x16x32_bf16 v[4:7], v[44:47], v[248:251], v[4:7]
 v_exp_f32 v111, v111
 v_mfma_f32_16x16x32_bf16 a[192:195], v[148:151], v[116:119], a[192:195]
 s_waitcnt lgkmcnt(0)
 ds_read_b64_tr_b16 v[212:213], v14 offset:0
 v_cvt_pk_bf16_f32 v126, v76, v77
 v_mfma_f32_16x16x32_bf16 a[196:199], v[180:183], v[140:143], a[196:199]
 v_cvt_pk_bf16_f32 v127, v78, v79
 v_mfma_f32_16x16x32_bf16 a[200:203], v[180:183], v[172:175], a[200:203]
 ds_read_b64_tr_b16 v[214:215], v14 offset:4096
 v_cvt_pk_bf16_f32 v158, v108, v109
 v_mfma_f32_16x16x32_bf16 a[204:207], v[180:183], v[204:207], a[204:207]
 v_cvt_pk_bf16_f32 v159, v110, v111
 v_mfma_f32_16x16x32_bf16 a[208:211], v[180:183], v[236:239], a[208:211]
 ds_read_b64_tr_b16 v[148:149], v15 offset:0
 v_mfma_f32_16x16x32_bf16 a[212:215], v[180:183], v[52:55], a[212:215]
 v_mfma_f32_16x16x32_bf16 a[216:219], v[180:183], v[84:87], a[216:219]
 ds_read_b64_tr_b16 v[150:151], v15 offset:4096
 v_mfma_f32_16x16x32_bf16 a[220:223], v[180:183], v[116:119], a[220:223]
 v_mfma_f32_16x16x32_bf16 a[248:251], v[28:31], v[116:119], a[248:251]
 s_waitcnt lgkmcnt(6)
 v_mfma_f32_16x16x32_bf16 v[76:79], v[36:39], v[32:35], 0
 v_exp_f32 v252, v252
 v_mfma_f32_16x16x32_bf16 v[76:79], v[68:71], v[40:43], v[76:79]
 v_exp_f32 v253, v253
 v_mfma_f32_16x16x32_bf16 v[76:79], v[100:103], v[48:51], v[76:79]
 v_exp_f32 v254, v254
 v_mfma_f32_16x16x32_bf16 v[76:79], v[132:135], v[56:59], v[76:79]
 v_exp_f32 v255, v255
 v_mfma_f32_16x16x32_bf16 v[108:111], v[36:39], v[64:67], 0
 v_exp_f32 v4, v4
 v_mfma_f32_16x16x32_bf16 v[108:111], v[68:71], v[72:75], v[108:111]
 v_exp_f32 v5, v5
 v_mfma_f32_16x16x32_bf16 v[108:111], v[100:103], v[80:83], v[108:111]
 v_exp_f32 v6, v6
 v_mfma_f32_16x16x32_bf16 v[108:111], v[132:135], v[88:91], v[108:111]
 s_waitcnt lgkmcnt(2)
 v_exp_f32 v7, v7
 v_mfma_f32_16x16x32_bf16 a[0:3], v[212:215], v[244:247], a[0:3]
 ds_read_b64_tr_b16 v[180:181], v16 offset:0
 v_cvt_pk_bf16_f32 v190, v252, v253
 v_mfma_f32_16x16x32_bf16 a[4:7], v[212:215], v[60:63], a[4:7]
 v_cvt_pk_bf16_f32 v191, v254, v255
 v_mfma_f32_16x16x32_bf16 a[8:11], v[212:215], v[92:95], a[8:11]
 ds_read_b64_tr_b16 v[182:183], v16 offset:4096
 v_cvt_pk_bf16_f32 v222, v4, v5
 v_mfma_f32_16x16x32_bf16 a[12:15], v[212:215], v[124:127], a[12:15]
 v_cvt_pk_bf16_f32 v223, v6, v7
 v_mfma_f32_16x16x32_bf16 a[16:19], v[212:215], v[156:159], a[16:19]
 ds_read_b128 v[164:167], v10 offset:45056
 v_add_u32 v10, 131072, v10
 v_mfma_f32_16x16x32_bf16 a[20:23], v[212:215], v[188:191], a[20:23]
 v_mfma_f32_16x16x32_bf16 a[24:27], v[212:215], v[220:223], a[24:27]
 s_waitcnt lgkmcnt(3)
 ds_read_b128 v[196:199], v11 offset:45056
 v_add_u32 v11, 131072, v11
 v_mfma_f32_16x16x32_bf16 a[28:31], v[148:151], v[244:247], a[28:31]
 buffer_load_dwordx4 v22, s[12:15], s40 offen nt lds
 v_mfma_f32_16x16x32_bf16 a[224:227], v[28:31], v[244:247], a[224:227]
 buffer_load_dwordx4 v23, s[12:15], s40 offen offset:2048 nt lds
 v_mfma_f32_16x16x32_bf16 v[252:255], v[36:39], v[96:99], 0
 s_add_u32 m0, s46, 32768
 v_exp_f32 v76, v76
 v_mfma_f32_16x16x32_bf16 v[252:255], v[68:71], v[104:107], v[252:255]
 s_xor_b32 s40, s101, 10240
 v_exp_f32 v77, v77
 v_mfma_f32_16x16x32_bf16 v[252:255], v[100:103], v[112:115], v[252:255]
 v_exp_f32 v78, v78
 v_mfma_f32_16x16x32_bf16 v[252:255], v[132:135], v[120:123], v[252:255]
 v_exp_f32 v79, v79
 v_mfma_f32_16x16x32_bf16 v[4:7], v[36:39], v[128:131], 0
 v_exp_f32 v108, v108
 v_mfma_f32_16x16x32_bf16 v[4:7], v[68:71], v[136:139], v[4:7]
 v_exp_f32 v109, v109
 v_mfma_f32_16x16x32_bf16 v[4:7], v[100:103], v[144:147], v[4:7]
 v_exp_f32 v110, v110
 v_mfma_f32_16x16x32_bf16 v[4:7], v[132:135], v[152:155], v[4:7]
 v_exp_f32 v111, v111
 v_mfma_f32_16x16x32_bf16 a[32:35], v[148:151], v[60:63], a[32:35]
 ds_read_b64_tr_b16 v[212:213], v17 offset:0
 v_cvt_pk_bf16_f32 v140, v76, v77
 v_mfma_f32_16x16x32_bf16 a[36:39], v[148:151], v[92:95], a[36:39]
 v_cvt_pk_bf16_f32 v141, v78, v79
 v_mfma_f32_16x16x32_bf16 a[40:43], v[148:151], v[124:127], a[40:43]
 ds_read_b64_tr_b16 v[214:215], v17 offset:4096
 v_cvt_pk_bf16_f32 v172, v108, v109
 v_mfma_f32_16x16x32_bf16 a[44:47], v[148:151], v[156:159], a[44:47]
 v_cvt_pk_bf16_f32 v173, v110, v111
 v_mfma_f32_16x16x32_bf16 a[48:51], v[148:151], v[188:191], a[48:51]
 ds_read_b128 v[228:231], v12 offset:45056
 v_add_u32 v12, 131072, v12
 v_mfma_f32_16x16x32_bf16 a[52:55], v[148:151], v[220:223], a[52:55]
 s_waitcnt lgkmcnt(5)
 v_mfma_f32_16x16x32_bf16 a[56:59], v[180:183], v[244:247], a[56:59]
 ds_read_b128 v[44:47], v13 offset:45056
 v_add_u32 v13, 131072, v13
 v_mfma_f32_16x16x32_bf16 a[60:63], v[180:183], v[60:63], a[60:63]
 v_mfma_f32_16x16x32_bf16 a[228:231], v[28:31], v[60:63], a[228:231]
 v_mfma_f32_16x16x32_bf16 v[76:79], v[36:39], v[160:163], 0
 v_exp_f32 v252, v252
 v_mfma_f32_16x16x32_bf16 v[76:79], v[68:71], v[168:171], v[76:79]
 v_exp_f32 v253, v253
 v_mfma_f32_16x16x32_bf16 v[76:79], v[100:103], v[176:179], v[76:79]
 v_exp_f32 v254, v254
 v_mfma_f32_16x16x32_bf16 v[76:79], v[132:135], v[184:187], v[76:79]
 v_exp_f32 v255, v255
 v_mfma_f32_16x16x32_bf16 v[108:111], v[36:39], v[192:195], 0
 v_exp_f32 v4, v4
 v_mfma_f32_16x16x32_bf16 v[108:111], v[68:71], v[200:203], v[108:111]
 v_exp_f32 v5, v5
 v_mfma_f32_16x16x32_bf16 v[108:111], v[100:103], v[208:211], v[108:111]
 v_exp_f32 v6, v6
 v_mfma_f32_16x16x32_bf16 v[108:111], v[132:135], v[216:219], v[108:111]
 v_exp_f32 v7, v7
 v_mfma_f32_16x16x32_bf16 a[64:67], v[180:183], v[92:95], a[64:67]
 ds_read_b64_tr_b16 v[148:149], v18 offset:0
 v_cvt_pk_bf16_f32 v204, v252, v253
 v_mfma_f32_16x16x32_bf16 a[68:71], v[180:183], v[124:127], a[68:71]
 v_cvt_pk_bf16_f32 v205, v254, v255
 v_mfma_f32_16x16x32_bf16 a[72:75], v[180:183], v[156:159], a[72:75]
 ds_read_b64_tr_b16 v[150:151], v18 offset:4096
 v_cvt_pk_bf16_f32 v236, v4, v5
 v_mfma_f32_16x16x32_bf16 a[76:79], v[180:183], v[188:191], a[76:79]
 v_cvt_pk_bf16_f32 v237, v6, v7
 v_mfma_f32_16x16x32_bf16 a[80:83], v[180:183], v[220:223], a[80:83]
 s_waitcnt lgkmcnt(4)
 v_mfma_f32_16x16x32_bf16 a[84:87], v[212:215], v[244:247], a[84:87]
 v_mfma_f32_16x16x32_bf16 a[88:91], v[212:215], v[60:63], a[88:91]
 v_mfma_f32_16x16x32_bf16 a[92:95], v[212:215], v[92:95], a[92:95]
 buffer_load_dwordx4 v24, s[16:19], s40 offen nt lds
 v_mfma_f32_16x16x32_bf16 a[232:235], v[28:31], v[92:95], a[232:235]
 buffer_load_dwordx4 v2, s[16:19], s40 offen offset:2048 nt lds
 s_waitcnt vmcnt(14) lgkmcnt(2)
 s_barrier
 v_mfma_f32_16x16x32_bf16 v[252:255], v[36:39], v[224:227], 0
 s_add_u32 m0, s46, 36864
 v_exp_f32 v76, v76
 v_mfma_f32_16x16x32_bf16 v[252:255], v[68:71], v[232:235], v[252:255]
 s_xor_b32 s40, s101, 26624
 v_exp_f32 v77, v77
 v_mfma_f32_16x16x32_bf16 v[252:255], v[100:103], v[240:243], v[252:255]
 v_exp_f32 v78, v78
 v_mfma_f32_16x16x32_bf16 v[252:255], v[132:135], v[248:251], v[252:255]
 v_exp_f32 v79, v79
 v_mfma_f32_16x16x32_bf16 v[4:7], v[164:167], v[32:35], 0
 v_exp_f32 v108, v108
 v_mfma_f32_16x16x32_bf16 v[4:7], v[196:199], v[40:43], v[4:7]
 v_exp_f32 v109, v109
 v_mfma_f32_16x16x32_bf16 v[4:7], v[228:231], v[48:51], v[4:7]
 v_exp_f32 v110, v110
 v_mfma_f32_16x16x32_bf16 v[4:7], v[44:47], v[56:59], v[4:7]
 s_branch SK5263
PG5263:
 s_branch PG7640
SK5263:
 v_exp_f32 v111, v111
 v_mfma_f32_16x16x32_bf16 a[96:99], v[212:215], v[124:127], a[96:99]
 ds_read_b64_tr_b16 v[180:181], v19 offset:0
 v_cvt_pk_bf16_f32 v52, v76, v77
 v_mfma_f32_16x16x32_bf16 a[100:103], v[212:215], v[156:159], a[100:103]
 v_cvt_pk_bf16_f32 v53, v78, v79
 v_mfma_f32_16x16x32_bf16 a[104:107], v[212:215], v[188:191], a[104:107]
 ds_read_b64_tr_b16 v[182:183], v19 offset:4096
 v_cvt_pk_bf16_f32 v84, v108, v109
 v_mfma_f32_16x16x32_bf16 a[108:111], v[212:215], v[220:223], a[108:111]
 s_waitcnt lgkmcnt(2)
 v_cvt_pk_bf16_f32 v85, v110, v111
 v_mfma_f32_16x16x32_bf16 a[112:115], v[148:151], v[244:247], a[112:115]
 ds_read_b128 v[36:39], v10 offset:0
 v_mfma_f32_16x16x32_bf16 a[116:119], v[148:151], v[60:63], a[116:119]
 v_mfma_f32_16x16x32_bf16 a[120:123], v[148:151], v[92:95], a[120:123]
 ds_read_b128 v[68:71], v11 offset:0
 v_mfma_f32_16x16x32_bf16 a[124:127], v[148:151], v[124:127], a[124:127]
 v_mfma_f32_16x16x32_bf16 a[236:239], v[28:31], v[124:127], a[236:239]
 v_mfma_f32_16x16x32_bf16 v[76:79], v[164:167], v[64:67], 0
 v_exp_f32 v252, v252
 v_mfma_f32_16x16x32_bf16 v[76:79], v[196:199], v[72:75], v[76:79]
 v_exp_f32 v253, v253
 v_mfma_f32_16x16x32_bf16 v[76:79], v[228:231], v[80:83], v[76:79]
 v_exp_f32 v254, v254
 v_mfma_f32_16x16x32_bf16 v[76:79], v[44:47], v[88:91], v[76:79]
 v_exp_f32 v255, v255
 v_mfma_f32_16x16x32_bf16 v[108:111], v[164:167], v[96:99], 0
 v_exp_f32 v4, v4
 v_mfma_f32_16x16x32_bf16 v[108:111], v[196:199], v[104:107], v[108:111]
 v_exp_f32 v5, v5
 v_mfma_f32_16x16x32_bf16 v[108:111], v[228:231], v[112:115], v[108:111]
 v_exp_f32 v6, v6
 v_mfma_f32_16x16x32_bf16 v[108:111], v[44:47], v[120:123], v[108:111]
 v_exp_f32 v7, v7
 v_mfma_f32_16x16x32_bf16 a[128:131], v[148:151], v[156:159], a[128:131]
 ds_read_b64_tr_b16 v[212:213], v20 offset:0
 v_cvt_pk_bf16_f32 v116, v252, v253
 v_mfma_f32_16x16x32_bf16 a[132:135], v[148:151], v[188:191], a[132:135]
 v_cvt_pk_bf16_f32 v117, v254, v255
 v_mfma_f32_16x16x32_bf16 a[136:139], v[148:151], v[220:223], a[136:139]
 s_waitcnt lgkmcnt(3)
 ds_read_b64_tr_b16 v[214:215], v20 offset:4096
 v_cvt_pk_bf16_f32 v142, v4, v5
 v_mfma_f32_16x16x32_bf16 a[140:143], v[180:183], v[244:247], a[140:143]
 v_cvt_pk_bf16_f32 v143, v6, v7
 v_mfma_f32_16x16x32_bf16 a[144:147], v[180:183], v[60:63], a[144:147]
 ds_read_b128 v[100:103], v12 offset:0
 v_mfma_f32_16x16x32_bf16 a[148:151], v[180:183], v[92:95], a[148:151]
 v_mfma_f32_16x16x32_bf16 a[152:155], v[180:183], v[124:127], a[152:155]
 ds_read_b128 v[132:135], v13 offset:0
 v_mfma_f32_16x16x32_bf16 a[156:159], v[180:183], v[156:159], a[156:159]
 buffer_load_dwordx4 v24, s[16:19], s40 offen nt lds
 v_mfma_f32_16x16x32_bf16 a[240:243], v[28:31], v[156:159], a[240:243]
 buffer_load_dwordx4 v2, s[16:19], s40 offen offset:2048 nt lds
 v_mfma_f32_16x16x32_bf16 v[252:255], v[164:167], v[128:131], 0
 s_add_u32 m0, s45, 32768
 v_exp_f32 v76, v76
 v_mfma_f32_16x16x32_bf16 v[252:255], v[196:199], v[136:139], v[252:255]
 s_xor_b32 s40, s101, 12288
 v_exp_f32 v77, v77
 v_mfma_f32_16x16x32_bf16 v[252:255], v[228:231], v[144:147], v[252:255]
 v_exp_f32 v78, v78
 v_mfma_f32_16x16x32_bf16 v[252:255], v[44:47], v[152:155], v[252:255]
 v_exp_f32 v79, v79
 v_mfma_f32_16x16x32_bf16 v[4:7], v[164:167], v[160:163], 0
 v_exp_f32 v108, v108
 v_mfma_f32_16x16x32_bf16 v[4:7], v[196:199], v[168:171], v[4:7]
 v_exp_f32 v109, v109
 v_mfma_f32_16x16x32_bf16 v[4:7], v[228:231], v[176:179], v[4:7]
 v_exp_f32 v110, v110
 v_mfma_f32_16x16x32_bf16 v[4:7], v[44:47], v[184:187], v[4:7]
 v_exp_f32 v111, v111
 v_mfma_f32_16x16x32_bf16 a[160:163], v[180:183], v[188:191], a[160:163]
 ds_read_b64_tr_b16 v[148:149], v21 offset:0
 v_cvt_pk_bf16_f32 v174, v76, v77
 v_mfma_f32_16x16x32_bf16 a[164:167], v[180:183], v[220:223], a[164:167]
 s_waitcnt lgkmcnt(3)
 v_cvt_pk_bf16_f32 v175, v78, v79
 v_mfma_f32_16x16x32_bf16 a[168:171], v[212:215], v[244:247], a[168:171]
 ds_read_b64_tr_b16 v[150:151], v21 offset:4096
 v_cvt_pk_bf16_f32 v206, v108, v109
 v_mfma_f32_16x16x32_bf16 a[172:175], v[212:215], v[60:63], a[172:175]
 v_cvt_pk_bf16_f32 v207, v110, v111
 v_mfma_f32_16x16x32_bf16 a[176:179], v[212:215], v[92:95], a[176:179]
 v_mfma_f32_16x16x32_bf16 a[180:183], v[212:215], v[124:127], a[180:183]
 v_mfma_f32_16x16x32_bf16 a[184:187], v[212:215], v[156:159], a[184:187]
 v_mfma_f32_16x16x32_bf16 a[188:191], v[212:215], v[188:191], a[188:191]
 v_mfma_f32_16x16x32_bf16 a[244:247], v[28:31], v[188:191], a[244:247]
 v_mfma_f32_16x16x32_bf16 v[76:79], v[164:167], v[192:195], 0
 v_exp_f32 v252, v252
 v_mfma_f32_16x16x32_bf16 v[76:79], v[196:199], v[200:203], v[76:79]
 v_exp_f32 v253, v253
 v_mfma_f32_16x16x32_bf16 v[76:79], v[228:231], v[208:211], v[76:79]
 v_exp_f32 v254, v254
 v_mfma_f32_16x16x32_bf16 v[76:79], v[44:47], v[216:219], v[76:79]
 v_exp_f32 v255, v255
 v_mfma_f32_16x16x32_bf16 v[108:111], v[164:167], v[224:227], 0
 v_exp_f32 v4, v4
 v_mfma_f32_16x16x32_bf16 v[108:111], v[196:199], v[232:235], v[108:111]
 v_exp_f32 v5, v5
 v_mfma_f32_16x16x32_bf16 v[108:111], v[228:231], v[240:243], v[108:111]
 v_exp_f32 v6, v6
 v_mfma_f32_16x16x32_bf16 v[108:111], v[44:47], v[248:251], v[108:111]
 v_exp_f32 v7, v7
 v_mfma_f32_16x16x32_bf16 a[192:195], v[212:215], v[220:223], a[192:195]
 s_waitcnt lgkmcnt(0)
 ds_read_b64_tr_b16 v[180:181], v14 offset:8192
 v_cvt_pk_bf16_f32 v238, v252, v253
 v_mfma_f32_16x16x32_bf16 a[196:199], v[148:151], v[244:247], a[196:199]
 v_cvt_pk_bf16_f32 v239, v254, v255
 v_mfma_f32_16x16x32_bf16 a[200:203], v[148:151], v[60:63], a[200:203]
 ds_read_b64_tr_b16 v[182:183], v14 offset:12288
 v_add_u32 v14, 73728, v14
 v_cvt_pk_bf16_f32 v54, v4, v5
 v_mfma_f32_16x16x32_bf16 a[204:207], v[148:151], v[92:95], a[204:207]
 v_cvt_pk_bf16_f32 v55, v6, v7
 v_mfma_f32_16x16x32_bf16 a[208:211], v[148:151], v[124:127], a[208:211]
 ds_read_b64_tr_b16 v[212:213], v15 offset:8192
 v_mfma_f32_16x16x32_bf16 a[212:215], v[148:151], v[156:159], a[212:215]
 v_mfma_f32_16x16x32_bf16 a[216:219], v[148:151], v[188:191], a[216:219]
 ds_read_b64_tr_b16 v[214:215], v15 offset:12288
 v_add_u32 v15, 73728, v15
 v_mfma_f32_16x16x32_bf16 a[220:223], v[148:151], v[220:223], a[220:223]
 buffer_load_dwordx4 v22, s[12:15], s40 offen nt lds
 v_mfma_f32_16x16x32_bf16 a[248:251], v[28:31], v[220:223], a[248:251]
 s_waitcnt lgkmcnt(6)
 buffer_load_dwordx4 v23, s[12:15], s40 offen offset:2048 nt lds
 v_mfma_f32_16x16x32_bf16 v[252:255], v[36:39], v[32:35], 0
 s_add_u32 m0, s45, 36864
 v_exp_f32 v76, v76
 v_mfma_f32_16x16x32_bf16 v[252:255], v[68:71], v[40:43], v[252:255]
 s_xor_b32 s40, s101, 28672
 v_exp_f32 v77, v77
 v_mfma_f32_16x16x32_bf16 v[252:255], v[100:103], v[48:51], v[252:255]
 v_exp_f32 v78, v78
 v_mfma_f32_16x16x32_bf16 v[252:255], v[132:135], v[56:59], v[252:255]
 v_exp_f32 v79, v79
 v_mfma_f32_16x16x32_bf16 v[4:7], v[36:39], v[64:67], 0
 v_exp_f32 v108, v108
 v_mfma_f32_16x16x32_bf16 v[4:7], v[68:71], v[72:75], v[4:7]
 v_exp_f32 v109, v109
 v_mfma_f32_16x16x32_bf16 v[4:7], v[100:103], v[80:83], v[4:7]
 v_exp_f32 v110, v110
 v_mfma_f32_16x16x32_bf16 v[4:7], v[132:135], v[88:91], v[4:7]
 s_waitcnt lgkmcnt(2)
 v_exp_f32 v111, v111
 v_mfma_f32_16x16x32_bf16 a[0:3], v[180:183], v[140:143], a[0:3]
 ds_read_b64_tr_b16 v[148:149], v16 offset:8192
 v_cvt_pk_bf16_f32 v86, v76, v77
 v_mfma_f32_16x16x32_bf16 a[4:7], v[180:183], v[172:175], a[4:7]
 v_cvt_pk_bf16_f32 v87, v78, v79
 v_mfma_f32_16x16x32_bf16 a[8:11], v[180:183], v[204:207], a[8:11]
 ds_read_b64_tr_b16 v[150:151], v16 offset:12288
 v_add_u32 v16, 73728, v16
 v_cvt_pk_bf16_f32 v118, v108, v109
 v_mfma_f32_16x16x32_bf16 a[12:15], v[180:183], v[236:239], a[12:15]
 v_cvt_pk_bf16_f32 v119, v110, v111
 v_mfma_f32_16x16x32_bf16 a[16:19], v[180:183], v[52:55], a[16:19]
 ds_read_b128 v[164:167], v10 offset:4096
 v_add_u32 v10, 0xfffe0000, v10
 v_mfma_f32_16x16x32_bf16 a[20:23], v[180:183], v[84:87], a[20:23]
 v_mfma_f32_16x16x32_bf16 a[24:27], v[180:183], v[116:119], a[24:27]
 s_waitcnt lgkmcnt(3)
 ds_read_b128 v[196:199], v11 offset:4096
 v_add_u32 v11, 0xfffe0000, v11
 v_mfma_f32_16x16x32_bf16 a[28:31], v[212:215], v[140:143], a[28:31]
 v_mfma_f32_16x16x32_bf16 a[224:227], v[28:31], v[140:143], a[224:227]
 v_mfma_f32_16x16x32_bf16 v[76:79], v[36:39], v[96:99], 0
 v_exp_f32 v252, v252
 v_mfma_f32_16x16x32_bf16 v[76:79], v[68:71], v[104:107], v[76:79]
 v_exp_f32 v253, v253
 v_mfma_f32_16x16x32_bf16 v[76:79], v[100:103], v[112:115], v[76:79]
 v_exp_f32 v254, v254
 v_mfma_f32_16x16x32_bf16 v[76:79], v[132:135], v[120:123], v[76:79]
 v_exp_f32 v255, v255
 v_mfma_f32_16x16x32_bf16 v[108:111], v[36:39], v[128:131], 0
 v_exp_f32 v4, v4
 v_mfma_f32_16x16x32_bf16 v[108:111], v[68:71], v[136:139], v[108:111]
 v_exp_f32 v5, v5
 v_mfma_f32_16x16x32_bf16 v[108:111], v[100:103], v[144:147], v[108:111]
 v_exp_f32 v6, v6
 v_mfma_f32_16x16x32_bf16 v[108:111], v[132:135], v[152:155], v[108:111]
 v_exp_f32 v7, v7
 v_mfma_f32_16x16x32_bf16 a[32:35], v[212:215], v[172:175], a[32:35]
 ds_read_b64_tr_b16 v[180:181], v17 offset:8192
 v_cvt_pk_bf16_f32 v244, v252, v253
 v_mfma_f32_16x16x32_bf16 a[36:39], v[212:215], v[204:207], a[36:39]
 v_cvt_pk_bf16_f32 v245, v254, v255
 v_mfma_f32_16x16x32_bf16 a[40:43], v[212:215], v[236:239], a[40:43]
 ds_read_b64_tr_b16 v[182:183], v17 offset:12288
 v_add_u32 v17, 73728, v17
 v_cvt_pk_bf16_f32 v60, v4, v5
 v_mfma_f32_16x16x32_bf16 a[44:47], v[212:215], v[52:55], a[44:47]
 v_cvt_pk_bf16_f32 v61, v6, v7
 v_mfma_f32_16x16x32_bf16 a[48:51], v[212:215], v[84:87], a[48:51]
 ds_read_b128 v[228:231], v12 offset:4096
 v_add_u32 v12, 0xfffe0000, v12
 v_mfma_f32_16x16x32_bf16 a[52:55], v[212:215], v[116:119], a[52:55]
 s_waitcnt lgkmcnt(5)
 v_mfma_f32_16x16x32_bf16 a[56:59], v[148:151], v[140:143], a[56:59]
 ds_read_b128 v[44:47], v13 offset:4096
 v_add_u32 v13, 0xfffe0000, v13
 v_mfma_f32_16x16x32_bf16 a[60:63], v[148:151], v[172:175], a[60:63]
 buffer_load_dwordx4 v22, s[12:15], s40 offen nt lds
 v_mfma_f32_16x16x32_bf16 a[228:231], v[28:31], v[172:175], a[228:231]
 buffer_load_dwordx4 v23, s[12:15], s40 offen offset:2048 nt lds
 v_mfma_f32_16x16x32_bf16 v[252:255], v[36:39], v[160:163], 0
 s_add_u32 m0, s46, 40960
 v_exp_f32 v76, v76
 v_mfma_f32_16x16x32_bf16 v[252:255], v[68:71], v[168:171], v[252:255]
 s_xor_b32 s40, s101, 11264
 v_exp_f32 v77, v77
 v_mfma_f32_16x16x32_bf16 v[252:255], v[100:103], v[176:179], v[252:255]
 v_exp_f32 v78, v78
 v_mfma_f32_16x16x32_bf16 v[252:255], v[132:135], v[184:187], v[252:255]
 v_exp_f32 v79, v79
 v_mfma_f32_16x16x32_bf16 v[4:7], v[36:39], v[192:195], 0
 v_exp_f32 v108, v108
 v_mfma_f32_16x16x32_bf16 v[4:7], v[68:71], v[200:203], v[4:7]
 v_exp_f32 v109, v109
 v_mfma_f32_16x16x32_bf16 v[4:7], v[100:103], v[208:211], v[4:7]
 v_exp_f32 v110, v110
 v_mfma_f32_16x16x32_bf16 v[4:7], v[132:135], v[216:219], v[4:7]
 v_exp_f32 v111, v111
 v_mfma_f32_16x16x32_bf16 a[64:67], v[148:151], v[204:207], a[64:67]
 ds_read_b64_tr_b16 v[212:213], v18 offset:8192
 v_cvt_pk_bf16_f32 v92, v76, v77
 v_mfma_f32_16x16x32_bf16 a[68:71], v[148:151], v[236:239], a[68:71]
 v_cvt_pk_bf16_f32 v93, v78, v79
 v_mfma_f32_16x16x32_bf16 a[72:75], v[148:151], v[52:55], a[72:75]
 ds_read_b64_tr_b16 v[214:215], v18 offset:12288
 v_add_u32 v18, 73728, v18
 v_cvt_pk_bf16_f32 v124, v108, v109
 v_mfma_f32_16x16x32_bf16 a[76:79], v[148:151], v[84:87], a[76:79]
 v_cvt_pk_bf16_f32 v125, v110, v111
 v_mfma_f32_16x16x32_bf16 a[80:83], v[148:151], v[116:119], a[80:83]
 s_waitcnt lgkmcnt(4)
 v_mfma_f32_16x16x32_bf16 a[84:87], v[180:183], v[140:143], a[84:87]
 v_mfma_f32_16x16x32_bf16 a[88:91], v[180:183], v[172:175], a[88:91]
 v_mfma_f32_16x16x32_bf16 a[92:95], v[180:183], v[204:207], a[92:95]
 v_mfma_f32_16x16x32_bf16 a[232:235], v[28:31], v[204:207], a[232:235]
 s_waitcnt vmcnt(12) lgkmcnt(2)
 s_barrier
 v_mfma_f32_16x16x32_bf16 v[76:79], v[36:39], v[224:227], 0
 v_exp_f32 v252, v252
 v_mfma_f32_16x16x32_bf16 v[76:79], v[68:71], v[232:235], v[76:79]
 v_exp_f32 v253, v253
 v_mfma_f32_16x16x32_bf16 v[76:79], v[100:103], v[240:243], v[76:79]
 v_exp_f32 v254, v254
 v_mfma_f32_16x16x32_bf16 v[76:79], v[132:135], v[248:251], v[76:79]
 v_exp_f32 v255, v255
 v_mfma_f32_16x16x32_bf16 v[108:111], v[164:167], v[32:35], 0
 v_exp_f32 v4, v4
 v_mfma_f32_16x16x32_bf16 v[108:111], v[196:199], v[40:43], v[108:111]
 v_exp_f32 v5, v5
 v_mfma_f32_16x16x32_bf16 v[108:111], v[228:231], v[48:51], v[108:111]
 v_exp_f32 v6, v6
 v_mfma_f32_16x16x32_bf16 v[108:111], v[44:47], v[56:59], v[108:111]
 v_exp_f32 v7, v7
 v_mfma_f32_16x16x32_bf16 a[96:99], v[180:183], v[236:239], a[96:99]
 ds_read_b64_tr_b16 v[148:149], v19 offset:8192
 v_cvt_pk_bf16_f32 v156, v252, v253
 v_mfma_f32_16x16x32_bf16 a[100:103], v[180:183], v[52:55], a[100:103]
 v_cvt_pk_bf16_f32 v157, v254, v255
 v_mfma_f32_16x16x32_bf16 a[104:107], v[180:183], v[84:87], a[104:107]
 ds_read_b64_tr_b16 v[150:151], v19 offset:12288
 v_add_u32 v19, 73728, v19
 v_cvt_pk_bf16_f32 v188, v4, v5
 v_mfma_f32_16x16x32_bf16 a[108:111], v[180:183], v[116:119], a[108:111]
 s_waitcnt lgkmcnt(2)
 v_cvt_pk_bf16_f32 v189, v6, v7
 v_mfma_f32_16x16x32_bf16 a[112:115], v[212:215], v[140:143], a[112:115]
 ds_read_b128 v[36:39], v10 offset:0
 v_mfma_f32_16x16x32_bf16 a[116:119], v[212:215], v[172:175], a[116:119]
 v_mfma_f32_16x16x32_bf16 a[120:123], v[212:215], v[204:207], a[120:123]
 ds_read_b128 v[68:71], v11 offset:0
 v_mfma_f32_16x16x32_bf16 a[124:127], v[212:215], v[236:239], a[124:127]
 buffer_load_dwordx4 v24, s[16:19], s40 offen nt lds
 v_mfma_f32_16x16x32_bf16 a[236:239], v[28:31], v[236:239], a[236:239]
 buffer_load_dwordx4 v2, s[16:19], s40 offen offset:2048 nt lds
 v_mfma_f32_16x16x32_bf16 v[252:255], v[164:167], v[64:67], 0
 s_and_b32 s54, s2, 3
 v_exp_f32 v76, v76
 v_mfma_f32_16x16x32_bf16 v[252:255], v[196:199], v[72:75], v[252:255]
 s_add_u32 s66, s54, 0
 v_exp_f32 v77, v77
 v_mfma_f32_16x16x32_bf16 v[252:255], v[228:231], v[80:83], v[252:255]
 s_lshl_b32 s54, s54, 2
 v_exp_f32 v78, v78
 v_mfma_f32_16x16x32_bf16 v[252:255], v[44:47], v[88:91], v[252:255]
 s_lshr_b32 s55, s2, 6
 v_exp_f32 v79, v79
 v_mfma_f32_16x16x32_bf16 v[4:7], v[164:167], v[96:99], 0
 s_add_u32 s52, s54, s55
 v_exp_f32 v108, v108
 v_mfma_f32_16x16x32_bf16 v[4:7], v[196:199], v[104:107], v[4:7]
 s_lshr_b32 s55, s2, 3
 v_exp_f32 v109, v109
 v_mfma_f32_16x16x32_bf16 v[4:7], v[228:231], v[112:115], v[4:7]
 s_and_b32 s53, s55, 7
 v_exp_f32 v110, v110
 v_mfma_f32_16x16x32_bf16 v[4:7], v[44:47], v[120:123], v[4:7]
 s_mov_b32 s56, 0x100000
 v_exp_f32 v111, v111
 v_mfma_f32_16x16x32_bf16 a[128:131], v[212:215], v[52:55], a[128:131]
 s_add_u32 m0, s46, 45056
 ds_read_b64_tr_b16 v[180:181], v20 offset:8192
 v_cvt_pk_bf16_f32 v220, v76, v77
 v_mfma_f32_16x16x32_bf16 a[132:135], v[212:215], v[84:87], a[132:135]
 s_xor_b32 s40, s101, 27648
 v_cvt_pk_bf16_f32 v221, v78, v79
 v_mfma_f32_16x16x32_bf16 a[136:139], v[212:215], v[116:119], a[136:139]
 s_waitcnt lgkmcnt(3)
 ds_read_b64_tr_b16 v[182:183], v20 offset:12288
 v_add_u32 v20, 73728, v20
 v_cvt_pk_bf16_f32 v246, v108, v109
 v_mfma_f32_16x16x32_bf16 a[140:143], v[148:151], v[140:143], a[140:143]
 v_cvt_pk_bf16_f32 v247, v110, v111
 v_mfma_f32_16x16x32_bf16 a[144:147], v[148:151], v[172:175], a[144:147]
 ds_read_b128 v[100:103], v12 offset:0
 v_mfma_f32_16x16x32_bf16 a[148:151], v[148:151], v[204:207], a[148:151]
 v_mfma_f32_16x16x32_bf16 a[152:155], v[148:151], v[236:239], a[152:155]
 ds_read_b128 v[132:135], v13 offset:0
 v_mfma_f32_16x16x32_bf16 a[156:159], v[148:151], v[52:55], a[156:159]
 v_mfma_f32_16x16x32_bf16 a[240:243], v[28:31], v[52:55], a[240:243]
 v_mfma_f32_16x16x32_bf16 v[76:79], v[164:167], v[128:131], 0
 v_exp_f32 v252, v252
 v_mfma_f32_16x16x32_bf16 v[76:79], v[196:199], v[136:139], v[76:79]
 v_exp_f32 v253, v253
 v_mfma_f32_16x16x32_bf16 v[76:79], v[228:231], v[144:147], v[76:79]
 v_exp_f32 v254, v254
 v_mfma_f32_16x16x32_bf16 v[76:79], v[44:47], v[152:155], v[76:79]
 v_exp_f32 v255, v255
 v_mfma_f32_16x16x32_bf16 v[108:111], v[164:167], v[160:163], 0
 v_exp_f32 v4, v4
 v_mfma_f32_16x16x32_bf16 v[108:111], v[196:199], v[168:171], v[108:111]
 v_exp_f32 v5, v5
 v_mfma_f32_16x16x32_bf16 v[108:111], v[228:231], v[176:179], v[108:111]
 v_exp_f32 v6, v6
 v_mfma_f32_16x16x32_bf16 v[108:111], v[44:47], v[184:187], v[108:111]
 v_exp_f32 v7, v7
 v_mfma_f32_16x16x32_bf16 a[160:163], v[148:151], v[84:87], a[160:163]
 ds_read_b64_tr_b16 v[212:213], v21 offset:8192
 v_cvt_pk_bf16_f32 v62, v252, v253
 v_mfma_f32_16x16x32_bf16 a[164:167], v[148:151], v[116:119], a[164:167]
 s_waitcnt lgkmcnt(3)
 v_cvt_pk_bf16_f32 v63, v254, v255
 v_mfma_f32_16x16x32_bf16 a[168:171], v[180:183], v[140:143], a[168:171]
 ds_read_b64_tr_b16 v[214:215], v21 offset:12288
 v_add_u32 v21, 73728, v21
 v_cvt_pk_bf16_f32 v94, v4, v5
 v_mfma_f32_16x16x32_bf16 a[172:175], v[180:183], v[172:175], a[172:175]
 v_cvt_pk_bf16_f32 v95, v6, v7
 v_mfma_f32_16x16x32_bf16 a[176:179], v[180:183], v[204:207], a[176:179]
 v_mfma_f32_16x16x32_bf16 a[180:183], v[180:183], v[236:239], a[180:183]
 v_mfma_f32_16x16x32_bf16 a[184:187], v[180:183], v[52:55], a[184:187]
 v_mfma_f32_16x16x32_bf16 a[188:191], v[180:183], v[84:87], a[188:191]
 buffer_load_dwordx4 v24, s[16:19], s40 offen nt lds
 v_mfma_f32_16x16x32_bf16 a[244:247], v[28:31], v[84:87], a[244:247]
 buffer_load_dwordx4 v2, s[16:19], s40 offen offset:2048 nt lds
CPF6:
 s_mov_b32 s88, CPF6-K1_BASE+2048
 buffer_load_dword v8, v9, s[96:99], s88 offen
 v_mfma_f32_16x16x32_bf16 v[252:255], v[164:167], v[192:195], 0
 s_add_u32 m0, s45, 40960
 v_exp_f32 v76, v76
 v_mfma_f32_16x16x32_bf16 v[252:255], v[196:199], v[200:203], v[252:255]
 s_xor_b32 s40, s101, 13312
 v_exp_f32 v77, v77
 v_mfma_f32_16x16x32_bf16 v[252:255], v[228:231], v[208:211], v[252:255]
 v_exp_f32 v78, v78
 v_mfma_f32_16x16x32_bf16 v[252:255], v[44:47], v[216:219], v[252:255]
 v_exp_f32 v79, v79
 v_mfma_f32_16x16x32_bf16 v[4:7], v[164:167], v[224:227], 0
 v_exp_f32 v108, v108
 v_mfma_f32_16x16x32_bf16 v[4:7], v[196:199], v[232:235], v[4:7]
 v_exp_f32 v109, v109
 v_mfma_f32_16x16x32_bf16 v[4:7], v[228:231], v[240:243], v[4:7]
 v_exp_f32 v110, v110
 v_mfma_f32_16x16x32_bf16 v[4:7], v[44:47], v[248:251], v[4:7]
 v_exp_f32 v111, v111
 v_mfma_f32_16x16x32_bf16 a[192:195], v[180:183], v[116:119], a[192:195]
 s_waitcnt lgkmcnt(0)
 ds_read_b64_tr_b16 v[148:149], v14 offset:0
 v_cvt_pk_bf16_f32 v126, v76, v77
 v_mfma_f32_16x16x32_bf16 a[196:199], v[212:215], v[140:143], a[196:199]
 v_cvt_pk_bf16_f32 v127, v78, v79
 v_mfma_f32_16x16x32_bf16 a[200:203], v[212:215], v[172:175], a[200:203]
 ds_read_b64_tr_b16 v[150:151], v14 offset:4096
 v_add_u32 v14, 0xfffee000, v14
 v_cvt_pk_bf16_f32 v158, v108, v109
 v_mfma_f32_16x16x32_bf16 a[204:207], v[212:215], v[204:207], a[204:207]
 v_cvt_pk_bf16_f32 v159, v110, v111
 v_mfma_f32_16x16x32_bf16 a[208:211], v[212:215], v[236:239], a[208:211]
 ds_read_b64_tr_b16 v[180:181], v15 offset:0
 v_mfma_f32_16x16x32_bf16 a[212:215], v[212:215], v[52:55], a[212:215]
 v_mfma_f32_16x16x32_bf16 a[216:219], v[212:215], v[84:87], a[216:219]
 ds_read_b64_tr_b16 v[182:183], v15 offset:4096
 v_add_u32 v15, 0xfffee000, v15
 v_mfma_f32_16x16x32_bf16 a[220:223], v[212:215], v[116:119], a[220:223]
 v_mfma_f32_16x16x32_bf16 a[248:251], v[28:31], v[116:119], a[248:251]
 s_waitcnt lgkmcnt(6)
 v_mfma_f32_16x16x32_bf16 v[76:79], v[36:39], v[32:35], 0
 s_lshr_b32 s54, s52, 1
 v_exp_f32 v252, v252
 v_mfma_f32_16x16x32_bf16 v[76:79], v[68:71], v[40:43], v[76:79]
 s_mul_i32 s54, s54, 69632
 v_exp_f32 v253, v253
 v_mfma_f32_16x16x32_bf16 v[76:79], v[100:103], v[48:51], v[76:79]
 s_and_b32 s55, s52, 1
 v_exp_f32 v254, v254
 v_mfma_f32_16x16x32_bf16 v[76:79], v[132:135], v[56:59], v[76:79]
 s_lshl_b32 s55, s55, 2
 v_exp_f32 v255, v255
 v_mfma_f32_16x16x32_bf16 v[108:111], v[36:39], v[64:67], 0
 s_add_u32 s54, s54, s55
 v_exp_f32 v4, v4
 v_mfma_f32_16x16x32_bf16 v[108:111], v[68:71], v[72:75], v[108:111]
 s_mul_i32 s55, s36, 4352
 v_exp_f32 v5, v5
 v_mfma_f32_16x16x32_bf16 v[108:111], v[100:103], v[80:83], v[108:111]
 s_add_u32 s75, s54, s55
 v_exp_f32 v6, v6
 v_mfma_f32_16x16x32_bf16 v[108:111], v[132:135], v[88:91], v[108:111]
 s_waitcnt lgkmcnt(2)
 s_add_u32 s54, s66, 0
 v_exp_f32 v7, v7
 v_mfma_f32_16x16x32_bf16 a[0:3], v[148:151], v[244:247], a[0:3]
 ds_read_b64_tr_b16 v[212:213], v16 offset:0
 v_cvt_pk_bf16_f32 v190, v252, v253
 v_mfma_f32_16x16x32_bf16 a[4:7], v[148:151], v[60:63], a[4:7]
 v_cvt_pk_bf16_f32 v191, v254, v255
 v_mfma_f32_16x16x32_bf16 a[8:11], v[148:151], v[92:95], a[8:11]
 ds_read_b64_tr_b16 v[214:215], v16 offset:4096
 v_add_u32 v16, 0xfffee000, v16
 v_cvt_pk_bf16_f32 v222, v4, v5
 v_mfma_f32_16x16x32_bf16 a[12:15], v[148:151], v[124:127], a[12:15]
 v_cvt_pk_bf16_f32 v223, v6, v7
 v_mfma_f32_16x16x32_bf16 a[16:19], v[148:151], v[156:159], a[16:19]
 ds_read_b128 v[164:167], v10 offset:4096
 v_mfma_f32_16x16x32_bf16 a[20:23], v[148:151], v[188:191], a[20:23]
 v_mfma_f32_16x16x32_bf16 a[24:27], v[148:151], v[220:223], a[24:27]
 s_waitcnt lgkmcnt(3)
 ds_read_b128 v[196:199], v11 offset:4096
 v_mfma_f32_16x16x32_bf16 a[28:31], v[180:183], v[244:247], a[28:31]
 buffer_load_dwordx4 v22, s[12:15], s40 offen nt lds
 v_mfma_f32_16x16x32_bf16 a[224:227], v[28:31], v[244:247], a[224:227]
 buffer_load_dwordx4 v23, s[12:15], s40 offen offset:2048 nt lds
 v_mfma_f32_16x16x32_bf16 v[252:255], v[36:39], v[96:99], 0
 s_and_b32 s54, s54, 3
 v_exp_f32 v76, v76
 v_mfma_f32_16x16x32_bf16 v[252:255], v[68:71], v[104:107], v[252:255]
 s_mul_i32 s58, s54, 57344
 v_exp_f32 v77, v77
 v_mfma_f32_16x16x32_bf16 v[252:255], v[100:103], v[112:115], v[252:255]
 s_mul_i32 s62, s54, 40960
 v_exp_f32 v78, v78
 v_mfma_f32_16x16x32_bf16 v[252:255], v[132:135], v[120:123], v[252:255]
 s_mul_i32 s54, s54, 17408
 v_exp_f32 v79, v79
 v_mfma_f32_16x16x32_bf16 v[4:7], v[36:39], v[128:131], 0
 s_add_u32 s92, s54, s75
 v_exp_f32 v108, v108
 v_mfma_f32_16x16x32_bf16 v[4:7], v[68:71], v[136:139], v[4:7]
 s_add_u32 s54, s66, 1
 v_exp_f32 v109, v109
 v_mfma_f32_16x16x32_bf16 v[4:7], v[100:103], v[144:147], v[4:7]
 s_and_b32 s54, s54, 3
 v_exp_f32 v110, v110
 v_mfma_f32_16x16x32_bf16 v[4:7], v[132:135], v[152:155], v[4:7]
 s_mul_i32 s59, s54, 57344
 v_exp_f32 v111, v111
 v_mfma_f32_16x16x32_bf16 a[32:35], v[180:183], v[60:63], a[32:35]
 s_add_u32 m0, s45, 45056
 ds_read_b64_tr_b16 v[148:149], v17 offset:0
 v_cvt_pk_bf16_f32 v140, v76, v77
 v_mfma_f32_16x16x32_bf16 a[36:39], v[180:183], v[92:95], a[36:39]
 s_xor_b32 s40, s101, 29696
 v_cvt_pk_bf16_f32 v141, v78, v79
 v_mfma_f32_16x16x32_bf16 a[40:43], v[180:183], v[124:127], a[40:43]
 ds_read_b64_tr_b16 v[150:151], v17 offset:4096
 v_add_u32 v17, 0xfffee000, v17
 v_cvt_pk_bf16_f32 v172, v108, v109
 v_mfma_f32_16x16x32_bf16 a[44:47], v[180:183], v[156:159], a[44:47]
 v_cvt_pk_bf16_f32 v173, v110, v111
 v_mfma_f32_16x16x32_bf16 a[48:51], v[180:183], v[188:191], a[48:51]
 ds_read_b128 v[228:231], v12 offset:4096
 v_mfma_f32_16x16x32_bf16 a[52:55], v[180:183], v[220:223], a[52:55]
 s_waitcnt lgkmcnt(5)
 v_mfma_f32_16x16x32_bf16 a[56:59], v[212:215], v[244:247], a[56:59]
 ds_read_b128 v[44:47], v13 offset:4096
 v_mfma_f32_16x16x32_bf16 a[60:63], v[212:215], v[60:63], a[60:63]
 v_mfma_f32_16x16x32_bf16 a[228:231], v[28:31], v[60:63], a[228:231]
 v_mfma_f32_16x16x32_bf16 v[76:79], v[36:39], v[160:163], 0
 s_mul_i32 s63, s54, 40960
 v_exp_f32 v252, v252
 v_mfma_f32_16x16x32_bf16 v[76:79], v[68:71], v[168:171], v[76:79]
 s_mul_i32 s54, s54, 17408
 v_exp_f32 v253, v253
 v_mfma_f32_16x16x32_bf16 v[76:79], v[100:103], v[176:179], v[76:79]
 s_add_u32 s93, s54, s75
 v_exp_f32 v254, v254
 v_mfma_f32_16x16x32_bf16 v[76:79], v[132:135], v[184:187], v[76:79]
 s_add_u32 s54, s66, 2
 v_exp_f32 v255, v255
 v_mfma_f32_16x16x32_bf16 v[108:111], v[36:39], v[192:195], 0
 s_and_b32 s54, s54, 3
 v_exp_f32 v4, v4
 v_mfma_f32_16x16x32_bf16 v[108:111], v[68:71], v[200:203], v[108:111]
 s_mul_i32 s60, s54, 57344
 v_exp_f32 v5, v5
 v_mfma_f32_16x16x32_bf16 v[108:111], v[100:103], v[208:211], v[108:111]
 s_mul_i32 s64, s54, 40960
 v_exp_f32 v6, v6
 v_mfma_f32_16x16x32_bf16 v[108:111], v[132:135], v[216:219], v[108:111]
 s_mul_i32 s54, s54, 17408
 v_exp_f32 v7, v7
 v_mfma_f32_16x16x32_bf16 a[64:67], v[212:215], v[92:95], a[64:67]
 ds_read_b64_tr_b16 v[180:181], v18 offset:0
 v_cvt_pk_bf16_f32 v204, v252, v253
 v_mfma_f32_16x16x32_bf16 a[68:71], v[212:215], v[124:127], a[68:71]
 v_cvt_pk_bf16_f32 v205, v254, v255
 v_mfma_f32_16x16x32_bf16 a[72:75], v[212:215], v[156:159], a[72:75]
 ds_read_b64_tr_b16 v[182:183], v18 offset:4096
 v_add_u32 v18, 0xfffee000, v18
 v_cvt_pk_bf16_f32 v236, v4, v5
 v_mfma_f32_16x16x32_bf16 a[76:79], v[212:215], v[188:191], a[76:79]
 v_cvt_pk_bf16_f32 v237, v6, v7
 v_mfma_f32_16x16x32_bf16 a[80:83], v[212:215], v[220:223], a[80:83]
 s_waitcnt lgkmcnt(4)
 v_mfma_f32_16x16x32_bf16 a[84:87], v[148:151], v[244:247], a[84:87]
 v_mfma_f32_16x16x32_bf16 a[88:91], v[148:151], v[60:63], a[88:91]
 v_mfma_f32_16x16x32_bf16 a[92:95], v[148:151], v[92:95], a[92:95]
 buffer_load_dwordx4 v22, s[12:15], s40 offen nt lds
 v_mfma_f32_16x16x32_bf16 a[232:235], v[28:31], v[92:95], a[232:235]
 buffer_load_dwordx4 v23, s[12:15], s40 offen offset:2048 nt lds
 s_waitcnt vmcnt(13) lgkmcnt(2)
 s_barrier
 v_mfma_f32_16x16x32_bf16 v[252:255], v[36:39], v[224:227], 0
 s_add_u32 s94, s54, s75
 v_exp_f32 v76, v76
 v_mfma_f32_16x16x32_bf16 v[252:255], v[68:71], v[232:235], v[252:255]
 s_add_u32 s54, s66, 3
 v_exp_f32 v77, v77
 v_mfma_f32_16x16x32_bf16 v[252:255], v[100:103], v[240:243], v[252:255]
 s_and_b32 s54, s54, 3
 v_exp_f32 v78, v78
 v_mfma_f32_16x16x32_bf16 v[252:255], v[132:135], v[248:251], v[252:255]
 s_mul_i32 s61, s54, 57344
 v_exp_f32 v79, v79
 v_mfma_f32_16x16x32_bf16 v[4:7], v[164:167], v[32:35], 0
 s_mul_i32 s65, s54, 40960
 v_exp_f32 v108, v108
 v_mfma_f32_16x16x32_bf16 v[4:7], v[196:199], v[40:43], v[4:7]
 s_mul_i32 s54, s54, 17408
 v_exp_f32 v109, v109
 v_mfma_f32_16x16x32_bf16 v[4:7], v[228:231], v[48:51], v[4:7]
 s_add_u32 s67, s54, s75
 v_exp_f32 v110, v110
 v_mfma_f32_16x16x32_bf16 v[4:7], v[44:47], v[56:59], v[4:7]
 s_add_u32 m0, s46, 0
 v_exp_f32 v111, v111
 v_mfma_f32_16x16x32_bf16 a[96:99], v[148:151], v[124:127], a[96:99]
 s_xor_b32 s40, s101, 12288
 ds_read_b64_tr_b16 v[212:213], v19 offset:0
 v_cvt_pk_bf16_f32 v52, v76, v77
 v_mfma_f32_16x16x32_bf16 a[100:103], v[148:151], v[156:159], a[100:103]
 v_cvt_pk_bf16_f32 v53, v78, v79
 v_mfma_f32_16x16x32_bf16 a[104:107], v[148:151], v[188:191], a[104:107]
 ds_read_b64_tr_b16 v[214:215], v19 offset:4096
 v_add_u32 v19, 0xfffee000, v19
 v_cvt_pk_bf16_f32 v84, v108, v109
 v_mfma_f32_16x16x32_bf16 a[108:111], v[148:151], v[220:223], a[108:111]
 s_waitcnt lgkmcnt(2)
 v_cvt_pk_bf16_f32 v85, v110, v111
 v_mfma_f32_16x16x32_bf16 a[112:115], v[180:183], v[244:247], a[112:115]
 ds_read_b128 v[36:39], v10 offset:8192
 v_mfma_f32_16x16x32_bf16 a[116:119], v[180:183], v[60:63], a[116:119]
 v_mfma_f32_16x16x32_bf16 a[120:123], v[180:183], v[92:95], a[120:123]
 ds_read_b128 v[68:71], v11 offset:8192
 v_mfma_f32_16x16x32_bf16 a[124:127], v[180:183], v[124:127], a[124:127]
 v_mfma_f32_16x16x32_bf16 a[236:239], v[28:31], v[124:127], a[236:239]
 v_mfma_f32_16x16x32_bf16 v[76:79], v[164:167], v[64:67], 0
 v_exp_f32 v252, v252
 v_mfma_f32_16x16x32_bf16 v[76:79], v[196:199], v[72:75], v[76:79]
 v_exp_f32 v253, v253
 v_mfma_f32_16x16x32_bf16 v[76:79], v[228:231], v[80:83], v[76:79]
 v_exp_f32 v254, v254
 v_mfma_f32_16x16x32_bf16 v[76:79], v[44:47], v[88:91], v[76:79]
 v_exp_f32 v255, v255
 v_mfma_f32_16x16x32_bf16 v[108:111], v[164:167], v[96:99], 0
 v_exp_f32 v4, v4
 v_mfma_f32_16x16x32_bf16 v[108:111], v[196:199], v[104:107], v[108:111]
 v_exp_f32 v5, v5
 v_mfma_f32_16x16x32_bf16 v[108:111], v[228:231], v[112:115], v[108:111]
 s_branch SK5860
PG5860:
 s_branch RET1
SK5860:
 v_exp_f32 v6, v6
 v_mfma_f32_16x16x32_bf16 v[108:111], v[44:47], v[120:123], v[108:111]
 v_exp_f32 v7, v7
 v_mfma_f32_16x16x32_bf16 a[128:131], v[180:183], v[156:159], a[128:131]
 ds_read_b64_tr_b16 v[148:149], v20 offset:0
 v_cvt_pk_bf16_f32 v116, v252, v253
 v_mfma_f32_16x16x32_bf16 a[132:135], v[180:183], v[188:191], a[132:135]
 v_cvt_pk_bf16_f32 v117, v254, v255
 v_mfma_f32_16x16x32_bf16 a[136:139], v[180:183], v[220:223], a[136:139]
 s_waitcnt lgkmcnt(3)
 ds_read_b64_tr_b16 v[150:151], v20 offset:4096
 v_add_u32 v20, 0xfffee000, v20
 v_cvt_pk_bf16_f32 v142, v4, v5
 v_mfma_f32_16x16x32_bf16 a[140:143], v[212:215], v[244:247], a[140:143]
 v_cvt_pk_bf16_f32 v143, v6, v7
 v_mfma_f32_16x16x32_bf16 a[144:147], v[212:215], v[60:63], a[144:147]
 ds_read_b128 v[100:103], v12 offset:8192
 v_mfma_f32_16x16x32_bf16 a[148:151], v[212:215], v[92:95], a[148:151]
 v_mfma_f32_16x16x32_bf16 a[152:155], v[212:215], v[124:127], a[152:155]
 ds_read_b128 v[132:135], v13 offset:8192
 v_mfma_f32_16x16x32_bf16 a[156:159], v[212:215], v[156:159], a[156:159]
 buffer_load_dwordx4 v24, s[16:19], s40 offen nt lds
 v_mfma_f32_16x16x32_bf16 a[240:243], v[28:31], v[156:159], a[240:243]
 buffer_load_dwordx4 v2, s[16:19], s40 offen offset:2048 nt lds
 v_mfma_f32_16x16x32_bf16 v[252:255], v[164:167], v[128:131], 0
 s_add_u32 m0, s46, 4096
 v_exp_f32 v76, v76
 v_mfma_f32_16x16x32_bf16 v[252:255], v[196:199], v[136:139], v[252:255]
 s_xor_b32 s40, s101, 28672
 v_exp_f32 v77, v77
 v_mfma_f32_16x16x32_bf16 v[252:255], v[228:231], v[144:147], v[252:255]
 v_exp_f32 v78, v78
 v_mfma_f32_16x16x32_bf16 v[252:255], v[44:47], v[152:155], v[252:255]
 v_exp_f32 v79, v79
 v_mfma_f32_16x16x32_bf16 v[4:7], v[164:167], v[160:163], 0
 v_exp_f32 v108, v108
 v_mfma_f32_16x16x32_bf16 v[4:7], v[196:199], v[168:171], v[4:7]
 v_exp_f32 v109, v109
 v_mfma_f32_16x16x32_bf16 v[4:7], v[228:231], v[176:179], v[4:7]
 v_exp_f32 v110, v110
 v_mfma_f32_16x16x32_bf16 v[4:7], v[44:47], v[184:187], v[4:7]
 v_exp_f32 v111, v111
 v_mfma_f32_16x16x32_bf16 a[160:163], v[212:215], v[188:191], a[160:163]
 ds_read_b64_tr_b16 v[180:181], v21 offset:0
 v_cvt_pk_bf16_f32 v174, v76, v77
 v_mfma_f32_16x16x32_bf16 a[164:167], v[212:215], v[220:223], a[164:167]
 s_waitcnt lgkmcnt(3)
 v_cvt_pk_bf16_f32 v175, v78, v79
 v_mfma_f32_16x16x32_bf16 a[168:171], v[148:151], v[244:247], a[168:171]
 ds_read_b64_tr_b16 v[182:183], v21 offset:4096
 v_add_u32 v21, 0xfffee000, v21
 v_cvt_pk_bf16_f32 v206, v108, v109
 v_mfma_f32_16x16x32_bf16 a[172:175], v[148:151], v[60:63], a[172:175]
 v_cvt_pk_bf16_f32 v207, v110, v111
 v_mfma_f32_16x16x32_bf16 a[176:179], v[148:151], v[92:95], a[176:179]
 v_mfma_f32_16x16x32_bf16 a[180:183], v[148:151], v[124:127], a[180:183]
 v_mfma_f32_16x16x32_bf16 a[184:187], v[148:151], v[156:159], a[184:187]
 v_mfma_f32_16x16x32_bf16 a[188:191], v[148:151], v[188:191], a[188:191]
 v_mfma_f32_16x16x32_bf16 a[244:247], v[28:31], v[188:191], a[244:247]
 v_mfma_f32_16x16x32_bf16 v[76:79], v[164:167], v[192:195], 0
 v_exp_f32 v252, v252
 v_mfma_f32_16x16x32_bf16 v[76:79], v[196:199], v[200:203], v[76:79]
 v_exp_f32 v253, v253
 v_mfma_f32_16x16x32_bf16 v[76:79], v[228:231], v[208:211], v[76:79]
 v_exp_f32 v254, v254
 v_mfma_f32_16x16x32_bf16 v[76:79], v[44:47], v[216:219], v[76:79]
 v_exp_f32 v255, v255
 v_mfma_f32_16x16x32_bf16 v[108:111], v[164:167], v[224:227], 0
 v_exp_f32 v4, v4
 v_mfma_f32_16x16x32_bf16 v[108:111], v[196:199], v[232:235], v[108:111]
 v_exp_f32 v5, v5
 v_mfma_f32_16x16x32_bf16 v[108:111], v[228:231], v[240:243], v[108:111]
 v_exp_f32 v6, v6
 v_mfma_f32_16x16x32_bf16 v[108:111], v[44:47], v[248:251], v[108:111]
 v_exp_f32 v7, v7
 v_mfma_f32_16x16x32_bf16 a[192:195], v[148:151], v[220:223], a[192:195]
 s_waitcnt lgkmcnt(0)
 ds_read_b64_tr_b16 v[212:213], v14 offset:32768
 v_cvt_pk_bf16_f32 v238, v252, v253
 v_mfma_f32_16x16x32_bf16 a[196:199], v[180:183], v[244:247], a[196:199]
 v_cvt_pk_bf16_f32 v239, v254, v255
 v_mfma_f32_16x16x32_bf16 a[200:203], v[180:183], v[60:63], a[200:203]
 ds_read_b64_tr_b16 v[214:215], v14 offset:36864
 v_cvt_pk_bf16_f32 v54, v4, v5
 v_mfma_f32_16x16x32_bf16 a[204:207], v[180:183], v[92:95], a[204:207]
 v_cvt_pk_bf16_f32 v55, v6, v7
 v_mfma_f32_16x16x32_bf16 a[208:211], v[180:183], v[124:127], a[208:211]
 ds_read_b64_tr_b16 v[148:149], v15 offset:32768
 v_mfma_f32_16x16x32_bf16 a[212:215], v[180:183], v[156:159], a[212:215]
 v_mfma_f32_16x16x32_bf16 a[216:219], v[180:183], v[188:191], a[216:219]
 ds_read_b64_tr_b16 v[150:151], v15 offset:36864
 v_mfma_f32_16x16x32_bf16 a[220:223], v[180:183], v[220:223], a[220:223]
 buffer_load_dwordx4 v24, s[16:19], s40 offen nt lds
 v_mfma_f32_16x16x32_bf16 a[248:251], v[28:31], v[220:223], a[248:251]
 s_waitcnt lgkmcnt(6)
 buffer_load_dwordx4 v2, s[16:19], s40 offen offset:2048 nt lds
 v_mfma_f32_16x16x32_bf16 v[252:255], v[36:39], v[32:35], 0
 s_add_u32 m0, s45, 131072
 v_exp_f32 v76, v76
 v_mfma_f32_16x16x32_bf16 v[252:255], v[68:71], v[40:43], v[252:255]
 s_xor_b32 s40, s101, 14336
 v_exp_f32 v77, v77
 v_mfma_f32_16x16x32_bf16 v[252:255], v[100:103], v[48:51], v[252:255]
 v_exp_f32 v78, v78
 v_mfma_f32_16x16x32_bf16 v[252:255], v[132:135], v[56:59], v[252:255]
 v_exp_f32 v79, v79
 v_mfma_f32_16x16x32_bf16 v[4:7], v[36:39], v[64:67], 0
 v_exp_f32 v108, v108
 v_mfma_f32_16x16x32_bf16 v[4:7], v[68:71], v[72:75], v[4:7]
 v_exp_f32 v109, v109
 v_mfma_f32_16x16x32_bf16 v[4:7], v[100:103], v[80:83], v[4:7]
 v_exp_f32 v110, v110
 v_mfma_f32_16x16x32_bf16 v[4:7], v[132:135], v[88:91], v[4:7]
 s_waitcnt lgkmcnt(2)
 v_exp_f32 v111, v111
 v_mfma_f32_16x16x32_bf16 a[0:3], v[212:215], v[140:143], a[0:3]
 ds_read_b64_tr_b16 v[180:181], v16 offset:32768
 v_cvt_pk_bf16_f32 v86, v76, v77
 v_mfma_f32_16x16x32_bf16 a[4:7], v[212:215], v[172:175], a[4:7]
 v_cvt_pk_bf16_f32 v87, v78, v79
 v_mfma_f32_16x16x32_bf16 a[8:11], v[212:215], v[204:207], a[8:11]
 ds_read_b64_tr_b16 v[182:183], v16 offset:36864
 v_cvt_pk_bf16_f32 v118, v108, v109
 v_mfma_f32_16x16x32_bf16 a[12:15], v[212:215], v[236:239], a[12:15]
 v_cvt_pk_bf16_f32 v119, v110, v111
 v_mfma_f32_16x16x32_bf16 a[16:19], v[212:215], v[52:55], a[16:19]
 ds_read_b128 v[164:167], v10 offset:12288
 v_mfma_f32_16x16x32_bf16 a[20:23], v[212:215], v[84:87], a[20:23]
 v_mfma_f32_16x16x32_bf16 a[24:27], v[212:215], v[116:119], a[24:27]
 s_waitcnt lgkmcnt(3)
 ds_read_b128 v[196:199], v11 offset:12288
 v_mfma_f32_16x16x32_bf16 a[28:31], v[148:151], v[140:143], a[28:31]
 v_mfma_f32_16x16x32_bf16 a[224:227], v[28:31], v[140:143], a[224:227]
 v_mfma_f32_16x16x32_bf16 v[76:79], v[36:39], v[96:99], 0
 v_exp_f32 v252, v252
 v_mfma_f32_16x16x32_bf16 v[76:79], v[68:71], v[104:107], v[76:79]
 v_exp_f32 v253, v253
 v_mfma_f32_16x16x32_bf16 v[76:79], v[100:103], v[112:115], v[76:79]
 v_exp_f32 v254, v254
 v_mfma_f32_16x16x32_bf16 v[76:79], v[132:135], v[120:123], v[76:79]
 v_exp_f32 v255, v255
 v_mfma_f32_16x16x32_bf16 v[108:111], v[36:39], v[128:131], 0
 v_exp_f32 v4, v4
 v_mfma_f32_16x16x32_bf16 v[108:111], v[68:71], v[136:139], v[108:111]
 v_exp_f32 v5, v5
 v_mfma_f32_16x16x32_bf16 v[108:111], v[100:103], v[144:147], v[108:111]
 v_exp_f32 v6, v6
 v_mfma_f32_16x16x32_bf16 v[108:111], v[132:135], v[152:155], v[108:111]
 v_exp_f32 v7, v7
 v_mfma_f32_16x16x32_bf16 a[32:35], v[148:151], v[172:175], a[32:35]
 ds_read_b64_tr_b16 v[212:213], v17 offset:32768
 v_cvt_pk_bf16_f32 v244, v252, v253
 v_mfma_f32_16x16x32_bf16 a[36:39], v[148:151], v[204:207], a[36:39]
 v_cvt_pk_bf16_f32 v245, v254, v255
 v_mfma_f32_16x16x32_bf16 a[40:43], v[148:151], v[236:239], a[40:43]
 ds_read_b64_tr_b16 v[214:215], v17 offset:36864
 v_cvt_pk_bf16_f32 v60, v4, v5
 v_mfma_f32_16x16x32_bf16 a[44:47], v[148:151], v[52:55], a[44:47]
 v_cvt_pk_bf16_f32 v61, v6, v7
 v_mfma_f32_16x16x32_bf16 a[48:51], v[148:151], v[84:87], a[48:51]
 ds_read_b128 v[228:231], v12 offset:12288
 v_mfma_f32_16x16x32_bf16 a[52:55], v[148:151], v[116:119], a[52:55]
 s_waitcnt lgkmcnt(5)
 v_mfma_f32_16x16x32_bf16 a[56:59], v[180:183], v[140:143], a[56:59]
 ds_read_b128 v[44:47], v13 offset:12288
 v_mfma_f32_16x16x32_bf16 a[60:63], v[180:183], v[172:175], a[60:63]
 buffer_load_dwordx4 v22, s[12:15], s40 offen nt lds
 v_mfma_f32_16x16x32_bf16 a[228:231], v[28:31], v[172:175], a[228:231]
 buffer_load_dwordx4 v23, s[12:15], s40 offen offset:2048 nt lds
 v_mfma_f32_16x16x32_bf16 v[252:255], v[36:39], v[160:163], 0
 s_add_u32 m0, s45, 135168
 v_exp_f32 v76, v76
 v_mfma_f32_16x16x32_bf16 v[252:255], v[68:71], v[168:171], v[252:255]
 s_xor_b32 s40, s101, 30720
 v_exp_f32 v77, v77
 v_mfma_f32_16x16x32_bf16 v[252:255], v[100:103], v[176:179], v[252:255]
 v_exp_f32 v78, v78
 v_mfma_f32_16x16x32_bf16 v[252:255], v[132:135], v[184:187], v[252:255]
 v_exp_f32 v79, v79
 v_mfma_f32_16x16x32_bf16 v[4:7], v[36:39], v[192:195], 0
 v_exp_f32 v108, v108
 v_mfma_f32_16x16x32_bf16 v[4:7], v[68:71], v[200:203], v[4:7]
 v_exp_f32 v109, v109
 v_mfma_f32_16x16x32_bf16 v[4:7], v[100:103], v[208:211], v[4:7]
 v_exp_f32 v110, v110
 v_mfma_f32_16x16x32_bf16 v[4:7], v[132:135], v[216:219], v[4:7]
 v_exp_f32 v111, v111
 v_mfma_f32_16x16x32_bf16 a[64:67], v[180:183], v[204:207], a[64:67]
 ds_read_b64_tr_b16 v[148:149], v18 offset:32768
 v_cvt_pk_bf16_f32 v92, v76, v77
 v_mfma_f32_16x16x32_bf16 a[68:71], v[180:183], v[236:239], a[68:71]
 v_cvt_pk_bf16_f32 v93, v78, v79
 v_mfma_f32_16x16x32_bf16 a[72:75], v[180:183], v[52:55], a[72:75]
 ds_read_b64_tr_b16 v[150:151], v18 offset:36864
 v_cvt_pk_bf16_f32 v124, v108, v109
 v_mfma_f32_16x16x32_bf16 a[76:79], v[180:183], v[84:87], a[76:79]
 v_cvt_pk_bf16_f32 v125, v110, v111
 v_mfma_f32_16x16x32_bf16 a[80:83], v[180:183], v[116:119], a[80:83]
 s_waitcnt lgkmcnt(4)
 v_mfma_f32_16x16x32_bf16 a[84:87], v[212:215], v[140:143], a[84:87]
 v_mfma_f32_16x16x32_bf16 a[88:91], v[212:215], v[172:175], a[88:91]
 v_mfma_f32_16x16x32_bf16 a[92:95], v[212:215], v[204:207], a[92:95]
 v_mfma_f32_16x16x32_bf16 a[232:235], v[28:31], v[204:207], a[232:235]
 s_waitcnt vmcnt(11) lgkmcnt(2)
 s_barrier
 v_mfma_f32_16x16x32_bf16 v[76:79], v[36:39], v[224:227], 0
 v_exp_f32 v252, v252
 v_mfma_f32_16x16x32_bf16 v[76:79], v[68:71], v[232:235], v[76:79]
 v_exp_f32 v253, v253
 v_mfma_f32_16x16x32_bf16 v[76:79], v[100:103], v[240:243], v[76:79]
 v_exp_f32 v254, v254
 v_mfma_f32_16x16x32_bf16 v[76:79], v[132:135], v[248:251], v[76:79]
 v_exp_f32 v255, v255
 v_mfma_f32_16x16x32_bf16 v[108:111], v[164:167], v[32:35], 0
 v_exp_f32 v4, v4
 v_mfma_f32_16x16x32_bf16 v[108:111], v[196:199], v[40:43], v[108:111]
 v_exp_f32 v5, v5
 v_mfma_f32_16x16x32_bf16 v[108:111], v[228:231], v[48:51], v[108:111]
 v_exp_f32 v6, v6
 v_mfma_f32_16x16x32_bf16 v[108:111], v[44:47], v[56:59], v[108:111]
 v_exp_f32 v7, v7
 v_mfma_f32_16x16x32_bf16 a[96:99], v[212:215], v[236:239], a[96:99]
 ds_read_b64_tr_b16 v[180:181], v19 offset:32768
 v_cvt_pk_bf16_f32 v156, v252, v253
 v_mfma_f32_16x16x32_bf16 a[100:103], v[212:215], v[52:55], a[100:103]
 v_cvt_pk_bf16_f32 v157, v254, v255
 v_mfma_f32_16x16x32_bf16 a[104:107], v[212:215], v[84:87], a[104:107]
 ds_read_b64_tr_b16 v[182:183], v19 offset:36864
 v_cvt_pk_bf16_f32 v188, v4, v5
 v_mfma_f32_16x16x32_bf16 a[108:111], v[212:215], v[116:119], a[108:111]
 s_waitcnt lgkmcnt(2)
 v_cvt_pk_bf16_f32 v189, v6, v7
 v_mfma_f32_16x16x32_bf16 a[112:115], v[148:151], v[140:143], a[112:115]
 ds_read_b128 v[36:39], v10 offset:32768
 v_mfma_f32_16x16x32_bf16 a[116:119], v[148:151], v[172:175], a[116:119]
 v_mfma_f32_16x16x32_bf16 a[120:123], v[148:151], v[204:207], a[120:123]
 ds_read_b128 v[68:71], v11 offset:32768
 v_mfma_f32_16x16x32_bf16 a[124:127], v[148:151], v[236:239], a[124:127]
 buffer_load_dwordx4 v22, s[12:15], s40 offen nt lds
 v_mfma_f32_16x16x32_bf16 a[236:239], v[28:31], v[236:239], a[236:239]
 buffer_load_dwordx4 v23, s[12:15], s40 offen offset:2048 nt lds
 v_mfma_f32_16x16x32_bf16 v[252:255], v[164:167], v[64:67], 0
 s_add_u32 m0, s46, 8192
 v_exp_f32 v76, v76
 v_mfma_f32_16x16x32_bf16 v[252:255], v[196:199], v[72:75], v[252:255]
 s_xor_b32 s40, s101, 13312
 v_exp_f32 v77, v77
 v_mfma_f32_16x16x32_bf16 v[252:255], v[228:231], v[80:83], v[252:255]
 v_exp_f32 v78, v78
 v_mfma_f32_16x16x32_bf16 v[252:255], v[44:47], v[88:91], v[252:255]
 v_exp_f32 v79, v79
 v_mfma_f32_16x16x32_bf16 v[4:7], v[164:167], v[96:99], 0
 v_exp_f32 v108, v108
 v_mfma_f32_16x16x32_bf16 v[4:7], v[196:199], v[104:107], v[4:7]
 v_exp_f32 v109, v109
 v_mfma_f32_16x16x32_bf16 v[4:7], v[228:231], v[112:115], v[4:7]
 v_exp_f32 v110, v110
 v_mfma_f32_16x16x32_bf16 v[4:7], v[44:47], v[120:123], v[4:7]
 v_exp_f32 v111, v111
 v_mfma_f32_16x16x32_bf16 a[128:131], v[148:151], v[52:55], a[128:131]
 ds_read_b64_tr_b16 v[212:213], v20 offset:32768
 v_cvt_pk_bf16_f32 v220, v76, v77
 v_mfma_f32_16x16x32_bf16 a[132:135], v[148:151], v[84:87], a[132:135]
 v_cvt_pk_bf16_f32 v221, v78, v79
 v_mfma_f32_16x16x32_bf16 a[136:139], v[148:151], v[116:119], a[136:139]
 s_waitcnt lgkmcnt(3)
 ds_read_b64_tr_b16 v[214:215], v20 offset:36864
 v_cvt_pk_bf16_f32 v246, v108, v109
 v_mfma_f32_16x16x32_bf16 a[140:143], v[180:183], v[140:143], a[140:143]
 v_cvt_pk_bf16_f32 v247, v110, v111
 v_mfma_f32_16x16x32_bf16 a[144:147], v[180:183], v[172:175], a[144:147]
 ds_read_b128 v[100:103], v12 offset:32768
 v_mfma_f32_16x16x32_bf16 a[148:151], v[180:183], v[204:207], a[148:151]
 v_mfma_f32_16x16x32_bf16 a[152:155], v[180:183], v[236:239], a[152:155]
 ds_read_b128 v[132:135], v13 offset:32768
 v_mfma_f32_16x16x32_bf16 a[156:159], v[180:183], v[52:55], a[156:159]
 v_mfma_f32_16x16x32_bf16 a[240:243], v[28:31], v[52:55], a[240:243]
 v_mfma_f32_16x16x32_bf16 v[76:79], v[164:167], v[128:131], 0
 v_exp_f32 v252, v252
 v_mfma_f32_16x16x32_bf16 v[76:79], v[196:199], v[136:139], v[76:79]
 v_exp_f32 v253, v253
 v_mfma_f32_16x16x32_bf16 v[76:79], v[228:231], v[144:147], v[76:79]
 v_exp_f32 v254, v254
 v_mfma_f32_16x16x32_bf16 v[76:79], v[44:47], v[152:155], v[76:79]
 v_exp_f32 v255, v255
 v_mfma_f32_16x16x32_bf16 v[108:111], v[164:167], v[160:163], 0
 v_exp_f32 v4, v4
 v_mfma_f32_16x16x32_bf16 v[108:111], v[196:199], v[168:171], v[108:111]
 v_exp_f32 v5, v5
 v_mfma_f32_16x16x32_bf16 v[108:111], v[228:231], v[176:179], v[108:111]
 v_exp_f32 v6, v6
 v_mfma_f32_16x16x32_bf16 v[108:111], v[44:47], v[184:187], v[108:111]
 v_exp_f32 v7, v7
 v_mfma_f32_16x16x32_bf16 a[160:163], v[180:183], v[84:87], a[160:163]
 ds_read_b64_tr_b16 v[148:149], v21 offset:32768
 v_cvt_pk_bf16_f32 v62, v252, v253
 v_mfma_f32_16x16x32_bf16 a[164:167], v[180:183], v[116:119], a[164:167]
 s_waitcnt lgkmcnt(3)
 v_cvt_pk_bf16_f32 v63, v254, v255
 v_mfma_f32_16x16x32_bf16 a[168:171], v[212:215], v[140:143], a[168:171]
 ds_read_b64_tr_b16 v[150:151], v21 offset:36864
 v_cvt_pk_bf16_f32 v94, v4, v5
 v_mfma_f32_16x16x32_bf16 a[172:175], v[212:215], v[172:175], a[172:175]
 v_cvt_pk_bf16_f32 v95, v6, v7
 v_mfma_f32_16x16x32_bf16 a[176:179], v[212:215], v[204:207], a[176:179]
 v_mfma_f32_16x16x32_bf16 a[180:183], v[212:215], v[236:239], a[180:183]
 v_bfe_u32 v3, v0, 2, 7
 v_mfma_f32_16x16x32_bf16 a[184:187], v[212:215], v[52:55], a[184:187]
 v_mfma_f32_16x16x32_bf16 a[188:191], v[212:215], v[84:87], a[188:191]
 v_mfma_f32_16x16x32_bf16 a[244:247], v[28:31], v[84:87], a[244:247]
 v_mfma_f32_16x16x32_bf16 v[252:255], v[164:167], v[192:195], 0
 v_exp_f32 v76, v76
 v_mfma_f32_16x16x32_bf16 v[252:255], v[196:199], v[200:203], v[252:255]
 v_exp_f32 v77, v77
 v_mfma_f32_16x16x32_bf16 v[252:255], v[228:231], v[208:211], v[252:255]
 v_exp_f32 v78, v78
 v_mfma_f32_16x16x32_bf16 v[252:255], v[44:47], v[216:219], v[252:255]
 v_exp_f32 v79, v79
 v_mfma_f32_16x16x32_bf16 v[4:7], v[164:167], v[224:227], 0
 v_exp_f32 v108, v108
 v_mfma_f32_16x16x32_bf16 v[4:7], v[196:199], v[232:235], v[4:7]
 v_exp_f32 v109, v109
 v_mfma_f32_16x16x32_bf16 v[4:7], v[228:231], v[240:243], v[4:7]
 v_exp_f32 v110, v110
 v_mfma_f32_16x16x32_bf16 v[4:7], v[44:47], v[248:251], v[4:7]
 v_exp_f32 v111, v111
 v_mfma_f32_16x16x32_bf16 a[192:195], v[212:215], v[116:119], a[192:195]
 s_waitcnt lgkmcnt(0)
 ds_read_b64_tr_b16 v[180:181], v14 offset:40960
 v_cvt_pk_bf16_f32 v126, v76, v77
 v_mfma_f32_16x16x32_bf16 a[196:199], v[148:151], v[140:143], a[196:199]
 v_cvt_pk_bf16_f32 v127, v78, v79
 v_mfma_f32_16x16x32_bf16 a[200:203], v[148:151], v[172:175], a[200:203]
 ds_read_b64_tr_b16 v[182:183], v14 offset:45056
 v_cvt_pk_bf16_f32 v158, v108, v109
 v_mfma_f32_16x16x32_bf16 a[204:207], v[148:151], v[204:207], a[204:207]
 v_cvt_pk_bf16_f32 v159, v110, v111
 v_mfma_f32_16x16x32_bf16 a[208:211], v[148:151], v[236:239], a[208:211]
 ds_read_b64_tr_b16 v[212:213], v15 offset:40960
 v_mfma_f32_16x16x32_bf16 a[212:215], v[148:151], v[52:55], a[212:215]
 v_mfma_f32_16x16x32_bf16 a[216:219], v[148:151], v[84:87], a[216:219]
 ds_read_b64_tr_b16 v[214:215], v15 offset:45056
 v_mfma_f32_16x16x32_bf16 a[220:223], v[148:151], v[116:119], a[220:223]
 buffer_load_dwordx4 v24, s[16:19], s40 offen nt lds
 v_mfma_f32_16x16x32_bf16 a[248:251], v[28:31], v[116:119], a[248:251]
 s_waitcnt lgkmcnt(6)
 buffer_load_dwordx4 v2, s[16:19], s40 offen offset:2048 nt lds
 v_mfma_f32_16x16x32_bf16 v[76:79], v[36:39], v[32:35], 0
 s_nop 0
 v_exp_f32 v252, v252
 v_mfma_f32_16x16x32_bf16 v[76:79], v[68:71], v[40:43], v[76:79]
 s_mul_i32 s54, s3, 5242880
 v_exp_f32 v253, v253
 v_mfma_f32_16x16x32_bf16 v[76:79], v[100:103], v[48:51], v[76:79]
 s_mul_i32 s55, s53, 655360
 v_exp_f32 v254, v254
 v_mfma_f32_16x16x32_bf16 v[76:79], v[132:135], v[56:59], v[76:79]
 s_add_u32 s54, s54, s55
 v_exp_f32 v255, v255
 v_mfma_f32_16x16x32_bf16 v[108:111], v[36:39], v[64:67], 0
 s_mul_i32 s55, s36, 10240
 v_exp_f32 v4, v4
 v_mfma_f32_16x16x32_bf16 v[108:111], v[68:71], v[72:75], v[108:111]
 s_add_u32 s54, s54, s55
 v_exp_f32 v5, v5
 v_mfma_f32_16x16x32_bf16 v[108:111], v[100:103], v[80:83], v[108:111]
 s_add_u32 s54, s54, 33554432
 v_exp_f32 v6, v6
 v_mfma_f32_16x16x32_bf16 v[108:111], v[132:135], v[88:91], v[108:111]
 s_waitcnt lgkmcnt(2)
 v_exp_f32 v7, v7
 v_mfma_f32_16x16x32_bf16 a[0:3], v[180:183], v[244:247], a[0:3]
 s_add_u32 m0, s46, 12288
 ds_read_b64_tr_b16 v[148:149], v16 offset:40960
 v_cvt_pk_bf16_f32 v190, v252, v253
 v_mfma_f32_16x16x32_bf16 a[4:7], v[180:183], v[60:63], a[4:7]
 s_xor_b32 s40, s101, 29696
 v_cvt_pk_bf16_f32 v191, v254, v255
 v_mfma_f32_16x16x32_bf16 a[8:11], v[180:183], v[92:95], a[8:11]
 ds_read_b64_tr_b16 v[150:151], v16 offset:45056
 v_cvt_pk_bf16_f32 v222, v4, v5
 v_mfma_f32_16x16x32_bf16 a[12:15], v[180:183], v[124:127], a[12:15]
 v_cvt_pk_bf16_f32 v223, v6, v7
 v_mfma_f32_16x16x32_bf16 a[16:19], v[180:183], v[156:159], a[16:19]
 ds_read_b128 v[164:167], v10 offset:36864
 v_mfma_f32_16x16x32_bf16 a[20:23], v[180:183], v[188:191], a[20:23]
 v_mfma_f32_16x16x32_bf16 a[24:27], v[180:183], v[220:223], a[24:27]
 s_waitcnt lgkmcnt(3)
 ds_read_b128 v[196:199], v11 offset:36864
 v_mfma_f32_16x16x32_bf16 a[28:31], v[212:215], v[244:247], a[28:31]
 v_mfma_f32_16x16x32_bf16 a[224:227], v[28:31], v[244:247], a[224:227]
 v_mfma_f32_16x16x32_bf16 v[252:255], v[36:39], v[96:99], 0
 v_exp_f32 v76, v76
 v_mfma_f32_16x16x32_bf16 v[252:255], v[68:71], v[104:107], v[252:255]
 v_exp_f32 v77, v77
 v_mfma_f32_16x16x32_bf16 v[252:255], v[100:103], v[112:115], v[252:255]
 v_exp_f32 v78, v78
 v_mfma_f32_16x16x32_bf16 v[252:255], v[132:135], v[120:123], v[252:255]
 v_exp_f32 v79, v79
 v_mfma_f32_16x16x32_bf16 v[4:7], v[36:39], v[128:131], 0
 s_and_b32 s9, s9, 0xffff
 v_exp_f32 v108, v108
 v_mfma_f32_16x16x32_bf16 v[4:7], v[68:71], v[136:139], v[4:7]
 s_mov_b32 s10, 655360
 v_exp_f32 v109, v109
 v_mfma_f32_16x16x32_bf16 v[4:7], v[100:103], v[144:147], v[4:7]
 s_mov_b32 s11, 0x20000
 v_exp_f32 v110, v110
 v_mfma_f32_16x16x32_bf16 v[4:7], v[132:135], v[152:155], v[4:7]
 v_exp_f32 v111, v111
 v_mfma_f32_16x16x32_bf16 a[32:35], v[212:215], v[60:63], a[32:35]
 ds_read_b64_tr_b16 v[180:181], v17 offset:40960
 v_cvt_pk_bf16_f32 v140, v76, v77
 v_mfma_f32_16x16x32_bf16 a[36:39], v[212:215], v[92:95], a[36:39]
 v_cvt_pk_bf16_f32 v141, v78, v79
 v_mfma_f32_16x16x32_bf16 a[40:43], v[212:215], v[124:127], a[40:43]
 ds_read_b64_tr_b16 v[182:183], v17 offset:45056
 v_cvt_pk_bf16_f32 v172, v108, v109
 v_mfma_f32_16x16x32_bf16 a[44:47], v[212:215], v[156:159], a[44:47]
 v_cvt_pk_bf16_f32 v173, v110, v111
 s_add_u32 s8, s72, s54
 s_addc_u32 s9, s73, 0
 v_mfma_f32_16x16x32_bf16 a[48:51], v[212:215], v[188:191], a[48:51]
 ds_read_b128 v[228:231], v12 offset:36864
 v_mfma_f32_16x16x32_bf16 a[52:55], v[212:215], v[220:223], a[52:55]
 s_waitcnt lgkmcnt(5)
 v_mfma_f32_16x16x32_bf16 a[56:59], v[148:151], v[244:247], a[56:59]
 ds_read_b128 v[44:47], v13 offset:36864
 v_mfma_f32_16x16x32_bf16 a[60:63], v[148:151], v[60:63], a[60:63]
 buffer_load_dwordx4 v24, s[16:19], s40 offen nt lds
 v_mfma_f32_16x16x32_bf16 a[228:231], v[28:31], v[60:63], a[228:231]
 buffer_load_dwordx4 v2, s[16:19], s40 offen offset:2048 nt lds
 v_mfma_f32_16x16x32_bf16 v[76:79], v[36:39], v[160:163], 0
 s_add_u32 m0, s45, 0
 v_exp_f32 v252, v252
 v_mfma_f32_16x16x32_bf16 v[76:79], v[68:71], v[168:171], v[76:79]
 s_xor_b32 s40, s101, 15360
 v_exp_f32 v253, v253
 v_mfma_f32_16x16x32_bf16 v[76:79], v[100:103], v[176:179], v[76:79]
 v_exp_f32 v254, v254
 v_mfma_f32_16x16x32_bf16 v[76:79], v[132:135], v[184:187], v[76:79]
 v_exp_f32 v255, v255
 v_mfma_f32_16x16x32_bf16 v[108:111], v[36:39], v[192:195], 0
 v_exp_f32 v4, v4
 v_mfma_f32_16x16x32_bf16 v[108:111], v[68:71], v[200:203], v[108:111]
 v_exp_f32 v5, v5
 v_mfma_f32_16x16x32_bf16 v[108:111], v[100:103], v[208:211], v[108:111]
 v_exp_f32 v6, v6
 v_mfma_f32_16x16x32_bf16 v[108:111], v[132:135], v[216:219], v[108:111]
 v_exp_f32 v7, v7
 v_mfma_f32_16x16x32_bf16 a[64:67], v[148:151], v[92:95], a[64:67]
 ds_read_b64_tr_b16 v[212:213], v18 offset:40960
 v_cvt_pk_bf16_f32 v204, v252, v253
 v_mfma_f32_16x16x32_bf16 a[68:71], v[148:151], v[124:127], a[68:71]
 v_cvt_pk_bf16_f32 v205, v254, v255
 v_mfma_f32_16x16x32_bf16 a[72:75], v[148:151], v[156:159], a[72:75]
 ds_read_b64_tr_b16 v[214:215], v18 offset:45056
 v_cvt_pk_bf16_f32 v236, v4, v5
 v_mfma_f32_16x16x32_bf16 a[76:79], v[148:151], v[188:191], a[76:79]
 v_cvt_pk_bf16_f32 v237, v6, v7
 v_mfma_f32_16x16x32_bf16 a[80:83], v[148:151], v[220:223], a[80:83]
 s_waitcnt lgkmcnt(4)
 v_mfma_f32_16x16x32_bf16 a[84:87], v[180:183], v[244:247], a[84:87]
 v_mfma_f32_16x16x32_bf16 a[88:91], v[180:183], v[60:63], a[88:91]
 v_mfma_f32_16x16x32_bf16 a[92:95], v[180:183], v[92:95], a[92:95]
 v_mfma_f32_16x16x32_bf16 a[232:235], v[28:31], v[92:95], a[232:235]
 s_waitcnt vmcnt(8) lgkmcnt(2)
 s_barrier
 v_mfma_f32_16x16x32_bf16 v[252:255], v[36:39], v[224:227], 0
 v_exp_f32 v76, v76
 v_mfma_f32_16x16x32_bf16 v[252:255], v[68:71], v[232:235], v[252:255]
 v_exp_f32 v77, v77
 v_mfma_f32_16x16x32_bf16 v[252:255], v[100:103], v[240:243], v[252:255]
 v_exp_f32 v78, v78
 v_mfma_f32_16x16x32_bf16 v[252:255], v[132:135], v[248:251], v[252:255]
 v_exp_f32 v79, v79
 v_mfma_f32_16x16x32_bf16 v[4:7], v[164:167], v[32:35], 0
 v_exp_f32 v108, v108
 v_mfma_f32_16x16x32_bf16 v[4:7], v[196:199], v[40:43], v[4:7]
 v_exp_f32 v109, v109
 v_mfma_f32_16x16x32_bf16 v[4:7], v[228:231], v[48:51], v[4:7]
 v_exp_f32 v110, v110
 v_mfma_f32_16x16x32_bf16 v[4:7], v[44:47], v[56:59], v[4:7]
 v_exp_f32 v111, v111
 v_mfma_f32_16x16x32_bf16 a[96:99], v[180:183], v[124:127], a[96:99]
 ds_read_b64_tr_b16 v[148:149], v19 offset:40960
 v_cvt_pk_bf16_f32 v52, v76, v77
 v_mfma_f32_16x16x32_bf16 a[100:103], v[180:183], v[156:159], a[100:103]
 v_cvt_pk_bf16_f32 v53, v78, v79
 v_mfma_f32_16x16x32_bf16 a[104:107], v[180:183], v[188:191], a[104:107]
 ds_read_b64_tr_b16 v[150:151], v19 offset:45056
 v_cvt_pk_bf16_f32 v84, v108, v109
 v_mfma_f32_16x16x32_bf16 a[108:111], v[180:183], v[220:223], a[108:111]
 s_waitcnt lgkmcnt(2)
 v_cvt_pk_bf16_f32 v85, v110, v111
 v_mfma_f32_16x16x32_bf16 a[112:115], v[212:215], v[244:247], a[112:115]
 ds_read_b128 v[36:39], v10 offset:40960
 v_mfma_f32_16x16x32_bf16 a[116:119], v[212:215], v[60:63], a[116:119]
 v_mfma_f32_16x16x32_bf16 a[120:123], v[212:215], v[92:95], a[120:123]
 ds_read_b128 v[68:71], v11 offset:40960
 v_mfma_f32_16x16x32_bf16 a[124:127], v[212:215], v[124:127], a[124:127]
 buffer_load_dwordx4 v22, s[12:15], s40 offen nt lds
 v_mfma_f32_16x16x32_bf16 a[236:239], v[28:31], v[124:127], a[236:239]
 buffer_load_dwordx4 v23, s[12:15], s40 offen offset:2048 nt lds
 v_mfma_f32_16x16x32_bf16 v[76:79], v[164:167], v[64:67], 0
 s_add_u32 m0, s45, 4096
 v_exp_f32 v252, v252
 v_mfma_f32_16x16x32_bf16 v[76:79], v[196:199], v[72:75], v[76:79]
 s_xor_b32 s40, s101, 31744
 v_exp_f32 v253, v253
 v_mfma_f32_16x16x32_bf16 v[76:79], v[228:231], v[80:83], v[76:79]
 v_exp_f32 v254, v254
 v_mfma_f32_16x16x32_bf16 v[76:79], v[44:47], v[88:91], v[76:79]
 v_exp_f32 v255, v255
 v_mfma_f32_16x16x32_bf16 v[108:111], v[164:167], v[96:99], 0
 s_lshl_b32 s54, s38, 12
 v_exp_f32 v4, v4
 v_mfma_f32_16x16x32_bf16 v[108:111], v[196:199], v[104:107], v[108:111]
 s_lshl_b32 s55, s37, 14
 v_exp_f32 v5, v5
 v_mfma_f32_16x16x32_bf16 v[108:111], v[228:231], v[112:115], v[108:111]
 s_add_u32 s57, s54, s55
 v_exp_f32 v6, v6
 v_mfma_f32_16x16x32_bf16 v[108:111], v[44:47], v[120:123], v[108:111]
 s_and_b32 s54, s52, 3
 v_exp_f32 v7, v7
 v_mfma_f32_16x16x32_bf16 a[128:131], v[212:215], v[156:159], a[128:131]
 ds_read_b64_tr_b16 v[180:181], v20 offset:40960
 v_cvt_pk_bf16_f32 v116, v252, v253
 v_mfma_f32_16x16x32_bf16 a[132:135], v[212:215], v[188:191], a[132:135]
 v_cvt_pk_bf16_f32 v117, v254, v255
 v_mfma_f32_16x16x32_bf16 a[136:139], v[212:215], v[220:223], a[136:139]
 s_waitcnt lgkmcnt(3)
 ds_read_b64_tr_b16 v[182:183], v20 offset:45056
 v_cvt_pk_bf16_f32 v142, v4, v5
 v_mfma_f32_16x16x32_bf16 a[140:143], v[148:151], v[244:247], a[140:143]
 v_cvt_pk_bf16_f32 v143, v6, v7
 v_mfma_f32_16x16x32_bf16 a[144:147], v[148:151], v[60:63], a[144:147]
 ds_read_b128 v[100:103], v12 offset:40960
 v_mfma_f32_16x16x32_bf16 a[148:151], v[148:151], v[92:95], a[148:151]
 buffer_load_dword v26, v3, s[84:87], 0 offen sc1
 v_mfma_f32_16x16x32_bf16 a[152:155], v[148:151], v[124:127], a[152:155]
 ds_read_b128 v[132:135], v13 offset:40960
 v_mfma_f32_16x16x32_bf16 a[156:159], v[148:151], v[156:159], a[156:159]
 v_mfma_f32_16x16x32_bf16 a[240:243], v[28:31], v[156:159], a[240:243]
 v_mfma_f32_16x16x32_bf16 v[252:255], v[164:167], v[128:131], 0
 s_mul_i32 s54, s54, 0
 v_exp_f32 v76, v76
 v_mfma_f32_16x16x32_bf16 v[252:255], v[196:199], v[136:139], v[252:255]
 s_lshr_b32 s55, 0x21043210, s54
 v_exp_f32 v77, v77
 v_mfma_f32_16x16x32_bf16 v[252:255], v[228:231], v[144:147], v[252:255]
 s_bfe_u32 s54, s55, 0x30000
 v_exp_f32 v78, v78
 v_mfma_f32_16x16x32_bf16 v[252:255], v[44:47], v[152:155], v[252:255]
 s_lshl_b32 s20, s54, 10
 v_exp_f32 v79, v79
 v_mfma_f32_16x16x32_bf16 v[4:7], v[164:167], v[160:163], 0
 s_bfe_u32 s54, s55, 0x30004
 v_exp_f32 v108, v108
 v_mfma_f32_16x16x32_bf16 v[4:7], v[196:199], v[168:171], v[4:7]
 s_lshl_b32 s21, s54, 10
 v_exp_f32 v109, v109
 v_mfma_f32_16x16x32_bf16 v[4:7], v[228:231], v[176:179], v[4:7]
 s_bfe_u32 s54, s55, 0x30008
 v_exp_f32 v110, v110
 v_mfma_f32_16x16x32_bf16 v[4:7], v[44:47], v[184:187], v[4:7]
 s_lshl_b32 s22, s54, 10
 v_exp_f32 v111, v111
 v_mfma_f32_16x16x32_bf16 a[160:163], v[148:151], v[188:191], a[160:163]
 ds_read_b64_tr_b16 v[212:213], v21 offset:40960
 v_cvt_pk_bf16_f32 v174, v76, v77
 v_mfma_f32_16x16x32_bf16 a[164:167], v[148:151], v[220:223], a[164:167]
 s_waitcnt lgkmcnt(3)
 v_cvt_pk_bf16_f32 v175, v78, v79
 v_mfma_f32_16x16x32_bf16 a[168:171], v[180:183], v[244:247], a[168:171]
 ds_read_b64_tr_b16 v[214:215], v21 offset:45056
 v_cvt_pk_bf16_f32 v206, v108, v109
 v_mfma_f32_16x16x32_bf16 a[172:175], v[180:183], v[60:63], a[172:175]
 v_cvt_pk_bf16_f32 v207, v110, v111
 v_mfma_f32_16x16x32_bf16 a[176:179], v[180:183], v[92:95], a[176:179]
 v_mfma_f32_16x16x32_bf16 a[180:183], v[180:183], v[124:127], a[180:183]
 v_mfma_f32_16x16x32_bf16 a[184:187], v[180:183], v[156:159], a[184:187]
 v_mfma_f32_16x16x32_bf16 a[188:191], v[180:183], v[188:191], a[188:191]
 buffer_load_dwordx4 v22, s[12:15], s40 offen nt lds
 v_mfma_f32_16x16x32_bf16 a[244:247], v[28:31], v[188:191], a[244:247]
 buffer_load_dwordx4 v23, s[12:15], s40 offen offset:2048 nt lds
 v_mfma_f32_16x16x32_bf16 v[76:79], v[164:167], v[192:195], 0
 s_bfe_u32 s54, s55, 0x3000c
 v_exp_f32 v252, v252
 v_mfma_f32_16x16x32_bf16 v[76:79], v[196:199], v[200:203], v[76:79]
 s_branch SK6452
PG6452:
 s_branch RET1
SK6452:
 s_lshl_b32 s23, s54, 10
 v_exp_f32 v253, v253
 v_mfma_f32_16x16x32_bf16 v[76:79], v[228:231], v[208:211], v[76:79]
 s_bfe_u32 s54, s55, 0x30010
 v_exp_f32 v254, v254
 v_mfma_f32_16x16x32_bf16 v[76:79], v[44:47], v[216:219], v[76:79]
 s_lshl_b32 s28, s54, 10
 v_exp_f32 v255, v255
 v_mfma_f32_16x16x32_bf16 v[108:111], v[164:167], v[224:227], 0
 s_add_u32 m0, s46, 73728
 v_exp_f32 v4, v4
 v_mfma_f32_16x16x32_bf16 v[108:111], v[196:199], v[232:235], v[108:111]
 s_xor_b32 s40, s101, 14336
 v_exp_f32 v5, v5
 v_mfma_f32_16x16x32_bf16 v[108:111], v[228:231], v[240:243], v[108:111]
 v_exp_f32 v6, v6
 v_mfma_f32_16x16x32_bf16 v[108:111], v[44:47], v[248:251], v[108:111]
 v_exp_f32 v7, v7
 v_mfma_f32_16x16x32_bf16 a[192:195], v[180:183], v[220:223], a[192:195]
 s_waitcnt lgkmcnt(0)
 ds_read_b64_tr_b16 v[148:149], v14 offset:0
 v_cvt_pk_bf16_f32 v238, v252, v253
 v_mfma_f32_16x16x32_bf16 a[196:199], v[212:215], v[244:247], a[196:199]
 v_cvt_pk_bf16_f32 v239, v254, v255
 v_mfma_f32_16x16x32_bf16 a[200:203], v[212:215], v[60:63], a[200:203]
 ds_read_b64_tr_b16 v[150:151], v14 offset:4096
 v_cvt_pk_bf16_f32 v54, v4, v5
 v_mfma_f32_16x16x32_bf16 a[204:207], v[212:215], v[92:95], a[204:207]
 v_cvt_pk_bf16_f32 v55, v6, v7
 v_mfma_f32_16x16x32_bf16 a[208:211], v[212:215], v[124:127], a[208:211]
 ds_read_b64_tr_b16 v[180:181], v15 offset:0
 v_mfma_f32_16x16x32_bf16 a[212:215], v[212:215], v[156:159], a[212:215]
 v_mfma_f32_16x16x32_bf16 a[216:219], v[212:215], v[188:191], a[216:219]
 ds_read_b64_tr_b16 v[182:183], v15 offset:4096
 v_mfma_f32_16x16x32_bf16 a[220:223], v[212:215], v[220:223], a[220:223]
 v_mfma_f32_16x16x32_bf16 a[248:251], v[28:31], v[220:223], a[248:251]
 s_waitcnt lgkmcnt(6)
 v_mfma_f32_16x16x32_bf16 v[252:255], v[36:39], v[32:35], 0
 v_exp_f32 v76, v76
 v_mfma_f32_16x16x32_bf16 v[252:255], v[68:71], v[40:43], v[252:255]
 v_exp_f32 v77, v77
 v_mfma_f32_16x16x32_bf16 v[252:255], v[100:103], v[48:51], v[252:255]
 v_exp_f32 v78, v78
 v_mfma_f32_16x16x32_bf16 v[252:255], v[132:135], v[56:59], v[252:255]
 v_exp_f32 v79, v79
 v_mfma_f32_16x16x32_bf16 v[4:7], v[36:39], v[64:67], 0
 v_exp_f32 v108, v108
 v_mfma_f32_16x16x32_bf16 v[4:7], v[68:71], v[72:75], v[4:7]
 v_exp_f32 v109, v109
 v_mfma_f32_16x16x32_bf16 v[4:7], v[100:103], v[80:83], v[4:7]
 v_exp_f32 v110, v110
 v_mfma_f32_16x16x32_bf16 v[4:7], v[132:135], v[88:91], v[4:7]
 s_waitcnt lgkmcnt(2)
 v_exp_f32 v111, v111
 v_mfma_f32_16x16x32_bf16 a[0:3], v[148:151], v[140:143], a[0:3]
 ds_read_b64_tr_b16 v[212:213], v16 offset:0
 v_cvt_pk_bf16_f32 v86, v76, v77
 v_mfma_f32_16x16x32_bf16 a[4:7], v[148:151], v[172:175], a[4:7]
 v_cvt_pk_bf16_f32 v87, v78, v79
 v_mfma_f32_16x16x32_bf16 a[8:11], v[148:151], v[204:207], a[8:11]
 ds_read_b64_tr_b16 v[214:215], v16 offset:4096
 v_cvt_pk_bf16_f32 v118, v108, v109
 v_mfma_f32_16x16x32_bf16 a[12:15], v[148:151], v[236:239], a[12:15]
 v_cvt_pk_bf16_f32 v119, v110, v111
 v_mfma_f32_16x16x32_bf16 a[16:19], v[148:151], v[52:55], a[16:19]
 ds_read_b128 v[164:167], v10 offset:45056
 v_add_u32 v10, 131072, v10
 v_mfma_f32_16x16x32_bf16 a[20:23], v[148:151], v[84:87], a[20:23]
 v_mfma_f32_16x16x32_bf16 a[24:27], v[148:151], v[116:119], a[24:27]
 s_waitcnt lgkmcnt(3)
 ds_read_b128 v[196:199], v11 offset:45056
 v_add_u32 v11, 131072, v11
 v_mfma_f32_16x16x32_bf16 a[28:31], v[180:183], v[140:143], a[28:31]
 buffer_load_dwordx4 v24, s[16:19], s40 offen nt lds
 v_mfma_f32_16x16x32_bf16 a[224:227], v[28:31], v[140:143], a[224:227]
 buffer_load_dwordx4 v2, s[16:19], s40 offen offset:2048 nt lds
 v_mfma_f32_16x16x32_bf16 v[76:79], v[36:39], v[96:99], 0
 s_add_u32 m0, s46, 77824
 v_exp_f32 v252, v252
 v_mfma_f32_16x16x32_bf16 v[76:79], v[68:71], v[104:107], v[76:79]
 s_xor_b32 s40, s101, 30720
 v_exp_f32 v253, v253
 v_mfma_f32_16x16x32_bf16 v[76:79], v[100:103], v[112:115], v[76:79]
 v_exp_f32 v254, v254
 v_mfma_f32_16x16x32_bf16 v[76:79], v[132:135], v[120:123], v[76:79]
 v_exp_f32 v255, v255
 v_mfma_f32_16x16x32_bf16 v[108:111], v[36:39], v[128:131], 0
 v_exp_f32 v4, v4
 v_mfma_f32_16x16x32_bf16 v[108:111], v[68:71], v[136:139], v[108:111]
 v_exp_f32 v5, v5
 v_mfma_f32_16x16x32_bf16 v[108:111], v[100:103], v[144:147], v[108:111]
 v_exp_f32 v6, v6
 v_mfma_f32_16x16x32_bf16 v[108:111], v[132:135], v[152:155], v[108:111]
 v_exp_f32 v7, v7
 v_mfma_f32_16x16x32_bf16 a[32:35], v[180:183], v[172:175], a[32:35]
 ds_read_b64_tr_b16 v[148:149], v17 offset:0
 v_cvt_pk_bf16_f32 v244, v252, v253
 v_mfma_f32_16x16x32_bf16 a[36:39], v[180:183], v[204:207], a[36:39]
 v_cvt_pk_bf16_f32 v245, v254, v255
 v_mfma_f32_16x16x32_bf16 a[40:43], v[180:183], v[236:239], a[40:43]
 ds_read_b64_tr_b16 v[150:151], v17 offset:4096
 v_cvt_pk_bf16_f32 v60, v4, v5
 v_mfma_f32_16x16x32_bf16 a[44:47], v[180:183], v[52:55], a[44:47]
 v_cvt_pk_bf16_f32 v61, v6, v7
 v_mfma_f32_16x16x32_bf16 a[48:51], v[180:183], v[84:87], a[48:51]
 ds_read_b128 v[228:231], v12 offset:45056
 v_add_u32 v12, 131072, v12
 v_mfma_f32_16x16x32_bf16 a[52:55], v[180:183], v[116:119], a[52:55]
 s_waitcnt lgkmcnt(5)
 v_mfma_f32_16x16x32_bf16 a[56:59], v[212:215], v[140:143], a[56:59]
 ds_read_b128 v[44:47], v13 offset:45056
 v_add_u32 v13, 131072, v13
 v_mfma_f32_16x16x32_bf16 a[60:63], v[212:215], v[172:175], a[60:63]
 v_mfma_f32_16x16x32_bf16 a[228:231], v[28:31], v[172:175], a[228:231]
 v_mfma_f32_16x16x32_bf16 v[252:255], v[36:39], v[160:163], 0
 v_exp_f32 v76, v76
 v_mfma_f32_16x16x32_bf16 v[252:255], v[68:71], v[168:171], v[252:255]
 v_exp_f32 v77, v77
 v_mfma_f32_16x16x32_bf16 v[252:255], v[100:103], v[176:179], v[252:255]
 v_exp_f32 v78, v78
 v_mfma_f32_16x16x32_bf16 v[252:255], v[132:135], v[184:187], v[252:255]
 v_exp_f32 v79, v79
 v_mfma_f32_16x16x32_bf16 v[4:7], v[36:39], v[192:195], 0
 v_exp_f32 v108, v108
 v_mfma_f32_16x16x32_bf16 v[4:7], v[68:71], v[200:203], v[4:7]
 v_exp_f32 v109, v109
 v_mfma_f32_16x16x32_bf16 v[4:7], v[100:103], v[208:211], v[4:7]
 v_exp_f32 v110, v110
 v_mfma_f32_16x16x32_bf16 v[4:7], v[132:135], v[216:219], v[4:7]
 v_exp_f32 v111, v111
 v_mfma_f32_16x16x32_bf16 a[64:67], v[212:215], v[204:207], a[64:67]
 ds_read_b64_tr_b16 v[180:181], v18 offset:0
 v_cvt_pk_bf16_f32 v92, v76, v77
 v_mfma_f32_16x16x32_bf16 a[68:71], v[212:215], v[236:239], a[68:71]
 v_cvt_pk_bf16_f32 v93, v78, v79
 v_mfma_f32_16x16x32_bf16 a[72:75], v[212:215], v[52:55], a[72:75]
 ds_read_b64_tr_b16 v[182:183], v18 offset:4096
 v_cvt_pk_bf16_f32 v124, v108, v109
 v_mfma_f32_16x16x32_bf16 a[76:79], v[212:215], v[84:87], a[76:79]
 v_cvt_pk_bf16_f32 v125, v110, v111
 v_mfma_f32_16x16x32_bf16 a[80:83], v[212:215], v[116:119], a[80:83]
 s_waitcnt lgkmcnt(4)
 v_mfma_f32_16x16x32_bf16 a[84:87], v[148:151], v[140:143], a[84:87]
 v_mfma_f32_16x16x32_bf16 a[88:91], v[148:151], v[172:175], a[88:91]
 v_mfma_f32_16x16x32_bf16 a[92:95], v[148:151], v[204:207], a[92:95]
 buffer_load_dwordx4 v24, s[16:19], s40 offen nt lds
 v_mfma_f32_16x16x32_bf16 a[232:235], v[28:31], v[204:207], a[232:235]
 buffer_load_dwordx4 v2, s[16:19], s40 offen offset:2048 nt lds
 s_waitcnt vmcnt(9) lgkmcnt(2)
 s_barrier
 v_mfma_f32_16x16x32_bf16 v[76:79], v[36:39], v[224:227], 0
 s_add_u32 m0, s46, 32768
 v_exp_f32 v252, v252
 v_mfma_f32_16x16x32_bf16 v[76:79], v[68:71], v[232:235], v[76:79]
 s_xor_b32 s40, s101, 15360
 v_exp_f32 v253, v253
 v_mfma_f32_16x16x32_bf16 v[76:79], v[100:103], v[240:243], v[76:79]
 v_exp_f32 v254, v254
 v_mfma_f32_16x16x32_bf16 v[76:79], v[132:135], v[248:251], v[76:79]
 v_exp_f32 v255, v255
 v_mfma_f32_16x16x32_bf16 v[108:111], v[164:167], v[32:35], 0
 v_exp_f32 v4, v4
 v_mfma_f32_16x16x32_bf16 v[108:111], v[196:199], v[40:43], v[108:111]
 v_exp_f32 v5, v5
 v_mfma_f32_16x16x32_bf16 v[108:111], v[228:231], v[48:51], v[108:111]
 v_exp_f32 v6, v6
 v_mfma_f32_16x16x32_bf16 v[108:111], v[44:47], v[56:59], v[108:111]
 v_exp_f32 v7, v7
 v_mfma_f32_16x16x32_bf16 a[96:99], v[148:151], v[236:239], a[96:99]
 ds_read_b64_tr_b16 v[212:213], v19 offset:0
 v_cvt_pk_bf16_f32 v156, v252, v253
 v_mfma_f32_16x16x32_bf16 a[100:103], v[148:151], v[52:55], a[100:103]
 v_cvt_pk_bf16_f32 v157, v254, v255
 v_mfma_f32_16x16x32_bf16 a[104:107], v[148:151], v[84:87], a[104:107]
 ds_read_b64_tr_b16 v[214:215], v19 offset:4096
 v_cvt_pk_bf16_f32 v188, v4, v5
 v_mfma_f32_16x16x32_bf16 a[108:111], v[148:151], v[116:119], a[108:111]
 s_waitcnt lgkmcnt(2)
 v_cvt_pk_bf16_f32 v189, v6, v7
 v_mfma_f32_16x16x32_bf16 a[112:115], v[180:183], v[140:143], a[112:115]
 ds_read_b128 v[36:39], v10 offset:0
 v_mfma_f32_16x16x32_bf16 a[116:119], v[180:183], v[172:175], a[116:119]
 v_mfma_f32_16x16x32_bf16 a[120:123], v[180:183], v[204:207], a[120:123]
 ds_read_b128 v[68:71], v11 offset:0
 v_mfma_f32_16x16x32_bf16 a[124:127], v[180:183], v[236:239], a[124:127]
 v_mfma_f32_16x16x32_bf16 a[236:239], v[28:31], v[236:239], a[236:239]
 v_mfma_f32_16x16x32_bf16 v[252:255], v[164:167], v[64:67], 0
 s_waitcnt vmcnt(6)
 v_exp_f32 v76, v76
 v_mfma_f32_16x16x32_bf16 v[252:255], v[196:199], v[72:75], v[252:255]
 v_exp_f32 v77, v77
 v_mfma_f32_16x16x32_bf16 v[252:255], v[228:231], v[80:83], v[252:255]
 v_exp_f32 v78, v78
 v_mfma_f32_16x16x32_bf16 v[252:255], v[44:47], v[88:91], v[252:255]
 v_exp_f32 v79, v79
 v_mfma_f32_16x16x32_bf16 v[4:7], v[164:167], v[96:99], 0
 s_mul_i32 s54, s3, 14680064
 v_exp_f32 v108, v108
 v_mfma_f32_16x16x32_bf16 v[4:7], v[196:199], v[104:107], v[4:7]
 s_mul_i32 s55, s52, 917504
 v_exp_f32 v109, v109
 v_mfma_f32_16x16x32_bf16 v[4:7], v[228:231], v[112:115], v[4:7]
 s_add_u32 s54, s54, s55
 v_exp_f32 v110, v110
 v_mfma_f32_16x16x32_bf16 v[4:7], v[44:47], v[120:123], v[4:7]
 s_mul_i32 s55, s36, 14336
 v_exp_f32 v111, v111
 v_mfma_f32_16x16x32_bf16 a[128:131], v[180:183], v[52:55], a[128:131]
 ds_read_b64_tr_b16 v[148:149], v20 offset:0
 v_cvt_pk_bf16_f32 v220, v76, v77
 v_mfma_f32_16x16x32_bf16 a[132:135], v[180:183], v[84:87], a[132:135]
 v_cvt_pk_bf16_f32 v221, v78, v79
 v_mfma_f32_16x16x32_bf16 a[136:139], v[180:183], v[116:119], a[136:139]
 s_waitcnt lgkmcnt(3)
 ds_read_b64_tr_b16 v[150:151], v20 offset:4096
 v_cvt_pk_bf16_f32 v246, v108, v109
 v_mfma_f32_16x16x32_bf16 a[140:143], v[212:215], v[140:143], a[140:143]
 v_cvt_pk_bf16_f32 v247, v110, v111
 v_cmp_ne_u32 vcc, 0x01010101, v26
 s_nop 1
 s_cmp_lg_u64 vcc, 0
 s_cbranch_scc1 P2_SPINW
P2_GOW:
 v_mfma_f32_16x16x32_bf16 a[144:147], v[212:215], v[172:175], a[144:147]
 ds_read_b128 v[100:103], v12 offset:0
 v_mfma_f32_16x16x32_bf16 a[148:151], v[212:215], v[204:207], a[148:151]
 v_mfma_f32_16x16x32_bf16 a[152:155], v[212:215], v[236:239], a[152:155]
 ds_read_b128 v[132:135], v13 offset:0
 v_mfma_f32_16x16x32_bf16 a[156:159], v[212:215], v[52:55], a[156:159]
 buffer_load_dwordx4 v24, s[16:19], s40 offen nt lds
 v_mfma_f32_16x16x32_bf16 a[240:243], v[28:31], v[52:55], a[240:243]
 buffer_load_dwordx4 v2, s[16:19], s40 offen offset:2048 nt lds
 v_mfma_f32_16x16x32_bf16 v[76:79], v[164:167], v[128:131], 0
 s_add_u32 s54, s54, s55
 v_exp_f32 v252, v252
 v_mfma_f32_16x16x32_bf16 v[76:79], v[196:199], v[136:139], v[76:79]
 s_add_u32 m0, s46, 36864
 v_exp_f32 v253, v253
 v_mfma_f32_16x16x32_bf16 v[76:79], v[228:231], v[144:147], v[76:79]
 s_xor_b32 s40, s101, 31744
 v_exp_f32 v254, v254
 v_mfma_f32_16x16x32_bf16 v[76:79], v[44:47], v[152:155], v[76:79]
 v_exp_f32 v255, v255
 v_mfma_f32_16x16x32_bf16 v[108:111], v[164:167], v[160:163], 0
 v_exp_f32 v4, v4
 v_mfma_f32_16x16x32_bf16 v[108:111], v[196:199], v[168:171], v[108:111]
 v_exp_f32 v5, v5
 v_mfma_f32_16x16x32_bf16 v[108:111], v[228:231], v[176:179], v[108:111]
 v_exp_f32 v6, v6
 v_mfma_f32_16x16x32_bf16 v[108:111], v[44:47], v[184:187], v[108:111]
 v_exp_f32 v7, v7
 v_mfma_f32_16x16x32_bf16 a[160:163], v[212:215], v[84:87], a[160:163]
 ds_read_b64_tr_b16 v[180:181], v21 offset:0
 v_cvt_pk_bf16_f32 v62, v252, v253
 v_mfma_f32_16x16x32_bf16 a[164:167], v[212:215], v[116:119], a[164:167]
 s_waitcnt lgkmcnt(3)
 v_cvt_pk_bf16_f32 v63, v254, v255
 v_mfma_f32_16x16x32_bf16 a[168:171], v[148:151], v[140:143], a[168:171]
 ds_read_b64_tr_b16 v[182:183], v21 offset:4096
 v_cvt_pk_bf16_f32 v94, v4, v5
 v_mfma_f32_16x16x32_bf16 a[172:175], v[148:151], v[172:175], a[172:175]
 v_cvt_pk_bf16_f32 v95, v6, v7
 v_mfma_f32_16x16x32_bf16 a[176:179], v[148:151], v[204:207], a[176:179]
 v_mfma_f32_16x16x32_bf16 a[180:183], v[148:151], v[236:239], a[180:183]
 s_add_u32 s4, s72, s54
 s_addc_u32 s5, s73, 0
 v_mfma_f32_16x16x32_bf16 a[184:187], v[148:151], v[52:55], a[184:187]
 v_mfma_f32_16x16x32_bf16 a[188:191], v[148:151], v[84:87], a[188:191]
CPF7:
 s_mov_b32 s88, CPF7-K1_BASE+2048
 buffer_load_dword v8, v9, s[96:99], s88 offen
 v_mfma_f32_16x16x32_bf16 a[244:247], v[28:31], v[84:87], a[244:247]
 v_mfma_f32_16x16x32_bf16 v[252:255], v[164:167], v[192:195], 0
 s_and_b32 s5, s5, 0xffff
 v_exp_f32 v76, v76
 v_mfma_f32_16x16x32_bf16 v[252:255], v[196:199], v[200:203], v[252:255]
 s_mov_b32 s6, 917504
 v_exp_f32 v77, v77
 v_mfma_f32_16x16x32_bf16 v[252:255], v[228:231], v[208:211], v[252:255]
 s_mov_b32 s7, 0x20000
 v_exp_f32 v78, v78
 v_mfma_f32_16x16x32_bf16 v[252:255], v[44:47], v[216:219], v[252:255]
 v_exp_f32 v79, v79
 v_mfma_f32_16x16x32_bf16 v[4:7], v[164:167], v[224:227], 0
 v_exp_f32 v108, v108
 v_mfma_f32_16x16x32_bf16 v[4:7], v[196:199], v[232:235], v[4:7]
 v_exp_f32 v109, v109
 v_mfma_f32_16x16x32_bf16 v[4:7], v[228:231], v[240:243], v[4:7]
 v_exp_f32 v110, v110
 v_mfma_f32_16x16x32_bf16 v[4:7], v[44:47], v[248:251], v[4:7]
 v_exp_f32 v111, v111
 v_mfma_f32_16x16x32_bf16 a[192:195], v[148:151], v[116:119], a[192:195]
 s_waitcnt lgkmcnt(0)
 ds_read_b64_tr_b16 v[212:213], v14 offset:8192
 v_cvt_pk_bf16_f32 v126, v76, v77
 v_mfma_f32_16x16x32_bf16 a[196:199], v[180:183], v[140:143], a[196:199]
 v_cvt_pk_bf16_f32 v127, v78, v79
 v_mfma_f32_16x16x32_bf16 a[200:203], v[180:183], v[172:175], a[200:203]
 ds_read_b64_tr_b16 v[214:215], v14 offset:12288
 v_add_u32 v14, 73728, v14
 v_cvt_pk_bf16_f32 v158, v108, v109
 v_mfma_f32_16x16x32_bf16 a[204:207], v[180:183], v[204:207], a[204:207]
 v_cvt_pk_bf16_f32 v159, v110, v111
 v_mfma_f32_16x16x32_bf16 a[208:211], v[180:183], v[236:239], a[208:211]
 ds_read_b64_tr_b16 v[148:149], v15 offset:8192
 v_mfma_f32_16x16x32_bf16 a[212:215], v[180:183], v[52:55], a[212:215]
 v_mfma_f32_16x16x32_bf16 a[216:219], v[180:183], v[84:87], a[216:219]
 ds_read_b64_tr_b16 v[150:151], v15 offset:12288
 v_add_u32 v15, 73728, v15
 v_mfma_f32_16x16x32_bf16 a[220:223], v[180:183], v[116:119], a[220:223]
 buffer_load_dwordx4 v24, s[16:19], s40 offen nt lds
 v_mfma_f32_16x16x32_bf16 a[248:251], v[28:31], v[116:119], a[248:251]
 s_waitcnt lgkmcnt(6)
 buffer_load_dwordx4 v2, s[16:19], s40 offen offset:2048 nt lds
 v_mfma_f32_16x16x32_bf16 v[76:79], v[36:39], v[32:35], 0
 s_add_u32 m0, s57, 8192
 v_exp_f32 v252, v252
 v_mfma_f32_16x16x32_bf16 v[76:79], v[68:71], v[40:43], v[76:79]
 s_add_u32 s40, s62, 0
 v_exp_f32 v253, v253
 v_mfma_f32_16x16x32_bf16 v[76:79], v[100:103], v[48:51], v[76:79]
 s_add_u32 s40, s40, s20
 v_exp_f32 v254, v254
 v_mfma_f32_16x16x32_bf16 v[76:79], v[132:135], v[56:59], v[76:79]
 v_exp_f32 v255, v255
 v_mfma_f32_16x16x32_bf16 v[108:111], v[36:39], v[64:67], 0
 v_exp_f32 v4, v4
 v_mfma_f32_16x16x32_bf16 v[108:111], v[68:71], v[72:75], v[108:111]
 v_exp_f32 v5, v5
 v_mfma_f32_16x16x32_bf16 v[108:111], v[100:103], v[80:83], v[108:111]
 v_exp_f32 v6, v6
 v_mfma_f32_16x16x32_bf16 v[108:111], v[132:135], v[88:91], v[108:111]
 s_waitcnt lgkmcnt(2)
 v_exp_f32 v7, v7
 v_mfma_f32_16x16x32_bf16 a[0:3], v[212:215], v[244:247], a[0:3]
 ds_read_b64_tr_b16 v[180:181], v16 offset:8192
 v_cvt_pk_bf16_f32 v190, v252, v253
 v_mfma_f32_16x16x32_bf16 a[4:7], v[212:215], v[60:63], a[4:7]
 v_cvt_pk_bf16_f32 v191, v254, v255
 v_mfma_f32_16x16x32_bf16 a[8:11], v[212:215], v[92:95], a[8:11]
 ds_read_b64_tr_b16 v[182:183], v16 offset:12288
 v_add_u32 v16, 73728, v16
 v_cvt_pk_bf16_f32 v222, v4, v5
 v_mfma_f32_16x16x32_bf16 a[12:15], v[212:215], v[124:127], a[12:15]
 v_cvt_pk_bf16_f32 v223, v6, v7
 v_mfma_f32_16x16x32_bf16 a[16:19], v[212:215], v[156:159], a[16:19]
 ds_read_b128 v[164:167], v10 offset:4096
 v_add_u32 v10, 0xfffe0000, v10
 v_mfma_f32_16x16x32_bf16 a[20:23], v[212:215], v[188:191], a[20:23]
 buffer_load_dwordx4 v0, s[8:11], s40 offen sc1 lds
 v_mfma_f32_16x16x32_bf16 a[24:27], v[212:215], v[220:223], a[24:27]
 s_waitcnt lgkmcnt(3)
 ds_read_b128 v[196:199], v11 offset:4096
 v_add_u32 v11, 0xfffe0000, v11
 v_mfma_f32_16x16x32_bf16 a[28:31], v[148:151], v[244:247], a[28:31]
 s_add_u32 m0, s57, 9216
 s_add_u32 s40, s62, 0
 s_add_u32 s40, s40, s21
 buffer_load_dwordx4 v0, s[8:11], s40 offen sc1 lds
 v_mfma_f32_16x16x32_bf16 a[224:227], v[28:31], v[244:247], a[224:227]
 s_add_u32 m0, s57, 10240
 v_mfma_f32_16x16x32_bf16 v[252:255], v[36:39], v[96:99], 0
 s_add_u32 s40, s62, 0
 v_exp_f32 v76, v76
 v_mfma_f32_16x16x32_bf16 v[252:255], v[68:71], v[104:107], v[252:255]
 s_add_u32 s40, s40, s22
 v_exp_f32 v77, v77
 v_mfma_f32_16x16x32_bf16 v[252:255], v[100:103], v[112:115], v[252:255]
 v_exp_f32 v78, v78
 v_mfma_f32_16x16x32_bf16 v[252:255], v[132:135], v[120:123], v[252:255]
 v_exp_f32 v79, v79
 v_mfma_f32_16x16x32_bf16 v[4:7], v[36:39], v[128:131], 0
 v_exp_f32 v108, v108
 v_mfma_f32_16x16x32_bf16 v[4:7], v[68:71], v[136:139], v[4:7]
 v_exp_f32 v109, v109
 v_mfma_f32_16x16x32_bf16 v[4:7], v[100:103], v[144:147], v[4:7]
 v_exp_f32 v110, v110
 v_mfma_f32_16x16x32_bf16 v[4:7], v[132:135], v[152:155], v[4:7]
 v_exp_f32 v111, v111
 v_mfma_f32_16x16x32_bf16 a[32:35], v[148:151], v[60:63], a[32:35]
 ds_read_b64_tr_b16 v[212:213], v17 offset:8192
 v_cvt_pk_bf16_f32 v140, v76, v77
 v_mfma_f32_16x16x32_bf16 a[36:39], v[148:151], v[92:95], a[36:39]
 v_cvt_pk_bf16_f32 v141, v78, v79
 v_mfma_f32_16x16x32_bf16 a[40:43], v[148:151], v[124:127], a[40:43]
 ds_read_b64_tr_b16 v[214:215], v17 offset:12288
 v_add_u32 v17, 73728, v17
 v_cvt_pk_bf16_f32 v172, v108, v109
 v_mfma_f32_16x16x32_bf16 a[44:47], v[148:151], v[156:159], a[44:47]
 v_cvt_pk_bf16_f32 v173, v110, v111
 v_mfma_f32_16x16x32_bf16 a[48:51], v[148:151], v[188:191], a[48:51]
 ds_read_b128 v[228:231], v12 offset:4096
 v_add_u32 v12, 0xfffe0000, v12
 v_mfma_f32_16x16x32_bf16 a[52:55], v[148:151], v[220:223], a[52:55]
 s_waitcnt lgkmcnt(5)
 buffer_load_dwordx4 v0, s[8:11], s40 offen sc1 lds
 v_mfma_f32_16x16x32_bf16 a[56:59], v[180:183], v[244:247], a[56:59]
 s_add_u32 m0, s57, 11264
 ds_read_b128 v[44:47], v13 offset:4096
 v_add_u32 v13, 0xfffe0000, v13
 v_mfma_f32_16x16x32_bf16 a[60:63], v[180:183], v[60:63], a[60:63]
 s_add_u32 s40, s62, 0
 s_add_u32 s40, s40, s23
 buffer_load_dwordx4 v0, s[8:11], s40 offen sc1 lds
 v_mfma_f32_16x16x32_bf16 a[228:231], v[28:31], v[60:63], a[228:231]
 s_add_u32 m0, s57, 32768
 v_mfma_f32_16x16x32_bf16 v[76:79], v[36:39], v[160:163], 0
 s_add_u32 s40, s62, 0
 v_exp_f32 v252, v252
 v_mfma_f32_16x16x32_bf16 v[76:79], v[68:71], v[168:171], v[76:79]
 s_add_u32 s40, s40, s28
 v_exp_f32 v253, v253
 v_mfma_f32_16x16x32_bf16 v[76:79], v[100:103], v[176:179], v[76:79]
 v_exp_f32 v254, v254
 v_mfma_f32_16x16x32_bf16 v[76:79], v[132:135], v[184:187], v[76:79]
 v_exp_f32 v255, v255
 v_mfma_f32_16x16x32_bf16 v[108:111], v[36:39], v[192:195], 0
 v_exp_f32 v4, v4
 v_mfma_f32_16x16x32_bf16 v[108:111], v[68:71], v[200:203], v[108:111]
 v_exp_f32 v5, v5
 v_mfma_f32_16x16x32_bf16 v[108:111], v[100:103], v[208:211], v[108:111]
 v_exp_f32 v6, v6
 v_mfma_f32_16x16x32_bf16 v[108:111], v[132:135], v[216:219], v[108:111]
 v_exp_f32 v7, v7
 v_mfma_f32_16x16x32_bf16 a[64:67], v[180:183], v[92:95], a[64:67]
 ds_read_b64_tr_b16 v[148:149], v18 offset:8192
 v_cvt_pk_bf16_f32 v204, v252, v253
 v_mfma_f32_16x16x32_bf16 a[68:71], v[180:183], v[124:127], a[68:71]
 v_cvt_pk_bf16_f32 v205, v254, v255
 v_mfma_f32_16x16x32_bf16 a[72:75], v[180:183], v[156:159], a[72:75]
 ds_read_b64_tr_b16 v[150:151], v18 offset:12288
 v_add_u32 v18, 73728, v18
 v_cvt_pk_bf16_f32 v236, v4, v5
 v_mfma_f32_16x16x32_bf16 a[76:79], v[180:183], v[188:191], a[76:79]
 v_cvt_pk_bf16_f32 v237, v6, v7
 v_mfma_f32_16x16x32_bf16 a[80:83], v[180:183], v[220:223], a[80:83]
 s_waitcnt lgkmcnt(4)
 v_mfma_f32_16x16x32_bf16 a[84:87], v[212:215], v[244:247], a[84:87]
 buffer_load_dwordx4 v0, s[8:11], s40 offen sc1 lds
 v_mfma_f32_16x16x32_bf16 a[88:91], v[212:215], v[60:63], a[88:91]
 s_add_u32 m0, s57, 33792
 v_mfma_f32_16x16x32_bf16 a[92:95], v[212:215], v[92:95], a[92:95]
 s_add_u32 s40, s62, 5120
 s_add_u32 s40, s40, s20
 buffer_load_dwordx4 v0, s[8:11], s40 offen sc1 lds
 v_mfma_f32_16x16x32_bf16 a[232:235], v[28:31], v[92:95], a[232:235]
 s_waitcnt vmcnt(11) lgkmcnt(2)
 s_barrier
 v_mfma_f32_16x16x32_bf16 v[252:255], v[36:39], v[224:227], 0
 s_add_u32 m0, s57, 34816
 v_exp_f32 v76, v76
 v_mfma_f32_16x16x32_bf16 v[252:255], v[68:71], v[232:235], v[252:255]
 s_add_u32 s40, s62, 5120
 v_exp_f32 v77, v77
 v_mfma_f32_16x16x32_bf16 v[252:255], v[100:103], v[240:243], v[252:255]
 s_add_u32 s40, s40, s21
 v_exp_f32 v78, v78
 v_mfma_f32_16x16x32_bf16 v[252:255], v[132:135], v[248:251], v[252:255]
 v_exp_f32 v79, v79
 v_mfma_f32_16x16x32_bf16 v[4:7], v[164:167], v[32:35], 0
 v_exp_f32 v108, v108
 v_mfma_f32_16x16x32_bf16 v[4:7], v[196:199], v[40:43], v[4:7]
 v_exp_f32 v109, v109
 v_mfma_f32_16x16x32_bf16 v[4:7], v[228:231], v[48:51], v[4:7]
 v_exp_f32 v110, v110
 v_mfma_f32_16x16x32_bf16 v[4:7], v[44:47], v[56:59], v[4:7]
 v_exp_f32 v111, v111
 v_mfma_f32_16x16x32_bf16 a[96:99], v[212:215], v[124:127], a[96:99]
 ds_read_b64_tr_b16 v[180:181], v19 offset:8192
 v_cvt_pk_bf16_f32 v52, v76, v77
 v_mfma_f32_16x16x32_bf16 a[100:103], v[212:215], v[156:159], a[100:103]
 v_cvt_pk_bf16_f32 v53, v78, v79
 v_mfma_f32_16x16x32_bf16 a[104:107], v[212:215], v[188:191], a[104:107]
 ds_read_b64_tr_b16 v[182:183], v19 offset:12288
 v_add_u32 v19, 73728, v19
 v_cvt_pk_bf16_f32 v84, v108, v109
 v_mfma_f32_16x16x32_bf16 a[108:111], v[212:215], v[220:223], a[108:111]
 s_waitcnt lgkmcnt(2)
 v_cvt_pk_bf16_f32 v85, v110, v111
 v_mfma_f32_16x16x32_bf16 a[112:115], v[148:151], v[244:247], a[112:115]
 ds_read_b128 v[36:39], v10 offset:0
 v_mfma_f32_16x16x32_bf16 a[116:119], v[148:151], v[60:63], a[116:119]
 buffer_load_dwordx4 v0, s[8:11], s40 offen sc1 lds
 v_mfma_f32_16x16x32_bf16 a[120:123], v[148:151], v[92:95], a[120:123]
 s_add_u32 m0, s57, 35840
 ds_read_b128 v[68:71], v11 offset:0
 v_mfma_f32_16x16x32_bf16 a[124:127], v[148:151], v[124:127], a[124:127]
 s_add_u32 s40, s62, 5120
 s_add_u32 s40, s40, s22
 buffer_load_dwordx4 v0, s[8:11], s40 offen sc1 lds
 v_mfma_f32_16x16x32_bf16 a[236:239], v[28:31], v[124:127], a[236:239]
 s_add_u32 m0, s57, 40960
 v_mfma_f32_16x16x32_bf16 v[76:79], v[164:167], v[64:67], 0
 s_add_u32 s40, s62, 5120
 v_exp_f32 v252, v252
 v_mfma_f32_16x16x32_bf16 v[76:79], v[196:199], v[72:75], v[76:79]
 s_add_u32 s40, s40, s23
 v_exp_f32 v253, v253
 v_mfma_f32_16x16x32_bf16 v[76:79], v[228:231], v[80:83], v[76:79]
 v_exp_f32 v254, v254
 v_mfma_f32_16x16x32_bf16 v[76:79], v[44:47], v[88:91], v[76:79]
 v_exp_f32 v255, v255
 v_mfma_f32_16x16x32_bf16 v[108:111], v[164:167], v[96:99], 0
 v_exp_f32 v4, v4
 v_mfma_f32_16x16x32_bf16 v[108:111], v[196:199], v[104:107], v[108:111]
 v_exp_f32 v5, v5
 v_mfma_f32_16x16x32_bf16 v[108:111], v[228:231], v[112:115], v[108:111]
 v_exp_f32 v6, v6
 v_mfma_f32_16x16x32_bf16 v[108:111], v[44:47], v[120:123], v[108:111]
 v_exp_f32 v7, v7
 v_mfma_f32_16x16x32_bf16 a[128:131], v[148:151], v[156:159], a[128:131]
 ds_read_b64_tr_b16 v[212:213], v20 offset:8192
 v_cvt_pk_bf16_f32 v116, v252, v253
 v_mfma_f32_16x16x32_bf16 a[132:135], v[148:151], v[188:191], a[132:135]
 v_cvt_pk_bf16_f32 v117, v254, v255
 v_mfma_f32_16x16x32_bf16 a[136:139], v[148:151], v[220:223], a[136:139]
 s_waitcnt lgkmcnt(3)
 ds_read_b64_tr_b16 v[214:215], v20 offset:12288
 v_add_u32 v20, 73728, v20
 v_cvt_pk_bf16_f32 v142, v4, v5
 v_mfma_f32_16x16x32_bf16 a[140:143], v[180:183], v[244:247], a[140:143]
 v_cvt_pk_bf16_f32 v143, v6, v7
 v_mfma_f32_16x16x32_bf16 a[144:147], v[180:183], v[60:63], a[144:147]
 ds_read_b128 v[100:103], v12 offset:0
 v_mfma_f32_16x16x32_bf16 a[148:151], v[180:183], v[92:95], a[148:151]
 buffer_load_dwordx4 v0, s[8:11], s40 offen sc1 lds
 v_mfma_f32_16x16x32_bf16 a[152:155], v[180:183], v[124:127], a[152:155]
 s_add_u32 m0, s57, 41984
 ds_read_b128 v[132:135], v13 offset:0
 v_mfma_f32_16x16x32_bf16 a[156:159], v[180:183], v[156:159], a[156:159]
 s_add_u32 s40, s62, 5120
 s_add_u32 s40, s40, s28
 buffer_load_dwordx4 v0, s[8:11], s40 offen sc1 lds
 v_mfma_f32_16x16x32_bf16 a[240:243], v[28:31], v[156:159], a[240:243]
 s_add_u32 m0, s57, 43008
 v_mfma_f32_16x16x32_bf16 v[252:255], v[164:167], v[128:131], 0
 s_add_u32 s40, s62, 163840
 v_exp_f32 v76, v76
 v_mfma_f32_16x16x32_bf16 v[252:255], v[196:199], v[136:139], v[252:255]
 s_add_u32 s40, s40, s20
 v_exp_f32 v77, v77
 v_mfma_f32_16x16x32_bf16 v[252:255], v[228:231], v[144:147], v[252:255]
 v_exp_f32 v78, v78
 v_mfma_f32_16x16x32_bf16 v[252:255], v[44:47], v[152:155], v[252:255]
 v_exp_f32 v79, v79
 v_mfma_f32_16x16x32_bf16 v[4:7], v[164:167], v[160:163], 0
 v_exp_f32 v108, v108
 v_mfma_f32_16x16x32_bf16 v[4:7], v[196:199], v[168:171], v[4:7]
 v_exp_f32 v109, v109
 v_mfma_f32_16x16x32_bf16 v[4:7], v[228:231], v[176:179], v[4:7]
 v_exp_f32 v110, v110
 v_mfma_f32_16x16x32_bf16 v[4:7], v[44:47], v[184:187], v[4:7]
 v_exp_f32 v111, v111
 v_mfma_f32_16x16x32_bf16 a[160:163], v[180:183], v[188:191], a[160:163]
 ds_read_b64_tr_b16 v[148:149], v21 offset:8192
 v_cvt_pk_bf16_f32 v174, v76, v77
 v_mfma_f32_16x16x32_bf16 a[164:167], v[180:183], v[220:223], a[164:167]
 s_waitcnt lgkmcnt(3)
 v_cvt_pk_bf16_f32 v175, v78, v79
 v_mfma_f32_16x16x32_bf16 a[168:171], v[212:215], v[244:247], a[168:171]
 ds_read_b64_tr_b16 v[150:151], v21 offset:12288
 v_add_u32 v21, 73728, v21
 v_cvt_pk_bf16_f32 v206, v108, v109
 v_mfma_f32_16x16x32_bf16 a[172:175], v[212:215], v[60:63], a[172:175]
 v_cvt_pk_bf16_f32 v207, v110, v111
 v_mfma_f32_16x16x32_bf16 a[176:179], v[212:215], v[92:95], a[176:179]
 v_mfma_f32_16x16x32_bf16 a[180:183], v[212:215], v[124:127], a[180:183]
 buffer_load_dwordx4 v0, s[8:11], s40 offen sc1 lds
 v_mfma_f32_16x16x32_bf16 a[184:187], v[212:215], v[156:159], a[184:187]
 s_add_u32 m0, s57, 44032
 v_mfma_f32_16x16x32_bf16 a[188:191], v[212:215], v[188:191], a[188:191]
 s_add_u32 s40, s62, 163840
 s_add_u32 s40, s40, s21
 buffer_load_dwordx4 v0, s[8:11], s40 offen sc1 lds
 v_mfma_f32_16x16x32_bf16 a[244:247], v[28:31], v[188:191], a[244:247]
 s_add_u32 m0, s57, 106496
 v_mfma_f32_16x16x32_bf16 v[76:79], v[164:167], v[192:195], 0
 s_add_u32 s40, s62, 163840
 v_exp_f32 v252, v252
 v_mfma_f32_16x16x32_bf16 v[76:79], v[196:199], v[200:203], v[76:79]
 s_add_u32 s40, s40, s22
 v_exp_f32 v253, v253
 v_mfma_f32_16x16x32_bf16 v[76:79], v[228:231], v[208:211], v[76:79]
 v_exp_f32 v254, v254
 v_mfma_f32_16x16x32_bf16 v[76:79], v[44:47], v[216:219], v[76:79]
 v_exp_f32 v255, v255
 v_mfma_f32_16x16x32_bf16 v[108:111], v[164:167], v[224:227], 0
 v_exp_f32 v4, v4
 v_mfma_f32_16x16x32_bf16 v[108:111], v[196:199], v[232:235], v[108:111]
 v_exp_f32 v5, v5
 v_mfma_f32_16x16x32_bf16 v[108:111], v[228:231], v[240:243], v[108:111]
 v_exp_f32 v6, v6
 v_mfma_f32_16x16x32_bf16 v[108:111], v[44:47], v[248:251], v[108:111]
 v_exp_f32 v7, v7
 v_mfma_f32_16x16x32_bf16 a[192:195], v[212:215], v[220:223], a[192:195]
 s_waitcnt lgkmcnt(0)
 ds_read_b64_tr_b16 v[180:181], v14 offset:0
 v_cvt_pk_bf16_f32 v238, v252, v253
 v_mfma_f32_16x16x32_bf16 a[196:199], v[148:151], v[244:247], a[196:199]
 s_branch SK7052
PG7052:
 s_branch RET1
SK7052:
 v_cvt_pk_bf16_f32 v239, v254, v255
 v_mfma_f32_16x16x32_bf16 a[200:203], v[148:151], v[60:63], a[200:203]
 ds_read_b64_tr_b16 v[182:183], v14 offset:4096
 v_add_u32 v14, 0xfffee000, v14
 v_cvt_pk_bf16_f32 v54, v4, v5
 v_mfma_f32_16x16x32_bf16 a[204:207], v[148:151], v[92:95], a[204:207]
 v_cvt_pk_bf16_f32 v55, v6, v7
 v_mfma_f32_16x16x32_bf16 a[208:211], v[148:151], v[124:127], a[208:211]
 ds_read_b64_tr_b16 v[212:213], v15 offset:0
 v_mfma_f32_16x16x32_bf16 a[212:215], v[148:151], v[156:159], a[212:215]
 buffer_load_dwordx4 v0, s[8:11], s40 offen sc1 lds
 v_mfma_f32_16x16x32_bf16 a[216:219], v[148:151], v[188:191], a[216:219]
 s_add_u32 m0, s57, 107520
 ds_read_b64_tr_b16 v[214:215], v15 offset:4096
 v_add_u32 v15, 0xfffee000, v15
 v_mfma_f32_16x16x32_bf16 a[220:223], v[148:151], v[220:223], a[220:223]
 s_add_u32 s40, s62, 163840
 s_add_u32 s40, s40, s23
 buffer_load_dwordx4 v0, s[8:11], s40 offen sc1 lds
 v_mfma_f32_16x16x32_bf16 a[248:251], v[28:31], v[220:223], a[248:251]
 s_waitcnt lgkmcnt(6)
 v_mfma_f32_16x16x32_bf16 v[252:255], v[36:39], v[32:35], 0
 s_add_u32 m0, s57, 108544
 v_exp_f32 v76, v76
 v_mfma_f32_16x16x32_bf16 v[252:255], v[68:71], v[40:43], v[252:255]
 s_add_u32 s40, s62, 163840
 v_exp_f32 v77, v77
 v_mfma_f32_16x16x32_bf16 v[252:255], v[100:103], v[48:51], v[252:255]
 s_add_u32 s40, s40, s28
 v_exp_f32 v78, v78
 v_mfma_f32_16x16x32_bf16 v[252:255], v[132:135], v[56:59], v[252:255]
 v_exp_f32 v79, v79
 v_mfma_f32_16x16x32_bf16 v[4:7], v[36:39], v[64:67], 0
 v_exp_f32 v108, v108
 v_mfma_f32_16x16x32_bf16 v[4:7], v[68:71], v[72:75], v[4:7]
 v_exp_f32 v109, v109
 v_mfma_f32_16x16x32_bf16 v[4:7], v[100:103], v[80:83], v[4:7]
 v_exp_f32 v110, v110
 v_mfma_f32_16x16x32_bf16 v[4:7], v[132:135], v[88:91], v[4:7]
 s_waitcnt lgkmcnt(2)
 v_exp_f32 v111, v111
 v_mfma_f32_16x16x32_bf16 a[0:3], v[180:183], v[140:143], a[0:3]
 ds_read_b64_tr_b16 v[148:149], v16 offset:0
 v_cvt_pk_bf16_f32 v86, v76, v77
 v_mfma_f32_16x16x32_bf16 a[4:7], v[180:183], v[172:175], a[4:7]
 v_cvt_pk_bf16_f32 v87, v78, v79
 v_mfma_f32_16x16x32_bf16 a[8:11], v[180:183], v[204:207], a[8:11]
 ds_read_b64_tr_b16 v[150:151], v16 offset:4096
 v_add_u32 v16, 0xfffee000, v16
 v_cvt_pk_bf16_f32 v118, v108, v109
 v_mfma_f32_16x16x32_bf16 a[12:15], v[180:183], v[236:239], a[12:15]
 v_cvt_pk_bf16_f32 v119, v110, v111
 v_mfma_f32_16x16x32_bf16 a[16:19], v[180:183], v[52:55], a[16:19]
 ds_read_b128 v[164:167], v10 offset:4096
 v_mfma_f32_16x16x32_bf16 a[20:23], v[180:183], v[84:87], a[20:23]
 buffer_load_dwordx4 v0, s[8:11], s40 offen sc1 lds
 v_mfma_f32_16x16x32_bf16 a[24:27], v[180:183], v[116:119], a[24:27]
 s_waitcnt lgkmcnt(3)
 ds_read_b128 v[196:199], v11 offset:4096
 v_mfma_f32_16x16x32_bf16 a[28:31], v[212:215], v[140:143], a[28:31]
 s_add_u32 m0, s57, 109568
 s_add_u32 s40, s62, 168960
 s_add_u32 s40, s40, s20
 buffer_load_dwordx4 v0, s[8:11], s40 offen sc1 lds
 v_mfma_f32_16x16x32_bf16 a[224:227], v[28:31], v[140:143], a[224:227]
 s_add_u32 m0, s57, 131072
 v_mfma_f32_16x16x32_bf16 v[76:79], v[36:39], v[96:99], 0
 s_add_u32 s40, s62, 168960
 v_exp_f32 v252, v252
 v_mfma_f32_16x16x32_bf16 v[76:79], v[68:71], v[104:107], v[76:79]
 s_add_u32 s40, s40, s21
 v_exp_f32 v253, v253
 v_mfma_f32_16x16x32_bf16 v[76:79], v[100:103], v[112:115], v[76:79]
 v_exp_f32 v254, v254
 v_mfma_f32_16x16x32_bf16 v[76:79], v[132:135], v[120:123], v[76:79]
 v_exp_f32 v255, v255
 v_mfma_f32_16x16x32_bf16 v[108:111], v[36:39], v[128:131], 0
 v_exp_f32 v4, v4
 v_mfma_f32_16x16x32_bf16 v[108:111], v[68:71], v[136:139], v[108:111]
 v_exp_f32 v5, v5
 v_mfma_f32_16x16x32_bf16 v[108:111], v[100:103], v[144:147], v[108:111]
 v_exp_f32 v6, v6
 v_mfma_f32_16x16x32_bf16 v[108:111], v[132:135], v[152:155], v[108:111]
 v_exp_f32 v7, v7
 v_mfma_f32_16x16x32_bf16 a[32:35], v[212:215], v[172:175], a[32:35]
 ds_read_b64_tr_b16 v[180:181], v17 offset:0
 v_cvt_pk_bf16_f32 v244, v252, v253
 v_mfma_f32_16x16x32_bf16 a[36:39], v[212:215], v[204:207], a[36:39]
 v_cvt_pk_bf16_f32 v245, v254, v255
 v_mfma_f32_16x16x32_bf16 a[40:43], v[212:215], v[236:239], a[40:43]
 ds_read_b64_tr_b16 v[182:183], v17 offset:4096
 v_add_u32 v17, 0xfffee000, v17
 v_cvt_pk_bf16_f32 v60, v4, v5
 v_mfma_f32_16x16x32_bf16 a[44:47], v[212:215], v[52:55], a[44:47]
 v_cvt_pk_bf16_f32 v61, v6, v7
 v_mfma_f32_16x16x32_bf16 a[48:51], v[212:215], v[84:87], a[48:51]
 ds_read_b128 v[228:231], v12 offset:4096
 v_mfma_f32_16x16x32_bf16 a[52:55], v[212:215], v[116:119], a[52:55]
 s_waitcnt lgkmcnt(5)
 buffer_load_dwordx4 v0, s[8:11], s40 offen sc1 lds
 v_mfma_f32_16x16x32_bf16 a[56:59], v[148:151], v[140:143], a[56:59]
 s_add_u32 m0, s57, 132096
 ds_read_b128 v[44:47], v13 offset:4096
 v_mfma_f32_16x16x32_bf16 a[60:63], v[148:151], v[172:175], a[60:63]
 s_add_u32 s40, s62, 168960
 s_add_u32 s40, s40, s22
 buffer_load_dwordx4 v0, s[8:11], s40 offen sc1 lds
 v_mfma_f32_16x16x32_bf16 a[228:231], v[28:31], v[172:175], a[228:231]
 s_add_u32 m0, s57, 133120
 v_mfma_f32_16x16x32_bf16 v[252:255], v[36:39], v[160:163], 0
 s_add_u32 s40, s62, 168960
 v_exp_f32 v76, v76
 v_mfma_f32_16x16x32_bf16 v[252:255], v[68:71], v[168:171], v[252:255]
 s_add_u32 s40, s40, s23
 v_exp_f32 v77, v77
 v_mfma_f32_16x16x32_bf16 v[252:255], v[100:103], v[176:179], v[252:255]
 v_exp_f32 v78, v78
 v_mfma_f32_16x16x32_bf16 v[252:255], v[132:135], v[184:187], v[252:255]
 v_exp_f32 v79, v79
 v_mfma_f32_16x16x32_bf16 v[4:7], v[36:39], v[192:195], 0
 v_exp_f32 v108, v108
 v_mfma_f32_16x16x32_bf16 v[4:7], v[68:71], v[200:203], v[4:7]
 v_exp_f32 v109, v109
 v_mfma_f32_16x16x32_bf16 v[4:7], v[100:103], v[208:211], v[4:7]
 v_exp_f32 v110, v110
 v_mfma_f32_16x16x32_bf16 v[4:7], v[132:135], v[216:219], v[4:7]
 v_exp_f32 v111, v111
 v_mfma_f32_16x16x32_bf16 a[64:67], v[148:151], v[204:207], a[64:67]
 ds_read_b64_tr_b16 v[212:213], v18 offset:0
 v_cvt_pk_bf16_f32 v92, v76, v77
 v_mfma_f32_16x16x32_bf16 a[68:71], v[148:151], v[236:239], a[68:71]
 v_cvt_pk_bf16_f32 v93, v78, v79
 v_mfma_f32_16x16x32_bf16 a[72:75], v[148:151], v[52:55], a[72:75]
 ds_read_b64_tr_b16 v[214:215], v18 offset:4096
 v_add_u32 v18, 0xfffee000, v18
 v_cvt_pk_bf16_f32 v124, v108, v109
 v_mfma_f32_16x16x32_bf16 a[76:79], v[148:151], v[84:87], a[76:79]
 v_cvt_pk_bf16_f32 v125, v110, v111
 v_mfma_f32_16x16x32_bf16 a[80:83], v[148:151], v[116:119], a[80:83]
 s_waitcnt lgkmcnt(4)
 v_mfma_f32_16x16x32_bf16 a[84:87], v[180:183], v[140:143], a[84:87]
 buffer_load_dwordx4 v0, s[8:11], s40 offen sc1 lds
 v_mfma_f32_16x16x32_bf16 a[88:91], v[180:183], v[172:175], a[88:91]
 s_add_u32 m0, s57, 134144
 v_mfma_f32_16x16x32_bf16 a[92:95], v[180:183], v[204:207], a[92:95]
 s_add_u32 s40, s62, 168960
 s_add_u32 s40, s40, s28
 buffer_load_dwordx4 v0, s[8:11], s40 offen sc1 lds
 v_mfma_f32_16x16x32_bf16 a[232:235], v[28:31], v[204:207], a[232:235]
 s_waitcnt vmcnt(20) lgkmcnt(2)
 s_barrier
 v_mfma_f32_16x16x32_bf16 v[76:79], v[36:39], v[224:227], 0
 s_add_u32 m0, s57, 65536
 v_exp_f32 v252, v252
 v_mfma_f32_16x16x32_bf16 v[76:79], v[68:71], v[232:235], v[76:79]
 s_add_u32 s40, s62, 327680
 v_exp_f32 v253, v253
 v_mfma_f32_16x16x32_bf16 v[76:79], v[100:103], v[240:243], v[76:79]
 s_add_u32 s40, s40, s20
 v_exp_f32 v254, v254
 v_mfma_f32_16x16x32_bf16 v[76:79], v[132:135], v[248:251], v[76:79]
 v_exp_f32 v255, v255
 v_mfma_f32_16x16x32_bf16 v[108:111], v[164:167], v[32:35], 0
 v_exp_f32 v4, v4
 v_mfma_f32_16x16x32_bf16 v[108:111], v[196:199], v[40:43], v[108:111]
 v_exp_f32 v5, v5
 v_mfma_f32_16x16x32_bf16 v[108:111], v[228:231], v[48:51], v[108:111]
 v_exp_f32 v6, v6
 v_mfma_f32_16x16x32_bf16 v[108:111], v[44:47], v[56:59], v[108:111]
 v_exp_f32 v7, v7
 v_mfma_f32_16x16x32_bf16 a[96:99], v[180:183], v[236:239], a[96:99]
 ds_read_b64_tr_b16 v[148:149], v19 offset:0
 v_cvt_pk_bf16_f32 v156, v252, v253
 v_mfma_f32_16x16x32_bf16 a[100:103], v[180:183], v[52:55], a[100:103]
 v_cvt_pk_bf16_f32 v157, v254, v255
 v_mfma_f32_16x16x32_bf16 a[104:107], v[180:183], v[84:87], a[104:107]
 ds_read_b64_tr_b16 v[150:151], v19 offset:4096
 v_add_u32 v19, 0xfffee000, v19
 v_cvt_pk_bf16_f32 v188, v4, v5
 v_mfma_f32_16x16x32_bf16 a[108:111], v[180:183], v[116:119], a[108:111]
 s_waitcnt lgkmcnt(2)
 v_cvt_pk_bf16_f32 v189, v6, v7
 v_mfma_f32_16x16x32_bf16 a[112:115], v[212:215], v[140:143], a[112:115]
 v_mfma_f32_16x16x32_bf16 a[116:119], v[212:215], v[172:175], a[116:119]
 buffer_load_dwordx4 v0, s[8:11], s40 offen sc1 lds
 v_mfma_f32_16x16x32_bf16 a[120:123], v[212:215], v[204:207], a[120:123]
 s_add_u32 m0, s57, 66560
 v_mfma_f32_16x16x32_bf16 a[124:127], v[212:215], v[236:239], a[124:127]
 s_add_u32 s40, s62, 327680
 s_add_u32 s40, s40, s21
 buffer_load_dwordx4 v0, s[8:11], s40 offen sc1 lds
 v_mfma_f32_16x16x32_bf16 a[236:239], v[28:31], v[236:239], a[236:239]
 s_add_u32 m0, s57, 67584
 v_mfma_f32_16x16x32_bf16 v[252:255], v[164:167], v[64:67], 0
 s_add_u32 s40, s62, 327680
 v_exp_f32 v76, v76
 v_mfma_f32_16x16x32_bf16 v[252:255], v[196:199], v[72:75], v[252:255]
 s_add_u32 s40, s40, s22
 v_exp_f32 v77, v77
 v_mfma_f32_16x16x32_bf16 v[252:255], v[228:231], v[80:83], v[252:255]
 v_exp_f32 v78, v78
 v_mfma_f32_16x16x32_bf16 v[252:255], v[44:47], v[88:91], v[252:255]
 v_exp_f32 v79, v79
 v_mfma_f32_16x16x32_bf16 v[4:7], v[164:167], v[96:99], 0
 v_exp_f32 v108, v108
 v_mfma_f32_16x16x32_bf16 v[4:7], v[196:199], v[104:107], v[4:7]
 v_exp_f32 v109, v109
 v_mfma_f32_16x16x32_bf16 v[4:7], v[228:231], v[112:115], v[4:7]
 v_exp_f32 v110, v110
 v_mfma_f32_16x16x32_bf16 v[4:7], v[44:47], v[120:123], v[4:7]
 v_exp_f32 v111, v111
 v_mfma_f32_16x16x32_bf16 a[128:131], v[212:215], v[52:55], a[128:131]
 ds_read_b64_tr_b16 v[180:181], v20 offset:0
 v_cvt_pk_bf16_f32 v220, v76, v77
 v_mfma_f32_16x16x32_bf16 a[132:135], v[212:215], v[84:87], a[132:135]
 v_cvt_pk_bf16_f32 v221, v78, v79
 v_mfma_f32_16x16x32_bf16 a[136:139], v[212:215], v[116:119], a[136:139]
 s_waitcnt lgkmcnt(1)
 ds_read_b64_tr_b16 v[182:183], v20 offset:4096
 v_add_u32 v20, 0xfffee000, v20
 v_cvt_pk_bf16_f32 v246, v108, v109
 v_mfma_f32_16x16x32_bf16 a[140:143], v[148:151], v[140:143], a[140:143]
 v_cvt_pk_bf16_f32 v247, v110, v111
 v_mfma_f32_16x16x32_bf16 a[144:147], v[148:151], v[172:175], a[144:147]
 v_mfma_f32_16x16x32_bf16 a[148:151], v[148:151], v[204:207], a[148:151]
 buffer_load_dwordx4 v0, s[8:11], s40 offen sc1 lds
 v_mfma_f32_16x16x32_bf16 a[152:155], v[148:151], v[236:239], a[152:155]
 s_add_u32 m0, s57, 68608
 v_mfma_f32_16x16x32_bf16 a[156:159], v[148:151], v[52:55], a[156:159]
 s_add_u32 s40, s62, 327680
 s_add_u32 s40, s40, s23
 buffer_load_dwordx4 v0, s[8:11], s40 offen sc1 lds
 v_mfma_f32_16x16x32_bf16 a[240:243], v[28:31], v[52:55], a[240:243]
CPF8:
 s_mov_b32 s88, CPF8-K1_BASE+34816
 buffer_load_dword v8, v9, s[96:99], s88 offen
 v_mfma_f32_16x16x32_bf16 v[76:79], v[164:167], v[128:131], 0
 s_add_u32 m0, s57, 0
 v_exp_f32 v252, v252
 v_mfma_f32_16x16x32_bf16 v[76:79], v[196:199], v[136:139], v[76:79]
 s_add_u32 s40, s62, 327680
 v_exp_f32 v253, v253
 v_mfma_f32_16x16x32_bf16 v[76:79], v[228:231], v[144:147], v[76:79]
 s_add_u32 s40, s40, s28
 v_exp_f32 v254, v254
 v_mfma_f32_16x16x32_bf16 v[76:79], v[44:47], v[152:155], v[76:79]
 v_exp_f32 v255, v255
 v_mfma_f32_16x16x32_bf16 v[108:111], v[164:167], v[160:163], 0
 v_exp_f32 v4, v4
 v_mfma_f32_16x16x32_bf16 v[108:111], v[196:199], v[168:171], v[108:111]
 v_exp_f32 v5, v5
 v_mfma_f32_16x16x32_bf16 v[108:111], v[228:231], v[176:179], v[108:111]
 v_exp_f32 v6, v6
 v_mfma_f32_16x16x32_bf16 v[108:111], v[44:47], v[184:187], v[108:111]
 v_exp_f32 v7, v7
 v_mfma_f32_16x16x32_bf16 a[160:163], v[148:151], v[84:87], a[160:163]
 ds_read_b64_tr_b16 v[212:213], v21 offset:0
 v_cvt_pk_bf16_f32 v62, v252, v253
 v_mfma_f32_16x16x32_bf16 a[164:167], v[148:151], v[116:119], a[164:167]
 s_waitcnt lgkmcnt(1)
 v_cvt_pk_bf16_f32 v63, v254, v255
 v_mfma_f32_16x16x32_bf16 a[168:171], v[180:183], v[140:143], a[168:171]
 ds_read_b64_tr_b16 v[214:215], v21 offset:4096
 v_add_u32 v21, 0xfffee000, v21
 v_cvt_pk_bf16_f32 v94, v4, v5
 v_mfma_f32_16x16x32_bf16 a[172:175], v[180:183], v[172:175], a[172:175]
 v_cvt_pk_bf16_f32 v95, v6, v7
 v_mfma_f32_16x16x32_bf16 a[176:179], v[180:183], v[204:207], a[176:179]
 v_mfma_f32_16x16x32_bf16 a[180:183], v[180:183], v[236:239], a[180:183]
 buffer_load_dwordx4 v0, s[8:11], s40 offen sc1 lds
 v_mfma_f32_16x16x32_bf16 a[184:187], v[180:183], v[52:55], a[184:187]
 s_add_u32 m0, s57, 1024
 v_mfma_f32_16x16x32_bf16 a[188:191], v[180:183], v[84:87], a[188:191]
 s_add_u32 s40, s62, 332800
 s_add_u32 s40, s40, s20
 buffer_load_dwordx4 v0, s[8:11], s40 offen sc1 lds
 v_mfma_f32_16x16x32_bf16 a[244:247], v[28:31], v[84:87], a[244:247]
CPF9:
 s_mov_b32 s88, CPF9-K1_BASE+2048
 buffer_load_dword v8, v9, s[96:99], s88 offen
 v_mfma_f32_16x16x32_bf16 v[252:255], v[164:167], v[192:195], 0
 s_add_u32 m0, s57, 2048
 v_exp_f32 v76, v76
 v_mfma_f32_16x16x32_bf16 v[252:255], v[196:199], v[200:203], v[252:255]
 s_add_u32 s40, s62, 332800
 v_exp_f32 v77, v77
 v_mfma_f32_16x16x32_bf16 v[252:255], v[228:231], v[208:211], v[252:255]
 s_add_u32 s40, s40, s21
 v_exp_f32 v78, v78
 v_mfma_f32_16x16x32_bf16 v[252:255], v[44:47], v[216:219], v[252:255]
 v_exp_f32 v79, v79
 v_mfma_f32_16x16x32_bf16 v[4:7], v[164:167], v[224:227], 0
 v_exp_f32 v108, v108
 v_mfma_f32_16x16x32_bf16 v[4:7], v[196:199], v[232:235], v[4:7]
 v_exp_f32 v109, v109
 v_mfma_f32_16x16x32_bf16 v[4:7], v[228:231], v[240:243], v[4:7]
 v_exp_f32 v110, v110
 v_mfma_f32_16x16x32_bf16 v[4:7], v[44:47], v[248:251], v[4:7]
 v_exp_f32 v111, v111
 v_mfma_f32_16x16x32_bf16 a[192:195], v[180:183], v[116:119], a[192:195]
 s_waitcnt lgkmcnt(0)
 ds_read_b64_tr_b16 v[148:149], v14 offset:32768
 v_cvt_pk_bf16_f32 v126, v76, v77
 v_mfma_f32_16x16x32_bf16 a[196:199], v[212:215], v[140:143], a[196:199]
 v_cvt_pk_bf16_f32 v127, v78, v79
 v_mfma_f32_16x16x32_bf16 a[200:203], v[212:215], v[172:175], a[200:203]
 ds_read_b64_tr_b16 v[150:151], v14 offset:36864
 v_cvt_pk_bf16_f32 v158, v108, v109
 v_mfma_f32_16x16x32_bf16 a[204:207], v[212:215], v[204:207], a[204:207]
 v_cvt_pk_bf16_f32 v159, v110, v111
 v_mfma_f32_16x16x32_bf16 a[208:211], v[212:215], v[236:239], a[208:211]
 ds_read_b64_tr_b16 v[180:181], v15 offset:32768
 v_mfma_f32_16x16x32_bf16 a[212:215], v[212:215], v[52:55], a[212:215]
 buffer_load_dwordx4 v0, s[8:11], s40 offen sc1 lds
 v_mfma_f32_16x16x32_bf16 a[216:219], v[212:215], v[84:87], a[216:219]
 s_add_u32 m0, s57, 3072
 ds_read_b64_tr_b16 v[182:183], v15 offset:36864
 v_mfma_f32_16x16x32_bf16 a[220:223], v[212:215], v[116:119], a[220:223]
 s_add_u32 s40, s62, 332800
 s_add_u32 s40, s40, s22
 buffer_load_dwordx4 v0, s[8:11], s40 offen sc1 lds
 v_mfma_f32_16x16x32_bf16 a[248:251], v[28:31], v[116:119], a[248:251]
 s_add_u32 m0, s57, 73728
 v_exp_f32 v252, v252
 v_exp_f32 v253, v253
 v_exp_f32 v254, v254
 v_exp_f32 v255, v255
 v_mfma_f32_16x16x32_bf16 a[224:227], v[28:31], v[244:247], a[224:227]
 s_add_u32 s40, s62, 332800
 v_exp_f32 v4, v4
 v_mfma_f32_16x16x32_bf16 a[228:231], v[28:31], v[60:63], a[228:231]
 s_add_u32 s40, s40, s23
 v_exp_f32 v5, v5
 v_mfma_f32_16x16x32_bf16 a[232:235], v[28:31], v[92:95], a[232:235]
 v_exp_f32 v6, v6
 v_mfma_f32_16x16x32_bf16 a[236:239], v[28:31], v[124:127], a[236:239]
 v_exp_f32 v7, v7
 v_mfma_f32_16x16x32_bf16 a[240:243], v[28:31], v[156:159], a[240:243]
 s_waitcnt lgkmcnt(2)
 v_cvt_pk_bf16_f32 v190, v252, v253
 v_cvt_pk_bf16_f32 v191, v254, v255
 v_mfma_f32_16x16x32_bf16 a[0:3], v[148:151], v[244:247], a[0:3]
 v_cvt_pk_bf16_f32 v222, v4, v5
 v_cvt_pk_bf16_f32 v223, v6, v7
 v_mfma_f32_16x16x32_bf16 a[244:247], v[28:31], v[188:191], a[244:247]
 buffer_load_dwordx4 v0, s[8:11], s40 offen sc1 lds
 v_mfma_f32_16x16x32_bf16 a[4:7], v[148:151], v[60:63], a[4:7]
 s_add_u32 m0, s57, 74752
 ds_read_b64_tr_b16 v[212:213], v16 offset:32768
 v_mfma_f32_16x16x32_bf16 a[248:251], v[28:31], v[220:223], a[248:251]
 s_add_u32 s40, s62, 332800
 s_add_u32 s40, s40, s28
 buffer_load_dwordx4 v0, s[8:11], s40 offen sc1 lds
 v_mfma_f32_16x16x32_bf16 a[8:11], v[148:151], v[92:95], a[8:11]
 ds_read_b64_tr_b16 v[214:215], v16 offset:36864
 v_accvgpr_read_b32 v25, a224
 v_mfma_f32_16x16x32_bf16 a[12:15], v[148:151], v[124:127], a[12:15]
 v_mov_b32 v7, 0
 v_accvgpr_read_b32 v26, a228
 v_mfma_f32_16x16x32_bf16 a[16:19], v[148:151], v[156:159], a[16:19]
 v_accvgpr_read_b32 v27, a232
 v_accvgpr_read_b32 v28, a236
 v_mfma_f32_16x16x32_bf16 a[20:23], v[148:151], v[188:191], a[20:23]
 v_accvgpr_read_b32 v29, a240
 v_mfma_f32_16x16x32_bf16 a[24:27], v[148:151], v[220:223], a[24:27]
 s_waitcnt lgkmcnt(2)
 v_mfma_f32_16x16x32_bf16 a[28:31], v[180:183], v[244:247], a[28:31]
 ds_read_b64_tr_b16 v[148:149], v17 offset:32768
 v_mfma_f32_16x16x32_bf16 a[32:35], v[180:183], v[60:63], a[32:35]
 v_accvgpr_read_b32 v30, a244
 v_mfma_f32_16x16x32_bf16 a[36:39], v[180:183], v[92:95], a[36:39]
 ds_read_b64_tr_b16 v[150:151], v17 offset:36864
 v_accvgpr_read_b32 v31, a248
 v_mfma_f32_16x16x32_bf16 a[40:43], v[180:183], v[124:127], a[40:43]
 v_min3_u32 v3, v25, v26, v27
 v_max3_u32 v2, v25, v26, v27
 v_mfma_f32_16x16x32_bf16 a[44:47], v[180:183], v[156:159], a[44:47]
 v_min3_u32 v3, v3, v28, v29
 v_max3_u32 v2, v2, v28, v29
 v_mfma_f32_16x16x32_bf16 a[48:51], v[180:183], v[188:191], a[48:51]
 v_min3_u32 v3, v3, v30, v31
 v_max3_u32 v2, v2, v30, v31
 s_mov_b32 s74, 0x5d800000
 v_mfma_f32_16x16x32_bf16 a[52:55], v[180:183], v[220:223], a[52:55]
 s_waitcnt lgkmcnt(2)
 v_cmp_gt_u32 vcc, 0x2b800000, v3
 v_cmp_lt_u32 s[90:91], s74, v2
 v_mfma_f32_16x16x32_bf16 a[56:59], v[212:215], v[244:247], a[56:59]
 ds_read_b64_tr_b16 v[180:181], v18 offset:32768
 v_mfma_f32_16x16x32_bf16 a[60:63], v[212:215], v[60:63], a[60:63]
 v_rcp_f32 v25, v25
 v_mfma_f32_16x16x32_bf16 a[64:67], v[212:215], v[92:95], a[64:67]
 ds_read_b64_tr_b16 v[182:183], v18 offset:36864
 v_mfma_f32_16x16x32_bf16 a[68:71], v[212:215], v[124:127], a[68:71]
 s_mov_b32 s74, 0x06543210
 v_rcp_f32 v26, v26
 v_mfma_f32_16x16x32_bf16 a[72:75], v[212:215], v[156:159], a[72:75]
 s_mov_b32 s75, 0x00654321
 v_rcp_f32 v27, v27
 v_mfma_f32_16x16x32_bf16 a[76:79], v[212:215], v[188:191], a[76:79]
 s_mul_i32 s54, s53, 0
 v_rcp_f32 v28, v28
 v_mfma_f32_16x16x32_bf16 a[80:83], v[212:215], v[220:223], a[80:83]
 s_waitcnt lgkmcnt(2)
 v_rcp_f32 v29, v29
 v_mfma_f32_16x16x32_bf16 a[84:87], v[148:151], v[244:247], a[84:87]
 s_lshr_b64 s[74:75], s[74:75], s54
 ds_read_b64_tr_b16 v[212:213], v19 offset:32768
 v_mfma_f32_16x16x32_bf16 a[88:91], v[148:151], v[60:63], a[88:91]
 s_bfe_u32 s54, s74, 0x30000
 v_rcp_f32 v30, v30
 v_mfma_f32_16x16x32_bf16 a[92:95], v[148:151], v[92:95], a[92:95]
 s_lshl_b32 s84, s54, 10
 ds_read_b64_tr_b16 v[214:215], v19 offset:36864
 v_mfma_f32_16x16x32_bf16 a[96:99], v[148:151], v[124:127], a[96:99]
 s_bfe_u32 s54, s74, 0x30004
 v_rcp_f32 v31, v31
 v_mfma_f32_16x16x32_bf16 a[100:103], v[148:151], v[156:159], a[100:103]
 s_lshl_b32 s85, s54, 10
 v_accvgpr_read_b32 v52, a0
 v_accvgpr_read_b32 v53, a1
 v_mfma_f32_16x16x32_bf16 a[104:107], v[148:151], v[188:191], a[104:107]
 s_bfe_u32 s54, s74, 0x30008
 v_accvgpr_read_b32 v54, a2
 v_accvgpr_read_b32 v55, a3
 v_mfma_f32_16x16x32_bf16 a[108:111], v[148:151], v[220:223], a[108:111]
 s_waitcnt lgkmcnt(2)
 v_accvgpr_read_b32 v84, a28
 v_accvgpr_read_b32 v85, a29
 v_mfma_f32_16x16x32_bf16 a[112:115], v[180:183], v[244:247], a[112:115]
 s_lshl_b32 s86, s54, 10
 ds_read_b64_tr_b16 v[148:149], v20 offset:32768
 v_accvgpr_read_b32 v86, a30
 v_mfma_f32_16x16x32_bf16 a[116:119], v[180:183], v[60:63], a[116:119]
 s_bfe_u32 s54, s74, 0x3000c
 v_accvgpr_read_b32 v87, a31
 v_mul_f32 v52, v25, v52
 v_mfma_f32_16x16x32_bf16 a[120:123], v[180:183], v[92:95], a[120:123]
 s_lshl_b32 s87, s54, 10
 ds_read_b64_tr_b16 v[150:151], v20 offset:36864
 v_mul_f32 v53, v25, v53
 v_mfma_f32_16x16x32_bf16 a[124:127], v[180:183], v[124:127], a[124:127]
 s_bfe_u32 s54, s74, 0x30010
 v_mul_f32 v54, v25, v54
 v_mul_f32 v55, v25, v55
 v_mfma_f32_16x16x32_bf16 a[128:131], v[180:183], v[156:159], a[128:131]
 s_lshl_b32 s96, s54, 10
 v_mul_f32 v84, v25, v84
 v_mul_f32 v85, v25, v85
 v_mfma_f32_16x16x32_bf16 a[132:135], v[180:183], v[188:191], a[132:135]
 s_bfe_u32 s54, s74, 0x30014
 v_mul_f32 v86, v25, v86
 v_mul_f32 v87, v25, v87
 v_mfma_f32_16x16x32_bf16 a[136:139], v[180:183], v[220:223], a[136:139]
 s_waitcnt lgkmcnt(2)
 v_cvt_pk_bf16_f32 v52, v52, v53
 v_cvt_pk_bf16_f32 v53, v54, v55
 v_mfma_f32_16x16x32_bf16 a[140:143], v[212:215], v[244:247], a[140:143]
 s_lshl_b32 s97, s54, 10
 ds_read_b64_tr_b16 v[180:181], v21 offset:32768
 v_cvt_pk_bf16_f32 v54, v84, v85
 v_mfma_f32_16x16x32_bf16 a[144:147], v[212:215], v[60:63], a[144:147]
 s_bfe_u32 s54, s74, 0x30018
 v_cvt_pk_bf16_f32 v55, v86, v87
 s_mov_b32 s41, 0
 v_mfma_f32_16x16x32_bf16 a[148:151], v[212:215], v[92:95], a[148:151]
 s_lshl_b32 s98, s54, 10
 ds_read_b64_tr_b16 v[182:183], v21 offset:36864
 v_mfma_f32_16x16x32_bf16 a[152:155], v[212:215], v[124:127], a[152:155]
 buffer_store_dwordx4 v[52:55], v0, s[24:27], s41 offen sc1
 v_mfma_f32_16x16x32_bf16 a[156:159], v[212:215], v[156:159], a[156:159]
 v_accvgpr_read_b32 v76, a4
 v_accvgpr_read_b32 v77, a5
 v_mfma_f32_16x16x32_bf16 a[160:163], v[212:215], v[188:191], a[160:163]
 v_accvgpr_read_b32 v78, a6
 v_accvgpr_read_b32 v79, a7
 v_mfma_f32_16x16x32_bf16 a[164:167], v[212:215], v[220:223], a[164:167]
 s_waitcnt lgkmcnt(2)
 v_accvgpr_read_b32 v108, a32
 v_accvgpr_read_b32 v109, a33
 v_mfma_f32_16x16x32_bf16 a[168:171], v[148:151], v[244:247], a[168:171]
 v_accvgpr_read_b32 v110, a34
 v_accvgpr_read_b32 v111, a35
 v_mfma_f32_16x16x32_bf16 a[172:175], v[148:151], v[60:63], a[172:175]
 v_mul_f32 v76, v26, v76
 v_mul_f32 v77, v26, v77
 v_mfma_f32_16x16x32_bf16 a[176:179], v[148:151], v[92:95], a[176:179]
 v_mul_f32 v78, v26, v78
 v_mul_f32 v79, v26, v79
 v_mfma_f32_16x16x32_bf16 a[180:183], v[148:151], v[124:127], a[180:183]
 v_mul_f32 v108, v26, v108
 v_mul_f32 v109, v26, v109
 v_mfma_f32_16x16x32_bf16 a[184:187], v[148:151], v[156:159], a[184:187]
 v_mul_f32 v110, v26, v110
 v_mul_f32 v111, v26, v111
 v_mfma_f32_16x16x32_bf16 a[188:191], v[148:151], v[188:191], a[188:191]
 v_cvt_pk_bf16_f32 v76, v76, v77
 v_cvt_pk_bf16_f32 v77, v78, v79
 v_mfma_f32_16x16x32_bf16 a[192:195], v[148:151], v[220:223], a[192:195]
 s_waitcnt lgkmcnt(0)
 v_cvt_pk_bf16_f32 v78, v108, v109
 v_cvt_pk_bf16_f32 v79, v110, v111
 v_mfma_f32_16x16x32_bf16 a[196:199], v[180:183], v[244:247], a[196:199]
 buffer_store_dwordx4 v[76:79], v0, s[24:27], s41 offen offset:1024 sc1
 v_mfma_f32_16x16x32_bf16 a[200:203], v[180:183], v[60:63], a[200:203]
 v_accvgpr_read_b32 v52, a8
 v_accvgpr_read_b32 v53, a9
 v_mfma_f32_16x16x32_bf16 a[204:207], v[180:183], v[92:95], a[204:207]
 v_accvgpr_read_b32 v54, a10
 v_accvgpr_read_b32 v55, a11
 v_mfma_f32_16x16x32_bf16 a[208:211], v[180:183], v[124:127], a[208:211]
 v_accvgpr_read_b32 v84, a36
 v_accvgpr_read_b32 v85, a37
 v_mfma_f32_16x16x32_bf16 a[212:215], v[180:183], v[156:159], a[212:215]
 v_accvgpr_read_b32 v86, a38
 v_accvgpr_read_b32 v87, a39
 v_mfma_f32_16x16x32_bf16 a[216:219], v[180:183], v[188:191], a[216:219]
 v_mul_f32 v52, v27, v52
 v_mul_f32 v53, v27, v53
 v_mfma_f32_16x16x32_bf16 a[220:223], v[180:183], v[220:223], a[220:223]
 v_mul_f32 v54, v27, v54
 v_mul_f32 v55, v27, v55
 s_nop 1
 s_or_b64 s[90:91], vcc, s[90:91]
 s_cbranch_scc1 K1_SLOW
 v_pk_mul_f32 v[84:85], v[26:27], v[84:85] op_sel:[1,0] op_sel_hi:[1,1]
 v_pk_mul_f32 v[86:87], v[26:27], v[86:87] op_sel:[1,0] op_sel_hi:[1,1]
 v_cvt_pk_bf16_f32 v52, v52, v53
 v_cvt_pk_bf16_f32 v53, v54, v55
 v_cvt_pk_bf16_f32 v54, v84, v85
 v_cvt_pk_bf16_f32 v55, v86, v87
 buffer_store_dwordx4 v[52:55], v0, s[24:27], s41 offen offset:2048 sc1
 v_accvgpr_read_b32 v76, a12
 v_accvgpr_read_b32 v77, a13
 v_accvgpr_read_b32 v78, a14
 v_accvgpr_read_b32 v79, a15
 v_accvgpr_read_b32 v108, a40
 v_accvgpr_read_b32 v109, a41
 v_accvgpr_read_b32 v110, a42
 v_accvgpr_read_b32 v111, a43
 v_pk_mul_f32 v[76:77], v[28:29], v[76:77] op_sel_hi:[0,1]
 v_pk_mul_f32 v[78:79], v[28:29], v[78:79] op_sel_hi:[0,1]
 v_pk_mul_f32 v[108:109], v[28:29], v[108:109] op_sel_hi:[0,1]
 v_pk_mul_f32 v[110:111], v[28:29], v[110:111] op_sel_hi:[0,1]
 v_cvt_pk_bf16_f32 v76, v76, v77
 v_cvt_pk_bf16_f32 v77, v78, v79
 v_cvt_pk_bf16_f32 v78, v108, v109
 v_cvt_pk_bf16_f32 v79, v110, v111
 buffer_store_dwordx4 v[76:79], v0, s[24:27], s41 offen offset:3072 sc1
 v_accvgpr_read_b32 v52, a16
 v_accvgpr_read_b32 v53, a17
 v_accvgpr_read_b32 v54, a18
 v_accvgpr_read_b32 v55, a19
 v_accvgpr_read_b32 v84, a44
 v_accvgpr_read_b32 v85, a45
 v_accvgpr_read_b32 v86, a46
 v_accvgpr_read_b32 v87, a47
 v_pk_mul_f32 v[52:53], v[28:29], v[52:53] op_sel:[1,0] op_sel_hi:[1,1]
 v_pk_mul_f32 v[54:55], v[28:29], v[54:55] op_sel:[1,0] op_sel_hi:[1,1]
 v_pk_mul_f32 v[84:85], v[28:29], v[84:85] op_sel:[1,0] op_sel_hi:[1,1]
 v_pk_mul_f32 v[86:87], v[28:29], v[86:87] op_sel:[1,0] op_sel_hi:[1,1]
 v_cvt_pk_bf16_f32 v52, v52, v53
 v_cvt_pk_bf16_f32 v53, v54, v55
 v_cvt_pk_bf16_f32 v54, v84, v85
 v_cvt_pk_bf16_f32 v55, v86, v87
 s_mov_b32 s41, 4096
 buffer_store_dwordx4 v[52:55], v0, s[24:27], s41 offen sc1
 v_accvgpr_read_b32 v76, a20
 v_accvgpr_read_b32 v77, a21
 v_accvgpr_read_b32 v78, a22
 v_accvgpr_read_b32 v79, a23
 v_accvgpr_read_b32 v108, a48
 v_accvgpr_read_b32 v109, a49
 v_accvgpr_read_b32 v110, a50
 v_accvgpr_read_b32 v111, a51
 v_pk_mul_f32 v[76:77], v[30:31], v[76:77] op_sel_hi:[0,1]
 v_pk_mul_f32 v[78:79], v[30:31], v[78:79] op_sel_hi:[0,1]
 v_pk_mul_f32 v[108:109], v[30:31], v[108:109] op_sel_hi:[0,1]
 v_pk_mul_f32 v[110:111], v[30:31], v[110:111] op_sel_hi:[0,1]
 v_cvt_pk_bf16_f32 v76, v76, v77
 v_cvt_pk_bf16_f32 v77, v78, v79
 v_cvt_pk_bf16_f32 v78, v108, v109
 v_cvt_pk_bf16_f32 v79, v110, v111
 buffer_store_dwordx4 v[76:79], v0, s[24:27], s41 offen offset:1024 sc1
 v_accvgpr_read_b32 v52, a24
 v_accvgpr_read_b32 v53, a25
 v_accvgpr_read_b32 v54, a26
 s_branch SK7640
PG7640:
 s_branch RET1
SK7640:
 v_accvgpr_read_b32 v55, a27
 v_accvgpr_read_b32 v84, a52
 v_accvgpr_read_b32 v85, a53
 v_accvgpr_read_b32 v86, a54
 v_accvgpr_read_b32 v87, a55
 v_pk_mul_f32 v[52:53], v[30:31], v[52:53] op_sel:[1,0] op_sel_hi:[1,1]
 v_pk_mul_f32 v[54:55], v[30:31], v[54:55] op_sel:[1,0] op_sel_hi:[1,1]
 v_pk_mul_f32 v[84:85], v[30:31], v[84:85] op_sel:[1,0] op_sel_hi:[1,1]
 v_pk_mul_f32 v[86:87], v[30:31], v[86:87] op_sel:[1,0] op_sel_hi:[1,1]
 v_cvt_pk_bf16_f32 v52, v52, v53
 v_cvt_pk_bf16_f32 v53, v54, v55
 v_cvt_pk_bf16_f32 v54, v84, v85
 v_cvt_pk_bf16_f32 v55, v86, v87
 buffer_store_dwordx4 v[52:55], v0, s[24:27], s41 offen offset:2048 sc1
 v_accvgpr_read_b32 v76, a56
 v_accvgpr_read_b32 v77, a57
 v_accvgpr_read_b32 v78, a58
 v_accvgpr_read_b32 v79, a59
 v_accvgpr_read_b32 v108, a84
 v_accvgpr_read_b32 v109, a85
 v_accvgpr_read_b32 v110, a86
 v_accvgpr_read_b32 v111, a87
 v_pk_mul_f32 v[76:77], v[24:25], v[76:77] op_sel:[1,0] op_sel_hi:[1,1]
 v_pk_mul_f32 v[78:79], v[24:25], v[78:79] op_sel:[1,0] op_sel_hi:[1,1]
 v_pk_mul_f32 v[108:109], v[24:25], v[108:109] op_sel:[1,0] op_sel_hi:[1,1]
 v_pk_mul_f32 v[110:111], v[24:25], v[110:111] op_sel:[1,0] op_sel_hi:[1,1]
 v_cvt_pk_bf16_f32 v76, v76, v77
 v_cvt_pk_bf16_f32 v77, v78, v79
 v_cvt_pk_bf16_f32 v78, v108, v109
 v_cvt_pk_bf16_f32 v79, v110, v111
 s_mov_b32 s41, 229376
 buffer_store_dwordx4 v[76:79], v0, s[24:27], s41 offen sc1
 v_accvgpr_read_b32 v52, a60
 v_accvgpr_read_b32 v53, a61
 v_accvgpr_read_b32 v54, a62
 v_accvgpr_read_b32 v55, a63
 v_accvgpr_read_b32 v84, a88
 v_accvgpr_read_b32 v85, a89
 v_accvgpr_read_b32 v86, a90
 v_accvgpr_read_b32 v87, a91
 v_pk_mul_f32 v[52:53], v[26:27], v[52:53] op_sel_hi:[0,1]
 v_pk_mul_f32 v[54:55], v[26:27], v[54:55] op_sel_hi:[0,1]
 v_pk_mul_f32 v[84:85], v[26:27], v[84:85] op_sel_hi:[0,1]
 v_pk_mul_f32 v[86:87], v[26:27], v[86:87] op_sel_hi:[0,1]
 v_cvt_pk_bf16_f32 v52, v52, v53
 v_cvt_pk_bf16_f32 v53, v54, v55
 v_cvt_pk_bf16_f32 v54, v84, v85
 v_cvt_pk_bf16_f32 v55, v86, v87
 buffer_store_dwordx4 v[52:55], v0, s[24:27], s41 offen offset:1024 sc1
 v_accvgpr_read_b32 v76, a64
 v_accvgpr_read_b32 v77, a65
 v_accvgpr_read_b32 v78, a66
 v_accvgpr_read_b32 v79, a67
 v_accvgpr_read_b32 v108, a92
 v_accvgpr_read_b32 v109, a93
 v_accvgpr_read_b32 v110, a94
 v_accvgpr_read_b32 v111, a95
 v_pk_mul_f32 v[76:77], v[26:27], v[76:77] op_sel:[1,0] op_sel_hi:[1,1]
 v_pk_mul_f32 v[78:79], v[26:27], v[78:79] op_sel:[1,0] op_sel_hi:[1,1]
 v_pk_mul_f32 v[108:109], v[26:27], v[108:109] op_sel:[1,0] op_sel_hi:[1,1]
 v_pk_mul_f32 v[110:111], v[26:27], v[110:111] op_sel:[1,0] op_sel_hi:[1,1]
 v_cvt_pk_bf16_f32 v76, v76, v77
 v_cvt_pk_bf16_f32 v77, v78, v79
 v_cvt_pk_bf16_f32 v78, v108, v109
 v_cvt_pk_bf16_f32 v79, v110, v111
 buffer_store_dwordx4 v[76:79], v0, s[24:27], s41 offen offset:2048 sc1
 v_accvgpr_read_b32 v52, a68
 v_accvgpr_read_b32 v53, a69
 v_accvgpr_read_b32 v54, a70
 v_accvgpr_read_b32 v55, a71
 v_accvgpr_read_b32 v84, a96
 v_accvgpr_read_b32 v85, a97
 v_accvgpr_read_b32 v86, a98
 v_accvgpr_read_b32 v87, a99
 v_pk_mul_f32 v[52:53], v[28:29], v[52:53] op_sel_hi:[0,1]
 v_pk_mul_f32 v[54:55], v[28:29], v[54:55] op_sel_hi:[0,1]
 v_pk_mul_f32 v[84:85], v[28:29], v[84:85] op_sel_hi:[0,1]
 v_pk_mul_f32 v[86:87], v[28:29], v[86:87] op_sel_hi:[0,1]
 v_cvt_pk_bf16_f32 v52, v52, v53
 v_cvt_pk_bf16_f32 v53, v54, v55
 v_cvt_pk_bf16_f32 v54, v84, v85
 v_cvt_pk_bf16_f32 v55, v86, v87
 buffer_store_dwordx4 v[52:55], v0, s[24:27], s41 offen offset:3072 sc1
 v_accvgpr_read_b32 v76, a72
 v_accvgpr_read_b32 v77, a73
 v_accvgpr_read_b32 v78, a74
 v_accvgpr_read_b32 v79, a75
 v_accvgpr_read_b32 v108, a100
 v_accvgpr_read_b32 v109, a101
 v_accvgpr_read_b32 v110, a102
 v_accvgpr_read_b32 v111, a103
 v_pk_mul_f32 v[76:77], v[28:29], v[76:77] op_sel:[1,0] op_sel_hi:[1,1]
 v_pk_mul_f32 v[78:79], v[28:29], v[78:79] op_sel:[1,0] op_sel_hi:[1,1]
 v_pk_mul_f32 v[108:109], v[28:29], v[108:109] op_sel:[1,0] op_sel_hi:[1,1]
 v_pk_mul_f32 v[110:111], v[28:29], v[110:111] op_sel:[1,0] op_sel_hi:[1,1]
 v_cvt_pk_bf16_f32 v76, v76, v77
 v_cvt_pk_bf16_f32 v77, v78, v79
 v_cvt_pk_bf16_f32 v78, v108, v109
 v_cvt_pk_bf16_f32 v79, v110, v111
 s_mov_b32 s41, 233472
 buffer_store_dwordx4 v[76:79], v0, s[24:27], s41 offen sc1
 v_accvgpr_read_b32 v52, a76
 v_accvgpr_read_b32 v53, a77
 v_accvgpr_read_b32 v54, a78
 v_accvgpr_read_b32 v55, a79
 v_accvgpr_read_b32 v84, a104
 v_accvgpr_read_b32 v85, a105
 v_accvgpr_read_b32 v86, a106
 v_accvgpr_read_b32 v87, a107
 v_pk_mul_f32 v[52:53], v[30:31], v[52:53] op_sel_hi:[0,1]
 v_pk_mul_f32 v[54:55], v[30:31], v[54:55] op_sel_hi:[0,1]
 v_pk_mul_f32 v[84:85], v[30:31], v[84:85] op_sel_hi:[0,1]
 v_pk_mul_f32 v[86:87], v[30:31], v[86:87] op_sel_hi:[0,1]
 v_cvt_pk_bf16_f32 v52, v52, v53
 v_cvt_pk_bf16_f32 v53, v54, v55
 v_cvt_pk_bf16_f32 v54, v84, v85
 v_cvt_pk_bf16_f32 v55, v86, v87
 buffer_store_dwordx4 v[52:55], v0, s[24:27], s41 offen offset:1024 sc1
 v_accvgpr_read_b32 v76, a80
 v_accvgpr_read_b32 v77, a81
 v_accvgpr_read_b32 v78, a82
 v_accvgpr_read_b32 v79, a83
 v_accvgpr_read_b32 v108, a108
 v_accvgpr_read_b32 v109, a109
 v_accvgpr_read_b32 v110, a110
 v_accvgpr_read_b32 v111, a111
 v_pk_mul_f32 v[76:77], v[30:31], v[76:77] op_sel:[1,0] op_sel_hi:[1,1]
 v_pk_mul_f32 v[78:79], v[30:31], v[78:79] op_sel:[1,0] op_sel_hi:[1,1]
 v_pk_mul_f32 v[108:109], v[30:31], v[108:109] op_sel:[1,0] op_sel_hi:[1,1]
 v_pk_mul_f32 v[110:111], v[30:31], v[110:111] op_sel:[1,0] op_sel_hi:[1,1]
 v_cvt_pk_bf16_f32 v76, v76, v77
 v_cvt_pk_bf16_f32 v77, v78, v79
 v_cvt_pk_bf16_f32 v78, v108, v109
 v_cvt_pk_bf16_f32 v79, v110, v111
 buffer_store_dwordx4 v[76:79], v0, s[24:27], s41 offen offset:2048 sc1
 v_accvgpr_read_b32 v52, a112
 v_accvgpr_read_b32 v53, a113
 v_accvgpr_read_b32 v54, a114
 v_accvgpr_read_b32 v55, a115
 v_accvgpr_read_b32 v84, a140
 v_accvgpr_read_b32 v85, a141
 v_accvgpr_read_b32 v86, a142
 v_accvgpr_read_b32 v87, a143
 v_pk_mul_f32 v[52:53], v[24:25], v[52:53] op_sel:[1,0] op_sel_hi:[1,1]
 v_pk_mul_f32 v[54:55], v[24:25], v[54:55] op_sel:[1,0] op_sel_hi:[1,1]
 v_pk_mul_f32 v[84:85], v[24:25], v[84:85] op_sel:[1,0] op_sel_hi:[1,1]
 v_pk_mul_f32 v[86:87], v[24:25], v[86:87] op_sel:[1,0] op_sel_hi:[1,1]
 v_cvt_pk_bf16_f32 v52, v52, v53
 v_cvt_pk_bf16_f32 v53, v54, v55
 v_cvt_pk_bf16_f32 v54, v84, v85
 v_cvt_pk_bf16_f32 v55, v86, v87
 s_mov_b32 s41, 458752
 buffer_store_dwordx4 v[52:55], v0, s[24:27], s41 offen sc1
 v_accvgpr_read_b32 v76, a116
 v_accvgpr_read_b32 v77, a117
 v_accvgpr_read_b32 v78, a118
 v_accvgpr_read_b32 v79, a119
 v_accvgpr_read_b32 v108, a144
 v_accvgpr_read_b32 v109, a145
 v_accvgpr_read_b32 v110, a146
 v_accvgpr_read_b32 v111, a147
 v_pk_mul_f32 v[76:77], v[26:27], v[76:77] op_sel_hi:[0,1]
 v_pk_mul_f32 v[78:79], v[26:27], v[78:79] op_sel_hi:[0,1]
 v_pk_mul_f32 v[108:109], v[26:27], v[108:109] op_sel_hi:[0,1]
 v_pk_mul_f32 v[110:111], v[26:27], v[110:111] op_sel_hi:[0,1]
 v_cvt_pk_bf16_f32 v76, v76, v77
 v_cvt_pk_bf16_f32 v77, v78, v79
 v_cvt_pk_bf16_f32 v78, v108, v109
 v_cvt_pk_bf16_f32 v79, v110, v111
 buffer_store_dwordx4 v[76:79], v0, s[24:27], s41 offen offset:1024 sc1
 v_accvgpr_read_b32 v52, a120
 v_accvgpr_read_b32 v53, a121
 v_accvgpr_read_b32 v54, a122
 v_accvgpr_read_b32 v55, a123
 v_accvgpr_read_b32 v84, a148
 v_accvgpr_read_b32 v85, a149
 v_accvgpr_read_b32 v86, a150
 v_accvgpr_read_b32 v87, a151
 v_pk_mul_f32 v[52:53], v[26:27], v[52:53] op_sel:[1,0] op_sel_hi:[1,1]
 v_pk_mul_f32 v[54:55], v[26:27], v[54:55] op_sel:[1,0] op_sel_hi:[1,1]
 v_pk_mul_f32 v[84:85], v[26:27], v[84:85] op_sel:[1,0] op_sel_hi:[1,1]
 v_pk_mul_f32 v[86:87], v[26:27], v[86:87] op_sel:[1,0] op_sel_hi:[1,1]
 v_cvt_pk_bf16_f32 v52, v52, v53
 v_cvt_pk_bf16_f32 v53, v54, v55
 v_cvt_pk_bf16_f32 v54, v84, v85
 v_cvt_pk_bf16_f32 v55, v86, v87
 buffer_store_dwordx4 v[52:55], v0, s[24:27], s41 offen offset:2048 sc1
 v_accvgpr_read_b32 v76, a124
 v_accvgpr_read_b32 v77, a125
 v_accvgpr_read_b32 v78, a126
 v_accvgpr_read_b32 v79, a127
 v_accvgpr_read_b32 v108, a152
 v_accvgpr_read_b32 v109, a153
 v_accvgpr_read_b32 v110, a154
 v_accvgpr_read_b32 v111, a155
 v_pk_mul_f32 v[76:77], v[28:29], v[76:77] op_sel_hi:[0,1]
 v_pk_mul_f32 v[78:79], v[28:29], v[78:79] op_sel_hi:[0,1]
 v_pk_mul_f32 v[108:109], v[28:29], v[108:109] op_sel_hi:[0,1]
 v_pk_mul_f32 v[110:111], v[28:29], v[110:111] op_sel_hi:[0,1]
 v_cvt_pk_bf16_f32 v76, v76, v77
 v_cvt_pk_bf16_f32 v77, v78, v79
 v_cvt_pk_bf16_f32 v78, v108, v109
 v_cvt_pk_bf16_f32 v79, v110, v111
 v_mov_b32 v5, 2
 s_waitcnt vmcnt(10)
 s_mov_b64 exec, 1
 buffer_store_dword v5, v7, s[80:83], s100 offen sc1
 s_mov_b64 exec, -1
 buffer_store_dwordx4 v[76:79], v0, s[24:27], s41 offen offset:3072 sc1
 v_accvgpr_read_b32 v52, a128
 v_accvgpr_read_b32 v53, a129
 v_accvgpr_read_b32 v54, a130
 v_accvgpr_read_b32 v55, a131
 v_accvgpr_read_b32 v84, a156
 v_accvgpr_read_b32 v85, a157
 v_accvgpr_read_b32 v86, a158
 v_accvgpr_read_b32 v87, a159
 v_pk_mul_f32 v[52:53], v[28:29], v[52:53] op_sel:[1,0] op_sel_hi:[1,1]
 v_pk_mul_f32 v[54:55], v[28:29], v[54:55] op_sel:[1,0] op_sel_hi:[1,1]
 v_pk_mul_f32 v[84:85], v[28:29], v[84:85] op_sel:[1,0] op_sel_hi:[1,1]
 v_pk_mul_f32 v[86:87], v[28:29], v[86:87] op_sel:[1,0] op_sel_hi:[1,1]
 v_cvt_pk_bf16_f32 v52, v52, v53
 v_cvt_pk_bf16_f32 v53, v54, v55
 v_cvt_pk_bf16_f32 v54, v84, v85
 v_cvt_pk_bf16_f32 v55, v86, v87
 s_mov_b32 s41, 462848
 buffer_store_dwordx4 v[52:55], v0, s[24:27], s41 offen sc1
 v_accvgpr_read_b32 v76, a132
 v_accvgpr_read_b32 v77, a133
 v_accvgpr_read_b32 v78, a134
 v_accvgpr_read_b32 v79, a135
 v_accvgpr_read_b32 v108, a160
 v_accvgpr_read_b32 v109, a161
 v_accvgpr_read_b32 v110, a162
 v_accvgpr_read_b32 v111, a163
 v_pk_mul_f32 v[76:77], v[30:31], v[76:77] op_sel_hi:[0,1]
 v_pk_mul_f32 v[78:79], v[30:31], v[78:79] op_sel_hi:[0,1]
 v_pk_mul_f32 v[108:109], v[30:31], v[108:109] op_sel_hi:[0,1]
 v_pk_mul_f32 v[110:111], v[30:31], v[110:111] op_sel_hi:[0,1]
 v_cvt_pk_bf16_f32 v76, v76, v77
 v_cvt_pk_bf16_f32 v77, v78, v79
 v_cvt_pk_bf16_f32 v78, v108, v109
 v_cvt_pk_bf16_f32 v79, v110, v111
 buffer_store_dwordx4 v[76:79], v0, s[24:27], s41 offen offset:1024 sc1
 v_accvgpr_read_b32 v52, a136
 v_accvgpr_read_b32 v53, a137
 v_accvgpr_read_b32 v54, a138
 v_accvgpr_read_b32 v55, a139
 v_accvgpr_read_b32 v84, a164
 v_accvgpr_read_b32 v85, a165
 v_accvgpr_read_b32 v86, a166
 v_accvgpr_read_b32 v87, a167
 v_pk_mul_f32 v[52:53], v[30:31], v[52:53] op_sel:[1,0] op_sel_hi:[1,1]
 v_pk_mul_f32 v[54:55], v[30:31], v[54:55] op_sel:[1,0] op_sel_hi:[1,1]
 v_pk_mul_f32 v[84:85], v[30:31], v[84:85] op_sel:[1,0] op_sel_hi:[1,1]
 v_pk_mul_f32 v[86:87], v[30:31], v[86:87] op_sel:[1,0] op_sel_hi:[1,1]
 v_cvt_pk_bf16_f32 v52, v52, v53
 v_cvt_pk_bf16_f32 v53, v54, v55
 v_cvt_pk_bf16_f32 v54, v84, v85
 v_cvt_pk_bf16_f32 v55, v86, v87
 buffer_store_dwordx4 v[52:55], v0, s[24:27], s41 offen offset:2048 sc1
 v_accvgpr_read_b32 v76, a168
 v_accvgpr_read_b32 v77, a169
 v_accvgpr_read_b32 v78, a170
 v_accvgpr_read_b32 v79, a171
 v_accvgpr_read_b32 v108, a196
 v_accvgpr_read_b32 v109, a197
 v_accvgpr_read_b32 v110, a198
 v_accvgpr_read_b32 v111, a199
 v_pk_mul_f32 v[76:77], v[24:25], v[76:77] op_sel:[1,0] op_sel_hi:[1,1]
 v_pk_mul_f32 v[78:79], v[24:25], v[78:79] op_sel:[1,0] op_sel_hi:[1,1]
 v_pk_mul_f32 v[108:109], v[24:25], v[108:109] op_sel:[1,0] op_sel_hi:[1,1]
 v_pk_mul_f32 v[110:111], v[24:25], v[110:111] op_sel:[1,0] op_sel_hi:[1,1]
 v_cvt_pk_bf16_f32 v76, v76, v77
 v_cvt_pk_bf16_f32 v77, v78, v79
 v_cvt_pk_bf16_f32 v78, v108, v109
 v_cvt_pk_bf16_f32 v79, v110, v111
 s_mov_b32 s41, 688128
 buffer_store_dwordx4 v[76:79], v0, s[24:27], s41 offen sc1
 v_accvgpr_read_b32 v52, a172
 v_accvgpr_read_b32 v53, a173
 v_accvgpr_read_b32 v54, a174
 v_accvgpr_read_b32 v55, a175
 v_accvgpr_read_b32 v84, a200
 v_accvgpr_read_b32 v85, a201
 v_accvgpr_read_b32 v86, a202
 v_accvgpr_read_b32 v87, a203
 v_pk_mul_f32 v[52:53], v[26:27], v[52:53] op_sel_hi:[0,1]
 v_pk_mul_f32 v[54:55], v[26:27], v[54:55] op_sel_hi:[0,1]
 v_pk_mul_f32 v[84:85], v[26:27], v[84:85] op_sel_hi:[0,1]
 v_pk_mul_f32 v[86:87], v[26:27], v[86:87] op_sel_hi:[0,1]
 v_cvt_pk_bf16_f32 v52, v52, v53
 s_load_dwordx4 s[44:47], s[80:81], s92 glc
 v_cvt_pk_bf16_f32 v53, v54, v55
 v_cvt_pk_bf16_f32 v54, v84, v85
 v_cvt_pk_bf16_f32 v55, v86, v87
 buffer_store_dwordx4 v[52:55], v0, s[24:27], s41 offen offset:1024 sc1
 v_accvgpr_read_b32 v76, a176
 v_accvgpr_read_b32 v77, a177
 v_accvgpr_read_b32 v78, a178
 v_accvgpr_read_b32 v79, a179
 v_accvgpr_read_b32 v108, a204
 v_accvgpr_read_b32 v109, a205
 v_accvgpr_read_b32 v110, a206
 v_accvgpr_read_b32 v111, a207
 v_pk_mul_f32 v[76:77], v[26:27], v[76:77] op_sel:[1,0] op_sel_hi:[1,1]
 v_pk_mul_f32 v[78:79], v[26:27], v[78:79] op_sel:[1,0] op_sel_hi:[1,1]
 v_pk_mul_f32 v[108:109], v[26:27], v[108:109] op_sel:[1,0] op_sel_hi:[1,1]
 v_pk_mul_f32 v[110:111], v[26:27], v[110:111] op_sel:[1,0] op_sel_hi:[1,1]
 v_cvt_pk_bf16_f32 v76, v76, v77
 v_cvt_pk_bf16_f32 v77, v78, v79
 v_cvt_pk_bf16_f32 v78, v108, v109
 v_cvt_pk_bf16_f32 v79, v110, v111
 buffer_store_dwordx4 v[76:79], v0, s[24:27], s41 offen offset:2048 sc1
 v_accvgpr_read_b32 v52, a180
 v_accvgpr_read_b32 v53, a181
 v_accvgpr_read_b32 v54, a182
 v_accvgpr_read_b32 v55, a183
 v_accvgpr_read_b32 v84, a208
 v_accvgpr_read_b32 v85, a209
 v_accvgpr_read_b32 v86, a210
 v_accvgpr_read_b32 v87, a211
 v_pk_mul_f32 v[52:53], v[28:29], v[52:53] op_sel_hi:[0,1]
 v_pk_mul_f32 v[54:55], v[28:29], v[54:55] op_sel_hi:[0,1]
 v_pk_mul_f32 v[84:85], v[28:29], v[84:85] op_sel_hi:[0,1]
 v_pk_mul_f32 v[86:87], v[28:29], v[86:87] op_sel_hi:[0,1]
 v_cvt_pk_bf16_f32 v52, v52, v53
 v_cvt_pk_bf16_f32 v53, v54, v55
 v_cvt_pk_bf16_f32 v54, v84, v85
 v_cvt_pk_bf16_f32 v55, v86, v87
 v_mov_b32 v5, 3
 s_waitcnt vmcnt(11)
 s_mov_b64 exec, 1
 buffer_store_dword v5, v7, s[80:83], s100 offen sc1
 s_mov_b64 exec, -1
 buffer_store_dwordx4 v[52:55], v0, s[24:27], s41 offen offset:3072 sc1
 v_accvgpr_read_b32 v76, a184
 v_accvgpr_read_b32 v77, a185
 v_accvgpr_read_b32 v78, a186
 v_accvgpr_read_b32 v79, a187
 v_accvgpr_read_b32 v108, a212
 v_accvgpr_read_b32 v109, a213
 v_accvgpr_read_b32 v110, a214
 v_accvgpr_read_b32 v111, a215
 v_pk_mul_f32 v[76:77], v[28:29], v[76:77] op_sel:[1,0] op_sel_hi:[1,1]
 v_pk_mul_f32 v[78:79], v[28:29], v[78:79] op_sel:[1,0] op_sel_hi:[1,1]
 v_pk_mul_f32 v[108:109], v[28:29], v[108:109] op_sel:[1,0] op_sel_hi:[1,1]
 v_pk_mul_f32 v[110:111], v[28:29], v[110:111] op_sel:[1,0] op_sel_hi:[1,1]
 v_cvt_pk_bf16_f32 v76, v76, v77
 v_cvt_pk_bf16_f32 v77, v78, v79
 v_cvt_pk_bf16_f32 v78, v108, v109
 v_cvt_pk_bf16_f32 v79, v110, v111
 s_mov_b32 s41, 692224
 buffer_store_dwordx4 v[76:79], v0, s[24:27], s41 offen sc1
 v_accvgpr_read_b32 v52, a188
 v_accvgpr_read_b32 v53, a189
 v_accvgpr_read_b32 v54, a190
 v_accvgpr_read_b32 v55, a191
 v_accvgpr_read_b32 v84, a216
 v_accvgpr_read_b32 v85, a217
 v_accvgpr_read_b32 v86, a218
 v_accvgpr_read_b32 v87, a219
 v_pk_mul_f32 v[52:53], v[30:31], v[52:53] op_sel_hi:[0,1]
 v_pk_mul_f32 v[54:55], v[30:31], v[54:55] op_sel_hi:[0,1]
 v_pk_mul_f32 v[84:85], v[30:31], v[84:85] op_sel_hi:[0,1]
 v_pk_mul_f32 v[86:87], v[30:31], v[86:87] op_sel_hi:[0,1]
 v_cvt_pk_bf16_f32 v52, v52, v53
 v_cvt_pk_bf16_f32 v53, v54, v55
 v_cvt_pk_bf16_f32 v54, v84, v85
 v_cvt_pk_bf16_f32 v55, v86, v87
 buffer_store_dwordx4 v[52:55], v0, s[24:27], s41 offen offset:1024 sc1
 v_accvgpr_read_b32 v76, a192
 v_accvgpr_read_b32 v77, a193
 v_accvgpr_read_b32 v78, a194
 v_accvgpr_read_b32 v79, a195
 v_accvgpr_read_b32 v108, a220
 v_accvgpr_read_b32 v109, a221
 v_accvgpr_read_b32 v110, a222
 v_accvgpr_read_b32 v111, a223
 v_pk_mul_f32 v[76:77], v[30:31], v[76:77] op_sel:[1,0] op_sel_hi:[1,1]
 v_pk_mul_f32 v[78:79], v[30:31], v[78:79] op_sel:[1,0] op_sel_hi:[1,1]
 v_pk_mul_f32 v[108:109], v[30:31], v[108:109] op_sel:[1,0] op_sel_hi:[1,1]
 v_pk_mul_f32 v[110:111], v[30:31], v[110:111] op_sel:[1,0] op_sel_hi:[1,1]
 v_cvt_pk_bf16_f32 v76, v76, v77
 v_cvt_pk_bf16_f32 v77, v78, v79
 v_cvt_pk_bf16_f32 v78, v108, v109
 v_cvt_pk_bf16_f32 v79, v110, v111
 buffer_store_dwordx4 v[76:79], v0, s[24:27], s41 offen offset:2048 sc1
K1_DONE:
 v_add_u32 v208, s57, v0
 v_add_u32 v209, 0x10000, v208
 v_add_u32 v210, 0x20000, v208
 ds_read_b128 v[144:147], v208 offset:8192
 ds_read_b128 v[184:187], v208 offset:33792
 ds_read_b128 v[152:155], v208 offset:9216
 ds_read_b128 v[192:195], v208 offset:34816
 ds_read_b128 v[160:163], v208 offset:10240
 ds_read_b128 v[36:39], v208 offset:35840
 ds_read_b128 v[168:171], v208 offset:11264
 ds_read_b128 v[68:71], v208 offset:40960
 ds_read_b128 v[176:179], v208 offset:32768
 ds_read_b128 v[100:103], v208 offset:41984
 s_waitcnt lgkmcnt(0)
 s_min_u32 s55, s44, s46
 s_cmp_ge_u32 s55, 2
 s_cbranch_scc0 P2_SPINa
P2_GOa:
 s_load_dwordx4 s[44:47], s[80:81], s92 glc
 s_add_u32 s48, s58, 0
 s_add_u32 s40, s48, s84
 buffer_load_dwordx4 v[32:35], v0, s[4:7], s40 offen sc1
 s_add_u32 s49, s58, 7168
 s_add_u32 s40, s49, s84
 buffer_load_dwordx4 v[88:91], v0, s[4:7], s40 offen sc1
 s_add_u32 s40, s48, s85
 buffer_load_dwordx4 v[40:43], v0, s[4:7], s40 offen sc1
 s_add_u32 s40, s49, s85
 buffer_load_dwordx4 v[96:99], v0, s[4:7], s40 offen sc1
 s_add_u32 s40, s48, s86
 buffer_load_dwordx4 v[48:51], v0, s[4:7], s40 offen sc1
 s_add_u32 s40, s49, s86
 buffer_load_dwordx4 v[104:107], v0, s[4:7], s40 offen sc1
 s_add_u32 s40, s48, s87
 buffer_load_dwordx4 v[56:59], v0, s[4:7], s40 offen sc1
 s_add_u32 s40, s49, s87
 buffer_load_dwordx4 v[112:115], v0, s[4:7], s40 offen sc1
 s_add_u32 s40, s48, s96
 buffer_load_dwordx4 v[64:67], v0, s[4:7], s40 offen sc1
 s_add_u32 s40, s49, s96
 buffer_load_dwordx4 v[120:123], v0, s[4:7], s40 offen sc1
 s_add_u32 s40, s48, s97
 buffer_load_dwordx4 v[72:75], v0, s[4:7], s40 offen sc1
 s_add_u32 s40, s49, s97
 buffer_load_dwordx4 v[128:131], v0, s[4:7], s40 offen sc1
 s_add_u32 s40, s48, s98
 buffer_load_dwordx4 v[80:83], v0, s[4:7], s40 offen sc1
 s_add_u32 s40, s49, s98
 buffer_load_dwordx4 v[136:139], v0, s[4:7], s40 offen sc1
 s_waitcnt lgkmcnt(0)
 s_min_u32 s55, s44, s46
 s_cmp_ge_u32 s55, 3
 s_cbranch_scc0 P2_SPINb
P2_GOb:
 s_cmp_eq_u32 s36, 0
 s_cbranch_scc1 C2_0
 s_cmp_eq_u32 s36, 1
 s_cbranch_scc1 C2_1
 s_cmp_eq_u32 s36, 2
 s_cbranch_scc1 C2_2
 s_branch C2_3
RET2:
 s_waitcnt vmcnt(12) lgkmcnt(8)
 v_mfma_f32_16x16x32_bf16 a[0:3], v[144:147], v[32:35], 0
 v_mov_b32 v5, 5
 v_mfma_f32_16x16x32_bf16 a[0:3], v[184:187], v[88:91], a[0:3]
 s_waitcnt vmcnt(10)
 s_mov_b64 exec, 1
 buffer_store_dword v5, v7, s[80:83], s100 offen sc1
 s_mov_b64 exec, -1
 s_nop 3
 v_mfma_f32_16x16x32_bf16 a[4:7], v[144:147], v[40:43], 0
 s_add_u32 s48, s58, 229376
 s_add_u32 s40, s48, s84
 buffer_load_dwordx4 v[8:11], v0, s[4:7], s40 offen sc1
 v_mfma_f32_16x16x32_bf16 a[4:7], v[184:187], v[96:99], a[4:7]
 s_waitcnt vmcnt(10)
 s_add_u32 s49, s58, 236544
 s_add_u32 s40, s49, s84
 buffer_load_dwordx4 v[52:55], v0, s[4:7], s40 offen sc1
 v_mfma_f32_16x16x32_bf16 a[8:11], v[144:147], v[48:51], 0
 s_add_u32 s40, s48, s85
 buffer_load_dwordx4 v[12:15], v0, s[4:7], s40 offen sc1
 v_mfma_f32_16x16x32_bf16 a[8:11], v[184:187], v[104:107], a[8:11]
 s_waitcnt vmcnt(10)
 s_add_u32 s40, s49, s85
 buffer_load_dwordx4 v[60:63], v0, s[4:7], s40 offen sc1
 v_mfma_f32_16x16x32_bf16 a[12:15], v[144:147], v[56:59], 0
 s_add_u32 s40, s48, s86
 buffer_load_dwordx4 v[16:19], v0, s[4:7], s40 offen sc1
 v_mfma_f32_16x16x32_bf16 a[12:15], v[184:187], v[112:115], a[12:15]
 s_waitcnt vmcnt(10)
 s_add_u32 s40, s49, s86
 buffer_load_dwordx4 v[76:79], v0, s[4:7], s40 offen sc1
 v_mfma_f32_16x16x32_bf16 a[16:19], v[144:147], v[64:67], 0
 s_add_u32 s40, s48, s87
 buffer_load_dwordx4 v[20:23], v0, s[4:7], s40 offen sc1
 v_mfma_f32_16x16x32_bf16 a[16:19], v[184:187], v[120:123], a[16:19]
 s_waitcnt vmcnt(10)
 s_add_u32 s40, s49, s87
 buffer_load_dwordx4 v[84:87], v0, s[4:7], s40 offen sc1
 v_mfma_f32_16x16x32_bf16 a[20:23], v[144:147], v[72:75], 0
 s_add_u32 s40, s48, s96
 buffer_load_dwordx4 v[24:27], v0, s[4:7], s40 offen sc1
 v_mfma_f32_16x16x32_bf16 a[20:23], v[184:187], v[128:131], a[20:23]
 s_waitcnt vmcnt(10)
 s_add_u32 s40, s49, s96
 buffer_load_dwordx4 v[92:95], v0, s[4:7], s40 offen sc1
 v_mfma_f32_16x16x32_bf16 a[24:27], v[144:147], v[80:83], 0
 s_add_u32 s40, s48, s97
 buffer_load_dwordx4 v[28:31], v0, s[4:7], s40 offen sc1
 v_mfma_f32_16x16x32_bf16 a[24:27], v[184:187], v[136:139], a[24:27]
 s_add_u32 s40, s49, s97
 buffer_load_dwordx4 v[108:111], v0, s[4:7], s40 offen sc1
 v_mfma_f32_16x16x32_bf16 a[28:31], v[152:155], v[32:35], 0
 s_add_u32 s40, s48, s98
 buffer_load_dwordx4 v[44:47], v0, s[4:7], s40 offen sc1
 v_mfma_f32_16x16x32_bf16 a[28:31], v[192:195], v[88:91], a[28:31]
 s_add_u32 s40, s49, s98
 buffer_load_dwordx4 v[116:119], v0, s[4:7], s40 offen sc1
 v_mfma_f32_16x16x32_bf16 a[32:35], v[152:155], v[40:43], 0
 s_load_dwordx4 s[44:47], s[80:81], s92 glc
 v_mfma_f32_16x16x32_bf16 a[32:35], v[192:195], v[96:99], a[32:35]
 v_mfma_f32_16x16x32_bf16 a[36:39], v[152:155], v[48:51], 0
 v_mfma_f32_16x16x32_bf16 a[36:39], v[192:195], v[104:107], a[36:39]
 v_mfma_f32_16x16x32_bf16 a[40:43], v[152:155], v[56:59], 0
 v_mfma_f32_16x16x32_bf16 a[40:43], v[192:195], v[112:115], a[40:43]
 v_mfma_f32_16x16x32_bf16 a[44:47], v[152:155], v[64:67], 0
 v_mfma_f32_16x16x32_bf16 a[44:47], v[192:195], v[120:123], a[44:47]
 v_mfma_f32_16x16x32_bf16 a[48:51], v[152:155], v[72:75], 0
 v_mfma_f32_16x16x32_bf16 a[48:51], v[192:195], v[128:131], a[48:51]
 v_mfma_f32_16x16x32_bf16 a[52:55], v[152:155], v[80:83], 0
 v_mfma_f32_16x16x32_bf16 a[52:55], v[192:195], v[136:139], a[52:55]
 v_mfma_f32_16x16x32_bf16 a[56:59], v[160:163], v[32:35], 0
 v_mfma_f32_16x16x32_bf16 a[56:59], v[36:39], v[88:91], a[56:59]
 v_mfma_f32_16x16x32_bf16 a[60:63], v[160:163], v[40:43], 0
 v_mfma_f32_16x16x32_bf16 a[60:63], v[36:39], v[96:99], a[60:63]
 v_mfma_f32_16x16x32_bf16 a[64:67], v[160:163], v[48:51], 0
 v_mfma_f32_16x16x32_bf16 a[64:67], v[36:39], v[104:107], a[64:67]
 v_mfma_f32_16x16x32_bf16 a[68:71], v[160:163], v[56:59], 0
 v_mfma_f32_16x16x32_bf16 a[68:71], v[36:39], v[112:115], a[68:71]
 v_mfma_f32_16x16x32_bf16 a[72:75], v[160:163], v[64:67], 0
 v_mfma_f32_16x16x32_bf16 a[72:75], v[36:39], v[120:123], a[72:75]
 v_mfma_f32_16x16x32_bf16 a[76:79], v[160:163], v[72:75], 0
 v_mfma_f32_16x16x32_bf16 a[76:79], v[36:39], v[128:131], a[76:79]
 v_mfma_f32_16x16x32_bf16 a[80:83], v[160:163], v[80:83], 0
 s_waitcnt lgkmcnt(0)
 s_min_u32 s55, s44, s46
 s_cmp_ge_u32 s55, 5
 s_cbranch_scc0 P2_SPINc
P2_GOc:
 v_mfma_f32_16x16x32_bf16 a[80:83], v[36:39], v[136:139], a[80:83]
 s_add_u32 s48, s58, 458752
 s_add_u32 s40, s48, s84
 buffer_load_dwordx4 a[140:143], v0, s[4:7], s40 offen sc1
 v_mfma_f32_16x16x32_bf16 a[84:87], v[168:171], v[32:35], 0
 s_add_u32 s49, s58, 465920
 s_add_u32 s40, s49, s84
 buffer_load_dwordx4 a[168:171], v0, s[4:7], s40 offen sc1
 v_mfma_f32_16x16x32_bf16 a[84:87], v[68:71], v[88:91], a[84:87]
 s_branch SK8190
C2_0:
PG8190:
 s_branch PG10553
SK8190:
 s_add_u32 s40, s48, s85
 buffer_load_dwordx4 a[144:147], v0, s[4:7], s40 offen sc1
 v_mfma_f32_16x16x32_bf16 a[88:91], v[168:171], v[40:43], 0
 s_add_u32 s40, s49, s85
 buffer_load_dwordx4 a[172:175], v0, s[4:7], s40 offen sc1
 v_mfma_f32_16x16x32_bf16 a[88:91], v[68:71], v[96:99], a[88:91]
 s_add_u32 s40, s48, s86
 buffer_load_dwordx4 a[148:151], v0, s[4:7], s40 offen sc1
 v_mfma_f32_16x16x32_bf16 a[92:95], v[168:171], v[48:51], 0
 s_add_u32 s40, s49, s86
 buffer_load_dwordx4 a[176:179], v0, s[4:7], s40 offen sc1
 v_mfma_f32_16x16x32_bf16 a[92:95], v[68:71], v[104:107], a[92:95]
 s_add_u32 s40, s48, s87
 buffer_load_dwordx4 a[152:155], v0, s[4:7], s40 offen sc1
 v_mfma_f32_16x16x32_bf16 a[96:99], v[168:171], v[56:59], 0
 s_add_u32 s40, s49, s87
 buffer_load_dwordx4 a[180:183], v0, s[4:7], s40 offen sc1
 v_mfma_f32_16x16x32_bf16 a[96:99], v[68:71], v[112:115], a[96:99]
 s_add_u32 s40, s48, s96
 buffer_load_dwordx4 a[156:159], v0, s[4:7], s40 offen sc1
 v_mfma_f32_16x16x32_bf16 a[100:103], v[168:171], v[64:67], 0
 s_add_u32 s40, s49, s96
 buffer_load_dwordx4 a[184:187], v0, s[4:7], s40 offen sc1
 v_mfma_f32_16x16x32_bf16 a[100:103], v[68:71], v[120:123], a[100:103]
 s_add_u32 s40, s48, s97
 buffer_load_dwordx4 a[160:163], v0, s[4:7], s40 offen sc1
 v_mfma_f32_16x16x32_bf16 a[104:107], v[168:171], v[72:75], 0
 s_add_u32 s40, s49, s97
 buffer_load_dwordx4 a[188:191], v0, s[4:7], s40 offen sc1
 v_mfma_f32_16x16x32_bf16 a[104:107], v[68:71], v[128:131], a[104:107]
 s_add_u32 s40, s48, s98
 buffer_load_dwordx4 a[164:167], v0, s[4:7], s40 offen sc1
 v_mfma_f32_16x16x32_bf16 a[108:111], v[168:171], v[80:83], 0
 s_add_u32 s40, s49, s98
 buffer_load_dwordx4 a[192:195], v0, s[4:7], s40 offen sc1
 v_mfma_f32_16x16x32_bf16 a[108:111], v[68:71], v[136:139], a[108:111]
 v_mfma_f32_16x16x32_bf16 a[112:115], v[176:179], v[32:35], 0
 v_mfma_f32_16x16x32_bf16 a[112:115], v[100:103], v[88:91], a[112:115]
 v_mfma_f32_16x16x32_bf16 a[116:119], v[176:179], v[40:43], 0
 ds_read_b128 v[124:127], v208 offset:43008
 v_mfma_f32_16x16x32_bf16 a[116:119], v[100:103], v[96:99], a[116:119]
 ds_read_b128 v[164:167], v209 offset:44032
 v_mfma_f32_16x16x32_bf16 a[120:123], v[176:179], v[48:51], 0
 ds_read_b128 v[132:135], v208 offset:44032
 v_mfma_f32_16x16x32_bf16 a[120:123], v[100:103], v[104:107], a[120:123]
 ds_read_b128 v[172:175], v210 offset:0
 v_mfma_f32_16x16x32_bf16 a[124:127], v[176:179], v[56:59], 0
 ds_read_b128 v[140:143], v209 offset:40960
 v_mfma_f32_16x16x32_bf16 a[124:127], v[100:103], v[112:115], a[124:127]
 ds_read_b128 v[180:183], v210 offset:1024
 v_mfma_f32_16x16x32_bf16 a[128:131], v[176:179], v[64:67], 0
 ds_read_b128 v[148:151], v209 offset:41984
 v_mfma_f32_16x16x32_bf16 a[128:131], v[100:103], v[120:123], a[128:131]
 ds_read_b128 v[188:191], v210 offset:2048
 v_mfma_f32_16x16x32_bf16 a[132:135], v[176:179], v[72:75], 0
 ds_read_b128 v[156:159], v209 offset:43008
 v_mfma_f32_16x16x32_bf16 a[132:135], v[100:103], v[128:131], a[132:135]
 ds_read_b128 v[196:199], v210 offset:3072
 v_mfma_f32_16x16x32_bf16 a[136:139], v[176:179], v[80:83], 0
 v_mfma_f32_16x16x32_bf16 a[136:139], v[100:103], v[136:139], a[136:139]
 s_waitcnt vmcnt(26) lgkmcnt(8)
 v_mfma_f32_16x16x32_bf16 a[0:3], v[124:127], v[8:11], a[0:3]
 s_add_u32 s50, s62, 491520
 s_add_u32 s40, s50, s20
 buffer_load_dwordx4 v[144:147], v0, s[8:11], s40 offen sc1
 v_mfma_f32_16x16x32_bf16 a[0:3], v[164:167], v[52:55], a[0:3]
 s_waitcnt vmcnt(25)
 v_mfma_f32_16x16x32_bf16 a[4:7], v[124:127], v[12:15], a[4:7]
 v_mfma_f32_16x16x32_bf16 a[4:7], v[164:167], v[60:63], a[4:7]
 s_waitcnt vmcnt(23)
 s_add_u32 s51, s62, 496640
 s_add_u32 s40, s51, s20
 buffer_load_dwordx4 v[184:187], v0, s[8:11], s40 offen sc1
 v_mfma_f32_16x16x32_bf16 a[8:11], v[124:127], v[16:19], a[8:11]
 v_mfma_f32_16x16x32_bf16 a[8:11], v[164:167], v[76:79], a[8:11]
 s_waitcnt vmcnt(22)
 v_mfma_f32_16x16x32_bf16 a[12:15], v[124:127], v[20:23], a[12:15]
 s_add_u32 s48, s58, 688128
 s_add_u32 s40, s48, s84
 buffer_load_dwordx4 v[32:35], v0, s[4:7], s40 offen sc1
 v_mfma_f32_16x16x32_bf16 a[12:15], v[164:167], v[84:87], a[12:15]
 s_waitcnt vmcnt(21)
 v_mfma_f32_16x16x32_bf16 a[16:19], v[124:127], v[24:27], a[16:19]
 v_mfma_f32_16x16x32_bf16 a[16:19], v[164:167], v[92:95], a[16:19]
 s_waitcnt vmcnt(19)
 s_add_u32 s49, s58, 695296
 s_add_u32 s40, s49, s84
 buffer_load_dwordx4 v[88:91], v0, s[4:7], s40 offen sc1
 v_mfma_f32_16x16x32_bf16 a[20:23], v[124:127], v[28:31], a[20:23]
 v_mfma_f32_16x16x32_bf16 a[20:23], v[164:167], v[108:111], a[20:23]
 s_waitcnt vmcnt(18)
 v_mfma_f32_16x16x32_bf16 a[24:27], v[124:127], v[44:47], a[24:27]
 s_add_u32 s40, s48, s85
 buffer_load_dwordx4 v[40:43], v0, s[4:7], s40 offen sc1
 v_mfma_f32_16x16x32_bf16 a[24:27], v[164:167], v[116:119], a[24:27]
 s_waitcnt lgkmcnt(6)
 v_mfma_f32_16x16x32_bf16 a[28:31], v[132:135], v[8:11], a[28:31]
 v_mfma_f32_16x16x32_bf16 a[28:31], v[172:175], v[52:55], a[28:31]
 s_add_u32 s40, s49, s85
 buffer_load_dwordx4 v[96:99], v0, s[4:7], s40 offen sc1
 v_mfma_f32_16x16x32_bf16 a[32:35], v[132:135], v[12:15], a[32:35]
 v_mfma_f32_16x16x32_bf16 a[32:35], v[172:175], v[60:63], a[32:35]
 v_mfma_f32_16x16x32_bf16 a[36:39], v[132:135], v[16:19], a[36:39]
 s_add_u32 s40, s48, s86
 buffer_load_dwordx4 v[48:51], v0, s[4:7], s40 offen sc1
 v_mfma_f32_16x16x32_bf16 a[36:39], v[172:175], v[76:79], a[36:39]
 v_mfma_f32_16x16x32_bf16 a[40:43], v[132:135], v[20:23], a[40:43]
 v_mfma_f32_16x16x32_bf16 a[40:43], v[172:175], v[84:87], a[40:43]
 s_add_u32 s40, s49, s86
 buffer_load_dwordx4 v[104:107], v0, s[4:7], s40 offen sc1
 v_mfma_f32_16x16x32_bf16 a[44:47], v[132:135], v[24:27], a[44:47]
 v_mfma_f32_16x16x32_bf16 a[44:47], v[172:175], v[92:95], a[44:47]
 v_mfma_f32_16x16x32_bf16 a[48:51], v[132:135], v[28:31], a[48:51]
 s_add_u32 s40, s48, s87
 buffer_load_dwordx4 v[56:59], v0, s[4:7], s40 offen sc1
 v_mfma_f32_16x16x32_bf16 a[48:51], v[172:175], v[108:111], a[48:51]
 v_mfma_f32_16x16x32_bf16 a[52:55], v[132:135], v[44:47], a[52:55]
 v_mfma_f32_16x16x32_bf16 a[52:55], v[172:175], v[116:119], a[52:55]
 s_waitcnt lgkmcnt(4)
 s_add_u32 s40, s49, s87
 buffer_load_dwordx4 v[112:115], v0, s[4:7], s40 offen sc1
 v_mfma_f32_16x16x32_bf16 a[56:59], v[140:143], v[8:11], a[56:59]
 v_mfma_f32_16x16x32_bf16 a[56:59], v[180:183], v[52:55], a[56:59]
 v_mfma_f32_16x16x32_bf16 a[60:63], v[140:143], v[12:15], a[60:63]
 s_load_dwordx4 s[44:47], s[80:81], s93 glc
 s_add_u32 s40, s48, s96
 buffer_load_dwordx4 v[64:67], v0, s[4:7], s40 offen sc1
 v_mfma_f32_16x16x32_bf16 a[60:63], v[180:183], v[60:63], a[60:63]
 v_mfma_f32_16x16x32_bf16 a[64:67], v[140:143], v[16:19], a[64:67]
 v_mfma_f32_16x16x32_bf16 a[64:67], v[180:183], v[76:79], a[64:67]
 s_add_u32 s40, s49, s96
 buffer_load_dwordx4 v[120:123], v0, s[4:7], s40 offen sc1
 v_mfma_f32_16x16x32_bf16 a[68:71], v[140:143], v[20:23], a[68:71]
 v_mfma_f32_16x16x32_bf16 a[68:71], v[180:183], v[84:87], a[68:71]
 v_mfma_f32_16x16x32_bf16 a[72:75], v[140:143], v[24:27], a[72:75]
 s_add_u32 s40, s48, s97
 buffer_load_dwordx4 v[72:75], v0, s[4:7], s40 offen sc1
 v_mfma_f32_16x16x32_bf16 a[72:75], v[180:183], v[92:95], a[72:75]
 v_mfma_f32_16x16x32_bf16 a[76:79], v[140:143], v[28:31], a[76:79]
 v_mfma_f32_16x16x32_bf16 a[76:79], v[180:183], v[108:111], a[76:79]
 s_add_u32 s40, s49, s97
 buffer_load_dwordx4 v[128:131], v0, s[4:7], s40 offen sc1
 v_mfma_f32_16x16x32_bf16 a[80:83], v[140:143], v[44:47], a[80:83]
 v_mfma_f32_16x16x32_bf16 a[80:83], v[180:183], v[116:119], a[80:83]
 s_waitcnt lgkmcnt(2)
 v_mfma_f32_16x16x32_bf16 a[84:87], v[148:151], v[8:11], a[84:87]
 s_add_u32 s40, s48, s98
 buffer_load_dwordx4 v[80:83], v0, s[4:7], s40 offen sc1
 v_mfma_f32_16x16x32_bf16 a[84:87], v[188:191], v[52:55], a[84:87]
 v_mfma_f32_16x16x32_bf16 a[88:91], v[148:151], v[12:15], a[88:91]
 v_mfma_f32_16x16x32_bf16 a[88:91], v[188:191], v[60:63], a[88:91]
 s_add_u32 s40, s49, s98
 buffer_load_dwordx4 v[136:139], v0, s[4:7], s40 offen sc1
 v_mfma_f32_16x16x32_bf16 a[92:95], v[148:151], v[16:19], a[92:95]
 v_mfma_f32_16x16x32_bf16 a[92:95], v[188:191], v[76:79], a[92:95]
 v_mfma_f32_16x16x32_bf16 a[96:99], v[148:151], v[20:23], a[96:99]
 s_add_u32 s40, s50, s21
 buffer_load_dwordx4 v[152:155], v0, s[8:11], s40 offen sc1
 v_mfma_f32_16x16x32_bf16 a[96:99], v[188:191], v[84:87], a[96:99]
 v_mfma_f32_16x16x32_bf16 a[100:103], v[148:151], v[24:27], a[100:103]
 v_mfma_f32_16x16x32_bf16 a[100:103], v[188:191], v[92:95], a[100:103]
 s_add_u32 s40, s51, s21
 buffer_load_dwordx4 v[192:195], v0, s[8:11], s40 offen sc1
 v_mfma_f32_16x16x32_bf16 a[104:107], v[148:151], v[28:31], a[104:107]
 v_mfma_f32_16x16x32_bf16 a[104:107], v[188:191], v[108:111], a[104:107]
 v_mfma_f32_16x16x32_bf16 a[108:111], v[148:151], v[44:47], a[108:111]
 s_add_u32 s40, s50, s22
 buffer_load_dwordx4 v[160:163], v0, s[8:11], s40 offen sc1
 v_mfma_f32_16x16x32_bf16 a[108:111], v[188:191], v[116:119], a[108:111]
 s_waitcnt lgkmcnt(0)
 v_mfma_f32_16x16x32_bf16 a[112:115], v[156:159], v[8:11], a[112:115]
 v_mfma_f32_16x16x32_bf16 a[112:115], v[196:199], v[52:55], a[112:115]
 s_add_u32 s40, s51, s22
 buffer_load_dwordx4 v[36:39], v0, s[8:11], s40 offen sc1
 v_mfma_f32_16x16x32_bf16 a[116:119], v[156:159], v[12:15], a[116:119]
 ds_read_b128 a[196:199], v209 offset:0
 v_mfma_f32_16x16x32_bf16 a[116:119], v[196:199], v[60:63], a[116:119]
 ds_read_b128 a[216:219], v208 offset:1024
 v_mfma_f32_16x16x32_bf16 a[120:123], v[156:159], v[16:19], a[120:123]
 ds_read_b128 a[200:203], v209 offset:1024
 s_add_u32 s40, s50, s23
 buffer_load_dwordx4 v[168:171], v0, s[8:11], s40 offen sc1
 v_mfma_f32_16x16x32_bf16 a[120:123], v[196:199], v[76:79], a[120:123]
 ds_read_b128 a[220:223], v208 offset:2048
 v_mfma_f32_16x16x32_bf16 a[124:127], v[156:159], v[20:23], a[124:127]
 ds_read_b128 a[204:207], v209 offset:2048
 v_mfma_f32_16x16x32_bf16 a[124:127], v[196:199], v[84:87], a[124:127]
 ds_read_b128 a[224:227], v208 offset:3072
 s_add_u32 s40, s51, s23
 buffer_load_dwordx4 v[68:71], v0, s[8:11], s40 offen sc1
 v_mfma_f32_16x16x32_bf16 a[128:131], v[156:159], v[24:27], a[128:131]
 ds_read_b128 a[208:211], v209 offset:3072
 v_mfma_f32_16x16x32_bf16 a[128:131], v[196:199], v[92:95], a[128:131]
 ds_read_b128 a[228:231], v209 offset:8192
 v_mfma_f32_16x16x32_bf16 a[132:135], v[156:159], v[28:31], a[132:135]
 ds_read_b128 a[212:215], v208 offset:0
 s_add_u32 s40, s50, s28
 buffer_load_dwordx4 v[176:179], v0, s[8:11], s40 offen sc1
 v_mfma_f32_16x16x32_bf16 a[132:135], v[196:199], v[108:111], a[132:135]
 ds_read_b128 a[232:235], v209 offset:9216
 v_mfma_f32_16x16x32_bf16 a[136:139], v[156:159], v[44:47], a[136:139]
 v_mfma_f32_16x16x32_bf16 a[136:139], v[196:199], v[116:119], a[136:139]
 s_add_u32 s40, s51, s28
 buffer_load_dwordx4 v[100:103], v0, s[8:11], s40 offen sc1
 s_waitcnt vmcnt(36) lgkmcnt(8)
 v_mfma_f32_16x16x32_bf16 a[0:3], a[196:199], a[140:143], a[0:3]
 s_waitcnt lgkmcnt(0)
 s_min_u32 s55, s44, s46
 s_cmp_ge_u32 s55, 5
 s_cbranch_scc0 P2_SPIN2
P2_GO2:
 s_add_u32 s50, s63, 0
 s_add_u32 s40, s50, s20
 buffer_load_dwordx4 v[124:127], v0, s[8:11], s40 offen sc1
 v_mfma_f32_16x16x32_bf16 a[0:3], a[216:219], a[168:171], a[0:3]
 s_waitcnt vmcnt(35)
 v_mfma_f32_16x16x32_bf16 a[4:7], a[196:199], a[144:147], a[4:7]
 v_mfma_f32_16x16x32_bf16 a[4:7], a[216:219], a[172:175], a[4:7]
 s_waitcnt vmcnt(33)
 s_add_u32 s51, s63, 5120
 s_add_u32 s40, s51, s20
 buffer_load_dwordx4 v[164:167], v0, s[8:11], s40 offen sc1
 v_mfma_f32_16x16x32_bf16 a[8:11], a[196:199], a[148:151], a[8:11]
 v_mfma_f32_16x16x32_bf16 a[8:11], a[216:219], a[176:179], a[8:11]
 s_waitcnt vmcnt(32)
 v_mfma_f32_16x16x32_bf16 a[12:15], a[196:199], a[152:155], a[12:15]
 s_add_u32 s48, s59, 0
 s_add_u32 s40, s48, s84
 buffer_load_dwordx4 v[8:11], v0, s[4:7], s40 offen sc1
 v_mfma_f32_16x16x32_bf16 a[12:15], a[216:219], a[180:183], a[12:15]
 s_waitcnt vmcnt(31)
 v_mfma_f32_16x16x32_bf16 a[16:19], a[196:199], a[156:159], a[16:19]
 v_mfma_f32_16x16x32_bf16 a[16:19], a[216:219], a[184:187], a[16:19]
 s_waitcnt vmcnt(29)
 s_add_u32 s49, s59, 7168
 s_add_u32 s40, s49, s84
 buffer_load_dwordx4 v[52:55], v0, s[4:7], s40 offen sc1
 v_mfma_f32_16x16x32_bf16 a[20:23], a[196:199], a[160:163], a[20:23]
 v_mfma_f32_16x16x32_bf16 a[20:23], a[216:219], a[188:191], a[20:23]
 s_waitcnt vmcnt(28)
 v_mfma_f32_16x16x32_bf16 a[24:27], a[196:199], a[164:167], a[24:27]
 s_add_u32 s40, s48, s85
 buffer_load_dwordx4 v[12:15], v0, s[4:7], s40 offen sc1
 v_mfma_f32_16x16x32_bf16 a[24:27], a[216:219], a[192:195], a[24:27]
 s_waitcnt lgkmcnt(6)
 v_mfma_f32_16x16x32_bf16 a[28:31], a[200:203], a[140:143], a[28:31]
 v_mfma_f32_16x16x32_bf16 a[28:31], a[220:223], a[168:171], a[28:31]
 s_add_u32 s40, s49, s85
 buffer_load_dwordx4 v[60:63], v0, s[4:7], s40 offen sc1
 v_mfma_f32_16x16x32_bf16 a[32:35], a[200:203], a[144:147], a[32:35]
 v_mfma_f32_16x16x32_bf16 a[32:35], a[220:223], a[172:175], a[32:35]
 v_mfma_f32_16x16x32_bf16 a[36:39], a[200:203], a[148:151], a[36:39]
 s_add_u32 s40, s48, s86
 buffer_load_dwordx4 v[16:19], v0, s[4:7], s40 offen sc1
 v_mfma_f32_16x16x32_bf16 a[36:39], a[220:223], a[176:179], a[36:39]
 v_mfma_f32_16x16x32_bf16 a[40:43], a[200:203], a[152:155], a[40:43]
 v_mfma_f32_16x16x32_bf16 a[40:43], a[220:223], a[180:183], a[40:43]
 s_add_u32 s40, s49, s86
 buffer_load_dwordx4 v[76:79], v0, s[4:7], s40 offen sc1
 v_mfma_f32_16x16x32_bf16 a[44:47], a[200:203], a[156:159], a[44:47]
 v_mfma_f32_16x16x32_bf16 a[44:47], a[220:223], a[184:187], a[44:47]
 v_mfma_f32_16x16x32_bf16 a[48:51], a[200:203], a[160:163], a[48:51]
 s_add_u32 s40, s48, s87
 buffer_load_dwordx4 v[20:23], v0, s[4:7], s40 offen sc1
 v_mfma_f32_16x16x32_bf16 a[48:51], a[220:223], a[188:191], a[48:51]
 v_mfma_f32_16x16x32_bf16 a[52:55], a[200:203], a[164:167], a[52:55]
 v_mfma_f32_16x16x32_bf16 a[52:55], a[220:223], a[192:195], a[52:55]
 s_waitcnt lgkmcnt(4)
 s_add_u32 s40, s49, s87
 buffer_load_dwordx4 v[84:87], v0, s[4:7], s40 offen sc1
 v_mfma_f32_16x16x32_bf16 a[56:59], a[204:207], a[140:143], a[56:59]
 v_mfma_f32_16x16x32_bf16 a[56:59], a[224:227], a[168:171], a[56:59]
 v_mfma_f32_16x16x32_bf16 a[60:63], a[204:207], a[144:147], a[60:63]
 s_add_u32 s40, s48, s96
 buffer_load_dwordx4 v[24:27], v0, s[4:7], s40 offen sc1
 v_mfma_f32_16x16x32_bf16 a[60:63], a[224:227], a[172:175], a[60:63]
 v_mfma_f32_16x16x32_bf16 a[64:67], a[204:207], a[148:151], a[64:67]
 v_mfma_f32_16x16x32_bf16 a[64:67], a[224:227], a[176:179], a[64:67]
 s_add_u32 s40, s49, s96
 buffer_load_dwordx4 v[92:95], v0, s[4:7], s40 offen sc1
 v_mfma_f32_16x16x32_bf16 a[68:71], a[204:207], a[152:155], a[68:71]
 v_mfma_f32_16x16x32_bf16 a[68:71], a[224:227], a[180:183], a[68:71]
 v_mfma_f32_16x16x32_bf16 a[72:75], a[204:207], a[156:159], a[72:75]
 s_add_u32 s40, s48, s97
 buffer_load_dwordx4 v[28:31], v0, s[4:7], s40 offen sc1
 v_mfma_f32_16x16x32_bf16 a[72:75], a[224:227], a[184:187], a[72:75]
 v_mfma_f32_16x16x32_bf16 a[76:79], a[204:207], a[160:163], a[76:79]
 v_mfma_f32_16x16x32_bf16 a[76:79], a[224:227], a[188:191], a[76:79]
 s_add_u32 s40, s49, s97
 buffer_load_dwordx4 v[108:111], v0, s[4:7], s40 offen sc1
 v_mfma_f32_16x16x32_bf16 a[80:83], a[204:207], a[164:167], a[80:83]
 v_mfma_f32_16x16x32_bf16 a[80:83], a[224:227], a[192:195], a[80:83]
 s_waitcnt lgkmcnt(2)
 v_mfma_f32_16x16x32_bf16 a[84:87], a[208:211], a[140:143], a[84:87]
 s_add_u32 s40, s48, s98
 buffer_load_dwordx4 v[44:47], v0, s[4:7], s40 offen sc1
 v_mfma_f32_16x16x32_bf16 a[84:87], a[228:231], a[168:171], a[84:87]
 v_mfma_f32_16x16x32_bf16 a[88:91], a[208:211], a[144:147], a[88:91]
 v_mfma_f32_16x16x32_bf16 a[88:91], a[228:231], a[172:175], a[88:91]
 s_add_u32 s40, s49, s98
 buffer_load_dwordx4 v[116:119], v0, s[4:7], s40 offen sc1
 v_mfma_f32_16x16x32_bf16 a[92:95], a[208:211], a[148:151], a[92:95]
 v_mfma_f32_16x16x32_bf16 a[92:95], a[228:231], a[176:179], a[92:95]
 v_mfma_f32_16x16x32_bf16 a[96:99], a[208:211], a[152:155], a[96:99]
 s_add_u32 s40, s50, s21
 buffer_load_dwordx4 v[132:135], v0, s[8:11], s40 offen sc1
 v_mfma_f32_16x16x32_bf16 a[96:99], a[228:231], a[180:183], a[96:99]
 v_mfma_f32_16x16x32_bf16 a[100:103], a[208:211], a[156:159], a[100:103]
 v_mfma_f32_16x16x32_bf16 a[100:103], a[228:231], a[184:187], a[100:103]
 s_add_u32 s40, s51, s21
 buffer_load_dwordx4 v[172:175], v0, s[8:11], s40 offen sc1
 v_mfma_f32_16x16x32_bf16 a[104:107], a[208:211], a[160:163], a[104:107]
 v_mfma_f32_16x16x32_bf16 a[104:107], a[228:231], a[188:191], a[104:107]
 v_mfma_f32_16x16x32_bf16 a[108:111], a[208:211], a[164:167], a[108:111]
 s_add_u32 s40, s50, s22
 buffer_load_dwordx4 v[140:143], v0, s[8:11], s40 offen sc1
 v_mfma_f32_16x16x32_bf16 a[108:111], a[228:231], a[192:195], a[108:111]
 s_waitcnt lgkmcnt(0)
 v_mfma_f32_16x16x32_bf16 a[112:115], a[212:215], a[140:143], a[112:115]
 v_mfma_f32_16x16x32_bf16 a[112:115], a[232:235], a[168:171], a[112:115]
 s_add_u32 s40, s51, s22
 buffer_load_dwordx4 v[180:183], v0, s[8:11], s40 offen sc1
 v_mfma_f32_16x16x32_bf16 a[116:119], a[212:215], a[144:147], a[116:119]
 v_mfma_f32_16x16x32_bf16 a[116:119], a[232:235], a[172:175], a[116:119]
 v_mfma_f32_16x16x32_bf16 a[120:123], a[212:215], a[148:151], a[120:123]
 s_add_u32 s40, s50, s23
 buffer_load_dwordx4 v[148:151], v0, s[8:11], s40 offen sc1
 v_mfma_f32_16x16x32_bf16 a[120:123], a[232:235], a[176:179], a[120:123]
 v_mfma_f32_16x16x32_bf16 a[124:127], a[212:215], a[152:155], a[124:127]
 v_mfma_f32_16x16x32_bf16 a[124:127], a[232:235], a[180:183], a[124:127]
 s_add_u32 s40, s51, s23
 buffer_load_dwordx4 v[188:191], v0, s[8:11], s40 offen sc1
 v_mfma_f32_16x16x32_bf16 a[128:131], a[212:215], a[156:159], a[128:131]
 v_mfma_f32_16x16x32_bf16 a[128:131], a[232:235], a[184:187], a[128:131]
 v_mfma_f32_16x16x32_bf16 a[132:135], a[212:215], a[160:163], a[132:135]
 s_add_u32 s40, s50, s28
 buffer_load_dwordx4 v[156:159], v0, s[8:11], s40 offen sc1
 v_mfma_f32_16x16x32_bf16 a[132:135], a[232:235], a[188:191], a[132:135]
 v_mfma_f32_16x16x32_bf16 a[136:139], a[212:215], a[164:167], a[136:139]
 v_mfma_f32_16x16x32_bf16 a[136:139], a[232:235], a[192:195], a[136:139]
 s_add_u32 s40, s51, s28
 buffer_load_dwordx4 v[196:199], v0, s[8:11], s40 offen sc1
 s_waitcnt vmcnt(44)
 v_mfma_f32_16x16x32_bf16 a[0:3], v[144:147], v[32:35], a[0:3]
 s_add_u32 s50, s63, 163840
 s_add_u32 s40, s50, s20
 buffer_load_dwordx4 a[196:199], v0, s[8:11], s40 offen sc1
 v_mfma_f32_16x16x32_bf16 a[0:3], v[184:187], v[88:91], a[0:3]
 s_waitcnt vmcnt(43)
 v_mfma_f32_16x16x32_bf16 a[4:7], v[144:147], v[40:43], a[4:7]
 v_mfma_f32_16x16x32_bf16 a[4:7], v[184:187], v[96:99], a[4:7]
 s_waitcnt vmcnt(41)
 s_add_u32 s51, s63, 168960
 s_add_u32 s40, s51, s20
 buffer_load_dwordx4 a[216:219], v0, s[8:11], s40 offen sc1
 v_mfma_f32_16x16x32_bf16 a[8:11], v[144:147], v[48:51], a[8:11]
 v_mfma_f32_16x16x32_bf16 a[8:11], v[184:187], v[104:107], a[8:11]
 s_waitcnt vmcnt(40)
 v_mfma_f32_16x16x32_bf16 a[12:15], v[144:147], v[56:59], a[12:15]
 s_add_u32 s48, s59, 229376
 s_add_u32 s40, s48, s84
 buffer_load_dwordx4 a[140:143], v0, s[4:7], s40 offen sc1
 v_mfma_f32_16x16x32_bf16 a[12:15], v[184:187], v[112:115], a[12:15]
 s_waitcnt vmcnt(39)
 v_mfma_f32_16x16x32_bf16 a[16:19], v[144:147], v[64:67], a[16:19]
 v_mfma_f32_16x16x32_bf16 a[16:19], v[184:187], v[120:123], a[16:19]
 s_waitcnt vmcnt(37)
 s_add_u32 s49, s59, 236544
 s_add_u32 s40, s49, s84
 buffer_load_dwordx4 a[168:171], v0, s[4:7], s40 offen sc1
 v_mfma_f32_16x16x32_bf16 a[20:23], v[144:147], v[72:75], a[20:23]
 v_mfma_f32_16x16x32_bf16 a[20:23], v[184:187], v[128:131], a[20:23]
 s_waitcnt vmcnt(36)
 v_mfma_f32_16x16x32_bf16 a[24:27], v[144:147], v[80:83], a[24:27]
 s_add_u32 s40, s48, s85
 buffer_load_dwordx4 a[144:147], v0, s[4:7], s40 offen sc1
 v_mfma_f32_16x16x32_bf16 a[24:27], v[184:187], v[136:139], a[24:27]
 s_waitcnt vmcnt(35)
 v_mfma_f32_16x16x32_bf16 a[28:31], v[152:155], v[32:35], a[28:31]
 v_mfma_f32_16x16x32_bf16 a[28:31], v[192:195], v[88:91], a[28:31]
 s_add_u32 s40, s49, s85
 buffer_load_dwordx4 a[172:175], v0, s[4:7], s40 offen sc1
 v_mfma_f32_16x16x32_bf16 a[32:35], v[152:155], v[40:43], a[32:35]
 v_mfma_f32_16x16x32_bf16 a[32:35], v[192:195], v[96:99], a[32:35]
 v_mfma_f32_16x16x32_bf16 a[36:39], v[152:155], v[48:51], a[36:39]
 s_add_u32 s40, s48, s86
 buffer_load_dwordx4 a[148:151], v0, s[4:7], s40 offen sc1
 v_mfma_f32_16x16x32_bf16 a[36:39], v[192:195], v[104:107], a[36:39]
 v_mfma_f32_16x16x32_bf16 a[40:43], v[152:155], v[56:59], a[40:43]
 v_mfma_f32_16x16x32_bf16 a[40:43], v[192:195], v[112:115], a[40:43]
 s_add_u32 s40, s49, s86
 buffer_load_dwordx4 a[176:179], v0, s[4:7], s40 offen sc1
 v_mfma_f32_16x16x32_bf16 a[44:47], v[152:155], v[64:67], a[44:47]
 v_mfma_f32_16x16x32_bf16 a[44:47], v[192:195], v[120:123], a[44:47]
 v_mfma_f32_16x16x32_bf16 a[48:51], v[152:155], v[72:75], a[48:51]
 s_add_u32 s40, s48, s87
 buffer_load_dwordx4 a[152:155], v0, s[4:7], s40 offen sc1
 v_mfma_f32_16x16x32_bf16 a[48:51], v[192:195], v[128:131], a[48:51]
 v_mfma_f32_16x16x32_bf16 a[52:55], v[152:155], v[80:83], a[52:55]
 v_mfma_f32_16x16x32_bf16 a[52:55], v[192:195], v[136:139], a[52:55]
 s_waitcnt vmcnt(37)
 s_add_u32 s40, s49, s87
 buffer_load_dwordx4 a[180:183], v0, s[4:7], s40 offen sc1
 v_mfma_f32_16x16x32_bf16 a[56:59], v[160:163], v[32:35], a[56:59]
 v_mfma_f32_16x16x32_bf16 a[56:59], v[36:39], v[88:91], a[56:59]
 v_mfma_f32_16x16x32_bf16 a[60:63], v[160:163], v[40:43], a[60:63]
 s_add_u32 s40, s48, s96
 buffer_load_dwordx4 a[156:159], v0, s[4:7], s40 offen sc1
 v_mfma_f32_16x16x32_bf16 a[60:63], v[36:39], v[96:99], a[60:63]
 v_mfma_f32_16x16x32_bf16 a[64:67], v[160:163], v[48:51], a[64:67]
 v_mfma_f32_16x16x32_bf16 a[64:67], v[36:39], v[104:107], a[64:67]
 s_add_u32 s40, s49, s96
 buffer_load_dwordx4 a[184:187], v0, s[4:7], s40 offen sc1
 v_mfma_f32_16x16x32_bf16 a[68:71], v[160:163], v[56:59], a[68:71]
 v_mfma_f32_16x16x32_bf16 a[68:71], v[36:39], v[112:115], a[68:71]
 v_mfma_f32_16x16x32_bf16 a[72:75], v[160:163], v[64:67], a[72:75]
 s_add_u32 s40, s48, s97
 buffer_load_dwordx4 a[160:163], v0, s[4:7], s40 offen sc1
 v_mfma_f32_16x16x32_bf16 a[72:75], v[36:39], v[120:123], a[72:75]
 v_mfma_f32_16x16x32_bf16 a[76:79], v[160:163], v[72:75], a[76:79]
 v_mfma_f32_16x16x32_bf16 a[76:79], v[36:39], v[128:131], a[76:79]
 s_add_u32 s40, s49, s97
 buffer_load_dwordx4 a[188:191], v0, s[4:7], s40 offen sc1
 v_mfma_f32_16x16x32_bf16 a[80:83], v[160:163], v[80:83], a[80:83]
 v_mfma_f32_16x16x32_bf16 a[80:83], v[36:39], v[136:139], a[80:83]
 s_waitcnt vmcnt(40)
 v_mfma_f32_16x16x32_bf16 a[84:87], v[168:171], v[32:35], a[84:87]
 s_add_u32 s40, s48, s98
 buffer_load_dwordx4 a[164:167], v0, s[4:7], s40 offen sc1
 v_mfma_f32_16x16x32_bf16 a[84:87], v[68:71], v[88:91], a[84:87]
 v_mfma_f32_16x16x32_bf16 a[88:91], v[168:171], v[40:43], a[88:91]
 v_mfma_f32_16x16x32_bf16 a[88:91], v[68:71], v[96:99], a[88:91]
 s_add_u32 s40, s49, s98
 buffer_load_dwordx4 a[192:195], v0, s[4:7], s40 offen sc1
 v_mfma_f32_16x16x32_bf16 a[92:95], v[168:171], v[48:51], a[92:95]
 v_mfma_f32_16x16x32_bf16 a[92:95], v[68:71], v[104:107], a[92:95]
 v_mfma_f32_16x16x32_bf16 a[96:99], v[168:171], v[56:59], a[96:99]
 s_add_u32 s40, s50, s21
 buffer_load_dwordx4 a[200:203], v0, s[8:11], s40 offen sc1
 v_mfma_f32_16x16x32_bf16 a[96:99], v[68:71], v[112:115], a[96:99]
 v_mfma_f32_16x16x32_bf16 a[100:103], v[168:171], v[64:67], a[100:103]
 v_mfma_f32_16x16x32_bf16 a[100:103], v[68:71], v[120:123], a[100:103]
 s_add_u32 s40, s51, s21
 buffer_load_dwordx4 a[220:223], v0, s[8:11], s40 offen sc1
 v_mfma_f32_16x16x32_bf16 a[104:107], v[168:171], v[72:75], a[104:107]
 v_mfma_f32_16x16x32_bf16 a[104:107], v[68:71], v[128:131], a[104:107]
 v_mfma_f32_16x16x32_bf16 a[108:111], v[168:171], v[80:83], a[108:111]
 s_add_u32 s40, s50, s22
 buffer_load_dwordx4 a[204:207], v0, s[8:11], s40 offen sc1
 v_mfma_f32_16x16x32_bf16 a[108:111], v[68:71], v[136:139], a[108:111]
 s_waitcnt vmcnt(43)
 v_mfma_f32_16x16x32_bf16 a[112:115], v[176:179], v[32:35], a[112:115]
 v_mfma_f32_16x16x32_bf16 a[112:115], v[100:103], v[88:91], a[112:115]
 s_add_u32 s40, s51, s22
 buffer_load_dwordx4 a[224:227], v0, s[8:11], s40 offen sc1
 v_mfma_f32_16x16x32_bf16 a[116:119], v[176:179], v[40:43], a[116:119]
 v_mfma_f32_16x16x32_bf16 a[116:119], v[100:103], v[96:99], a[116:119]
 v_mfma_f32_16x16x32_bf16 a[120:123], v[176:179], v[48:51], a[120:123]
 s_add_u32 s40, s50, s23
 buffer_load_dwordx4 a[208:211], v0, s[8:11], s40 offen sc1
 v_mfma_f32_16x16x32_bf16 a[120:123], v[100:103], v[104:107], a[120:123]
 v_mfma_f32_16x16x32_bf16 a[124:127], v[176:179], v[56:59], a[124:127]
 v_mfma_f32_16x16x32_bf16 a[124:127], v[100:103], v[112:115], a[124:127]
 s_add_u32 s40, s51, s23
 buffer_load_dwordx4 a[228:231], v0, s[8:11], s40 offen sc1
 v_mfma_f32_16x16x32_bf16 a[128:131], v[176:179], v[64:67], a[128:131]
 v_mfma_f32_16x16x32_bf16 a[128:131], v[100:103], v[120:123], a[128:131]
 v_mfma_f32_16x16x32_bf16 a[132:135], v[176:179], v[72:75], a[132:135]
 s_add_u32 s40, s50, s28
 buffer_load_dwordx4 a[212:215], v0, s[8:11], s40 offen sc1
 v_mfma_f32_16x16x32_bf16 a[132:135], v[100:103], v[128:131], a[132:135]
 v_mfma_f32_16x16x32_bf16 a[136:139], v[176:179], v[80:83], a[136:139]
 v_mfma_f32_16x16x32_bf16 a[136:139], v[100:103], v[136:139], a[136:139]
 s_add_u32 s40, s51, s28
 buffer_load_dwordx4 a[232:235], v0, s[8:11], s40 offen sc1
 s_waitcnt vmcnt(44)
 v_mfma_f32_16x16x32_bf16 a[0:3], v[124:127], v[8:11], a[0:3]
 s_add_u32 s50, s63, 327680
 s_add_u32 s40, s50, s20
 buffer_load_dwordx4 v[144:147], v0, s[8:11], s40 offen sc1
 v_mfma_f32_16x16x32_bf16 a[0:3], v[164:167], v[52:55], a[0:3]
 s_waitcnt vmcnt(43)
 v_mfma_f32_16x16x32_bf16 a[4:7], v[124:127], v[12:15], a[4:7]
 v_mfma_f32_16x16x32_bf16 a[4:7], v[164:167], v[60:63], a[4:7]
 s_waitcnt vmcnt(41)
 s_add_u32 s51, s63, 332800
 s_add_u32 s40, s51, s20
 buffer_load_dwordx4 v[184:187], v0, s[8:11], s40 offen sc1
 v_mfma_f32_16x16x32_bf16 a[8:11], v[124:127], v[16:19], a[8:11]
 v_mfma_f32_16x16x32_bf16 a[8:11], v[164:167], v[76:79], a[8:11]
 s_waitcnt vmcnt(40)
 v_mfma_f32_16x16x32_bf16 a[12:15], v[124:127], v[20:23], a[12:15]
 s_add_u32 s48, s59, 458752
 s_add_u32 s40, s48, s84
 buffer_load_dwordx4 v[32:35], v0, s[4:7], s40 offen sc1
 v_mfma_f32_16x16x32_bf16 a[12:15], v[164:167], v[84:87], a[12:15]
 s_waitcnt vmcnt(39)
 v_mfma_f32_16x16x32_bf16 a[16:19], v[124:127], v[24:27], a[16:19]
 v_mfma_f32_16x16x32_bf16 a[16:19], v[164:167], v[92:95], a[16:19]
 s_waitcnt vmcnt(37)
 s_add_u32 s49, s59, 465920
 s_add_u32 s40, s49, s84
 buffer_load_dwordx4 v[88:91], v0, s[4:7], s40 offen sc1
 v_mfma_f32_16x16x32_bf16 a[20:23], v[124:127], v[28:31], a[20:23]
 v_mfma_f32_16x16x32_bf16 a[20:23], v[164:167], v[108:111], a[20:23]
 s_waitcnt vmcnt(36)
 v_mfma_f32_16x16x32_bf16 a[24:27], v[124:127], v[44:47], a[24:27]
 s_add_u32 s40, s48, s85
 buffer_load_dwordx4 v[40:43], v0, s[4:7], s40 offen sc1
 v_mfma_f32_16x16x32_bf16 a[24:27], v[164:167], v[116:119], a[24:27]
 s_waitcnt vmcnt(35)
 v_mfma_f32_16x16x32_bf16 a[28:31], v[132:135], v[8:11], a[28:31]
 v_mfma_f32_16x16x32_bf16 a[28:31], v[172:175], v[52:55], a[28:31]
 s_add_u32 s40, s49, s85
 buffer_load_dwordx4 v[96:99], v0, s[4:7], s40 offen sc1
 v_mfma_f32_16x16x32_bf16 a[32:35], v[132:135], v[12:15], a[32:35]
 v_mfma_f32_16x16x32_bf16 a[32:35], v[172:175], v[60:63], a[32:35]
 v_mfma_f32_16x16x32_bf16 a[36:39], v[132:135], v[16:19], a[36:39]
 s_add_u32 s40, s48, s86
 buffer_load_dwordx4 v[48:51], v0, s[4:7], s40 offen sc1
 v_mfma_f32_16x16x32_bf16 a[36:39], v[172:175], v[76:79], a[36:39]
 v_mfma_f32_16x16x32_bf16 a[40:43], v[132:135], v[20:23], a[40:43]
 v_mfma_f32_16x16x32_bf16 a[40:43], v[172:175], v[84:87], a[40:43]
 s_add_u32 s40, s49, s86
 buffer_load_dwordx4 v[104:107], v0, s[4:7], s40 offen sc1
 v_mfma_f32_16x16x32_bf16 a[44:47], v[132:135], v[24:27], a[44:47]
 v_mfma_f32_16x16x32_bf16 a[44:47], v[172:175], v[92:95], a[44:47]
 v_mfma_f32_16x16x32_bf16 a[48:51], v[132:135], v[28:31], a[48:51]
 s_add_u32 s40, s48, s87
 buffer_load_dwordx4 v[56:59], v0, s[4:7], s40 offen sc1
 v_mfma_f32_16x16x32_bf16 a[48:51], v[172:175], v[108:111], a[48:51]
 v_mfma_f32_16x16x32_bf16 a[52:55], v[132:135], v[44:47], a[52:55]
 v_mfma_f32_16x16x32_bf16 a[52:55], v[172:175], v[116:119], a[52:55]
 s_waitcnt vmcnt(37)
 s_add_u32 s40, s49, s87
 buffer_load_dwordx4 v[112:115], v0, s[4:7], s40 offen sc1
 v_mfma_f32_16x16x32_bf16 a[56:59], v[140:143], v[8:11], a[56:59]
 v_mfma_f32_16x16x32_bf16 a[56:59], v[180:183], v[52:55], a[56:59]
 v_mfma_f32_16x16x32_bf16 a[60:63], v[140:143], v[12:15], a[60:63]
 s_add_u32 s40, s48, s96
 buffer_load_dwordx4 v[64:67], v0, s[4:7], s40 offen sc1
 v_mfma_f32_16x16x32_bf16 a[60:63], v[180:183], v[60:63], a[60:63]
 v_mfma_f32_16x16x32_bf16 a[64:67], v[140:143], v[16:19], a[64:67]
 v_mfma_f32_16x16x32_bf16 a[64:67], v[180:183], v[76:79], a[64:67]
 s_add_u32 s40, s49, s96
 buffer_load_dwordx4 v[120:123], v0, s[4:7], s40 offen sc1
 v_mfma_f32_16x16x32_bf16 a[68:71], v[140:143], v[20:23], a[68:71]
 v_mfma_f32_16x16x32_bf16 a[68:71], v[180:183], v[84:87], a[68:71]
 v_mfma_f32_16x16x32_bf16 a[72:75], v[140:143], v[24:27], a[72:75]
 s_add_u32 s40, s48, s97
 buffer_load_dwordx4 v[72:75], v0, s[4:7], s40 offen sc1
 v_mfma_f32_16x16x32_bf16 a[72:75], v[180:183], v[92:95], a[72:75]
 v_mfma_f32_16x16x32_bf16 a[76:79], v[140:143], v[28:31], a[76:79]
 v_mfma_f32_16x16x32_bf16 a[76:79], v[180:183], v[108:111], a[76:79]
 s_add_u32 s40, s49, s97
 buffer_load_dwordx4 v[128:131], v0, s[4:7], s40 offen sc1
 v_mfma_f32_16x16x32_bf16 a[80:83], v[140:143], v[44:47], a[80:83]
 v_mfma_f32_16x16x32_bf16 a[80:83], v[180:183], v[116:119], a[80:83]
 s_waitcnt vmcnt(40)
 v_mfma_f32_16x16x32_bf16 a[84:87], v[148:151], v[8:11], a[84:87]
 s_add_u32 s40, s48, s98
 buffer_load_dwordx4 v[80:83], v0, s[4:7], s40 offen sc1
 v_mfma_f32_16x16x32_bf16 a[84:87], v[188:191], v[52:55], a[84:87]
 v_mfma_f32_16x16x32_bf16 a[88:91], v[148:151], v[12:15], a[88:91]
 v_mfma_f32_16x16x32_bf16 a[88:91], v[188:191], v[60:63], a[88:91]
 s_add_u32 s40, s49, s98
 buffer_load_dwordx4 v[136:139], v0, s[4:7], s40 offen sc1
 v_mfma_f32_16x16x32_bf16 a[92:95], v[148:151], v[16:19], a[92:95]
 v_mfma_f32_16x16x32_bf16 a[92:95], v[188:191], v[76:79], a[92:95]
 v_mfma_f32_16x16x32_bf16 a[96:99], v[148:151], v[20:23], a[96:99]
 s_add_u32 s40, s50, s21
 buffer_load_dwordx4 v[152:155], v0, s[8:11], s40 offen sc1
 v_mfma_f32_16x16x32_bf16 a[96:99], v[188:191], v[84:87], a[96:99]
 v_mfma_f32_16x16x32_bf16 a[100:103], v[148:151], v[24:27], a[100:103]
 v_mfma_f32_16x16x32_bf16 a[100:103], v[188:191], v[92:95], a[100:103]
 s_add_u32 s40, s51, s21
 buffer_load_dwordx4 v[192:195], v0, s[8:11], s40 offen sc1
 v_mfma_f32_16x16x32_bf16 a[104:107], v[148:151], v[28:31], a[104:107]
 v_mfma_f32_16x16x32_bf16 a[104:107], v[188:191], v[108:111], a[104:107]
 v_mfma_f32_16x16x32_bf16 a[108:111], v[148:151], v[44:47], a[108:111]
 s_add_u32 s40, s50, s22
 buffer_load_dwordx4 v[160:163], v0, s[8:11], s40 offen sc1
 v_mfma_f32_16x16x32_bf16 a[108:111], v[188:191], v[116:119], a[108:111]
 s_waitcnt vmcnt(43)
 v_mfma_f32_16x16x32_bf16 a[112:115], v[156:159], v[8:11], a[112:115]
 v_mfma_f32_16x16x32_bf16 a[112:115], v[196:199], v[52:55], a[112:115]
 s_branch SK8777
C2_1:
PG8777:
 s_branch PG11119
SK8777:
 s_add_u32 s40, s51, s22
 buffer_load_dwordx4 v[36:39], v0, s[8:11], s40 offen sc1
 v_mfma_f32_16x16x32_bf16 a[116:119], v[156:159], v[12:15], a[116:119]
 v_mfma_f32_16x16x32_bf16 a[116:119], v[196:199], v[60:63], a[116:119]
 v_mfma_f32_16x16x32_bf16 a[120:123], v[156:159], v[16:19], a[120:123]
 s_add_u32 s40, s50, s23
 buffer_load_dwordx4 v[168:171], v0, s[8:11], s40 offen sc1
 v_mfma_f32_16x16x32_bf16 a[120:123], v[196:199], v[76:79], a[120:123]
 v_mfma_f32_16x16x32_bf16 a[124:127], v[156:159], v[20:23], a[124:127]
 v_mfma_f32_16x16x32_bf16 a[124:127], v[196:199], v[84:87], a[124:127]
 s_add_u32 s40, s51, s23
 buffer_load_dwordx4 v[68:71], v0, s[8:11], s40 offen sc1
 v_mfma_f32_16x16x32_bf16 a[128:131], v[156:159], v[24:27], a[128:131]
 v_mfma_f32_16x16x32_bf16 a[128:131], v[196:199], v[92:95], a[128:131]
 v_mfma_f32_16x16x32_bf16 a[132:135], v[156:159], v[28:31], a[132:135]
 s_add_u32 s40, s50, s28
 buffer_load_dwordx4 v[176:179], v0, s[8:11], s40 offen sc1
 v_mfma_f32_16x16x32_bf16 a[132:135], v[196:199], v[108:111], a[132:135]
 v_mfma_f32_16x16x32_bf16 a[136:139], v[156:159], v[44:47], a[136:139]
 v_mfma_f32_16x16x32_bf16 a[136:139], v[196:199], v[116:119], a[136:139]
 s_add_u32 s40, s51, s28
 buffer_load_dwordx4 v[100:103], v0, s[8:11], s40 offen sc1
 s_waitcnt vmcnt(44)
 v_mfma_f32_16x16x32_bf16 a[0:3], a[196:199], a[140:143], a[0:3]
 s_add_u32 s50, s63, 491520
 s_add_u32 s40, s50, s20
 buffer_load_dwordx4 v[124:127], v0, s[8:11], s40 offen sc1
 v_mfma_f32_16x16x32_bf16 a[0:3], a[216:219], a[168:171], a[0:3]
 s_waitcnt vmcnt(43)
 v_mfma_f32_16x16x32_bf16 a[4:7], a[196:199], a[144:147], a[4:7]
 v_mfma_f32_16x16x32_bf16 a[4:7], a[216:219], a[172:175], a[4:7]
 s_waitcnt vmcnt(41)
 s_add_u32 s51, s63, 496640
 s_add_u32 s40, s51, s20
 buffer_load_dwordx4 v[164:167], v0, s[8:11], s40 offen sc1
 v_mfma_f32_16x16x32_bf16 a[8:11], a[196:199], a[148:151], a[8:11]
 v_mfma_f32_16x16x32_bf16 a[8:11], a[216:219], a[176:179], a[8:11]
 s_waitcnt vmcnt(40)
 v_mfma_f32_16x16x32_bf16 a[12:15], a[196:199], a[152:155], a[12:15]
 s_add_u32 s48, s59, 688128
 s_add_u32 s40, s48, s84
 buffer_load_dwordx4 v[8:11], v0, s[4:7], s40 offen sc1
 v_mfma_f32_16x16x32_bf16 a[12:15], a[216:219], a[180:183], a[12:15]
 s_waitcnt vmcnt(39)
 v_mfma_f32_16x16x32_bf16 a[16:19], a[196:199], a[156:159], a[16:19]
 v_mfma_f32_16x16x32_bf16 a[16:19], a[216:219], a[184:187], a[16:19]
 s_waitcnt vmcnt(37)
 s_add_u32 s49, s59, 695296
 s_add_u32 s40, s49, s84
 buffer_load_dwordx4 v[52:55], v0, s[4:7], s40 offen sc1
 v_mfma_f32_16x16x32_bf16 a[20:23], a[196:199], a[160:163], a[20:23]
 v_mfma_f32_16x16x32_bf16 a[20:23], a[216:219], a[188:191], a[20:23]
 s_waitcnt vmcnt(36)
 v_mfma_f32_16x16x32_bf16 a[24:27], a[196:199], a[164:167], a[24:27]
 s_add_u32 s40, s48, s85
 buffer_load_dwordx4 v[12:15], v0, s[4:7], s40 offen sc1
 v_mfma_f32_16x16x32_bf16 a[24:27], a[216:219], a[192:195], a[24:27]
 s_waitcnt vmcnt(35)
 v_mfma_f32_16x16x32_bf16 a[28:31], a[200:203], a[140:143], a[28:31]
 v_mfma_f32_16x16x32_bf16 a[28:31], a[220:223], a[168:171], a[28:31]
 s_add_u32 s40, s49, s85
 buffer_load_dwordx4 v[60:63], v0, s[4:7], s40 offen sc1
 v_mfma_f32_16x16x32_bf16 a[32:35], a[200:203], a[144:147], a[32:35]
 v_mfma_f32_16x16x32_bf16 a[32:35], a[220:223], a[172:175], a[32:35]
 v_mfma_f32_16x16x32_bf16 a[36:39], a[200:203], a[148:151], a[36:39]
 s_add_u32 s40, s48, s86
 buffer_load_dwordx4 v[16:19], v0, s[4:7], s40 offen sc1
 v_mfma_f32_16x16x32_bf16 a[36:39], a[220:223], a[176:179], a[36:39]
 v_mfma_f32_16x16x32_bf16 a[40:43], a[200:203], a[152:155], a[40:43]
 v_mfma_f32_16x16x32_bf16 a[40:43], a[220:223], a[180:183], a[40:43]
 s_add_u32 s40, s49, s86
 buffer_load_dwordx4 v[76:79], v0, s[4:7], s40 offen sc1
 v_mfma_f32_16x16x32_bf16 a[44:47], a[200:203], a[156:159], a[44:47]
 v_mfma_f32_16x16x32_bf16 a[44:47], a[220:223], a[184:187], a[44:47]
 v_mfma_f32_16x16x32_bf16 a[48:51], a[200:203], a[160:163], a[48:51]
 s_add_u32 s40, s48, s87
 buffer_load_dwordx4 v[20:23], v0, s[4:7], s40 offen sc1
 v_mfma_f32_16x16x32_bf16 a[48:51], a[220:223], a[188:191], a[48:51]
 v_mfma_f32_16x16x32_bf16 a[52:55], a[200:203], a[164:167], a[52:55]
 v_mfma_f32_16x16x32_bf16 a[52:55], a[220:223], a[192:195], a[52:55]
 s_waitcnt vmcnt(37)
 s_add_u32 s40, s49, s87
 buffer_load_dwordx4 v[84:87], v0, s[4:7], s40 offen sc1
 v_mfma_f32_16x16x32_bf16 a[56:59], a[204:207], a[140:143], a[56:59]
 v_mfma_f32_16x16x32_bf16 a[56:59], a[224:227], a[168:171], a[56:59]
 v_mfma_f32_16x16x32_bf16 a[60:63], a[204:207], a[144:147], a[60:63]
 s_load_dwordx4 s[44:47], s[80:81], s94 glc
 s_add_u32 s40, s48, s96
 buffer_load_dwordx4 v[24:27], v0, s[4:7], s40 offen sc1
 v_mfma_f32_16x16x32_bf16 a[60:63], a[224:227], a[172:175], a[60:63]
 v_mfma_f32_16x16x32_bf16 a[64:67], a[204:207], a[148:151], a[64:67]
 v_mfma_f32_16x16x32_bf16 a[64:67], a[224:227], a[176:179], a[64:67]
 s_add_u32 s40, s49, s96
 buffer_load_dwordx4 v[92:95], v0, s[4:7], s40 offen sc1
 v_mfma_f32_16x16x32_bf16 a[68:71], a[204:207], a[152:155], a[68:71]
 v_mfma_f32_16x16x32_bf16 a[68:71], a[224:227], a[180:183], a[68:71]
 v_mfma_f32_16x16x32_bf16 a[72:75], a[204:207], a[156:159], a[72:75]
 s_add_u32 s40, s48, s97
 buffer_load_dwordx4 v[28:31], v0, s[4:7], s40 offen sc1
 v_mfma_f32_16x16x32_bf16 a[72:75], a[224:227], a[184:187], a[72:75]
 v_mfma_f32_16x16x32_bf16 a[76:79], a[204:207], a[160:163], a[76:79]
 v_mfma_f32_16x16x32_bf16 a[76:79], a[224:227], a[188:191], a[76:79]
 s_add_u32 s40, s49, s97
 buffer_load_dwordx4 v[108:111], v0, s[4:7], s40 offen sc1
 v_mfma_f32_16x16x32_bf16 a[80:83], a[204:207], a[164:167], a[80:83]
 v_mfma_f32_16x16x32_bf16 a[80:83], a[224:227], a[192:195], a[80:83]
 s_waitcnt vmcnt(40)
 v_mfma_f32_16x16x32_bf16 a[84:87], a[208:211], a[140:143], a[84:87]
 s_add_u32 s40, s48, s98
 buffer_load_dwordx4 v[44:47], v0, s[4:7], s40 offen sc1
 v_mfma_f32_16x16x32_bf16 a[84:87], a[228:231], a[168:171], a[84:87]
 v_mfma_f32_16x16x32_bf16 a[88:91], a[208:211], a[144:147], a[88:91]
 v_mfma_f32_16x16x32_bf16 a[88:91], a[228:231], a[172:175], a[88:91]
 s_add_u32 s40, s49, s98
 buffer_load_dwordx4 v[116:119], v0, s[4:7], s40 offen sc1
 v_mfma_f32_16x16x32_bf16 a[92:95], a[208:211], a[148:151], a[92:95]
 v_mfma_f32_16x16x32_bf16 a[92:95], a[228:231], a[176:179], a[92:95]
 v_mfma_f32_16x16x32_bf16 a[96:99], a[208:211], a[152:155], a[96:99]
 s_add_u32 s40, s50, s21
 buffer_load_dwordx4 v[132:135], v0, s[8:11], s40 offen sc1
 v_mfma_f32_16x16x32_bf16 a[96:99], a[228:231], a[180:183], a[96:99]
 v_mfma_f32_16x16x32_bf16 a[100:103], a[208:211], a[156:159], a[100:103]
 v_mfma_f32_16x16x32_bf16 a[100:103], a[228:231], a[184:187], a[100:103]
 s_add_u32 s40, s51, s21
 buffer_load_dwordx4 v[172:175], v0, s[8:11], s40 offen sc1
 v_mfma_f32_16x16x32_bf16 a[104:107], a[208:211], a[160:163], a[104:107]
 v_mfma_f32_16x16x32_bf16 a[104:107], a[228:231], a[188:191], a[104:107]
 v_mfma_f32_16x16x32_bf16 a[108:111], a[208:211], a[164:167], a[108:111]
 s_add_u32 s40, s50, s22
 buffer_load_dwordx4 v[140:143], v0, s[8:11], s40 offen sc1
 v_mfma_f32_16x16x32_bf16 a[108:111], a[228:231], a[192:195], a[108:111]
 s_waitcnt vmcnt(43)
 v_mfma_f32_16x16x32_bf16 a[112:115], a[212:215], a[140:143], a[112:115]
 v_mfma_f32_16x16x32_bf16 a[112:115], a[232:235], a[168:171], a[112:115]
 s_add_u32 s40, s51, s22
 buffer_load_dwordx4 v[180:183], v0, s[8:11], s40 offen sc1
 v_mfma_f32_16x16x32_bf16 a[116:119], a[212:215], a[144:147], a[116:119]
 v_mfma_f32_16x16x32_bf16 a[116:119], a[232:235], a[172:175], a[116:119]
 v_mfma_f32_16x16x32_bf16 a[120:123], a[212:215], a[148:151], a[120:123]
 s_add_u32 s40, s50, s23
 buffer_load_dwordx4 v[148:151], v0, s[8:11], s40 offen sc1
 v_mfma_f32_16x16x32_bf16 a[120:123], a[232:235], a[176:179], a[120:123]
 v_mfma_f32_16x16x32_bf16 a[124:127], a[212:215], a[152:155], a[124:127]
 v_mfma_f32_16x16x32_bf16 a[124:127], a[232:235], a[180:183], a[124:127]
 s_add_u32 s40, s51, s23
 buffer_load_dwordx4 v[188:191], v0, s[8:11], s40 offen sc1
 v_mfma_f32_16x16x32_bf16 a[128:131], a[212:215], a[156:159], a[128:131]
 v_mfma_f32_16x16x32_bf16 a[128:131], a[232:235], a[184:187], a[128:131]
 v_mfma_f32_16x16x32_bf16 a[132:135], a[212:215], a[160:163], a[132:135]
 s_add_u32 s40, s50, s28
 buffer_load_dwordx4 v[156:159], v0, s[8:11], s40 offen sc1
 v_mfma_f32_16x16x32_bf16 a[132:135], a[232:235], a[188:191], a[132:135]
 v_mfma_f32_16x16x32_bf16 a[136:139], a[212:215], a[164:167], a[136:139]
 v_mfma_f32_16x16x32_bf16 a[136:139], a[232:235], a[192:195], a[136:139]
 s_add_u32 s40, s51, s28
 buffer_load_dwordx4 v[196:199], v0, s[8:11], s40 offen sc1
 s_waitcnt vmcnt(44)
 v_mfma_f32_16x16x32_bf16 a[0:3], v[144:147], v[32:35], a[0:3]
 s_waitcnt lgkmcnt(0)
 s_min_u32 s55, s44, s46
 s_cmp_ge_u32 s55, 5
 s_cbranch_scc0 P2_SPIN6
P2_GO6:
 s_add_u32 s50, s64, 0
 s_add_u32 s40, s50, s20
 buffer_load_dwordx4 a[196:199], v0, s[8:11], s40 offen sc1
 v_mfma_f32_16x16x32_bf16 a[0:3], v[184:187], v[88:91], a[0:3]
 s_waitcnt vmcnt(43)
 v_mfma_f32_16x16x32_bf16 a[4:7], v[144:147], v[40:43], a[4:7]
 v_mfma_f32_16x16x32_bf16 a[4:7], v[184:187], v[96:99], a[4:7]
 s_waitcnt vmcnt(41)
 s_add_u32 s51, s64, 5120
 s_add_u32 s40, s51, s20
 buffer_load_dwordx4 a[216:219], v0, s[8:11], s40 offen sc1
 v_mfma_f32_16x16x32_bf16 a[8:11], v[144:147], v[48:51], a[8:11]
 v_mfma_f32_16x16x32_bf16 a[8:11], v[184:187], v[104:107], a[8:11]
 s_waitcnt vmcnt(40)
 v_mfma_f32_16x16x32_bf16 a[12:15], v[144:147], v[56:59], a[12:15]
 s_add_u32 s48, s60, 0
 s_add_u32 s40, s48, s84
 buffer_load_dwordx4 a[140:143], v0, s[4:7], s40 offen sc1
 v_mfma_f32_16x16x32_bf16 a[12:15], v[184:187], v[112:115], a[12:15]
 s_waitcnt vmcnt(39)
 v_mfma_f32_16x16x32_bf16 a[16:19], v[144:147], v[64:67], a[16:19]
 v_mfma_f32_16x16x32_bf16 a[16:19], v[184:187], v[120:123], a[16:19]
 s_waitcnt vmcnt(37)
 s_add_u32 s49, s60, 7168
 s_add_u32 s40, s49, s84
 buffer_load_dwordx4 a[168:171], v0, s[4:7], s40 offen sc1
 v_mfma_f32_16x16x32_bf16 a[20:23], v[144:147], v[72:75], a[20:23]
 v_mfma_f32_16x16x32_bf16 a[20:23], v[184:187], v[128:131], a[20:23]
 s_waitcnt vmcnt(36)
 v_mfma_f32_16x16x32_bf16 a[24:27], v[144:147], v[80:83], a[24:27]
 s_add_u32 s40, s48, s85
 buffer_load_dwordx4 a[144:147], v0, s[4:7], s40 offen sc1
 v_mfma_f32_16x16x32_bf16 a[24:27], v[184:187], v[136:139], a[24:27]
 s_waitcnt vmcnt(35)
 v_mfma_f32_16x16x32_bf16 a[28:31], v[152:155], v[32:35], a[28:31]
 v_mfma_f32_16x16x32_bf16 a[28:31], v[192:195], v[88:91], a[28:31]
 s_add_u32 s40, s49, s85
 buffer_load_dwordx4 a[172:175], v0, s[4:7], s40 offen sc1
 v_mfma_f32_16x16x32_bf16 a[32:35], v[152:155], v[40:43], a[32:35]
 v_mfma_f32_16x16x32_bf16 a[32:35], v[192:195], v[96:99], a[32:35]
 v_mfma_f32_16x16x32_bf16 a[36:39], v[152:155], v[48:51], a[36:39]
 s_add_u32 s40, s48, s86
 buffer_load_dwordx4 a[148:151], v0, s[4:7], s40 offen sc1
 v_mfma_f32_16x16x32_bf16 a[36:39], v[192:195], v[104:107], a[36:39]
 v_mfma_f32_16x16x32_bf16 a[40:43], v[152:155], v[56:59], a[40:43]
 v_mfma_f32_16x16x32_bf16 a[40:43], v[192:195], v[112:115], a[40:43]
 s_add_u32 s40, s49, s86
 buffer_load_dwordx4 a[176:179], v0, s[4:7], s40 offen sc1
 v_mfma_f32_16x16x32_bf16 a[44:47], v[152:155], v[64:67], a[44:47]
 v_mfma_f32_16x16x32_bf16 a[44:47], v[192:195], v[120:123], a[44:47]
 v_mfma_f32_16x16x32_bf16 a[48:51], v[152:155], v[72:75], a[48:51]
 s_add_u32 s40, s48, s87
 buffer_load_dwordx4 a[152:155], v0, s[4:7], s40 offen sc1
 v_mfma_f32_16x16x32_bf16 a[48:51], v[192:195], v[128:131], a[48:51]
 v_mfma_f32_16x16x32_bf16 a[52:55], v[152:155], v[80:83], a[52:55]
 v_mfma_f32_16x16x32_bf16 a[52:55], v[192:195], v[136:139], a[52:55]
 s_waitcnt vmcnt(37)
 s_add_u32 s40, s49, s87
 buffer_load_dwordx4 a[180:183], v0, s[4:7], s40 offen sc1
 v_mfma_f32_16x16x32_bf16 a[56:59], v[160:163], v[32:35], a[56:59]
 v_mfma_f32_16x16x32_bf16 a[56:59], v[36:39], v[88:91], a[56:59]
 v_mfma_f32_16x16x32_bf16 a[60:63], v[160:163], v[40:43], a[60:63]
 s_add_u32 s40, s48, s96
 buffer_load_dwordx4 a[156:159], v0, s[4:7], s40 offen sc1
 v_mfma_f32_16x16x32_bf16 a[60:63], v[36:39], v[96:99], a[60:63]
 v_mfma_f32_16x16x32_bf16 a[64:67], v[160:163], v[48:51], a[64:67]
 v_mfma_f32_16x16x32_bf16 a[64:67], v[36:39], v[104:107], a[64:67]
 s_add_u32 s40, s49, s96
 buffer_load_dwordx4 a[184:187], v0, s[4:7], s40 offen sc1
 v_mfma_f32_16x16x32_bf16 a[68:71], v[160:163], v[56:59], a[68:71]
 v_mfma_f32_16x16x32_bf16 a[68:71], v[36:39], v[112:115], a[68:71]
 v_mfma_f32_16x16x32_bf16 a[72:75], v[160:163], v[64:67], a[72:75]
 s_add_u32 s40, s48, s97
 buffer_load_dwordx4 a[160:163], v0, s[4:7], s40 offen sc1
 v_mfma_f32_16x16x32_bf16 a[72:75], v[36:39], v[120:123], a[72:75]
 v_mfma_f32_16x16x32_bf16 a[76:79], v[160:163], v[72:75], a[76:79]
 v_mfma_f32_16x16x32_bf16 a[76:79], v[36:39], v[128:131], a[76:79]
 s_add_u32 s40, s49, s97
 buffer_load_dwordx4 a[188:191], v0, s[4:7], s40 offen sc1
 v_mfma_f32_16x16x32_bf16 a[80:83], v[160:163], v[80:83], a[80:83]
 v_mfma_f32_16x16x32_bf16 a[80:83], v[36:39], v[136:139], a[80:83]
 s_waitcnt vmcnt(40)
 v_mfma_f32_16x16x32_bf16 a[84:87], v[168:171], v[32:35], a[84:87]
 s_add_u32 s40, s48, s98
 buffer_load_dwordx4 a[164:167], v0, s[4:7], s40 offen sc1
 v_mfma_f32_16x16x32_bf16 a[84:87], v[68:71], v[88:91], a[84:87]
 v_mfma_f32_16x16x32_bf16 a[88:91], v[168:171], v[40:43], a[88:91]
 v_mfma_f32_16x16x32_bf16 a[88:91], v[68:71], v[96:99], a[88:91]
 s_add_u32 s40, s49, s98
 buffer_load_dwordx4 a[192:195], v0, s[4:7], s40 offen sc1
 v_mfma_f32_16x16x32_bf16 a[92:95], v[168:171], v[48:51], a[92:95]
 v_mfma_f32_16x16x32_bf16 a[92:95], v[68:71], v[104:107], a[92:95]
 v_mfma_f32_16x16x32_bf16 a[96:99], v[168:171], v[56:59], a[96:99]
 s_add_u32 s40, s50, s21
 buffer_load_dwordx4 a[200:203], v0, s[8:11], s40 offen sc1
 v_mfma_f32_16x16x32_bf16 a[96:99], v[68:71], v[112:115], a[96:99]
 v_mfma_f32_16x16x32_bf16 a[100:103], v[168:171], v[64:67], a[100:103]
 v_mfma_f32_16x16x32_bf16 a[100:103], v[68:71], v[120:123], a[100:103]
 s_add_u32 s40, s51, s21
 buffer_load_dwordx4 a[220:223], v0, s[8:11], s40 offen sc1
 v_mfma_f32_16x16x32_bf16 a[104:107], v[168:171], v[72:75], a[104:107]
 v_mfma_f32_16x16x32_bf16 a[104:107], v[68:71], v[128:131], a[104:107]
 v_mfma_f32_16x16x32_bf16 a[108:111], v[168:171], v[80:83], a[108:111]
 s_add_u32 s40, s50, s22
 buffer_load_dwordx4 a[204:207], v0, s[8:11], s40 offen sc1
 v_mfma_f32_16x16x32_bf16 a[108:111], v[68:71], v[136:139], a[108:111]
 s_waitcnt vmcnt(43)
 v_mfma_f32_16x16x32_bf16 a[112:115], v[176:179], v[32:35], a[112:115]
 v_mfma_f32_16x16x32_bf16 a[112:115], v[100:103], v[88:91], a[112:115]
 s_add_u32 s40, s51, s22
 buffer_load_dwordx4 a[224:227], v0, s[8:11], s40 offen sc1
 v_mfma_f32_16x16x32_bf16 a[116:119], v[176:179], v[40:43], a[116:119]
 v_mfma_f32_16x16x32_bf16 a[116:119], v[100:103], v[96:99], a[116:119]
 v_mfma_f32_16x16x32_bf16 a[120:123], v[176:179], v[48:51], a[120:123]
 s_add_u32 s40, s50, s23
 buffer_load_dwordx4 a[208:211], v0, s[8:11], s40 offen sc1
 v_mfma_f32_16x16x32_bf16 a[120:123], v[100:103], v[104:107], a[120:123]
 v_mfma_f32_16x16x32_bf16 a[124:127], v[176:179], v[56:59], a[124:127]
 v_mfma_f32_16x16x32_bf16 a[124:127], v[100:103], v[112:115], a[124:127]
 s_add_u32 s40, s51, s23
 buffer_load_dwordx4 a[228:231], v0, s[8:11], s40 offen sc1
 v_mfma_f32_16x16x32_bf16 a[128:131], v[176:179], v[64:67], a[128:131]
 v_mfma_f32_16x16x32_bf16 a[128:131], v[100:103], v[120:123], a[128:131]
 v_mfma_f32_16x16x32_bf16 a[132:135], v[176:179], v[72:75], a[132:135]
 s_add_u32 s40, s50, s28
 buffer_load_dwordx4 a[212:215], v0, s[8:11], s40 offen sc1
 v_mfma_f32_16x16x32_bf16 a[132:135], v[100:103], v[128:131], a[132:135]
 v_mfma_f32_16x16x32_bf16 a[136:139], v[176:179], v[80:83], a[136:139]
 v_mfma_f32_16x16x32_bf16 a[136:139], v[100:103], v[136:139], a[136:139]
 s_add_u32 s40, s51, s28
 buffer_load_dwordx4 a[232:235], v0, s[8:11], s40 offen sc1
 s_waitcnt vmcnt(44)
 v_mfma_f32_16x16x32_bf16 a[0:3], v[124:127], v[8:11], a[0:3]
 s_add_u32 s50, s64, 163840
 s_add_u32 s40, s50, s20
 buffer_load_dwordx4 v[144:147], v0, s[8:11], s40 offen sc1
 v_mfma_f32_16x16x32_bf16 a[0:3], v[164:167], v[52:55], a[0:3]
 s_waitcnt vmcnt(43)
 v_mfma_f32_16x16x32_bf16 a[4:7], v[124:127], v[12:15], a[4:7]
 v_mfma_f32_16x16x32_bf16 a[4:7], v[164:167], v[60:63], a[4:7]
 s_waitcnt vmcnt(41)
 s_add_u32 s51, s64, 168960
 s_add_u32 s40, s51, s20
 buffer_load_dwordx4 v[184:187], v0, s[8:11], s40 offen sc1
 v_mfma_f32_16x16x32_bf16 a[8:11], v[124:127], v[16:19], a[8:11]
 v_mfma_f32_16x16x32_bf16 a[8:11], v[164:167], v[76:79], a[8:11]
 s_waitcnt vmcnt(40)
 v_mfma_f32_16x16x32_bf16 a[12:15], v[124:127], v[20:23], a[12:15]
 s_add_u32 s48, s60, 229376
 s_add_u32 s40, s48, s84
 buffer_load_dwordx4 v[32:35], v0, s[4:7], s40 offen sc1
 v_mfma_f32_16x16x32_bf16 a[12:15], v[164:167], v[84:87], a[12:15]
 s_waitcnt vmcnt(39)
 v_mfma_f32_16x16x32_bf16 a[16:19], v[124:127], v[24:27], a[16:19]
 v_mfma_f32_16x16x32_bf16 a[16:19], v[164:167], v[92:95], a[16:19]
 s_waitcnt vmcnt(37)
 s_add_u32 s49, s60, 236544
 s_add_u32 s40, s49, s84
 buffer_load_dwordx4 v[88:91], v0, s[4:7], s40 offen sc1
 v_mfma_f32_16x16x32_bf16 a[20:23], v[124:127], v[28:31], a[20:23]
 v_mfma_f32_16x16x32_bf16 a[20:23], v[164:167], v[108:111], a[20:23]
 s_waitcnt vmcnt(36)
 v_mfma_f32_16x16x32_bf16 a[24:27], v[124:127], v[44:47], a[24:27]
 s_add_u32 s40, s48, s85
 buffer_load_dwordx4 v[40:43], v0, s[4:7], s40 offen sc1
 v_mfma_f32_16x16x32_bf16 a[24:27], v[164:167], v[116:119], a[24:27]
 s_waitcnt vmcnt(35)
 v_mfma_f32_16x16x32_bf16 a[28:31], v[132:135], v[8:11], a[28:31]
 v_mfma_f32_16x16x32_bf16 a[28:31], v[172:175], v[52:55], a[28:31]
 s_add_u32 s40, s49, s85
 buffer_load_dwordx4 v[96:99], v0, s[4:7], s40 offen sc1
 v_mfma_f32_16x16x32_bf16 a[32:35], v[132:135], v[12:15], a[32:35]
 v_mfma_f32_16x16x32_bf16 a[32:35], v[172:175], v[60:63], a[32:35]
 v_mfma_f32_16x16x32_bf16 a[36:39], v[132:135], v[16:19], a[36:39]
 s_add_u32 s40, s48, s86
 buffer_load_dwordx4 v[48:51], v0, s[4:7], s40 offen sc1
 v_mfma_f32_16x16x32_bf16 a[36:39], v[172:175], v[76:79], a[36:39]
 v_mfma_f32_16x16x32_bf16 a[40:43], v[132:135], v[20:23], a[40:43]
 v_mfma_f32_16x16x32_bf16 a[40:43], v[172:175], v[84:87], a[40:43]
 s_add_u32 s40, s49, s86
 buffer_load_dwordx4 v[104:107], v0, s[4:7], s40 offen sc1
 v_mfma_f32_16x16x32_bf16 a[44:47], v[132:135], v[24:27], a[44:47]
 v_mfma_f32_16x16x32_bf16 a[44:47], v[172:175], v[92:95], a[44:47]
 v_mfma_f32_16x16x32_bf16 a[48:51], v[132:135], v[28:31], a[48:51]
 s_add_u32 s40, s48, s87
 buffer_load_dwordx4 v[56:59], v0, s[4:7], s40 offen sc1
 v_mfma_f32_16x16x32_bf16 a[48:51], v[172:175], v[108:111], a[48:51]
 v_mfma_f32_16x16x32_bf16 a[52:55], v[132:135], v[44:47], a[52:55]
 v_mfma_f32_16x16x32_bf16 a[52:55], v[172:175], v[116:119], a[52:55]
 s_waitcnt vmcnt(37)
 s_add_u32 s40, s49, s87
 buffer_load_dwordx4 v[112:115], v0, s[4:7], s40 offen sc1
 v_mfma_f32_16x16x32_bf16 a[56:59], v[140:143], v[8:11], a[56:59]
 v_mfma_f32_16x16x32_bf16 a[56:59], v[180:183], v[52:55], a[56:59]
 v_mfma_f32_16x16x32_bf16 a[60:63], v[140:143], v[12:15], a[60:63]
 s_add_u32 s40, s48, s96
 buffer_load_dwordx4 v[64:67], v0, s[4:7], s40 offen sc1
 v_mfma_f32_16x16x32_bf16 a[60:63], v[180:183], v[60:63], a[60:63]
 v_mfma_f32_16x16x32_bf16 a[64:67], v[140:143], v[16:19], a[64:67]
 v_mfma_f32_16x16x32_bf16 a[64:67], v[180:183], v[76:79], a[64:67]
 s_add_u32 s40, s49, s96
 buffer_load_dwordx4 v[120:123], v0, s[4:7], s40 offen sc1
 v_mfma_f32_16x16x32_bf16 a[68:71], v[140:143], v[20:23], a[68:71]
 v_mfma_f32_16x16x32_bf16 a[68:71], v[180:183], v[84:87], a[68:71]
 v_mfma_f32_16x16x32_bf16 a[72:75], v[140:143], v[24:27], a[72:75]
 s_add_u32 s40, s48, s97
 buffer_load_dwordx4 v[72:75], v0, s[4:7], s40 offen sc1
 v_mfma_f32_16x16x32_bf16 a[72:75], v[180:183], v[92:95], a[72:75]
 v_mfma_f32_16x16x32_bf16 a[76:79], v[140:143], v[28:31], a[76:79]
 v_mfma_f32_16x16x32_bf16 a[76:79], v[180:183], v[108:111], a[76:79]
 s_add_u32 s40, s49, s97
 buffer_load_dwordx4 v[128:131], v0, s[4:7], s40 offen sc1
 v_mfma_f32_16x16x32_bf16 a[80:83], v[140:143], v[44:47], a[80:83]
 v_mfma_f32_16x16x32_bf16 a[80:83], v[180:183], v[116:119], a[80:83]
 s_waitcnt vmcnt(40)
 v_mfma_f32_16x16x32_bf16 a[84:87], v[148:151], v[8:11], a[84:87]
 s_add_u32 s40, s48, s98
 buffer_load_dwordx4 v[80:83], v0, s[4:7], s40 offen sc1
 v_mfma_f32_16x16x32_bf16 a[84:87], v[188:191], v[52:55], a[84:87]
 v_mfma_f32_16x16x32_bf16 a[88:91], v[148:151], v[12:15], a[88:91]
 v_mfma_f32_16x16x32_bf16 a[88:91], v[188:191], v[60:63], a[88:91]
 s_add_u32 s40, s49, s98
 buffer_load_dwordx4 v[136:139], v0, s[4:7], s40 offen sc1
 v_mfma_f32_16x16x32_bf16 a[92:95], v[148:151], v[16:19], a[92:95]
 v_mfma_f32_16x16x32_bf16 a[92:95], v[188:191], v[76:79], a[92:95]
 v_mfma_f32_16x16x32_bf16 a[96:99], v[148:151], v[20:23], a[96:99]
 s_add_u32 s40, s50, s21
 buffer_load_dwordx4 v[152:155], v0, s[8:11], s40 offen sc1
 v_mfma_f32_16x16x32_bf16 a[96:99], v[188:191], v[84:87], a[96:99]
 v_mfma_f32_16x16x32_bf16 a[100:103], v[148:151], v[24:27], a[100:103]
 v_mfma_f32_16x16x32_bf16 a[100:103], v[188:191], v[92:95], a[100:103]
 s_add_u32 s40, s51, s21
 buffer_load_dwordx4 v[192:195], v0, s[8:11], s40 offen sc1
 v_mfma_f32_16x16x32_bf16 a[104:107], v[148:151], v[28:31], a[104:107]
 v_mfma_f32_16x16x32_bf16 a[104:107], v[188:191], v[108:111], a[104:107]
 v_mfma_f32_16x16x32_bf16 a[108:111], v[148:151], v[44:47], a[108:111]
 s_add_u32 s40, s50, s22
 buffer_load_dwordx4 v[160:163], v0, s[8:11], s40 offen sc1
 v_mfma_f32_16x16x32_bf16 a[108:111], v[188:191], v[116:119], a[108:111]
 s_waitcnt vmcnt(43)
 v_mfma_f32_16x16x32_bf16 a[112:115], v[156:159], v[8:11], a[112:115]
 v_mfma_f32_16x16x32_bf16 a[112:115], v[196:199], v[52:55], a[112:115]
 s_add_u32 s40, s51, s22
 buffer_load_dwordx4 v[36:39], v0, s[8:11], s40 offen sc1
 v_mfma_f32_16x16x32_bf16 a[116:119], v[156:159], v[12:15], a[116:119]
 v_mfma_f32_16x16x32_bf16 a[116:119], v[196:199], v[60:63], a[116:119]
 v_mfma_f32_16x16x32_bf16 a[120:123], v[156:159], v[16:19], a[120:123]
 s_add_u32 s40, s50, s23
 buffer_load_dwordx4 v[168:171], v0, s[8:11], s40 offen sc1
 v_mfma_f32_16x16x32_bf16 a[120:123], v[196:199], v[76:79], a[120:123]
 v_mfma_f32_16x16x32_bf16 a[124:127], v[156:159], v[20:23], a[124:127]
 v_mfma_f32_16x16x32_bf16 a[124:127], v[196:199], v[84:87], a[124:127]
 s_add_u32 s40, s51, s23
 buffer_load_dwordx4 v[68:71], v0, s[8:11], s40 offen sc1
 v_mfma_f32_16x16x32_bf16 a[128:131], v[156:159], v[24:27], a[128:131]
 v_mfma_f32_16x16x32_bf16 a[128:131], v[196:199], v[92:95], a[128:131]
 v_mfma_f32_16x16x32_bf16 a[132:135], v[156:159], v[28:31], a[132:135]
 s_add_u32 s40, s50, s28
 buffer_load_dwordx4 v[176:179], v0, s[8:11], s40 offen sc1
 v_mfma_f32_16x16x32_bf16 a[132:135], v[196:199], v[108:111], a[132:135]
 v_mfma_f32_16x16x32_bf16 a[136:139], v[156:159], v[44:47], a[136:139]
 v_mfma_f32_16x16x32_bf16 a[136:139], v[196:199], v[116:119], a[136:139]
 s_add_u32 s40, s51, s28
 buffer_load_dwordx4 v[100:103], v0, s[8:11], s40 offen sc1
 s_waitcnt vmcnt(44)
 v_mfma_f32_16x16x32_bf16 a[0:3], a[196:199], a[140:143], a[0:3]
 s_add_u32 s50, s64, 327680
 s_add_u32 s40, s50, s20
 buffer_load_dwordx4 v[124:127], v0, s[8:11], s40 offen sc1
 v_mfma_f32_16x16x32_bf16 a[0:3], a[216:219], a[168:171], a[0:3]
 s_waitcnt vmcnt(43)
 v_mfma_f32_16x16x32_bf16 a[4:7], a[196:199], a[144:147], a[4:7]
 v_mfma_f32_16x16x32_bf16 a[4:7], a[216:219], a[172:175], a[4:7]
 s_waitcnt vmcnt(41)
 s_add_u32 s51, s64, 332800
 s_add_u32 s40, s51, s20
 buffer_load_dwordx4 v[164:167], v0, s[8:11], s40 offen sc1
 v_mfma_f32_16x16x32_bf16 a[8:11], a[196:199], a[148:151], a[8:11]
 v_mfma_f32_16x16x32_bf16 a[8:11], a[216:219], a[176:179], a[8:11]
 s_waitcnt vmcnt(40)
 v_mfma_f32_16x16x32_bf16 a[12:15], a[196:199], a[152:155], a[12:15]
 s_add_u32 s48, s60, 458752
 s_add_u32 s40, s48, s84
 buffer_load_dwordx4 v[8:11], v0, s[4:7], s40 offen sc1
 v_mfma_f32_16x16x32_bf16 a[12:15], a[216:219], a[180:183], a[12:15]
 s_waitcnt vmcnt(39)
 v_mfma_f32_16x16x32_bf16 a[16:19], a[196:199], a[156:159], a[16:19]
 v_mfma_f32_16x16x32_bf16 a[16:19], a[216:219], a[184:187], a[16:19]
 s_waitcnt vmcnt(37)
 s_add_u32 s49, s60, 465920
 s_add_u32 s40, s49, s84
 buffer_load_dwordx4 v[52:55], v0, s[4:7], s40 offen sc1
 v_mfma_f32_16x16x32_bf16 a[20:23], a[196:199], a[160:163], a[20:23]
 v_mfma_f32_16x16x32_bf16 a[20:23], a[216:219], a[188:191], a[20:23]
 s_waitcnt vmcnt(36)
 v_mfma_f32_16x16x32_bf16 a[24:27], a[196:199], a[164:167], a[24:27]
 s_add_u32 s40, s48, s85
 buffer_load_dwordx4 v[12:15], v0, s[4:7], s40 offen sc1
 v_mfma_f32_16x16x32_bf16 a[24:27], a[216:219], a[192:195], a[24:27]
 s_waitcnt vmcnt(35)
 v_mfma_f32_16x16x32_bf16 a[28:31], a[200:203], a[140:143], a[28:31]
 v_mfma_f32_16x16x32_bf16 a[28:31], a[220:223], a[168:171], a[28:31]
 s_add_u32 s40, s49, s85
 buffer_load_dwordx4 v[60:63], v0, s[4:7], s40 offen sc1
 v_mfma_f32_16x16x32_bf16 a[32:35], a[200:203], a[144:147], a[32:35]
 v_mfma_f32_16x16x32_bf16 a[32:35], a[220:223], a[172:175], a[32:35]
 v_mfma_f32_16x16x32_bf16 a[36:39], a[200:203], a[148:151], a[36:39]
 s_add_u32 s40, s48, s86
 buffer_load_dwordx4 v[16:19], v0, s[4:7], s40 offen sc1
 v_mfma_f32_16x16x32_bf16 a[36:39], a[220:223], a[176:179], a[36:39]
 v_mfma_f32_16x16x32_bf16 a[40:43], a[200:203], a[152:155], a[40:43]
 v_mfma_f32_16x16x32_bf16 a[40:43], a[220:223], a[180:183], a[40:43]
 s_add_u32 s40, s49, s86
 buffer_load_dwordx4 v[76:79], v0, s[4:7], s40 offen sc1
 v_mfma_f32_16x16x32_bf16 a[44:47], a[200:203], a[156:159], a[44:47]
 v_mfma_f32_16x16x32_bf16 a[44:47], a[220:223], a[184:187], a[44:47]
 v_mfma_f32_16x16x32_bf16 a[48:51], a[200:203], a[160:163], a[48:51]
 s_add_u32 s40, s48, s87
 buffer_load_dwordx4 v[20:23], v0, s[4:7], s40 offen sc1
 v_mfma_f32_16x16x32_bf16 a[48:51], a[220:223], a[188:191], a[48:51]
 v_mfma_f32_16x16x32_bf16 a[52:55], a[200:203], a[164:167], a[52:55]
 v_mfma_f32_16x16x32_bf16 a[52:55], a[220:223], a[192:195], a[52:55]
 s_waitcnt vmcnt(37)
 s_add_u32 s40, s49, s87
 buffer_load_dwordx4 v[84:87], v0, s[4:7], s40 offen sc1
 v_mfma_f32_16x16x32_bf16 a[56:59], a[204:207], a[140:143], a[56:59]
 v_mfma_f32_16x16x32_bf16 a[56:59], a[224:227], a[168:171], a[56:59]
 v_mfma_f32_16x16x32_bf16 a[60:63], a[204:207], a[144:147], a[60:63]
 s_add_u32 s40, s48, s96
 buffer_load_dwordx4 v[24:27], v0, s[4:7], s40 offen sc1
 v_mfma_f32_16x16x32_bf16 a[60:63], a[224:227], a[172:175], a[60:63]
 v_mfma_f32_16x16x32_bf16 a[64:67], a[204:207], a[148:151], a[64:67]
 v_mfma_f32_16x16x32_bf16 a[64:67], a[224:227], a[176:179], a[64:67]
 s_add_u32 s40, s49, s96
 buffer_load_dwordx4 v[92:95], v0, s[4:7], s40 offen sc1
 v_mfma_f32_16x16x32_bf16 a[68:71], a[204:207], a[152:155], a[68:71]
 v_mfma_f32_16x16x32_bf16 a[68:71], a[224:227], a[180:183], a[68:71]
 v_mfma_f32_16x16x32_bf16 a[72:75], a[204:207], a[156:159], a[72:75]
 s_add_u32 s40, s48, s97
 buffer_load_dwordx4 v[28:31], v0, s[4:7], s40 offen sc1
 v_mfma_f32_16x16x32_bf16 a[72:75], a[224:227], a[184:187], a[72:75]
 v_mfma_f32_16x16x32_bf16 a[76:79], a[204:207], a[160:163], a[76:79]
 v_mfma_f32_16x16x32_bf16 a[76:79], a[224:227], a[188:191], a[76:79]
 s_add_u32 s40, s49, s97
 buffer_load_dwordx4 v[108:111], v0, s[4:7], s40 offen sc1
 v_mfma_f32_16x16x32_bf16 a[80:83], a[204:207], a[164:167], a[80:83]
 v_mfma_f32_16x16x32_bf16 a[80:83], a[224:227], a[192:195], a[80:83]
 s_waitcnt vmcnt(40)
 v_mfma_f32_16x16x32_bf16 a[84:87], a[208:211], a[140:143], a[84:87]
 s_add_u32 s40, s48, s98
 buffer_load_dwordx4 v[44:47], v0, s[4:7], s40 offen sc1
 v_mfma_f32_16x16x32_bf16 a[84:87], a[228:231], a[168:171], a[84:87]
 v_mfma_f32_16x16x32_bf16 a[88:91], a[208:211], a[144:147], a[88:91]
 v_mfma_f32_16x16x32_bf16 a[88:91], a[228:231], a[172:175], a[88:91]
 s_add_u32 s40, s49, s98
 buffer_load_dwordx4 v[116:119], v0, s[4:7], s40 offen sc1
 v_mfma_f32_16x16x32_bf16 a[92:95], a[208:211], a[148:151], a[92:95]
 v_mfma_f32_16x16x32_bf16 a[92:95], a[228:231], a[176:179], a[92:95]
 v_mfma_f32_16x16x32_bf16 a[96:99], a[208:211], a[152:155], a[96:99]
 s_add_u32 s40, s50, s21
 buffer_load_dwordx4 v[132:135], v0, s[8:11], s40 offen sc1
 v_mfma_f32_16x16x32_bf16 a[96:99], a[228:231], a[180:183], a[96:99]
 v_mfma_f32_16x16x32_bf16 a[100:103], a[208:211], a[156:159], a[100:103]
 v_mfma_f32_16x16x32_bf16 a[100:103], a[228:231], a[184:187], a[100:103]
 s_add_u32 s40, s51, s21
 buffer_load_dwordx4 v[172:175], v0, s[8:11], s40 offen sc1
 v_mfma_f32_16x16x32_bf16 a[104:107], a[208:211], a[160:163], a[104:107]
 v_mfma_f32_16x16x32_bf16 a[104:107], a[228:231], a[188:191], a[104:107]
 v_mfma_f32_16x16x32_bf16 a[108:111], a[208:211], a[164:167], a[108:111]
 s_add_u32 s40, s50, s22
 buffer_load_dwordx4 v[140:143], v0, s[8:11], s40 offen sc1
 v_mfma_f32_16x16x32_bf16 a[108:111], a[228:231], a[192:195], a[108:111]
 s_waitcnt vmcnt(43)
 v_mfma_f32_16x16x32_bf16 a[112:115], a[212:215], a[140:143], a[112:115]
 v_mfma_f32_16x16x32_bf16 a[112:115], a[232:235], a[168:171], a[112:115]
 s_add_u32 s40, s51, s22
 buffer_load_dwordx4 v[180:183], v0, s[8:11], s40 offen sc1
 v_mfma_f32_16x16x32_bf16 a[116:119], a[212:215], a[144:147], a[116:119]
 v_mfma_f32_16x16x32_bf16 a[116:119], a[232:235], a[172:175], a[116:119]
 v_mfma_f32_16x16x32_bf16 a[120:123], a[212:215], a[148:151], a[120:123]
 s_add_u32 s40, s50, s23
 buffer_load_dwordx4 v[148:151], v0, s[8:11], s40 offen sc1
 v_mfma_f32_16x16x32_bf16 a[120:123], a[232:235], a[176:179], a[120:123]
 v_mfma_f32_16x16x32_bf16 a[124:127], a[212:215], a[152:155], a[124:127]
 v_mfma_f32_16x16x32_bf16 a[124:127], a[232:235], a[180:183], a[124:127]
 s_add_u32 s40, s51, s23
 buffer_load_dwordx4 v[188:191], v0, s[8:11], s40 offen sc1
 v_mfma_f32_16x16x32_bf16 a[128:131], a[212:215], a[156:159], a[128:131]
 v_mfma_f32_16x16x32_bf16 a[128:131], a[232:235], a[184:187], a[128:131]
 v_mfma_f32_16x16x32_bf16 a[132:135], a[212:215], a[160:163], a[132:135]
 s_add_u32 s40, s50, s28
 buffer_load_dwordx4 v[156:159], v0, s[8:11], s40 offen sc1
 v_mfma_f32_16x16x32_bf16 a[132:135], a[232:235], a[188:191], a[132:135]
 v_mfma_f32_16x16x32_bf16 a[136:139], a[212:215], a[164:167], a[136:139]
 v_mfma_f32_16x16x32_bf16 a[136:139], a[232:235], a[192:195], a[136:139]
 s_add_u32 s40, s51, s28
 buffer_load_dwordx4 v[196:199], v0, s[8:11], s40 offen sc1
 s_waitcnt vmcnt(44)
 v_mfma_f32_16x16x32_bf16 a[0:3], v[144:147], v[32:35], a[0:3]
 s_add_u32 s50, s64, 491520
 s_add_u32 s40, s50, s20
 buffer_load_dwordx4 a[196:199], v0, s[8:11], s40 offen sc1
 v_mfma_f32_16x16x32_bf16 a[0:3], v[184:187], v[88:91], a[0:3]
 s_waitcnt vmcnt(43)
 v_mfma_f32_16x16x32_bf16 a[4:7], v[144:147], v[40:43], a[4:7]
 v_mfma_f32_16x16x32_bf16 a[4:7], v[184:187], v[96:99], a[4:7]
 s_waitcnt vmcnt(41)
 s_add_u32 s51, s64, 496640
 s_add_u32 s40, s51, s20
 buffer_load_dwordx4 a[216:219], v0, s[8:11], s40 offen sc1
 v_mfma_f32_16x16x32_bf16 a[8:11], v[144:147], v[48:51], a[8:11]
 v_mfma_f32_16x16x32_bf16 a[8:11], v[184:187], v[104:107], a[8:11]
 s_waitcnt vmcnt(40)
 v_mfma_f32_16x16x32_bf16 a[12:15], v[144:147], v[56:59], a[12:15]
 s_add_u32 s48, s60, 688128
 s_add_u32 s40, s48, s84
 buffer_load_dwordx4 a[140:143], v0, s[4:7], s40 offen sc1
 v_mfma_f32_16x16x32_bf16 a[12:15], v[184:187], v[112:115], a[12:15]
 s_waitcnt vmcnt(39)
 v_mfma_f32_16x16x32_bf16 a[16:19], v[144:147], v[64:67], a[16:19]
 v_mfma_f32_16x16x32_bf16 a[16:19], v[184:187], v[120:123], a[16:19]
 s_waitcnt vmcnt(37)
 s_add_u32 s49, s60, 695296
 s_add_u32 s40, s49, s84
 buffer_load_dwordx4 a[168:171], v0, s[4:7], s40 offen sc1
 v_mfma_f32_16x16x32_bf16 a[20:23], v[144:147], v[72:75], a[20:23]
 v_mfma_f32_16x16x32_bf16 a[20:23], v[184:187], v[128:131], a[20:23]
 s_waitcnt vmcnt(36)
 v_mfma_f32_16x16x32_bf16 a[24:27], v[144:147], v[80:83], a[24:27]
 s_add_u32 s40, s48, s85
 buffer_load_dwordx4 a[144:147], v0, s[4:7], s40 offen sc1
 v_mfma_f32_16x16x32_bf16 a[24:27], v[184:187], v[136:139], a[24:27]
 s_branch SK9373
C2_2:
PG9373:
 s_branch PG10792
SK9373:
 s_waitcnt vmcnt(35)
 v_mfma_f32_16x16x32_bf16 a[28:31], v[152:155], v[32:35], a[28:31]
 v_mfma_f32_16x16x32_bf16 a[28:31], v[192:195], v[88:91], a[28:31]
 s_add_u32 s40, s49, s85
 buffer_load_dwordx4 a[172:175], v0, s[4:7], s40 offen sc1
 v_mfma_f32_16x16x32_bf16 a[32:35], v[152:155], v[40:43], a[32:35]
 v_mfma_f32_16x16x32_bf16 a[32:35], v[192:195], v[96:99], a[32:35]
 v_mfma_f32_16x16x32_bf16 a[36:39], v[152:155], v[48:51], a[36:39]
 s_add_u32 s40, s48, s86
 buffer_load_dwordx4 a[148:151], v0, s[4:7], s40 offen sc1
 v_mfma_f32_16x16x32_bf16 a[36:39], v[192:195], v[104:107], a[36:39]
 v_mfma_f32_16x16x32_bf16 a[40:43], v[152:155], v[56:59], a[40:43]
 v_mfma_f32_16x16x32_bf16 a[40:43], v[192:195], v[112:115], a[40:43]
 s_add_u32 s40, s49, s86
 buffer_load_dwordx4 a[176:179], v0, s[4:7], s40 offen sc1
 v_mfma_f32_16x16x32_bf16 a[44:47], v[152:155], v[64:67], a[44:47]
 v_mfma_f32_16x16x32_bf16 a[44:47], v[192:195], v[120:123], a[44:47]
 v_mfma_f32_16x16x32_bf16 a[48:51], v[152:155], v[72:75], a[48:51]
 s_add_u32 s40, s48, s87
 buffer_load_dwordx4 a[152:155], v0, s[4:7], s40 offen sc1
 v_mfma_f32_16x16x32_bf16 a[48:51], v[192:195], v[128:131], a[48:51]
 v_mfma_f32_16x16x32_bf16 a[52:55], v[152:155], v[80:83], a[52:55]
 v_mfma_f32_16x16x32_bf16 a[52:55], v[192:195], v[136:139], a[52:55]
 s_waitcnt vmcnt(37)
 s_add_u32 s40, s49, s87
 buffer_load_dwordx4 a[180:183], v0, s[4:7], s40 offen sc1
 v_mfma_f32_16x16x32_bf16 a[56:59], v[160:163], v[32:35], a[56:59]
 v_mfma_f32_16x16x32_bf16 a[56:59], v[36:39], v[88:91], a[56:59]
 v_mfma_f32_16x16x32_bf16 a[60:63], v[160:163], v[40:43], a[60:63]
 s_load_dwordx4 s[44:47], s[80:81], s67 glc
 s_add_u32 s40, s48, s96
 buffer_load_dwordx4 a[156:159], v0, s[4:7], s40 offen sc1
 v_mfma_f32_16x16x32_bf16 a[60:63], v[36:39], v[96:99], a[60:63]
 v_mfma_f32_16x16x32_bf16 a[64:67], v[160:163], v[48:51], a[64:67]
 v_mfma_f32_16x16x32_bf16 a[64:67], v[36:39], v[104:107], a[64:67]
 s_add_u32 s40, s49, s96
 buffer_load_dwordx4 a[184:187], v0, s[4:7], s40 offen sc1
 v_mfma_f32_16x16x32_bf16 a[68:71], v[160:163], v[56:59], a[68:71]
 v_mfma_f32_16x16x32_bf16 a[68:71], v[36:39], v[112:115], a[68:71]
 v_mfma_f32_16x16x32_bf16 a[72:75], v[160:163], v[64:67], a[72:75]
 s_add_u32 s40, s48, s97
 buffer_load_dwordx4 a[160:163], v0, s[4:7], s40 offen sc1
 v_mfma_f32_16x16x32_bf16 a[72:75], v[36:39], v[120:123], a[72:75]
 v_mfma_f32_16x16x32_bf16 a[76:79], v[160:163], v[72:75], a[76:79]
 v_mfma_f32_16x16x32_bf16 a[76:79], v[36:39], v[128:131], a[76:79]
 s_add_u32 s40, s49, s97
 buffer_load_dwordx4 a[188:191], v0, s[4:7], s40 offen sc1
 v_mfma_f32_16x16x32_bf16 a[80:83], v[160:163], v[80:83], a[80:83]
 v_mfma_f32_16x16x32_bf16 a[80:83], v[36:39], v[136:139], a[80:83]
 s_waitcnt vmcnt(40)
 v_mfma_f32_16x16x32_bf16 a[84:87], v[168:171], v[32:35], a[84:87]
 s_add_u32 s40, s48, s98
 buffer_load_dwordx4 a[164:167], v0, s[4:7], s40 offen sc1
 v_mfma_f32_16x16x32_bf16 a[84:87], v[68:71], v[88:91], a[84:87]
 v_mfma_f32_16x16x32_bf16 a[88:91], v[168:171], v[40:43], a[88:91]
 v_mfma_f32_16x16x32_bf16 a[88:91], v[68:71], v[96:99], a[88:91]
 s_add_u32 s40, s49, s98
 buffer_load_dwordx4 a[192:195], v0, s[4:7], s40 offen sc1
 v_mfma_f32_16x16x32_bf16 a[92:95], v[168:171], v[48:51], a[92:95]
 v_mfma_f32_16x16x32_bf16 a[92:95], v[68:71], v[104:107], a[92:95]
 v_mfma_f32_16x16x32_bf16 a[96:99], v[168:171], v[56:59], a[96:99]
 s_add_u32 s40, s50, s21
 buffer_load_dwordx4 a[200:203], v0, s[8:11], s40 offen sc1
 v_mfma_f32_16x16x32_bf16 a[96:99], v[68:71], v[112:115], a[96:99]
 v_mfma_f32_16x16x32_bf16 a[100:103], v[168:171], v[64:67], a[100:103]
 s_mul_i32 s54, s52, 286720
 v_mfma_f32_16x16x32_bf16 a[100:103], v[68:71], v[120:123], a[100:103]
 s_add_u32 s40, s51, s21
 buffer_load_dwordx4 a[220:223], v0, s[8:11], s40 offen sc1
 s_mul_i32 s55, s3, 1280
 v_mfma_f32_16x16x32_bf16 a[104:107], v[168:171], v[72:75], a[104:107]
 v_bfe_u32 v204, v0, 4, 4
 v_mul_u32_u24 v204, 2560, v204
 s_add_u32 s54, s54, s55
 v_mfma_f32_16x16x32_bf16 a[104:107], v[68:71], v[128:131], a[104:107]
 v_lshrrev_b32 v205, 8, v0
 v_lshl_add_u32 v204, v205, 3, v204
 s_mul_i32 s55, s53, 160
 v_mfma_f32_16x16x32_bf16 a[108:111], v[168:171], v[80:83], a[108:111]
 s_add_u32 s40, s50, s22
 buffer_load_dwordx4 a[204:207], v0, s[8:11], s40 offen sc1
 s_add_u32 s54, s54, s55
 v_mfma_f32_16x16x32_bf16 a[108:111], v[68:71], v[136:139], a[108:111]
 s_waitcnt vmcnt(43)
 v_lshl_add_u32 v206, v205, 3, v204
 v_and_b32_e64 v205, s53, 1
 s_and_b32 s55, s53, 1
 s_lshl_b32 s55, s55, 7
 s_sub_u32 s54, s54, s55
 v_mfma_f32_16x16x32_bf16 a[112:115], v[176:179], v[32:35], a[112:115]
 v_mul_u32_u24 v205, 160, v205
 v_add_u32 v206, v205, v206
 s_add_u32 s12, s68, s54
 s_addc_u32 s13, s69, 0
 v_mfma_f32_16x16x32_bf16 a[112:115], v[100:103], v[88:91], a[112:115]
 s_add_u32 s40, s51, s22
 buffer_load_dwordx4 a[224:227], v0, s[8:11], s40 offen sc1
 s_and_b32 s13, s13, 0xffff
 v_mfma_f32_16x16x32_bf16 a[116:119], v[176:179], v[40:43], a[116:119]
 v_mov_b32 v200, v0
 v_add_u32 v201, 0x10000, v0
 s_sub_u32 s14, 4587520, s54
 v_mfma_f32_16x16x32_bf16 a[116:119], v[100:103], v[96:99], a[116:119]
 s_mov_b32 s15, 0x20000
 v_mfma_f32_16x16x32_bf16 a[120:123], v[176:179], v[48:51], a[120:123]
 s_add_u32 s40, s50, s23
 buffer_load_dwordx4 a[208:211], v0, s[8:11], s40 offen sc1
 v_mfma_f32_16x16x32_bf16 a[120:123], v[100:103], v[104:107], a[120:123]
 v_mfma_f32_16x16x32_bf16 a[124:127], v[176:179], v[56:59], a[124:127]
 v_mfma_f32_16x16x32_bf16 a[124:127], v[100:103], v[112:115], a[124:127]
 s_add_u32 s40, s51, s23
 buffer_load_dwordx4 a[228:231], v0, s[8:11], s40 offen sc1
 v_mfma_f32_16x16x32_bf16 a[128:131], v[176:179], v[64:67], a[128:131]
 v_mfma_f32_16x16x32_bf16 a[128:131], v[100:103], v[120:123], a[128:131]
 v_mfma_f32_16x16x32_bf16 a[132:135], v[176:179], v[72:75], a[132:135]
 s_add_u32 s40, s50, s28
 buffer_load_dwordx4 a[212:215], v0, s[8:11], s40 offen sc1
 v_mfma_f32_16x16x32_bf16 a[132:135], v[100:103], v[128:131], a[132:135]
 v_mfma_f32_16x16x32_bf16 a[136:139], v[176:179], v[80:83], a[136:139]
 v_mfma_f32_16x16x32_bf16 a[136:139], v[100:103], v[136:139], a[136:139]
 s_add_u32 s40, s51, s28
 buffer_load_dwordx4 a[232:235], v0, s[8:11], s40 offen sc1
 s_waitcnt vmcnt(44)
 v_mfma_f32_16x16x32_bf16 a[0:3], v[124:127], v[8:11], a[0:3]
 s_waitcnt lgkmcnt(0)
 s_min_u32 s55, s44, s46
 s_cmp_ge_u32 s55, 5
 s_cbranch_scc0 P2_SPIN10
P2_GO10:
 s_add_u32 s50, s65, 0
 s_add_u32 s40, s50, s20
 buffer_load_dwordx4 v[144:147], v0, s[8:11], s40 offen sc1
 v_mfma_f32_16x16x32_bf16 a[0:3], v[164:167], v[52:55], a[0:3]
 s_waitcnt vmcnt(43)
 v_mfma_f32_16x16x32_bf16 a[4:7], v[124:127], v[12:15], a[4:7]
 v_mfma_f32_16x16x32_bf16 a[4:7], v[164:167], v[60:63], a[4:7]
 s_waitcnt vmcnt(41)
 s_add_u32 s51, s65, 5120
 s_add_u32 s40, s51, s20
 buffer_load_dwordx4 v[184:187], v0, s[8:11], s40 offen sc1
 v_mfma_f32_16x16x32_bf16 a[8:11], v[124:127], v[16:19], a[8:11]
 v_mfma_f32_16x16x32_bf16 a[8:11], v[164:167], v[76:79], a[8:11]
 s_waitcnt vmcnt(40)
 v_mfma_f32_16x16x32_bf16 a[12:15], v[124:127], v[20:23], a[12:15]
 s_add_u32 s48, s61, 0
 s_add_u32 s40, s48, s84
 buffer_load_dwordx4 v[32:35], v0, s[4:7], s40 offen sc1
 v_mfma_f32_16x16x32_bf16 a[12:15], v[164:167], v[84:87], a[12:15]
 s_waitcnt vmcnt(39)
 v_mfma_f32_16x16x32_bf16 a[16:19], v[124:127], v[24:27], a[16:19]
 v_mfma_f32_16x16x32_bf16 a[16:19], v[164:167], v[92:95], a[16:19]
 s_waitcnt vmcnt(37)
 s_add_u32 s49, s61, 7168
 s_add_u32 s40, s49, s84
 buffer_load_dwordx4 v[88:91], v0, s[4:7], s40 offen sc1
 v_mfma_f32_16x16x32_bf16 a[20:23], v[124:127], v[28:31], a[20:23]
 v_mfma_f32_16x16x32_bf16 a[20:23], v[164:167], v[108:111], a[20:23]
 s_waitcnt vmcnt(36)
 v_mfma_f32_16x16x32_bf16 a[24:27], v[124:127], v[44:47], a[24:27]
 s_add_u32 s40, s48, s85
 buffer_load_dwordx4 v[40:43], v0, s[4:7], s40 offen sc1
 v_mfma_f32_16x16x32_bf16 a[24:27], v[164:167], v[116:119], a[24:27]
 s_waitcnt vmcnt(35)
 v_mfma_f32_16x16x32_bf16 a[28:31], v[132:135], v[8:11], a[28:31]
 v_mfma_f32_16x16x32_bf16 a[28:31], v[172:175], v[52:55], a[28:31]
 s_add_u32 s40, s49, s85
 buffer_load_dwordx4 v[96:99], v0, s[4:7], s40 offen sc1
 v_mfma_f32_16x16x32_bf16 a[32:35], v[132:135], v[12:15], a[32:35]
 v_mfma_f32_16x16x32_bf16 a[32:35], v[172:175], v[60:63], a[32:35]
 v_mfma_f32_16x16x32_bf16 a[36:39], v[132:135], v[16:19], a[36:39]
 s_add_u32 s40, s48, s86
 buffer_load_dwordx4 v[48:51], v0, s[4:7], s40 offen sc1
 v_mfma_f32_16x16x32_bf16 a[36:39], v[172:175], v[76:79], a[36:39]
 v_mfma_f32_16x16x32_bf16 a[40:43], v[132:135], v[20:23], a[40:43]
 v_mfma_f32_16x16x32_bf16 a[40:43], v[172:175], v[84:87], a[40:43]
 s_add_u32 s40, s49, s86
 buffer_load_dwordx4 v[104:107], v0, s[4:7], s40 offen sc1
 v_mfma_f32_16x16x32_bf16 a[44:47], v[132:135], v[24:27], a[44:47]
 v_mfma_f32_16x16x32_bf16 a[44:47], v[172:175], v[92:95], a[44:47]
 v_mfma_f32_16x16x32_bf16 a[48:51], v[132:135], v[28:31], a[48:51]
 s_add_u32 s40, s48, s87
 buffer_load_dwordx4 v[56:59], v0, s[4:7], s40 offen sc1
 v_mfma_f32_16x16x32_bf16 a[48:51], v[172:175], v[108:111], a[48:51]
 v_mfma_f32_16x16x32_bf16 a[52:55], v[132:135], v[44:47], a[52:55]
 v_mfma_f32_16x16x32_bf16 a[52:55], v[172:175], v[116:119], a[52:55]
 s_waitcnt vmcnt(37)
 s_add_u32 s40, s49, s87
 buffer_load_dwordx4 v[112:115], v0, s[4:7], s40 offen sc1
 v_mfma_f32_16x16x32_bf16 a[56:59], v[140:143], v[8:11], a[56:59]
 v_mfma_f32_16x16x32_bf16 a[56:59], v[180:183], v[52:55], a[56:59]
 v_mfma_f32_16x16x32_bf16 a[60:63], v[140:143], v[12:15], a[60:63]
 s_add_u32 s40, s48, s96
 buffer_load_dwordx4 v[64:67], v0, s[4:7], s40 offen sc1
 v_mfma_f32_16x16x32_bf16 a[60:63], v[180:183], v[60:63], a[60:63]
 v_mfma_f32_16x16x32_bf16 a[64:67], v[140:143], v[16:19], a[64:67]
 v_mfma_f32_16x16x32_bf16 a[64:67], v[180:183], v[76:79], a[64:67]
 s_add_u32 s40, s49, s96
 buffer_load_dwordx4 v[120:123], v0, s[4:7], s40 offen sc1
 v_mfma_f32_16x16x32_bf16 a[68:71], v[140:143], v[20:23], a[68:71]
 v_mfma_f32_16x16x32_bf16 a[68:71], v[180:183], v[84:87], a[68:71]
 v_mfma_f32_16x16x32_bf16 a[72:75], v[140:143], v[24:27], a[72:75]
 s_add_u32 s40, s48, s97
 buffer_load_dwordx4 v[72:75], v0, s[4:7], s40 offen sc1
 v_mfma_f32_16x16x32_bf16 a[72:75], v[180:183], v[92:95], a[72:75]
 v_mfma_f32_16x16x32_bf16 a[76:79], v[140:143], v[28:31], a[76:79]
 v_mfma_f32_16x16x32_bf16 a[76:79], v[180:183], v[108:111], a[76:79]
 s_add_u32 s40, s49, s97
 buffer_load_dwordx4 v[128:131], v0, s[4:7], s40 offen sc1
 v_mfma_f32_16x16x32_bf16 a[80:83], v[140:143], v[44:47], a[80:83]
 v_mfma_f32_16x16x32_bf16 a[80:83], v[180:183], v[116:119], a[80:83]
 s_waitcnt vmcnt(40)
 v_mfma_f32_16x16x32_bf16 a[84:87], v[148:151], v[8:11], a[84:87]
 s_add_u32 s40, s48, s98
 buffer_load_dwordx4 v[80:83], v0, s[4:7], s40 offen sc1
 v_mfma_f32_16x16x32_bf16 a[84:87], v[188:191], v[52:55], a[84:87]
 v_mfma_f32_16x16x32_bf16 a[88:91], v[148:151], v[12:15], a[88:91]
 v_mfma_f32_16x16x32_bf16 a[88:91], v[188:191], v[60:63], a[88:91]
 s_add_u32 s40, s49, s98
 buffer_load_dwordx4 v[136:139], v0, s[4:7], s40 offen sc1
 v_mfma_f32_16x16x32_bf16 a[92:95], v[148:151], v[16:19], a[92:95]
 v_mfma_f32_16x16x32_bf16 a[92:95], v[188:191], v[76:79], a[92:95]
 v_mfma_f32_16x16x32_bf16 a[96:99], v[148:151], v[20:23], a[96:99]
 s_add_u32 s40, s50, s21
 buffer_load_dwordx4 v[152:155], v0, s[8:11], s40 offen sc1
 v_mfma_f32_16x16x32_bf16 a[96:99], v[188:191], v[84:87], a[96:99]
 v_mfma_f32_16x16x32_bf16 a[100:103], v[148:151], v[24:27], a[100:103]
 v_mfma_f32_16x16x32_bf16 a[100:103], v[188:191], v[92:95], a[100:103]
 s_add_u32 s40, s51, s21
 buffer_load_dwordx4 v[192:195], v0, s[8:11], s40 offen sc1
 v_mfma_f32_16x16x32_bf16 a[104:107], v[148:151], v[28:31], a[104:107]
 v_mfma_f32_16x16x32_bf16 a[104:107], v[188:191], v[108:111], a[104:107]
 v_mfma_f32_16x16x32_bf16 a[108:111], v[148:151], v[44:47], a[108:111]
 s_add_u32 s40, s50, s22
 buffer_load_dwordx4 v[160:163], v0, s[8:11], s40 offen sc1
 v_mfma_f32_16x16x32_bf16 a[108:111], v[188:191], v[116:119], a[108:111]
 s_waitcnt vmcnt(43)
 v_mfma_f32_16x16x32_bf16 a[112:115], v[156:159], v[8:11], a[112:115]
 v_mfma_f32_16x16x32_bf16 a[112:115], v[196:199], v[52:55], a[112:115]
 s_add_u32 s40, s51, s22
 buffer_load_dwordx4 v[36:39], v0, s[8:11], s40 offen sc1
 v_mfma_f32_16x16x32_bf16 a[116:119], v[156:159], v[12:15], a[116:119]
 v_mfma_f32_16x16x32_bf16 a[116:119], v[196:199], v[60:63], a[116:119]
 v_mfma_f32_16x16x32_bf16 a[120:123], v[156:159], v[16:19], a[120:123]
 s_add_u32 s40, s50, s23
 buffer_load_dwordx4 v[168:171], v0, s[8:11], s40 offen sc1
 v_mfma_f32_16x16x32_bf16 a[120:123], v[196:199], v[76:79], a[120:123]
 v_mfma_f32_16x16x32_bf16 a[124:127], v[156:159], v[20:23], a[124:127]
 v_mfma_f32_16x16x32_bf16 a[124:127], v[196:199], v[84:87], a[124:127]
 s_add_u32 s40, s51, s23
 buffer_load_dwordx4 v[68:71], v0, s[8:11], s40 offen sc1
 v_mfma_f32_16x16x32_bf16 a[128:131], v[156:159], v[24:27], a[128:131]
 v_mfma_f32_16x16x32_bf16 a[128:131], v[196:199], v[92:95], a[128:131]
 v_mfma_f32_16x16x32_bf16 a[132:135], v[156:159], v[28:31], a[132:135]
 s_add_u32 s40, s50, s28
 buffer_load_dwordx4 v[176:179], v0, s[8:11], s40 offen sc1
 v_mfma_f32_16x16x32_bf16 a[132:135], v[196:199], v[108:111], a[132:135]
 v_mfma_f32_16x16x32_bf16 a[136:139], v[156:159], v[44:47], a[136:139]
 v_mfma_f32_16x16x32_bf16 a[136:139], v[196:199], v[116:119], a[136:139]
 s_add_u32 s40, s51, s28
 buffer_load_dwordx4 v[100:103], v0, s[8:11], s40 offen sc1
 s_waitcnt vmcnt(44)
 v_mfma_f32_16x16x32_bf16 a[0:3], a[196:199], a[140:143], a[0:3]
 s_add_u32 s50, s65, 163840
 s_add_u32 s40, s50, s20
 buffer_load_dwordx4 v[124:127], v0, s[8:11], s40 offen sc1
 v_mfma_f32_16x16x32_bf16 a[0:3], a[216:219], a[168:171], a[0:3]
 s_waitcnt vmcnt(43)
 v_mfma_f32_16x16x32_bf16 a[4:7], a[196:199], a[144:147], a[4:7]
 v_mfma_f32_16x16x32_bf16 a[4:7], a[216:219], a[172:175], a[4:7]
 s_waitcnt vmcnt(41)
 s_add_u32 s51, s65, 168960
 s_add_u32 s40, s51, s20
 buffer_load_dwordx4 v[164:167], v0, s[8:11], s40 offen sc1
 v_mfma_f32_16x16x32_bf16 a[8:11], a[196:199], a[148:151], a[8:11]
 v_mfma_f32_16x16x32_bf16 a[8:11], a[216:219], a[176:179], a[8:11]
 s_waitcnt vmcnt(40)
 v_mfma_f32_16x16x32_bf16 a[12:15], a[196:199], a[152:155], a[12:15]
 s_add_u32 s48, s61, 229376
 s_add_u32 s40, s48, s84
 buffer_load_dwordx4 v[8:11], v0, s[4:7], s40 offen sc1
 v_mfma_f32_16x16x32_bf16 a[12:15], a[216:219], a[180:183], a[12:15]
 s_waitcnt vmcnt(39)
 v_mfma_f32_16x16x32_bf16 a[16:19], a[196:199], a[156:159], a[16:19]
 v_mfma_f32_16x16x32_bf16 a[16:19], a[216:219], a[184:187], a[16:19]
 s_waitcnt vmcnt(37)
 s_add_u32 s49, s61, 236544
 s_add_u32 s40, s49, s84
 buffer_load_dwordx4 v[52:55], v0, s[4:7], s40 offen sc1
 v_mfma_f32_16x16x32_bf16 a[20:23], a[196:199], a[160:163], a[20:23]
 v_mfma_f32_16x16x32_bf16 a[20:23], a[216:219], a[188:191], a[20:23]
 s_waitcnt vmcnt(36)
 v_mfma_f32_16x16x32_bf16 a[24:27], a[196:199], a[164:167], a[24:27]
 s_add_u32 s40, s48, s85
 buffer_load_dwordx4 v[12:15], v0, s[4:7], s40 offen sc1
 v_mfma_f32_16x16x32_bf16 a[24:27], a[216:219], a[192:195], a[24:27]
 s_waitcnt vmcnt(35)
 v_mfma_f32_16x16x32_bf16 a[28:31], a[200:203], a[140:143], a[28:31]
 v_mfma_f32_16x16x32_bf16 a[28:31], a[220:223], a[168:171], a[28:31]
 s_add_u32 s40, s49, s85
 buffer_load_dwordx4 v[60:63], v0, s[4:7], s40 offen sc1
 v_mfma_f32_16x16x32_bf16 a[32:35], a[200:203], a[144:147], a[32:35]
 v_mfma_f32_16x16x32_bf16 a[32:35], a[220:223], a[172:175], a[32:35]
 v_mfma_f32_16x16x32_bf16 a[36:39], a[200:203], a[148:151], a[36:39]
 s_add_u32 s40, s48, s86
 buffer_load_dwordx4 v[16:19], v0, s[4:7], s40 offen sc1
 v_mfma_f32_16x16x32_bf16 a[36:39], a[220:223], a[176:179], a[36:39]
 v_mfma_f32_16x16x32_bf16 a[40:43], a[200:203], a[152:155], a[40:43]
 v_mfma_f32_16x16x32_bf16 a[40:43], a[220:223], a[180:183], a[40:43]
 s_add_u32 s40, s49, s86
 buffer_load_dwordx4 v[76:79], v0, s[4:7], s40 offen sc1
 v_mfma_f32_16x16x32_bf16 a[44:47], a[200:203], a[156:159], a[44:47]
 v_mfma_f32_16x16x32_bf16 a[44:47], a[220:223], a[184:187], a[44:47]
 v_mfma_f32_16x16x32_bf16 a[48:51], a[200:203], a[160:163], a[48:51]
 s_add_u32 s40, s48, s87
 buffer_load_dwordx4 v[20:23], v0, s[4:7], s40 offen sc1
 v_mfma_f32_16x16x32_bf16 a[48:51], a[220:223], a[188:191], a[48:51]
 v_mfma_f32_16x16x32_bf16 a[52:55], a[200:203], a[164:167], a[52:55]
 v_mfma_f32_16x16x32_bf16 a[52:55], a[220:223], a[192:195], a[52:55]
 s_waitcnt vmcnt(37)
 s_add_u32 s40, s49, s87
 buffer_load_dwordx4 v[84:87], v0, s[4:7], s40 offen sc1
 v_mfma_f32_16x16x32_bf16 a[56:59], a[204:207], a[140:143], a[56:59]
 v_mfma_f32_16x16x32_bf16 a[56:59], a[224:227], a[168:171], a[56:59]
 v_mfma_f32_16x16x32_bf16 a[60:63], a[204:207], a[144:147], a[60:63]
 s_add_u32 s40, s48, s96
 buffer_load_dwordx4 v[24:27], v0, s[4:7], s40 offen sc1
 v_mfma_f32_16x16x32_bf16 a[60:63], a[224:227], a[172:175], a[60:63]
 v_mfma_f32_16x16x32_bf16 a[64:67], a[204:207], a[148:151], a[64:67]
 v_mfma_f32_16x16x32_bf16 a[64:67], a[224:227], a[176:179], a[64:67]
 s_add_u32 s40, s49, s96
 buffer_load_dwordx4 v[92:95], v0, s[4:7], s40 offen sc1
 v_mfma_f32_16x16x32_bf16 a[68:71], a[204:207], a[152:155], a[68:71]
 v_mfma_f32_16x16x32_bf16 a[68:71], a[224:227], a[180:183], a[68:71]
 v_mfma_f32_16x16x32_bf16 a[72:75], a[204:207], a[156:159], a[72:75]
 s_add_u32 s40, s48, s97
 buffer_load_dwordx4 v[28:31], v0, s[4:7], s40 offen sc1
 v_mfma_f32_16x16x32_bf16 a[72:75], a[224:227], a[184:187], a[72:75]
 v_mfma_f32_16x16x32_bf16 a[76:79], a[204:207], a[160:163], a[76:79]
 v_mfma_f32_16x16x32_bf16 a[76:79], a[224:227], a[188:191], a[76:79]
 s_add_u32 s40, s49, s97
 buffer_load_dwordx4 v[108:111], v0, s[4:7], s40 offen sc1
 v_mfma_f32_16x16x32_bf16 a[80:83], a[204:207], a[164:167], a[80:83]
 v_mfma_f32_16x16x32_bf16 a[80:83], a[224:227], a[192:195], a[80:83]
 s_waitcnt vmcnt(40)
 v_mfma_f32_16x16x32_bf16 a[84:87], a[208:211], a[140:143], a[84:87]
 s_add_u32 s40, s48, s98
 buffer_load_dwordx4 v[44:47], v0, s[4:7], s40 offen sc1
 v_mfma_f32_16x16x32_bf16 a[84:87], a[228:231], a[168:171], a[84:87]
 v_mfma_f32_16x16x32_bf16 a[88:91], a[208:211], a[144:147], a[88:91]
 v_mfma_f32_16x16x32_bf16 a[88:91], a[228:231], a[172:175], a[88:91]
 s_add_u32 s40, s49, s98
 buffer_load_dwordx4 v[116:119], v0, s[4:7], s40 offen sc1
 v_mfma_f32_16x16x32_bf16 a[92:95], a[208:211], a[148:151], a[92:95]
 v_mfma_f32_16x16x32_bf16 a[92:95], a[228:231], a[176:179], a[92:95]
 v_mfma_f32_16x16x32_bf16 a[96:99], a[208:211], a[152:155], a[96:99]
 s_add_u32 s40, s50, s21
 buffer_load_dwordx4 v[132:135], v0, s[8:11], s40 offen sc1
 v_mfma_f32_16x16x32_bf16 a[96:99], a[228:231], a[180:183], a[96:99]
 v_mfma_f32_16x16x32_bf16 a[100:103], a[208:211], a[156:159], a[100:103]
 v_mfma_f32_16x16x32_bf16 a[100:103], a[228:231], a[184:187], a[100:103]
 s_add_u32 s40, s51, s21
 buffer_load_dwordx4 v[172:175], v0, s[8:11], s40 offen sc1
 v_mfma_f32_16x16x32_bf16 a[104:107], a[208:211], a[160:163], a[104:107]
 v_mfma_f32_16x16x32_bf16 a[104:107], a[228:231], a[188:191], a[104:107]
 v_mfma_f32_16x16x32_bf16 a[108:111], a[208:211], a[164:167], a[108:111]
 s_add_u32 s40, s50, s22
 buffer_load_dwordx4 v[140:143], v0, s[8:11], s40 offen sc1
 v_mfma_f32_16x16x32_bf16 a[108:111], a[228:231], a[192:195], a[108:111]
 s_waitcnt vmcnt(43)
 v_mfma_f32_16x16x32_bf16 a[112:115], a[212:215], a[140:143], a[112:115]
 v_mfma_f32_16x16x32_bf16 a[112:115], a[232:235], a[168:171], a[112:115]
 s_add_u32 s40, s51, s22
 buffer_load_dwordx4 v[180:183], v0, s[8:11], s40 offen sc1
 v_mfma_f32_16x16x32_bf16 a[116:119], a[212:215], a[144:147], a[116:119]
 v_mfma_f32_16x16x32_bf16 a[116:119], a[232:235], a[172:175], a[116:119]
 v_mfma_f32_16x16x32_bf16 a[120:123], a[212:215], a[148:151], a[120:123]
 s_add_u32 s40, s50, s23
 buffer_load_dwordx4 v[148:151], v0, s[8:11], s40 offen sc1
 v_mfma_f32_16x16x32_bf16 a[120:123], a[232:235], a[176:179], a[120:123]
 v_mfma_f32_16x16x32_bf16 a[124:127], a[212:215], a[152:155], a[124:127]
 v_mfma_f32_16x16x32_bf16 a[124:127], a[232:235], a[180:183], a[124:127]
 s_add_u32 s40, s51, s23
 buffer_load_dwordx4 v[188:191], v0, s[8:11], s40 offen sc1
 v_mfma_f32_16x16x32_bf16 a[128:131], a[212:215], a[156:159], a[128:131]
 v_mfma_f32_16x16x32_bf16 a[128:131], a[232:235], a[184:187], a[128:131]
 v_mfma_f32_16x16x32_bf16 a[132:135], a[212:215], a[160:163], a[132:135]
 s_add_u32 s40, s50, s28
 buffer_load_dwordx4 v[156:159], v0, s[8:11], s40 offen sc1
 v_mfma_f32_16x16x32_bf16 a[132:135], a[232:235], a[188:191], a[132:135]
 v_mfma_f32_16x16x32_bf16 a[136:139], a[212:215], a[164:167], a[136:139]
 v_mfma_f32_16x16x32_bf16 a[136:139], a[232:235], a[192:195], a[136:139]
 s_add_u32 s40, s51, s28
 buffer_load_dwordx4 v[196:199], v0, s[8:11], s40 offen sc1
 s_waitcnt vmcnt(44)
 v_mfma_f32_16x16x32_bf16 a[0:3], v[144:147], v[32:35], a[0:3]
 s_add_u32 s50, s65, 327680
 s_add_u32 s40, s50, s20
 buffer_load_dwordx4 a[196:199], v0, s[8:11], s40 offen sc1
 v_mfma_f32_16x16x32_bf16 a[0:3], v[184:187], v[88:91], a[0:3]
 s_waitcnt vmcnt(43)
 v_mfma_f32_16x16x32_bf16 a[4:7], v[144:147], v[40:43], a[4:7]
 v_mfma_f32_16x16x32_bf16 a[4:7], v[184:187], v[96:99], a[4:7]
 s_waitcnt vmcnt(41)
 s_add_u32 s51, s65, 332800
 s_add_u32 s40, s51, s20
 buffer_load_dwordx4 a[216:219], v0, s[8:11], s40 offen sc1
 v_mfma_f32_16x16x32_bf16 a[8:11], v[144:147], v[48:51], a[8:11]
 v_mfma_f32_16x16x32_bf16 a[8:11], v[184:187], v[104:107], a[8:11]
 s_waitcnt vmcnt(40)
 v_mfma_f32_16x16x32_bf16 a[12:15], v[144:147], v[56:59], a[12:15]
 s_add_u32 s48, s61, 458752
 s_add_u32 s40, s48, s84
 buffer_load_dwordx4 a[140:143], v0, s[4:7], s40 offen sc1
 v_mfma_f32_16x16x32_bf16 a[12:15], v[184:187], v[112:115], a[12:15]
 s_waitcnt vmcnt(39)
 v_mfma_f32_16x16x32_bf16 a[16:19], v[144:147], v[64:67], a[16:19]
 v_mfma_f32_16x16x32_bf16 a[16:19], v[184:187], v[120:123], a[16:19]
 s_waitcnt vmcnt(37)
 s_add_u32 s49, s61, 465920
 s_add_u32 s40, s49, s84
 buffer_load_dwordx4 a[168:171], v0, s[4:7], s40 offen sc1
 v_mfma_f32_16x16x32_bf16 a[20:23], v[144:147], v[72:75], a[20:23]
 v_mfma_f32_16x16x32_bf16 a[20:23], v[184:187], v[128:131], a[20:23]
 s_waitcnt vmcnt(36)
 v_mfma_f32_16x16x32_bf16 a[24:27], v[144:147], v[80:83], a[24:27]
 s_add_u32 s40, s48, s85
 buffer_load_dwordx4 a[144:147], v0, s[4:7], s40 offen sc1
 v_mfma_f32_16x16x32_bf16 a[24:27], v[184:187], v[136:139], a[24:27]
 s_waitcnt vmcnt(35)
 v_mfma_f32_16x16x32_bf16 a[28:31], v[152:155], v[32:35], a[28:31]
 v_mfma_f32_16x16x32_bf16 a[28:31], v[192:195], v[88:91], a[28:31]
 s_add_u32 s40, s49, s85
 buffer_load_dwordx4 a[172:175], v0, s[4:7], s40 offen sc1
 v_mfma_f32_16x16x32_bf16 a[32:35], v[152:155], v[40:43], a[32:35]
 v_mfma_f32_16x16x32_bf16 a[32:35], v[192:195], v[96:99], a[32:35]
 v_mfma_f32_16x16x32_bf16 a[36:39], v[152:155], v[48:51], a[36:39]
 s_add_u32 s40, s48, s86
 buffer_load_dwordx4 a[148:151], v0, s[4:7], s40 offen sc1
 v_mfma_f32_16x16x32_bf16 a[36:39], v[192:195], v[104:107], a[36:39]
 v_mfma_f32_16x16x32_bf16 a[40:43], v[152:155], v[56:59], a[40:43]
 v_mfma_f32_16x16x32_bf16 a[40:43], v[192:195], v[112:115], a[40:43]
 s_add_u32 s40, s49, s86
 buffer_load_dwordx4 a[176:179], v0, s[4:7], s40 offen sc1
 v_mfma_f32_16x16x32_bf16 a[44:47], v[152:155], v[64:67], a[44:47]
 v_mfma_f32_16x16x32_bf16 a[44:47], v[192:195], v[120:123], a[44:47]
 v_mfma_f32_16x16x32_bf16 a[48:51], v[152:155], v[72:75], a[48:51]
 s_add_u32 s40, s48, s87
 buffer_load_dwordx4 a[152:155], v0, s[4:7], s40 offen sc1
 v_mfma_f32_16x16x32_bf16 a[48:51], v[192:195], v[128:131], a[48:51]
 v_mfma_f32_16x16x32_bf16 a[52:55], v[152:155], v[80:83], a[52:55]
 v_mfma_f32_16x16x32_bf16 a[52:55], v[192:195], v[136:139], a[52:55]
 s_waitcnt vmcnt(37)
 s_add_u32 s40, s49, s87
 buffer_load_dwordx4 a[180:183], v0, s[4:7], s40 offen sc1
 v_mfma_f32_16x16x32_bf16 a[56:59], v[160:163], v[32:35], a[56:59]
 v_mfma_f32_16x16x32_bf16 a[56:59], v[36:39], v[88:91], a[56:59]
 v_mfma_f32_16x16x32_bf16 a[60:63], v[160:163], v[40:43], a[60:63]
 s_add_u32 s40, s48, s96
 buffer_load_dwordx4 a[156:159], v0, s[4:7], s40 offen sc1
 v_mfma_f32_16x16x32_bf16 a[60:63], v[36:39], v[96:99], a[60:63]
 v_mfma_f32_16x16x32_bf16 a[64:67], v[160:163], v[48:51], a[64:67]
 v_mfma_f32_16x16x32_bf16 a[64:67], v[36:39], v[104:107], a[64:67]
 s_add_u32 s40, s49, s96
 buffer_load_dwordx4 a[184:187], v0, s[4:7], s40 offen sc1
 v_mfma_f32_16x16x32_bf16 a[68:71], v[160:163], v[56:59], a[68:71]
 v_mfma_f32_16x16x32_bf16 a[68:71], v[36:39], v[112:115], a[68:71]
 v_mfma_f32_16x16x32_bf16 a[72:75], v[160:163], v[64:67], a[72:75]
 s_add_u32 s40, s48, s97
 buffer_load_dwordx4 a[160:163], v0, s[4:7], s40 offen sc1
 v_mfma_f32_16x16x32_bf16 a[72:75], v[36:39], v[120:123], a[72:75]
 v_mfma_f32_16x16x32_bf16 a[76:79], v[160:163], v[72:75], a[76:79]
 v_mfma_f32_16x16x32_bf16 a[76:79], v[36:39], v[128:131], a[76:79]
 s_add_u32 s40, s49, s97
 buffer_load_dwordx4 a[188:191], v0, s[4:7], s40 offen sc1
 v_mfma_f32_16x16x32_bf16 a[80:83], v[160:163], v[80:83], a[80:83]
 v_mfma_f32_16x16x32_bf16 a[80:83], v[36:39], v[136:139], a[80:83]
 s_waitcnt vmcnt(40)
 v_mfma_f32_16x16x32_bf16 a[84:87], v[168:171], v[32:35], a[84:87]
 s_add_u32 s40, s48, s98
 buffer_load_dwordx4 a[164:167], v0, s[4:7], s40 offen sc1
 v_mfma_f32_16x16x32_bf16 a[84:87], v[68:71], v[88:91], a[84:87]
 v_mfma_f32_16x16x32_bf16 a[88:91], v[168:171], v[40:43], a[88:91]
 v_mfma_f32_16x16x32_bf16 a[88:91], v[68:71], v[96:99], a[88:91]
 s_add_u32 s40, s49, s98
 buffer_load_dwordx4 a[192:195], v0, s[4:7], s40 offen sc1
 v_mfma_f32_16x16x32_bf16 a[92:95], v[168:171], v[48:51], a[92:95]
 v_mfma_f32_16x16x32_bf16 a[92:95], v[68:71], v[104:107], a[92:95]
 v_mfma_f32_16x16x32_bf16 a[96:99], v[168:171], v[56:59], a[96:99]
 s_add_u32 s40, s50, s21
 buffer_load_dwordx4 a[200:203], v0, s[8:11], s40 offen sc1
 v_mfma_f32_16x16x32_bf16 a[96:99], v[68:71], v[112:115], a[96:99]
 v_mfma_f32_16x16x32_bf16 a[100:103], v[168:171], v[64:67], a[100:103]
 v_mfma_f32_16x16x32_bf16 a[100:103], v[68:71], v[120:123], a[100:103]
 s_add_u32 s40, s51, s21
 buffer_load_dwordx4 a[220:223], v0, s[8:11], s40 offen sc1
 v_mfma_f32_16x16x32_bf16 a[104:107], v[168:171], v[72:75], a[104:107]
 v_mfma_f32_16x16x32_bf16 a[104:107], v[68:71], v[128:131], a[104:107]
 v_mfma_f32_16x16x32_bf16 a[108:111], v[168:171], v[80:83], a[108:111]
 s_add_u32 s40, s50, s22
 buffer_load_dwordx4 a[204:207], v0, s[8:11], s40 offen sc1
 v_mfma_f32_16x16x32_bf16 a[108:111], v[68:71], v[136:139], a[108:111]
 s_waitcnt vmcnt(43)
 v_mfma_f32_16x16x32_bf16 a[112:115], v[176:179], v[32:35], a[112:115]
 v_mfma_f32_16x16x32_bf16 a[112:115], v[100:103], v[88:91], a[112:115]
 s_add_u32 s40, s51, s22
 buffer_load_dwordx4 a[224:227], v0, s[8:11], s40 offen sc1
 v_mfma_f32_16x16x32_bf16 a[116:119], v[176:179], v[40:43], a[116:119]
 v_mfma_f32_16x16x32_bf16 a[116:119], v[100:103], v[96:99], a[116:119]
 v_mfma_f32_16x16x32_bf16 a[120:123], v[176:179], v[48:51], a[120:123]
 s_add_u32 s40, s50, s23
 buffer_load_dwordx4 a[208:211], v0, s[8:11], s40 offen sc1
 v_mfma_f32_16x16x32_bf16 a[120:123], v[100:103], v[104:107], a[120:123]
 v_mfma_f32_16x16x32_bf16 a[124:127], v[176:179], v[56:59], a[124:127]
 v_mfma_f32_16x16x32_bf16 a[124:127], v[100:103], v[112:115], a[124:127]
 s_add_u32 s40, s51, s23
 buffer_load_dwordx4 a[228:231], v0, s[8:11], s40 offen sc1
 v_mfma_f32_16x16x32_bf16 a[128:131], v[176:179], v[64:67], a[128:131]
 v_mfma_f32_16x16x32_bf16 a[128:131], v[100:103], v[120:123], a[128:131]
 v_mfma_f32_16x16x32_bf16 a[132:135], v[176:179], v[72:75], a[132:135]
 s_add_u32 s40, s50, s28
 buffer_load_dwordx4 a[212:215], v0, s[8:11], s40 offen sc1
 v_mfma_f32_16x16x32_bf16 a[132:135], v[100:103], v[128:131], a[132:135]
 v_mfma_f32_16x16x32_bf16 a[136:139], v[176:179], v[80:83], a[136:139]
 v_mfma_f32_16x16x32_bf16 a[136:139], v[100:103], v[136:139], a[136:139]
 s_add_u32 s40, s51, s28
 buffer_load_dwordx4 a[232:235], v0, s[8:11], s40 offen sc1
 s_waitcnt vmcnt(44)
 v_mfma_f32_16x16x32_bf16 a[0:3], v[124:127], v[8:11], a[0:3]
 s_add_u32 s50, s65, 491520
 s_add_u32 s40, s50, s20
 buffer_load_dwordx4 v[144:147], v0, s[8:11], s40 offen sc1
 v_mfma_f32_16x16x32_bf16 a[0:3], v[164:167], v[52:55], a[0:3]
 s_waitcnt vmcnt(43)
 v_mfma_f32_16x16x32_bf16 a[4:7], v[124:127], v[12:15], a[4:7]
 v_mfma_f32_16x16x32_bf16 a[4:7], v[164:167], v[60:63], a[4:7]
 s_waitcnt vmcnt(41)
 s_add_u32 s51, s65, 496640
 s_add_u32 s40, s51, s20
 buffer_load_dwordx4 v[184:187], v0, s[8:11], s40 offen sc1
 v_mfma_f32_16x16x32_bf16 a[8:11], v[124:127], v[16:19], a[8:11]
 v_mfma_f32_16x16x32_bf16 a[8:11], v[164:167], v[76:79], a[8:11]
 s_waitcnt vmcnt(40)
 v_mfma_f32_16x16x32_bf16 a[12:15], v[124:127], v[20:23], a[12:15]
 s_add_u32 s48, s61, 688128
 s_add_u32 s40, s48, s84
 buffer_load_dwordx4 v[32:35], v0, s[4:7], s40 offen sc1
 v_mfma_f32_16x16x32_bf16 a[12:15], v[164:167], v[84:87], a[12:15]
 s_waitcnt vmcnt(39)
 v_mfma_f32_16x16x32_bf16 a[16:19], v[124:127], v[24:27], a[16:19]
 v_mfma_f32_16x16x32_bf16 a[16:19], v[164:167], v[92:95], a[16:19]
 s_waitcnt vmcnt(37)
 s_add_u32 s49, s61, 695296
 s_add_u32 s40, s49, s84
 buffer_load_dwordx4 v[88:91], v0, s[4:7], s40 offen sc1
 v_mfma_f32_16x16x32_bf16 a[20:23], v[124:127], v[28:31], a[20:23]
 v_mfma_f32_16x16x32_bf16 a[20:23], v[164:167], v[108:111], a[20:23]
 s_waitcnt vmcnt(36)
 v_mfma_f32_16x16x32_bf16 a[24:27], v[124:127], v[44:47], a[24:27]
 s_add_u32 s40, s48, s85
 buffer_load_dwordx4 v[40:43], v0, s[4:7], s40 offen sc1
 v_mfma_f32_16x16x32_bf16 a[24:27], v[164:167], v[116:119], a[24:27]
 s_waitcnt vmcnt(35)
 v_mfma_f32_16x16x32_bf16 a[28:31], v[132:135], v[8:11], a[28:31]
 v_mfma_f32_16x16x32_bf16 a[28:31], v[172:175], v[52:55], a[28:31]
 s_add_u32 s40, s49, s85
 buffer_load_dwordx4 v[96:99], v0, s[4:7], s40 offen sc1
 v_mfma_f32_16x16x32_bf16 a[32:35], v[132:135], v[12:15], a[32:35]
 v_mfma_f32_16x16x32_bf16 a[32:35], v[172:175], v[60:63], a[32:35]
 v_mfma_f32_16x16x32_bf16 a[36:39], v[132:135], v[16:19], a[36:39]
 s_add_u32 s40, s48, s86
 buffer_load_dwordx4 v[48:51], v0, s[4:7], s40 offen sc1
 v_mfma_f32_16x16x32_bf16 a[36:39], v[172:175], v[76:79], a[36:39]
 v_mfma_f32_16x16x32_bf16 a[40:43], v[132:135], v[20:23], a[40:43]
 v_mfma_f32_16x16x32_bf16 a[40:43], v[172:175], v[84:87], a[40:43]
 s_add_u32 s40, s49, s86
 buffer_load_dwordx4 v[104:107], v0, s[4:7], s40 offen sc1
 v_mfma_f32_16x16x32_bf16 a[44:47], v[132:135], v[24:27], a[44:47]
 v_mfma_f32_16x16x32_bf16 a[44:47], v[172:175], v[92:95], a[44:47]
 v_mfma_f32_16x16x32_bf16 a[48:51], v[132:135], v[28:31], a[48:51]
 s_add_u32 s40, s48, s87
 buffer_load_dwordx4 v[56:59], v0, s[4:7], s40 offen sc1
 v_mfma_f32_16x16x32_bf16 a[48:51], v[172:175], v[108:111], a[48:51]
 v_mfma_f32_16x16x32_bf16 a[52:55], v[132:135], v[44:47], a[52:55]
 v_mfma_f32_16x16x32_bf16 a[52:55], v[172:175], v[116:119], a[52:55]
 s_waitcnt vmcnt(37)
 s_add_u32 s40, s49, s87
 buffer_load_dwordx4 v[112:115], v0, s[4:7], s40 offen sc1
 v_mfma_f32_16x16x32_bf16 a[56:59], v[140:143], v[8:11], a[56:59]
 v_mfma_f32_16x16x32_bf16 a[56:59], v[180:183], v[52:55], a[56:59]
 v_mfma_f32_16x16x32_bf16 a[60:63], v[140:143], v[12:15], a[60:63]
 s_add_u32 s40, s48, s96
 buffer_load_dwordx4 v[64:67], v0, s[4:7], s40 offen sc1
 v_mfma_f32_16x16x32_bf16 a[60:63], v[180:183], v[60:63], a[60:63]
 s_branch SK9967
C2_3:
PG9967:
 s_branch PG11170
SK9967:
 v_mfma_f32_16x16x32_bf16 a[64:67], v[140:143], v[16:19], a[64:67]
 v_mfma_f32_16x16x32_bf16 a[64:67], v[180:183], v[76:79], a[64:67]
 s_add_u32 s40, s49, s96
 buffer_load_dwordx4 v[120:123], v0, s[4:7], s40 offen sc1
 v_mfma_f32_16x16x32_bf16 a[68:71], v[140:143], v[20:23], a[68:71]
 v_mfma_f32_16x16x32_bf16 a[68:71], v[180:183], v[84:87], a[68:71]
 v_mfma_f32_16x16x32_bf16 a[72:75], v[140:143], v[24:27], a[72:75]
 s_add_u32 s40, s48, s97
 buffer_load_dwordx4 v[72:75], v0, s[4:7], s40 offen sc1
 v_mfma_f32_16x16x32_bf16 a[72:75], v[180:183], v[92:95], a[72:75]
 v_mfma_f32_16x16x32_bf16 a[76:79], v[140:143], v[28:31], a[76:79]
 v_mfma_f32_16x16x32_bf16 a[76:79], v[180:183], v[108:111], a[76:79]
 s_add_u32 s40, s49, s97
 buffer_load_dwordx4 v[128:131], v0, s[4:7], s40 offen sc1
 v_mfma_f32_16x16x32_bf16 a[80:83], v[140:143], v[44:47], a[80:83]
 v_mfma_f32_16x16x32_bf16 a[80:83], v[180:183], v[116:119], a[80:83]
 s_waitcnt vmcnt(40)
 v_mfma_f32_16x16x32_bf16 a[84:87], v[148:151], v[8:11], a[84:87]
 s_add_u32 s40, s48, s98
 buffer_load_dwordx4 v[80:83], v0, s[4:7], s40 offen sc1
 v_mfma_f32_16x16x32_bf16 a[84:87], v[188:191], v[52:55], a[84:87]
 v_mfma_f32_16x16x32_bf16 a[88:91], v[148:151], v[12:15], a[88:91]
 v_mfma_f32_16x16x32_bf16 a[88:91], v[188:191], v[60:63], a[88:91]
 s_add_u32 s40, s49, s98
 buffer_load_dwordx4 v[136:139], v0, s[4:7], s40 offen sc1
 v_mfma_f32_16x16x32_bf16 a[92:95], v[148:151], v[16:19], a[92:95]
 v_mfma_f32_16x16x32_bf16 a[92:95], v[188:191], v[76:79], a[92:95]
 v_mfma_f32_16x16x32_bf16 a[96:99], v[148:151], v[20:23], a[96:99]
 s_add_u32 s40, s50, s21
 buffer_load_dwordx4 v[152:155], v0, s[8:11], s40 offen sc1
 v_mfma_f32_16x16x32_bf16 a[96:99], v[188:191], v[84:87], a[96:99]
 v_mfma_f32_16x16x32_bf16 a[100:103], v[148:151], v[24:27], a[100:103]
 v_mfma_f32_16x16x32_bf16 a[100:103], v[188:191], v[92:95], a[100:103]
 s_add_u32 s40, s51, s21
 buffer_load_dwordx4 v[192:195], v0, s[8:11], s40 offen sc1
 v_mfma_f32_16x16x32_bf16 a[104:107], v[148:151], v[28:31], a[104:107]
 v_mfma_f32_16x16x32_bf16 a[104:107], v[188:191], v[108:111], a[104:107]
 v_mfma_f32_16x16x32_bf16 a[108:111], v[148:151], v[44:47], a[108:111]
 s_add_u32 s40, s50, s22
 buffer_load_dwordx4 v[160:163], v0, s[8:11], s40 offen sc1
 v_mfma_f32_16x16x32_bf16 a[108:111], v[188:191], v[116:119], a[108:111]
 s_waitcnt vmcnt(43)
 v_mfma_f32_16x16x32_bf16 a[112:115], v[156:159], v[8:11], a[112:115]
 v_mfma_f32_16x16x32_bf16 a[112:115], v[196:199], v[52:55], a[112:115]
 s_add_u32 s40, s51, s22
 buffer_load_dwordx4 v[36:39], v0, s[8:11], s40 offen sc1
 v_mfma_f32_16x16x32_bf16 a[116:119], v[156:159], v[12:15], a[116:119]
 v_mfma_f32_16x16x32_bf16 a[116:119], v[196:199], v[60:63], a[116:119]
 v_mfma_f32_16x16x32_bf16 a[120:123], v[156:159], v[16:19], a[120:123]
 s_add_u32 s40, s50, s23
 buffer_load_dwordx4 v[168:171], v0, s[8:11], s40 offen sc1
 v_mfma_f32_16x16x32_bf16 a[120:123], v[196:199], v[76:79], a[120:123]
 v_mfma_f32_16x16x32_bf16 a[124:127], v[156:159], v[20:23], a[124:127]
 v_mfma_f32_16x16x32_bf16 a[124:127], v[196:199], v[84:87], a[124:127]
 s_add_u32 s40, s51, s23
 buffer_load_dwordx4 v[68:71], v0, s[8:11], s40 offen sc1
 v_mfma_f32_16x16x32_bf16 a[128:131], v[156:159], v[24:27], a[128:131]
 v_mfma_f32_16x16x32_bf16 a[128:131], v[196:199], v[92:95], a[128:131]
 v_mfma_f32_16x16x32_bf16 a[132:135], v[156:159], v[28:31], a[132:135]
 s_add_u32 s40, s50, s28
 buffer_load_dwordx4 v[176:179], v0, s[8:11], s40 offen sc1
 v_mfma_f32_16x16x32_bf16 a[132:135], v[196:199], v[108:111], a[132:135]
 v_mfma_f32_16x16x32_bf16 a[136:139], v[156:159], v[44:47], a[136:139]
 v_mfma_f32_16x16x32_bf16 a[136:139], v[196:199], v[116:119], a[136:139]
 s_add_u32 s40, s51, s28
 buffer_load_dwordx4 v[100:103], v0, s[8:11], s40 offen sc1
 s_barrier
 s_cmp_eq_u32 s36, 1
 s_cbranch_scc1 P2_V1
 s_cmp_eq_u32 s36, 2
 s_cbranch_scc1 P2_V2
 s_cmp_eq_u32 s36, 3
 s_cbranch_scc1 P2_V3
P2_V0:
 s_waitcnt vmcnt(42)
 v_mfma_f32_16x16x32_bf16 a[4:7], a[196:199], a[144:147], a[4:7]
 v_mfma_f32_16x16x32_bf16 a[4:7], a[216:219], a[172:175], a[4:7]
 s_waitcnt vmcnt(18)
 v_mfma_f32_16x16x32_bf16 a[4:7], v[144:147], v[40:43], a[4:7]
 v_mfma_f32_16x16x32_bf16 a[4:7], v[184:187], v[96:99], a[4:7]
 s_waitcnt vmcnt(40)
 v_mfma_f32_16x16x32_bf16 a[8:11], a[196:199], a[148:151], a[8:11]
 s_mul_i32 s58, s84, 40
 v_mfma_f32_16x16x32_bf16 a[8:11], a[216:219], a[176:179], a[8:11]
 s_waitcnt vmcnt(16)
 s_lshr_b32 s54, s20, 5
 v_mfma_f32_16x16x32_bf16 a[8:11], v[144:147], v[48:51], a[8:11]
 s_add_u32 s58, s58, s54
 v_mfma_f32_16x16x32_bf16 a[8:11], v[184:187], v[104:107], a[8:11]
 s_waitcnt vmcnt(38)
 v_mfma_f32_16x16x32_bf16 a[12:15], a[196:199], a[152:155], a[12:15]
 s_mul_i32 s59, s84, 40
 v_mfma_f32_16x16x32_bf16 a[12:15], a[216:219], a[180:183], a[12:15]
 s_waitcnt vmcnt(14)
 s_lshr_b32 s54, s21, 5
 v_mfma_f32_16x16x32_bf16 a[12:15], v[144:147], v[56:59], a[12:15]
 s_add_u32 s59, s59, s54
 v_mfma_f32_16x16x32_bf16 a[12:15], v[184:187], v[112:115], a[12:15]
 s_waitcnt vmcnt(34)
 ds_write_b128 v200, a[4:7] offset:46080
 v_mfma_f32_16x16x32_bf16 a[20:23], a[196:199], a[160:163], a[20:23]
 s_mul_i32 s60, s96, 40
 v_mfma_f32_16x16x32_bf16 a[20:23], a[216:219], a[188:191], a[20:23]
 s_waitcnt vmcnt(10)
 s_lshr_b32 s54, s20, 5
 v_mfma_f32_16x16x32_bf16 a[20:23], v[144:147], v[72:75], a[20:23]
 s_add_u32 s60, s60, s54
 v_mfma_f32_16x16x32_bf16 a[20:23], v[184:187], v[128:131], a[20:23]
 s_waitcnt vmcnt(32)
 ds_write_b128 v200, a[8:11] offset:64512
 v_mfma_f32_16x16x32_bf16 a[24:27], a[196:199], a[164:167], a[24:27]
 s_mul_i32 s61, s96, 40
 v_mfma_f32_16x16x32_bf16 a[24:27], a[216:219], a[192:195], a[24:27]
 s_waitcnt vmcnt(8)
 s_lshr_b32 s54, s21, 5
 v_mfma_f32_16x16x32_bf16 a[24:27], v[144:147], v[80:83], a[24:27]
 s_add_u32 s61, s61, s54
 v_mfma_f32_16x16x32_bf16 a[24:27], v[184:187], v[136:139], a[24:27]
 s_waitcnt vmcnt(30)
 ds_write_b128 v201, a[12:15] offset:17408
 v_mfma_f32_16x16x32_bf16 a[32:35], a[200:203], a[144:147], a[32:35]
 s_mul_i32 s62, s85, 40
 v_mfma_f32_16x16x32_bf16 a[32:35], a[220:223], a[172:175], a[32:35]
 s_waitcnt vmcnt(6)
 s_lshr_b32 s54, s22, 5
 v_mfma_f32_16x16x32_bf16 a[32:35], v[152:155], v[40:43], a[32:35]
 s_add_u32 s62, s62, s54
 v_mfma_f32_16x16x32_bf16 a[32:35], v[192:195], v[96:99], a[32:35]
 ds_write_b128 v200, a[20:23] offset:48128
 v_mfma_f32_16x16x32_bf16 a[36:39], a[200:203], a[148:151], a[36:39]
 s_mul_i32 s63, s85, 40
 v_mfma_f32_16x16x32_bf16 a[36:39], a[220:223], a[176:179], a[36:39]
 s_lshr_b32 s54, s23, 5
 v_mfma_f32_16x16x32_bf16 a[36:39], v[152:155], v[48:51], a[36:39]
 s_add_u32 s63, s63, s54
 v_mfma_f32_16x16x32_bf16 a[36:39], v[192:195], v[104:107], a[36:39]
 ds_write_b128 v201, a[24:27] offset:1024
 v_mfma_f32_16x16x32_bf16 a[40:43], a[200:203], a[152:155], a[40:43]
 s_mul_i32 s64, s97, 40
 v_mfma_f32_16x16x32_bf16 a[40:43], a[220:223], a[180:183], a[40:43]
 s_lshr_b32 s54, s22, 5
 v_mfma_f32_16x16x32_bf16 a[40:43], v[152:155], v[56:59], a[40:43]
 s_add_u32 s64, s64, s54
 v_mfma_f32_16x16x32_bf16 a[40:43], v[192:195], v[112:115], a[40:43]
 ds_write_b128 v200, a[32:35] offset:47104
 v_mfma_f32_16x16x32_bf16 a[48:51], a[200:203], a[160:163], a[48:51]
 s_mul_i32 s65, s97, 40
 v_mfma_f32_16x16x32_bf16 a[48:51], a[220:223], a[188:191], a[48:51]
 s_lshr_b32 s54, s23, 5
 v_mfma_f32_16x16x32_bf16 a[48:51], v[152:155], v[72:75], a[48:51]
 s_add_u32 s65, s65, s54
 v_mfma_f32_16x16x32_bf16 a[48:51], v[192:195], v[128:131], a[48:51]
 ds_write_b128 v201, a[36:39] offset:0
 v_mfma_f32_16x16x32_bf16 a[52:55], a[200:203], a[164:167], a[52:55]
 s_mul_i32 s48, s84, 40
 v_mfma_f32_16x16x32_bf16 a[52:55], a[220:223], a[192:195], a[52:55]
 s_lshr_b32 s54, s28, 5
 v_mfma_f32_16x16x32_bf16 a[52:55], v[152:155], v[80:83], a[52:55]
 s_add_u32 s48, s48, s54
 v_mfma_f32_16x16x32_bf16 a[52:55], v[192:195], v[136:139], a[52:55]
 s_waitcnt vmcnt(28)
 ds_write_b128 v201, a[40:43] offset:18432
 v_mfma_f32_16x16x32_bf16 a[56:59], a[204:207], a[140:143], a[56:59]
 v_mfma_f32_16x16x32_bf16 a[56:59], a[224:227], a[168:171], a[56:59]
 s_waitcnt vmcnt(4)
 v_mfma_f32_16x16x32_bf16 a[56:59], v[160:163], v[32:35], a[56:59]
 v_mfma_f32_16x16x32_bf16 a[56:59], v[36:39], v[88:91], a[56:59]
 ds_write_b128 v200, a[48:51] offset:49152
 v_mfma_f32_16x16x32_bf16 a[64:67], a[204:207], a[148:151], a[64:67]
 v_mfma_f32_16x16x32_bf16 a[64:67], a[224:227], a[176:179], a[64:67]
 v_mfma_f32_16x16x32_bf16 a[64:67], v[160:163], v[48:51], a[64:67]
 v_mfma_f32_16x16x32_bf16 a[64:67], v[36:39], v[104:107], a[64:67]
 ds_write_b128 v201, a[52:55] offset:2048
 v_mfma_f32_16x16x32_bf16 a[68:71], a[204:207], a[152:155], a[68:71]
 v_mfma_f32_16x16x32_bf16 a[68:71], a[224:227], a[180:183], a[68:71]
 v_mfma_f32_16x16x32_bf16 a[68:71], v[160:163], v[56:59], a[68:71]
 v_mfma_f32_16x16x32_bf16 a[68:71], v[36:39], v[112:115], a[68:71]
 s_waitcnt vmcnt(36)
 ds_write_b128 v201, a[56:59] offset:19456
 v_mfma_f32_16x16x32_bf16 a[72:75], a[204:207], a[156:159], a[72:75]
 v_mfma_f32_16x16x32_bf16 a[72:75], a[224:227], a[184:187], a[72:75]
 s_waitcnt vmcnt(12)
 v_mfma_f32_16x16x32_bf16 a[72:75], v[160:163], v[64:67], a[72:75]
 v_mfma_f32_16x16x32_bf16 a[72:75], v[36:39], v[120:123], a[72:75]
 ds_write_b128 v200, a[64:67] offset:50176
 v_mfma_f32_16x16x32_bf16 a[80:83], a[204:207], a[164:167], a[80:83]
 v_mfma_f32_16x16x32_bf16 a[80:83], a[224:227], a[192:195], a[80:83]
 v_mfma_f32_16x16x32_bf16 a[80:83], v[160:163], v[80:83], a[80:83]
 v_mfma_f32_16x16x32_bf16 a[80:83], v[36:39], v[136:139], a[80:83]
 s_waitcnt vmcnt(26)
 ds_write_b128 v201, a[68:71] offset:3072
 v_mfma_f32_16x16x32_bf16 a[84:87], a[208:211], a[140:143], a[84:87]
 v_mfma_f32_16x16x32_bf16 a[84:87], a[228:231], a[168:171], a[84:87]
 s_waitcnt vmcnt(2)
 v_mfma_f32_16x16x32_bf16 a[84:87], v[168:171], v[32:35], a[84:87]
 v_mfma_f32_16x16x32_bf16 a[84:87], v[68:71], v[88:91], a[84:87]
 ds_write_b128 v201, a[72:75] offset:21504
 v_mfma_f32_16x16x32_bf16 a[92:95], a[208:211], a[148:151], a[92:95]
 v_mfma_f32_16x16x32_bf16 a[92:95], a[228:231], a[176:179], a[92:95]
 v_mfma_f32_16x16x32_bf16 a[92:95], v[168:171], v[48:51], a[92:95]
 v_mfma_f32_16x16x32_bf16 a[92:95], v[68:71], v[104:107], a[92:95]
 ds_write_b128 v200, a[80:83] offset:52224
 v_mfma_f32_16x16x32_bf16 a[96:99], a[208:211], a[152:155], a[96:99]
 v_mfma_f32_16x16x32_bf16 a[96:99], a[228:231], a[180:183], a[96:99]
 v_mfma_f32_16x16x32_bf16 a[96:99], v[168:171], v[56:59], a[96:99]
 v_mfma_f32_16x16x32_bf16 a[96:99], v[68:71], v[112:115], a[96:99]
 ds_write_b128 v201, a[84:87] offset:20480
 v_mfma_f32_16x16x32_bf16 a[100:103], a[208:211], a[156:159], a[100:103]
 v_mfma_f32_16x16x32_bf16 a[100:103], a[228:231], a[184:187], a[100:103]
 v_mfma_f32_16x16x32_bf16 a[100:103], v[168:171], v[64:67], a[100:103]
 v_mfma_f32_16x16x32_bf16 a[100:103], v[68:71], v[120:123], a[100:103]
 ds_write_b128 v200, a[92:95] offset:51200
 v_mfma_f32_16x16x32_bf16 a[108:111], a[208:211], a[164:167], a[108:111]
 v_mfma_f32_16x16x32_bf16 a[108:111], a[228:231], a[192:195], a[108:111]
 v_mfma_f32_16x16x32_bf16 a[108:111], v[168:171], v[80:83], a[108:111]
 v_mfma_f32_16x16x32_bf16 a[108:111], v[68:71], v[136:139], a[108:111]
 s_waitcnt vmcnt(24)
 ds_write_b128 v201, a[96:99] offset:4096
 v_mfma_f32_16x16x32_bf16 a[116:119], a[212:215], a[144:147], a[116:119]
 v_mfma_f32_16x16x32_bf16 a[116:119], a[232:235], a[172:175], a[116:119]
 s_waitcnt vmcnt(0)
 v_mfma_f32_16x16x32_bf16 a[116:119], v[176:179], v[40:43], a[116:119]
 v_mfma_f32_16x16x32_bf16 a[116:119], v[100:103], v[96:99], a[116:119]
 ds_write_b128 v201, a[100:103] offset:22528
 v_mfma_f32_16x16x32_bf16 a[120:123], a[212:215], a[148:151], a[120:123]
 v_mfma_f32_16x16x32_bf16 a[120:123], a[232:235], a[176:179], a[120:123]
 v_mfma_f32_16x16x32_bf16 a[120:123], v[176:179], v[48:51], a[120:123]
 v_mfma_f32_16x16x32_bf16 a[120:123], v[100:103], v[104:107], a[120:123]
 ds_write_b128 v200, a[108:111] offset:53248
 v_mfma_f32_16x16x32_bf16 a[124:127], a[212:215], a[152:155], a[124:127]
 v_mfma_f32_16x16x32_bf16 a[124:127], a[232:235], a[180:183], a[124:127]
 v_mfma_f32_16x16x32_bf16 a[124:127], v[176:179], v[56:59], a[124:127]
 v_mfma_f32_16x16x32_bf16 a[124:127], v[100:103], v[112:115], a[124:127]
 ds_write_b128 v200, a[116:119] offset:54272
 v_mfma_f32_16x16x32_bf16 a[128:131], a[212:215], a[156:159], a[128:131]
 v_mfma_f32_16x16x32_bf16 a[128:131], a[232:235], a[184:187], a[128:131]
 v_mfma_f32_16x16x32_bf16 a[128:131], v[176:179], v[64:67], a[128:131]
 v_mfma_f32_16x16x32_bf16 a[128:131], v[100:103], v[120:123], a[128:131]
 ds_write_b128 v201, a[120:123] offset:5120
 v_mfma_f32_16x16x32_bf16 a[132:135], a[212:215], a[160:163], a[132:135]
 v_mfma_f32_16x16x32_bf16 a[132:135], a[232:235], a[188:191], a[132:135]
 v_mfma_f32_16x16x32_bf16 a[132:135], v[176:179], v[72:75], a[132:135]
 v_mfma_f32_16x16x32_bf16 a[132:135], v[100:103], v[128:131], a[132:135]
 ds_write_b128 v201, a[124:127] offset:6144
 v_mfma_f32_16x16x32_bf16 a[136:139], a[212:215], a[164:167], a[136:139]
 v_mfma_f32_16x16x32_bf16 a[136:139], a[232:235], a[192:195], a[136:139]
 v_mfma_f32_16x16x32_bf16 a[136:139], v[176:179], v[80:83], a[136:139]
 v_mfma_f32_16x16x32_bf16 a[136:139], v[100:103], v[136:139], a[136:139]
 ds_write_b128 v201, a[128:131] offset:7168
 v_mfma_f32_16x16x32_bf16 a[0:3], a[196:199], a[140:143], a[0:3]
 v_mfma_f32_16x16x32_bf16 a[0:3], a[216:219], a[168:171], a[0:3]
 v_mfma_f32_16x16x32_bf16 a[0:3], v[144:147], v[32:35], a[0:3]
 v_mfma_f32_16x16x32_bf16 a[0:3], v[184:187], v[88:91], a[0:3]
 ds_write_b128 v201, a[132:135] offset:23552
 v_mfma_f32_16x16x32_bf16 a[28:31], a[200:203], a[140:143], a[28:31]
 v_mfma_f32_16x16x32_bf16 a[28:31], a[220:223], a[168:171], a[28:31]
 v_mfma_f32_16x16x32_bf16 a[28:31], v[152:155], v[32:35], a[28:31]
 v_mfma_f32_16x16x32_bf16 a[28:31], v[192:195], v[88:91], a[28:31]
 ds_write_b128 v201, a[136:139] offset:24576
 v_mfma_f32_16x16x32_bf16 a[16:19], a[196:199], a[156:159], a[16:19]
 v_mfma_f32_16x16x32_bf16 a[16:19], a[216:219], a[184:187], a[16:19]
 s_waitcnt lgkmcnt(0)
 s_barrier
 v_mfma_f32_16x16x32_bf16 a[16:19], v[144:147], v[64:67], a[16:19]
 ds_read_b128 v[8:11], v200 offset:0
 v_mfma_f32_16x16x32_bf16 a[16:19], v[184:187], v[120:123], a[16:19]
 ds_read_b128 v[12:15], v200 offset:9216
 v_mfma_f32_16x16x32_bf16 a[44:47], a[200:203], a[156:159], a[44:47]
 ds_read_b128 v[16:19], v200 offset:18432
 v_mfma_f32_16x16x32_bf16 a[44:47], a[220:223], a[184:187], a[44:47]
 ds_read_b128 v[20:23], v200 offset:1024
 v_mfma_f32_16x16x32_bf16 a[44:47], v[152:155], v[64:67], a[44:47]
 ds_read_b128 v[24:27], v200 offset:10240
 v_mfma_f32_16x16x32_bf16 a[44:47], v[192:195], v[120:123], a[44:47]
 ds_read_b128 v[28:31], v200 offset:19456
 v_mfma_f32_16x16x32_bf16 a[60:63], a[204:207], a[144:147], a[60:63]
 ds_read_b128 v[44:47], v200 offset:2048
 v_mfma_f32_16x16x32_bf16 a[60:63], a[224:227], a[172:175], a[60:63]
 ds_read_b128 v[52:55], v200 offset:11264
 v_mfma_f32_16x16x32_bf16 a[60:63], v[160:163], v[40:43], a[60:63]
 ds_read_b128 v[60:63], v200 offset:20480
 v_accvgpr_read_b32 v220, a0
 v_mfma_f32_16x16x32_bf16 a[60:63], v[36:39], v[96:99], a[60:63]
 ds_read_b128 v[76:79], v200 offset:3072
 v_accvgpr_read_b32 v221, a1
 v_mfma_f32_16x16x32_bf16 a[88:91], a[208:211], a[144:147], a[88:91]
 ds_read_b128 v[84:87], v200 offset:12288
 v_accvgpr_read_b32 v222, a2
 v_mfma_f32_16x16x32_bf16 a[88:91], a[228:231], a[172:175], a[88:91]
 ds_read_b128 v[92:95], v200 offset:21504
 v_accvgpr_read_b32 v223, a3
 s_waitcnt lgkmcnt(9)
 v_mfma_f32_16x16x32_bf16 a[88:91], v[168:171], v[40:43], a[88:91]
 ds_read_b128 v[108:111], v200 offset:4096
 v_add_f32 v220, v220, v8
 v_mfma_f32_16x16x32_bf16 a[88:91], v[68:71], v[96:99], a[88:91]
 ds_read_b128 v[116:119], v200 offset:13312
 v_add_f32 v221, v221, v9
 v_mfma_f32_16x16x32_bf16 a[76:79], a[204:207], a[160:163], a[76:79]
 ds_read_b128 v[124:127], v200 offset:22528
 v_add_f32 v222, v222, v10
 v_mfma_f32_16x16x32_bf16 a[76:79], a[224:227], a[188:191], a[76:79]
 ds_read_b128 v[132:135], v200 offset:5120
 v_add_f32 v223, v223, v11
 v_mfma_f32_16x16x32_bf16 a[76:79], v[160:163], v[72:75], a[76:79]
 ds_read_b128 v[140:143], v200 offset:14336
 v_add_f32 v12, v12, v16
 v_mfma_f32_16x16x32_bf16 a[76:79], v[36:39], v[128:131], a[76:79]
 ds_read_b128 v[148:151], v200 offset:23552
 v_add_f32 v13, v13, v17
 v_mfma_f32_16x16x32_bf16 a[104:107], a[208:211], a[160:163], a[104:107]
 ds_read_b128 v[156:159], v200 offset:6144
 v_add_f32 v14, v14, v18
 v_mfma_f32_16x16x32_bf16 a[104:107], a[228:231], a[188:191], a[104:107]
 ds_read_b128 v[164:167], v200 offset:15360
 v_add_f32 v15, v15, v19
 v_mfma_f32_16x16x32_bf16 a[104:107], v[168:171], v[72:75], a[104:107]
 ds_read_b128 v[172:175], v200 offset:24576
 v_add_f32 v220, v220, v12
 v_mfma_f32_16x16x32_bf16 a[104:107], v[68:71], v[128:131], a[104:107]
 ds_read_b128 v[180:183], v200 offset:7168
 v_add_f32 v221, v221, v13
 v_mfma_f32_16x16x32_bf16 a[112:115], a[212:215], a[140:143], a[112:115]
 ds_read_b128 v[188:191], v200 offset:16384
 v_add_f32 v222, v222, v14
 v_mfma_f32_16x16x32_bf16 a[112:115], a[232:235], a[168:171], a[112:115]
 ds_read_b128 v[196:199], v200 offset:25600
 v_add_f32 v223, v223, v15
 v_mfma_f32_16x16x32_bf16 a[112:115], v[176:179], v[32:35], a[112:115]
 ds_read_b128 v[208:211], v200 offset:8192
 v_cvt_pk_bf16_f32 v220, v220, v221
 v_mfma_f32_16x16x32_bf16 a[112:115], v[100:103], v[88:91], a[112:115]
 ds_read_b128 v[212:215], v200 offset:17408
 v_cvt_pk_bf16_f32 v221, v222, v223
 ds_read_b128 v[216:219], v200 offset:26624
 s_nop 5
 v_accvgpr_read_b32 v224, a28
 v_accvgpr_read_b32 v225, a29
 v_accvgpr_read_b32 v226, a30
 v_accvgpr_read_b32 v227, a31
 s_waitcnt lgkmcnt(15)
 v_pk_add_f32 v[224:225], v[224:225], v[20:21]
 v_pk_add_f32 v[226:227], v[226:227], v[22:23]
 v_pk_add_f32 v[24:25], v[24:25], v[28:29]
 v_pk_add_f32 v[26:27], v[26:27], v[30:31]
 v_pk_add_f32 v[224:225], v[224:225], v[24:25]
 v_pk_add_f32 v[226:227], v[226:227], v[26:27]
 v_cvt_pk_bf16_f32 v222, v224, v225
 v_cvt_pk_bf16_f32 v223, v226, v227
 buffer_store_dwordx4 v[220:223], v206, s[12:15], s58 offen
 v_accvgpr_read_b32 v228, a16
 v_accvgpr_read_b32 v229, a17
 v_accvgpr_read_b32 v230, a18
 v_accvgpr_read_b32 v231, a19
 s_waitcnt lgkmcnt(15)
 v_pk_add_f32 v[228:229], v[228:229], v[44:45]
 v_pk_add_f32 v[230:231], v[230:231], v[46:47]
 v_pk_add_f32 v[52:53], v[52:53], v[60:61]
 v_pk_add_f32 v[54:55], v[54:55], v[62:63]
 v_pk_add_f32 v[228:229], v[228:229], v[52:53]
 v_pk_add_f32 v[230:231], v[230:231], v[54:55]
 v_cvt_pk_bf16_f32 v228, v228, v229
 v_cvt_pk_bf16_f32 v229, v230, v231
 v_accvgpr_read_b32 v232, a44
 v_accvgpr_read_b32 v233, a45
 v_accvgpr_read_b32 v234, a46
 v_accvgpr_read_b32 v235, a47
 s_waitcnt lgkmcnt(15)
 v_pk_add_f32 v[232:233], v[232:233], v[76:77]
 v_pk_add_f32 v[234:235], v[234:235], v[78:79]
 v_pk_add_f32 v[84:85], v[84:85], v[92:93]
 v_pk_add_f32 v[86:87], v[86:87], v[94:95]
 v_pk_add_f32 v[232:233], v[232:233], v[84:85]
 v_pk_add_f32 v[234:235], v[234:235], v[86:87]
 v_cvt_pk_bf16_f32 v230, v232, v233
 v_cvt_pk_bf16_f32 v231, v234, v235
 buffer_store_dwordx4 v[228:231], v206, s[12:15], s60 offen
 v_accvgpr_read_b32 v236, a60
 v_accvgpr_read_b32 v237, a61
 v_accvgpr_read_b32 v238, a62
 v_accvgpr_read_b32 v239, a63
 s_waitcnt lgkmcnt(12)
 v_pk_add_f32 v[236:237], v[236:237], v[108:109]
 v_pk_add_f32 v[238:239], v[238:239], v[110:111]
 v_pk_add_f32 v[116:117], v[116:117], v[124:125]
 v_pk_add_f32 v[118:119], v[118:119], v[126:127]
 v_pk_add_f32 v[236:237], v[236:237], v[116:117]
 v_pk_add_f32 v[238:239], v[238:239], v[118:119]
 v_cvt_pk_bf16_f32 v236, v236, v237
 v_cvt_pk_bf16_f32 v237, v238, v239
 v_accvgpr_read_b32 v240, a88
 v_accvgpr_read_b32 v241, a89
 v_accvgpr_read_b32 v242, a90
 v_accvgpr_read_b32 v243, a91
 s_waitcnt lgkmcnt(9)
 v_pk_add_f32 v[240:241], v[240:241], v[132:133]
 v_pk_add_f32 v[242:243], v[242:243], v[134:135]
 v_pk_add_f32 v[140:141], v[140:141], v[148:149]
 v_pk_add_f32 v[142:143], v[142:143], v[150:151]
 v_pk_add_f32 v[240:241], v[240:241], v[140:141]
 v_pk_add_f32 v[242:243], v[242:243], v[142:143]
 v_cvt_pk_bf16_f32 v238, v240, v241
 v_cvt_pk_bf16_f32 v239, v242, v243
 buffer_store_dwordx4 v[236:239], v206, s[12:15], s62 offen
 v_accvgpr_read_b32 v244, a76
 v_accvgpr_read_b32 v245, a77
 v_accvgpr_read_b32 v246, a78
 v_accvgpr_read_b32 v247, a79
 s_waitcnt lgkmcnt(6)
 v_pk_add_f32 v[244:245], v[244:245], v[156:157]
 v_pk_add_f32 v[246:247], v[246:247], v[158:159]
 v_pk_add_f32 v[164:165], v[164:165], v[172:173]
 v_pk_add_f32 v[166:167], v[166:167], v[174:175]
 v_pk_add_f32 v[244:245], v[244:245], v[164:165]
 v_pk_add_f32 v[246:247], v[246:247], v[166:167]
 v_cvt_pk_bf16_f32 v244, v244, v245
 v_cvt_pk_bf16_f32 v245, v246, v247
 v_accvgpr_read_b32 v248, a104
 v_accvgpr_read_b32 v249, a105
 v_accvgpr_read_b32 v250, a106
 v_accvgpr_read_b32 v251, a107
 s_waitcnt lgkmcnt(3)
 v_pk_add_f32 v[248:249], v[248:249], v[180:181]
 v_pk_add_f32 v[250:251], v[250:251], v[182:183]
 v_pk_add_f32 v[188:189], v[188:189], v[196:197]
 v_pk_add_f32 v[190:191], v[190:191], v[198:199]
 v_pk_add_f32 v[248:249], v[248:249], v[188:189]
 v_pk_add_f32 v[250:251], v[250:251], v[190:191]
 v_cvt_pk_bf16_f32 v246, v248, v249
 v_cvt_pk_bf16_f32 v247, v250, v251
 buffer_store_dwordx4 v[244:247], v206, s[12:15], s64 offen
 v_accvgpr_read_b32 v252, a112
 v_accvgpr_read_b32 v253, a113
 v_accvgpr_read_b32 v254, a114
 v_accvgpr_read_b32 v255, a115
 s_waitcnt lgkmcnt(0)
 v_pk_add_f32 v[252:253], v[252:253], v[208:209]
 v_pk_add_f32 v[254:255], v[254:255], v[210:211]
 v_pk_add_f32 v[212:213], v[212:213], v[216:217]
 v_pk_add_f32 v[214:215], v[214:215], v[218:219]
 v_pk_add_f32 v[252:253], v[252:253], v[212:213]
 v_pk_add_f32 v[254:255], v[254:255], v[214:215]
 v_cvt_pk_bf16_f32 v252, v252, v253
 v_cvt_pk_bf16_f32 v253, v254, v255
 buffer_store_dwordx2 v[252:253], v204, s[12:15], s48 offen
K1_END:
 s_endpgm
PG10415:
 s_branch RET2
P2_V1:
 s_waitcnt vmcnt(44)
 v_mfma_f32_16x16x32_bf16 a[0:3], a[196:199], a[140:143], a[0:3]
 v_mfma_f32_16x16x32_bf16 a[0:3], a[216:219], a[168:171], a[0:3]
 s_waitcnt vmcnt(20)
 v_mfma_f32_16x16x32_bf16 a[0:3], v[144:147], v[32:35], a[0:3]
 v_mfma_f32_16x16x32_bf16 a[0:3], v[184:187], v[88:91], a[0:3]
 s_waitcnt vmcnt(40)
 v_mfma_f32_16x16x32_bf16 a[8:11], a[196:199], a[148:151], a[8:11]
 s_mul_i32 s58, s85, 40
 v_mfma_f32_16x16x32_bf16 a[8:11], a[216:219], a[176:179], a[8:11]
 s_waitcnt vmcnt(16)
 s_lshr_b32 s54, s20, 5
 v_mfma_f32_16x16x32_bf16 a[8:11], v[144:147], v[48:51], a[8:11]
 s_add_u32 s58, s58, s54
 v_mfma_f32_16x16x32_bf16 a[8:11], v[184:187], v[104:107], a[8:11]
 s_waitcnt vmcnt(38)
 v_mfma_f32_16x16x32_bf16 a[12:15], a[196:199], a[152:155], a[12:15]
 s_mul_i32 s59, s85, 40
 v_mfma_f32_16x16x32_bf16 a[12:15], a[216:219], a[180:183], a[12:15]
 s_waitcnt vmcnt(14)
 s_lshr_b32 s54, s21, 5
 v_mfma_f32_16x16x32_bf16 a[12:15], v[144:147], v[56:59], a[12:15]
 s_add_u32 s59, s59, s54
 v_mfma_f32_16x16x32_bf16 a[12:15], v[184:187], v[112:115], a[12:15]
 s_waitcnt vmcnt(36)
 ds_write_b128 v200, a[0:3] offset:0
 v_mfma_f32_16x16x32_bf16 a[16:19], a[196:199], a[156:159], a[16:19]
 s_mul_i32 s60, s97, 40
 v_mfma_f32_16x16x32_bf16 a[16:19], a[216:219], a[184:187], a[16:19]
 s_waitcnt vmcnt(12)
 s_lshr_b32 s54, s20, 5
 v_mfma_f32_16x16x32_bf16 a[16:19], v[144:147], v[64:67], a[16:19]
 s_add_u32 s60, s60, s54
 v_mfma_f32_16x16x32_bf16 a[16:19], v[184:187], v[120:123], a[16:19]
 s_waitcnt vmcnt(32)
 ds_write_b128 v201, a[8:11] offset:8192
 v_mfma_f32_16x16x32_bf16 a[24:27], a[196:199], a[164:167], a[24:27]
 s_mul_i32 s61, s97, 40
 v_mfma_f32_16x16x32_bf16 a[24:27], a[216:219], a[192:195], a[24:27]
 s_waitcnt vmcnt(8)
 s_lshr_b32 s54, s21, 5
 v_mfma_f32_16x16x32_bf16 a[24:27], v[144:147], v[80:83], a[24:27]
 s_add_u32 s61, s61, s54
 v_mfma_f32_16x16x32_bf16 a[24:27], v[184:187], v[136:139], a[24:27]
 s_waitcnt vmcnt(30)
 ds_write_b128 v201, a[12:15] offset:26624
 v_mfma_f32_16x16x32_bf16 a[28:31], a[200:203], a[140:143], a[28:31]
 s_mul_i32 s62, s86, 40
 v_mfma_f32_16x16x32_bf16 a[28:31], a[220:223], a[168:171], a[28:31]
 s_waitcnt vmcnt(6)
 s_lshr_b32 s54, s22, 5
 v_mfma_f32_16x16x32_bf16 a[28:31], v[152:155], v[32:35], a[28:31]
 s_add_u32 s62, s62, s54
 v_mfma_f32_16x16x32_bf16 a[28:31], v[192:195], v[88:91], a[28:31]
 ds_write_b128 v200, a[16:19] offset:2048
 v_mfma_f32_16x16x32_bf16 a[36:39], a[200:203], a[148:151], a[36:39]
 s_mul_i32 s63, s86, 40
 v_mfma_f32_16x16x32_bf16 a[36:39], a[220:223], a[176:179], a[36:39]
 s_lshr_b32 s54, s23, 5
 v_mfma_f32_16x16x32_bf16 a[36:39], v[152:155], v[48:51], a[36:39]
 s_add_u32 s63, s63, s54
 v_mfma_f32_16x16x32_bf16 a[36:39], v[192:195], v[104:107], a[36:39]
 ds_write_b128 v201, a[24:27] offset:10240
 v_mfma_f32_16x16x32_bf16 a[40:43], a[200:203], a[152:155], a[40:43]
 s_mul_i32 s64, s98, 40
 v_mfma_f32_16x16x32_bf16 a[40:43], a[220:223], a[180:183], a[40:43]
 s_lshr_b32 s54, s22, 5
 v_mfma_f32_16x16x32_bf16 a[40:43], v[152:155], v[56:59], a[40:43]
 s_add_u32 s64, s64, s54
 v_mfma_f32_16x16x32_bf16 a[40:43], v[192:195], v[112:115], a[40:43]
 ds_write_b128 v200, a[28:31] offset:1024
 v_mfma_f32_16x16x32_bf16 a[44:47], a[200:203], a[156:159], a[44:47]
 s_mul_i32 s65, s98, 40
 v_mfma_f32_16x16x32_bf16 a[44:47], a[220:223], a[184:187], a[44:47]
 s_lshr_b32 s54, s23, 5
 v_mfma_f32_16x16x32_bf16 a[44:47], v[152:155], v[64:67], a[44:47]
 s_add_u32 s65, s65, s54
 v_mfma_f32_16x16x32_bf16 a[44:47], v[192:195], v[120:123], a[44:47]
 ds_write_b128 v201, a[36:39] offset:9216
 v_mfma_f32_16x16x32_bf16 a[52:55], a[200:203], a[164:167], a[52:55]
 s_mul_i32 s48, s85, 40
 v_mfma_f32_16x16x32_bf16 a[52:55], a[220:223], a[192:195], a[52:55]
 s_lshr_b32 s54, s28, 5
 v_mfma_f32_16x16x32_bf16 a[52:55], v[152:155], v[80:83], a[52:55]
 s_add_u32 s48, s48, s54
 v_mfma_f32_16x16x32_bf16 a[52:55], v[192:195], v[136:139], a[52:55]
 s_waitcnt vmcnt(28)
 ds_write_b128 v201, a[40:43] offset:27648
 v_mfma_f32_16x16x32_bf16 a[56:59], a[204:207], a[140:143], a[56:59]
 v_mfma_f32_16x16x32_bf16 a[56:59], a[224:227], a[168:171], a[56:59]
 s_waitcnt vmcnt(4)
 v_mfma_f32_16x16x32_bf16 a[56:59], v[160:163], v[32:35], a[56:59]
 v_mfma_f32_16x16x32_bf16 a[56:59], v[36:39], v[88:91], a[56:59]
 s_waitcnt vmcnt(42)
 ds_write_b128 v200, a[44:47] offset:3072
 v_mfma_f32_16x16x32_bf16 a[60:63], a[204:207], a[144:147], a[60:63]
 v_mfma_f32_16x16x32_bf16 a[60:63], a[224:227], a[172:175], a[60:63]
 s_waitcnt vmcnt(18)
 v_mfma_f32_16x16x32_bf16 a[60:63], v[160:163], v[40:43], a[60:63]
 v_mfma_f32_16x16x32_bf16 a[60:63], v[36:39], v[96:99], a[60:63]
 ds_write_b128 v201, a[52:55] offset:11264
 v_mfma_f32_16x16x32_bf16 a[68:71], a[204:207], a[152:155], a[68:71]
 v_mfma_f32_16x16x32_bf16 a[68:71], a[224:227], a[180:183], a[68:71]
 v_mfma_f32_16x16x32_bf16 a[68:71], v[160:163], v[56:59], a[68:71]
 v_mfma_f32_16x16x32_bf16 a[68:71], v[36:39], v[112:115], a[68:71]
 ds_write_b128 v201, a[56:59] offset:28672
 v_mfma_f32_16x16x32_bf16 a[72:75], a[204:207], a[156:159], a[72:75]
 v_mfma_f32_16x16x32_bf16 a[72:75], a[224:227], a[184:187], a[72:75]
 v_mfma_f32_16x16x32_bf16 a[72:75], v[160:163], v[64:67], a[72:75]
 v_mfma_f32_16x16x32_bf16 a[72:75], v[36:39], v[120:123], a[72:75]
 s_waitcnt vmcnt(34)
 ds_write_b128 v200, a[60:63] offset:4096
 v_mfma_f32_16x16x32_bf16 a[76:79], a[204:207], a[160:163], a[76:79]
 v_mfma_f32_16x16x32_bf16 a[76:79], a[224:227], a[188:191], a[76:79]
 s_waitcnt vmcnt(10)
 v_mfma_f32_16x16x32_bf16 a[76:79], v[160:163], v[72:75], a[76:79]
 v_mfma_f32_16x16x32_bf16 a[76:79], v[36:39], v[128:131], a[76:79]
 s_waitcnt vmcnt(26)
 ds_write_b128 v201, a[68:71] offset:12288
 v_mfma_f32_16x16x32_bf16 a[84:87], a[208:211], a[140:143], a[84:87]
 v_mfma_f32_16x16x32_bf16 a[84:87], a[228:231], a[168:171], a[84:87]
 s_waitcnt vmcnt(2)
 v_mfma_f32_16x16x32_bf16 a[84:87], v[168:171], v[32:35], a[84:87]
 v_mfma_f32_16x16x32_bf16 a[84:87], v[68:71], v[88:91], a[84:87]
 ds_write_b128 v201, a[72:75] offset:30720
 v_mfma_f32_16x16x32_bf16 a[88:91], a[208:211], a[144:147], a[88:91]
 v_mfma_f32_16x16x32_bf16 a[88:91], a[228:231], a[172:175], a[88:91]
 v_mfma_f32_16x16x32_bf16 a[88:91], v[168:171], v[40:43], a[88:91]
 v_mfma_f32_16x16x32_bf16 a[88:91], v[68:71], v[96:99], a[88:91]
 ds_write_b128 v200, a[76:79] offset:6144
 v_mfma_f32_16x16x32_bf16 a[96:99], a[208:211], a[152:155], a[96:99]
 v_mfma_f32_16x16x32_bf16 a[96:99], a[228:231], a[180:183], a[96:99]
 v_mfma_f32_16x16x32_bf16 a[96:99], v[168:171], v[56:59], a[96:99]
 v_mfma_f32_16x16x32_bf16 a[96:99], v[68:71], v[112:115], a[96:99]
 ds_write_b128 v201, a[84:87] offset:29696
 v_mfma_f32_16x16x32_bf16 a[100:103], a[208:211], a[156:159], a[100:103]
 s_branch SK10553
PG10553:
 s_branch RET2
SK10553:
 v_mfma_f32_16x16x32_bf16 a[100:103], a[228:231], a[184:187], a[100:103]
 v_mfma_f32_16x16x32_bf16 a[100:103], v[168:171], v[64:67], a[100:103]
 v_mfma_f32_16x16x32_bf16 a[100:103], v[68:71], v[120:123], a[100:103]
 ds_write_b128 v200, a[88:91] offset:5120
 v_mfma_f32_16x16x32_bf16 a[104:107], a[208:211], a[160:163], a[104:107]
 v_mfma_f32_16x16x32_bf16 a[104:107], a[228:231], a[188:191], a[104:107]
 v_mfma_f32_16x16x32_bf16 a[104:107], v[168:171], v[72:75], a[104:107]
 v_mfma_f32_16x16x32_bf16 a[104:107], v[68:71], v[128:131], a[104:107]
 s_waitcnt vmcnt(24)
 ds_write_b128 v201, a[96:99] offset:13312
 v_mfma_f32_16x16x32_bf16 a[112:115], a[212:215], a[140:143], a[112:115]
 v_mfma_f32_16x16x32_bf16 a[112:115], a[232:235], a[168:171], a[112:115]
 s_waitcnt vmcnt(0)
 v_mfma_f32_16x16x32_bf16 a[112:115], v[176:179], v[32:35], a[112:115]
 v_mfma_f32_16x16x32_bf16 a[112:115], v[100:103], v[88:91], a[112:115]
 ds_write_b128 v201, a[100:103] offset:31744
 v_mfma_f32_16x16x32_bf16 a[120:123], a[212:215], a[148:151], a[120:123]
 v_mfma_f32_16x16x32_bf16 a[120:123], a[232:235], a[176:179], a[120:123]
 v_mfma_f32_16x16x32_bf16 a[120:123], v[176:179], v[48:51], a[120:123]
 v_mfma_f32_16x16x32_bf16 a[120:123], v[100:103], v[104:107], a[120:123]
 ds_write_b128 v200, a[104:107] offset:7168
 v_mfma_f32_16x16x32_bf16 a[124:127], a[212:215], a[152:155], a[124:127]
 v_mfma_f32_16x16x32_bf16 a[124:127], a[232:235], a[180:183], a[124:127]
 v_mfma_f32_16x16x32_bf16 a[124:127], v[176:179], v[56:59], a[124:127]
 v_mfma_f32_16x16x32_bf16 a[124:127], v[100:103], v[112:115], a[124:127]
 ds_write_b128 v200, a[112:115] offset:8192
 v_mfma_f32_16x16x32_bf16 a[128:131], a[212:215], a[156:159], a[128:131]
 v_mfma_f32_16x16x32_bf16 a[128:131], a[232:235], a[184:187], a[128:131]
 v_mfma_f32_16x16x32_bf16 a[128:131], v[176:179], v[64:67], a[128:131]
 v_mfma_f32_16x16x32_bf16 a[128:131], v[100:103], v[120:123], a[128:131]
 ds_write_b128 v201, a[120:123] offset:14336
 v_mfma_f32_16x16x32_bf16 a[132:135], a[212:215], a[160:163], a[132:135]
 v_mfma_f32_16x16x32_bf16 a[132:135], a[232:235], a[188:191], a[132:135]
 v_mfma_f32_16x16x32_bf16 a[132:135], v[176:179], v[72:75], a[132:135]
 v_mfma_f32_16x16x32_bf16 a[132:135], v[100:103], v[128:131], a[132:135]
 ds_write_b128 v201, a[124:127] offset:15360
 v_mfma_f32_16x16x32_bf16 a[136:139], a[212:215], a[164:167], a[136:139]
 v_mfma_f32_16x16x32_bf16 a[136:139], a[232:235], a[192:195], a[136:139]
 v_mfma_f32_16x16x32_bf16 a[136:139], v[176:179], v[80:83], a[136:139]
 v_mfma_f32_16x16x32_bf16 a[136:139], v[100:103], v[136:139], a[136:139]
 ds_write_b128 v201, a[128:131] offset:16384
 v_mfma_f32_16x16x32_bf16 a[4:7], a[196:199], a[144:147], a[4:7]
 v_mfma_f32_16x16x32_bf16 a[4:7], a[216:219], a[172:175], a[4:7]
 v_mfma_f32_16x16x32_bf16 a[4:7], v[144:147], v[40:43], a[4:7]
 v_mfma_f32_16x16x32_bf16 a[4:7], v[184:187], v[96:99], a[4:7]
 ds_write_b128 v201, a[132:135] offset:32768
 v_mfma_f32_16x16x32_bf16 a[32:35], a[200:203], a[144:147], a[32:35]
 v_mfma_f32_16x16x32_bf16 a[32:35], a[220:223], a[172:175], a[32:35]
 v_mfma_f32_16x16x32_bf16 a[32:35], v[152:155], v[40:43], a[32:35]
 v_mfma_f32_16x16x32_bf16 a[32:35], v[192:195], v[96:99], a[32:35]
 ds_write_b128 v201, a[136:139] offset:33792
 v_mfma_f32_16x16x32_bf16 a[20:23], a[196:199], a[160:163], a[20:23]
 v_mfma_f32_16x16x32_bf16 a[20:23], a[216:219], a[188:191], a[20:23]
 s_waitcnt lgkmcnt(0)
 s_barrier
 v_mfma_f32_16x16x32_bf16 a[20:23], v[144:147], v[72:75], a[20:23]
 ds_read_b128 v[8:11], v200 offset:27648
 v_mfma_f32_16x16x32_bf16 a[20:23], v[184:187], v[128:131], a[20:23]
 ds_read_b128 v[12:15], v200 offset:36864
 v_mfma_f32_16x16x32_bf16 a[48:51], a[200:203], a[160:163], a[48:51]
 ds_read_b128 v[16:19], v200 offset:46080
 v_mfma_f32_16x16x32_bf16 a[48:51], a[220:223], a[188:191], a[48:51]
 ds_read_b128 v[20:23], v200 offset:28672
 v_mfma_f32_16x16x32_bf16 a[48:51], v[152:155], v[72:75], a[48:51]
 ds_read_b128 v[24:27], v200 offset:37888
 v_mfma_f32_16x16x32_bf16 a[48:51], v[192:195], v[128:131], a[48:51]
 ds_read_b128 v[28:31], v200 offset:47104
 v_mfma_f32_16x16x32_bf16 a[64:67], a[204:207], a[148:151], a[64:67]
 ds_read_b128 v[44:47], v200 offset:29696
 v_mfma_f32_16x16x32_bf16 a[64:67], a[224:227], a[176:179], a[64:67]
 ds_read_b128 v[52:55], v200 offset:38912
 v_mfma_f32_16x16x32_bf16 a[64:67], v[160:163], v[48:51], a[64:67]
 ds_read_b128 v[60:63], v200 offset:48128
 v_accvgpr_read_b32 v220, a4
 v_mfma_f32_16x16x32_bf16 a[64:67], v[36:39], v[104:107], a[64:67]
 ds_read_b128 v[76:79], v200 offset:30720
 v_accvgpr_read_b32 v221, a5
 v_mfma_f32_16x16x32_bf16 a[92:95], a[208:211], a[148:151], a[92:95]
 ds_read_b128 v[84:87], v200 offset:39936
 v_accvgpr_read_b32 v222, a6
 v_mfma_f32_16x16x32_bf16 a[92:95], a[228:231], a[176:179], a[92:95]
 ds_read_b128 v[92:95], v200 offset:49152
 v_accvgpr_read_b32 v223, a7
 s_waitcnt lgkmcnt(9)
 v_mfma_f32_16x16x32_bf16 a[92:95], v[168:171], v[48:51], a[92:95]
 ds_read_b128 v[108:111], v200 offset:31744
 v_add_f32 v16, v16, v220
 v_mfma_f32_16x16x32_bf16 a[92:95], v[68:71], v[104:107], a[92:95]
 ds_read_b128 v[116:119], v200 offset:40960
 v_add_f32 v17, v17, v221
 v_mfma_f32_16x16x32_bf16 a[80:83], a[204:207], a[164:167], a[80:83]
 ds_read_b128 v[124:127], v200 offset:50176
 v_add_f32 v18, v18, v222
 v_mfma_f32_16x16x32_bf16 a[80:83], a[224:227], a[192:195], a[80:83]
 ds_read_b128 v[132:135], v200 offset:32768
 v_add_f32 v19, v19, v223
 v_mfma_f32_16x16x32_bf16 a[80:83], v[160:163], v[80:83], a[80:83]
 ds_read_b128 v[140:143], v200 offset:41984
 v_add_f32 v8, v8, v12
 v_mfma_f32_16x16x32_bf16 a[80:83], v[36:39], v[136:139], a[80:83]
 ds_read_b128 v[148:151], v200 offset:51200
 v_add_f32 v9, v9, v13
 v_mfma_f32_16x16x32_bf16 a[108:111], a[208:211], a[164:167], a[108:111]
 ds_read_b128 v[156:159], v200 offset:33792
 v_add_f32 v10, v10, v14
 v_mfma_f32_16x16x32_bf16 a[108:111], a[228:231], a[192:195], a[108:111]
 ds_read_b128 v[164:167], v200 offset:43008
 v_add_f32 v11, v11, v15
 v_mfma_f32_16x16x32_bf16 a[108:111], v[168:171], v[80:83], a[108:111]
 ds_read_b128 v[172:175], v200 offset:52224
 v_add_f32 v16, v16, v8
 v_mfma_f32_16x16x32_bf16 a[108:111], v[68:71], v[136:139], a[108:111]
 ds_read_b128 v[180:183], v200 offset:34816
 v_add_f32 v17, v17, v9
 v_mfma_f32_16x16x32_bf16 a[116:119], a[212:215], a[144:147], a[116:119]
 ds_read_b128 v[188:191], v200 offset:44032
 v_add_f32 v18, v18, v10
 v_mfma_f32_16x16x32_bf16 a[116:119], a[232:235], a[172:175], a[116:119]
 ds_read_b128 v[196:199], v200 offset:53248
 v_add_f32 v19, v19, v11
 v_mfma_f32_16x16x32_bf16 a[116:119], v[176:179], v[40:43], a[116:119]
 ds_read_b128 v[208:211], v200 offset:35840
 v_cvt_pk_bf16_f32 v16, v16, v17
 v_mfma_f32_16x16x32_bf16 a[116:119], v[100:103], v[96:99], a[116:119]
 ds_read_b128 v[212:215], v200 offset:45056
 v_cvt_pk_bf16_f32 v17, v18, v19
 ds_read_b128 v[216:219], v200 offset:54272
 s_nop 5
 v_accvgpr_read_b32 v224, a32
 v_accvgpr_read_b32 v225, a33
 v_accvgpr_read_b32 v226, a34
 v_accvgpr_read_b32 v227, a35
 s_waitcnt lgkmcnt(15)
 v_pk_add_f32 v[28:29], v[28:29], v[224:225]
 v_pk_add_f32 v[30:31], v[30:31], v[226:227]
 v_pk_add_f32 v[20:21], v[20:21], v[24:25]
 v_pk_add_f32 v[22:23], v[22:23], v[26:27]
 v_pk_add_f32 v[28:29], v[28:29], v[20:21]
 v_pk_add_f32 v[30:31], v[30:31], v[22:23]
 v_cvt_pk_bf16_f32 v18, v28, v29
 v_cvt_pk_bf16_f32 v19, v30, v31
 buffer_store_dwordx4 v[16:19], v206, s[12:15], s58 offen
 v_accvgpr_read_b32 v228, a20
 v_accvgpr_read_b32 v229, a21
 v_accvgpr_read_b32 v230, a22
 v_accvgpr_read_b32 v231, a23
 s_waitcnt lgkmcnt(15)
 v_pk_add_f32 v[60:61], v[60:61], v[228:229]
 v_pk_add_f32 v[62:63], v[62:63], v[230:231]
 v_pk_add_f32 v[44:45], v[44:45], v[52:53]
 v_pk_add_f32 v[46:47], v[46:47], v[54:55]
 v_pk_add_f32 v[60:61], v[60:61], v[44:45]
 v_pk_add_f32 v[62:63], v[62:63], v[46:47]
 v_cvt_pk_bf16_f32 v60, v60, v61
 v_cvt_pk_bf16_f32 v61, v62, v63
 v_accvgpr_read_b32 v232, a48
 v_accvgpr_read_b32 v233, a49
 v_accvgpr_read_b32 v234, a50
 v_accvgpr_read_b32 v235, a51
 s_waitcnt lgkmcnt(15)
 v_pk_add_f32 v[92:93], v[92:93], v[232:233]
 v_pk_add_f32 v[94:95], v[94:95], v[234:235]
 v_pk_add_f32 v[76:77], v[76:77], v[84:85]
 v_pk_add_f32 v[78:79], v[78:79], v[86:87]
 v_pk_add_f32 v[92:93], v[92:93], v[76:77]
 v_pk_add_f32 v[94:95], v[94:95], v[78:79]
 v_cvt_pk_bf16_f32 v62, v92, v93
 v_cvt_pk_bf16_f32 v63, v94, v95
 buffer_store_dwordx4 v[60:63], v206, s[12:15], s60 offen
 v_accvgpr_read_b32 v236, a64
 v_accvgpr_read_b32 v237, a65
 v_accvgpr_read_b32 v238, a66
 v_accvgpr_read_b32 v239, a67
 s_waitcnt lgkmcnt(12)
 v_pk_add_f32 v[124:125], v[124:125], v[236:237]
 v_pk_add_f32 v[126:127], v[126:127], v[238:239]
 v_pk_add_f32 v[108:109], v[108:109], v[116:117]
 v_pk_add_f32 v[110:111], v[110:111], v[118:119]
 v_pk_add_f32 v[124:125], v[124:125], v[108:109]
 v_pk_add_f32 v[126:127], v[126:127], v[110:111]
 v_cvt_pk_bf16_f32 v124, v124, v125
 v_cvt_pk_bf16_f32 v125, v126, v127
 v_accvgpr_read_b32 v240, a92
 v_accvgpr_read_b32 v241, a93
 v_accvgpr_read_b32 v242, a94
 v_accvgpr_read_b32 v243, a95
 s_waitcnt lgkmcnt(9)
 v_pk_add_f32 v[148:149], v[148:149], v[240:241]
 v_pk_add_f32 v[150:151], v[150:151], v[242:243]
 v_pk_add_f32 v[132:133], v[132:133], v[140:141]
 v_pk_add_f32 v[134:135], v[134:135], v[142:143]
 v_pk_add_f32 v[148:149], v[148:149], v[132:133]
 v_pk_add_f32 v[150:151], v[150:151], v[134:135]
 v_cvt_pk_bf16_f32 v126, v148, v149
 v_cvt_pk_bf16_f32 v127, v150, v151
 buffer_store_dwordx4 v[124:127], v206, s[12:15], s62 offen
 v_accvgpr_read_b32 v244, a80
 v_accvgpr_read_b32 v245, a81
 v_accvgpr_read_b32 v246, a82
 v_accvgpr_read_b32 v247, a83
 s_waitcnt lgkmcnt(6)
 v_pk_add_f32 v[172:173], v[172:173], v[244:245]
 v_pk_add_f32 v[174:175], v[174:175], v[246:247]
 v_pk_add_f32 v[156:157], v[156:157], v[164:165]
 v_pk_add_f32 v[158:159], v[158:159], v[166:167]
 v_pk_add_f32 v[172:173], v[172:173], v[156:157]
 v_pk_add_f32 v[174:175], v[174:175], v[158:159]
 v_cvt_pk_bf16_f32 v172, v172, v173
 v_cvt_pk_bf16_f32 v173, v174, v175
 v_accvgpr_read_b32 v248, a108
 v_accvgpr_read_b32 v249, a109
 v_accvgpr_read_b32 v250, a110
 v_accvgpr_read_b32 v251, a111
 s_waitcnt lgkmcnt(3)
 v_pk_add_f32 v[196:197], v[196:197], v[248:249]
 v_pk_add_f32 v[198:199], v[198:199], v[250:251]
 v_pk_add_f32 v[180:181], v[180:181], v[188:189]
 v_pk_add_f32 v[182:183], v[182:183], v[190:191]
 v_pk_add_f32 v[196:197], v[196:197], v[180:181]
 v_pk_add_f32 v[198:199], v[198:199], v[182:183]
 v_cvt_pk_bf16_f32 v174, v196, v197
 v_cvt_pk_bf16_f32 v175, v198, v199
 buffer_store_dwordx4 v[172:175], v206, s[12:15], s64 offen
 v_accvgpr_read_b32 v252, a116
 v_accvgpr_read_b32 v253, a117
 v_accvgpr_read_b32 v254, a118
 v_accvgpr_read_b32 v255, a119
 s_waitcnt lgkmcnt(0)
 v_pk_add_f32 v[216:217], v[216:217], v[252:253]
 v_pk_add_f32 v[218:219], v[218:219], v[254:255]
 v_pk_add_f32 v[208:209], v[208:209], v[212:213]
 v_pk_add_f32 v[210:211], v[210:211], v[214:215]
 v_pk_add_f32 v[216:217], v[216:217], v[208:209]
 v_pk_add_f32 v[218:219], v[218:219], v[210:211]
 v_cvt_pk_bf16_f32 v216, v216, v217
 v_cvt_pk_bf16_f32 v217, v218, v219
 buffer_store_dwordx2 v[216:217], v204, s[12:15], s48 offen
 s_endpgm
PG10792:
 s_branch RET2
P2_V2:
 s_waitcnt vmcnt(44)
 v_mfma_f32_16x16x32_bf16 a[0:3], a[196:199], a[140:143], a[0:3]
 v_mfma_f32_16x16x32_bf16 a[0:3], a[216:219], a[168:171], a[0:3]
 s_waitcnt vmcnt(20)
 v_mfma_f32_16x16x32_bf16 a[0:3], v[144:147], v[32:35], a[0:3]
 v_mfma_f32_16x16x32_bf16 a[0:3], v[184:187], v[88:91], a[0:3]
 s_waitcnt vmcnt(42)
 v_mfma_f32_16x16x32_bf16 a[4:7], a[196:199], a[144:147], a[4:7]
 s_mul_i32 s58, s86, 40
 v_mfma_f32_16x16x32_bf16 a[4:7], a[216:219], a[172:175], a[4:7]
 s_waitcnt vmcnt(18)
 s_lshr_b32 s54, s20, 5
 v_mfma_f32_16x16x32_bf16 a[4:7], v[144:147], v[40:43], a[4:7]
 s_add_u32 s58, s58, s54
 v_mfma_f32_16x16x32_bf16 a[4:7], v[184:187], v[96:99], a[4:7]
 s_waitcnt vmcnt(38)
 v_mfma_f32_16x16x32_bf16 a[12:15], a[196:199], a[152:155], a[12:15]
 s_mul_i32 s59, s86, 40
 v_mfma_f32_16x16x32_bf16 a[12:15], a[216:219], a[180:183], a[12:15]
 s_waitcnt vmcnt(14)
 s_lshr_b32 s54, s21, 5
 v_mfma_f32_16x16x32_bf16 a[12:15], v[144:147], v[56:59], a[12:15]
 s_add_u32 s59, s59, s54
 v_mfma_f32_16x16x32_bf16 a[12:15], v[184:187], v[112:115], a[12:15]
 s_waitcnt vmcnt(36)
 ds_write_b128 v200, a[0:3] offset:9216
 v_mfma_f32_16x16x32_bf16 a[16:19], a[196:199], a[156:159], a[16:19]
 s_mul_i32 s60, s98, 40
 v_mfma_f32_16x16x32_bf16 a[16:19], a[216:219], a[184:187], a[16:19]
 s_waitcnt vmcnt(12)
 s_lshr_b32 s54, s20, 5
 v_mfma_f32_16x16x32_bf16 a[16:19], v[144:147], v[64:67], a[16:19]
 s_add_u32 s60, s60, s54
 v_mfma_f32_16x16x32_bf16 a[16:19], v[184:187], v[120:123], a[16:19]
 s_waitcnt vmcnt(34)
 ds_write_b128 v200, a[4:7] offset:27648
 v_mfma_f32_16x16x32_bf16 a[20:23], a[196:199], a[160:163], a[20:23]
 s_mul_i32 s61, s98, 40
 v_mfma_f32_16x16x32_bf16 a[20:23], a[216:219], a[188:191], a[20:23]
 s_waitcnt vmcnt(10)
 s_lshr_b32 s54, s21, 5
 v_mfma_f32_16x16x32_bf16 a[20:23], v[144:147], v[72:75], a[20:23]
 s_add_u32 s61, s61, s54
 v_mfma_f32_16x16x32_bf16 a[20:23], v[184:187], v[128:131], a[20:23]
 s_waitcnt vmcnt(30)
 ds_write_b128 v201, a[12:15] offset:35840
 v_mfma_f32_16x16x32_bf16 a[28:31], a[200:203], a[140:143], a[28:31]
 s_mul_i32 s62, s87, 40
 v_mfma_f32_16x16x32_bf16 a[28:31], a[220:223], a[168:171], a[28:31]
 s_waitcnt vmcnt(6)
 s_lshr_b32 s54, s22, 5
 v_mfma_f32_16x16x32_bf16 a[28:31], v[152:155], v[32:35], a[28:31]
 s_add_u32 s62, s62, s54
 v_mfma_f32_16x16x32_bf16 a[28:31], v[192:195], v[88:91], a[28:31]
 ds_write_b128 v200, a[16:19] offset:11264
 v_mfma_f32_16x16x32_bf16 a[32:35], a[200:203], a[144:147], a[32:35]
 s_mul_i32 s63, s87, 40
 v_mfma_f32_16x16x32_bf16 a[32:35], a[220:223], a[172:175], a[32:35]
 s_lshr_b32 s54, s23, 5
 v_mfma_f32_16x16x32_bf16 a[32:35], v[152:155], v[40:43], a[32:35]
 s_add_u32 s63, s63, s54
 v_mfma_f32_16x16x32_bf16 a[32:35], v[192:195], v[96:99], a[32:35]
 ds_write_b128 v200, a[20:23] offset:29696
 v_mfma_f32_16x16x32_bf16 a[40:43], a[200:203], a[152:155], a[40:43]
 s_mul_i32 s64, s86, 40
 v_mfma_f32_16x16x32_bf16 a[40:43], a[220:223], a[180:183], a[40:43]
 s_lshr_b32 s54, s28, 5
 v_mfma_f32_16x16x32_bf16 a[40:43], v[152:155], v[56:59], a[40:43]
 s_add_u32 s64, s64, s54
 v_mfma_f32_16x16x32_bf16 a[40:43], v[192:195], v[112:115], a[40:43]
 ds_write_b128 v200, a[28:31] offset:10240
 v_mfma_f32_16x16x32_bf16 a[44:47], a[200:203], a[156:159], a[44:47]
 s_mul_i32 s65, s87, 40
 v_mfma_f32_16x16x32_bf16 a[44:47], a[220:223], a[184:187], a[44:47]
 s_lshr_b32 s54, s28, 5
 v_mfma_f32_16x16x32_bf16 a[44:47], v[152:155], v[64:67], a[44:47]
 s_add_u32 s65, s65, s54
 v_mfma_f32_16x16x32_bf16 a[44:47], v[192:195], v[120:123], a[44:47]
 ds_write_b128 v200, a[32:35] offset:28672
 v_mfma_f32_16x16x32_bf16 a[48:51], a[200:203], a[160:163], a[48:51]
 s_mul_i32 s48, s96, 40
 v_mfma_f32_16x16x32_bf16 a[48:51], a[220:223], a[188:191], a[48:51]
 s_lshr_b32 s54, s28, 5
 v_mfma_f32_16x16x32_bf16 a[48:51], v[152:155], v[72:75], a[48:51]
 s_add_u32 s48, s48, s54
 v_mfma_f32_16x16x32_bf16 a[48:51], v[192:195], v[128:131], a[48:51]
 s_waitcnt vmcnt(28)
 ds_write_b128 v201, a[40:43] offset:36864
 v_mfma_f32_16x16x32_bf16 a[56:59], a[204:207], a[140:143], a[56:59]
 v_mfma_f32_16x16x32_bf16 a[56:59], a[224:227], a[168:171], a[56:59]
 s_waitcnt vmcnt(4)
 v_mfma_f32_16x16x32_bf16 a[56:59], v[160:163], v[32:35], a[56:59]
 v_mfma_f32_16x16x32_bf16 a[56:59], v[36:39], v[88:91], a[56:59]
 ds_write_b128 v200, a[44:47] offset:12288
 v_mfma_f32_16x16x32_bf16 a[60:63], a[204:207], a[144:147], a[60:63]
 v_mfma_f32_16x16x32_bf16 a[60:63], a[224:227], a[172:175], a[60:63]
 v_mfma_f32_16x16x32_bf16 a[60:63], v[160:163], v[40:43], a[60:63]
 v_mfma_f32_16x16x32_bf16 a[60:63], v[36:39], v[96:99], a[60:63]
 s_waitcnt vmcnt(40)
 ds_write_b128 v200, a[48:51] offset:30720
 v_mfma_f32_16x16x32_bf16 a[64:67], a[204:207], a[148:151], a[64:67]
 v_mfma_f32_16x16x32_bf16 a[64:67], a[224:227], a[176:179], a[64:67]
 s_waitcnt vmcnt(16)
 v_mfma_f32_16x16x32_bf16 a[64:67], v[160:163], v[48:51], a[64:67]
 v_mfma_f32_16x16x32_bf16 a[64:67], v[36:39], v[104:107], a[64:67]
 ds_write_b128 v201, a[56:59] offset:37888
 v_mfma_f32_16x16x32_bf16 a[72:75], a[204:207], a[156:159], a[72:75]
 v_mfma_f32_16x16x32_bf16 a[72:75], a[224:227], a[184:187], a[72:75]
 v_mfma_f32_16x16x32_bf16 a[72:75], v[160:163], v[64:67], a[72:75]
 v_mfma_f32_16x16x32_bf16 a[72:75], v[36:39], v[120:123], a[72:75]
 ds_write_b128 v200, a[60:63] offset:13312
 v_mfma_f32_16x16x32_bf16 a[76:79], a[204:207], a[160:163], a[76:79]
 v_mfma_f32_16x16x32_bf16 a[76:79], a[224:227], a[188:191], a[76:79]
 v_mfma_f32_16x16x32_bf16 a[76:79], v[160:163], v[72:75], a[76:79]
 v_mfma_f32_16x16x32_bf16 a[76:79], v[36:39], v[128:131], a[76:79]
 s_waitcnt vmcnt(32)
 ds_write_b128 v200, a[64:67] offset:31744
 v_mfma_f32_16x16x32_bf16 a[80:83], a[204:207], a[164:167], a[80:83]
 v_mfma_f32_16x16x32_bf16 a[80:83], a[224:227], a[192:195], a[80:83]
 s_waitcnt vmcnt(8)
 v_mfma_f32_16x16x32_bf16 a[80:83], v[160:163], v[80:83], a[80:83]
 v_mfma_f32_16x16x32_bf16 a[80:83], v[36:39], v[136:139], a[80:83]
 s_waitcnt vmcnt(26)
 ds_write_b128 v201, a[72:75] offset:39936
 v_mfma_f32_16x16x32_bf16 a[84:87], a[208:211], a[140:143], a[84:87]
 v_mfma_f32_16x16x32_bf16 a[84:87], a[228:231], a[168:171], a[84:87]
 s_waitcnt vmcnt(2)
 v_mfma_f32_16x16x32_bf16 a[84:87], v[168:171], v[32:35], a[84:87]
 v_mfma_f32_16x16x32_bf16 a[84:87], v[68:71], v[88:91], a[84:87]
 ds_write_b128 v200, a[76:79] offset:15360
 v_mfma_f32_16x16x32_bf16 a[88:91], a[208:211], a[144:147], a[88:91]
 v_mfma_f32_16x16x32_bf16 a[88:91], a[228:231], a[172:175], a[88:91]
 v_mfma_f32_16x16x32_bf16 a[88:91], v[168:171], v[40:43], a[88:91]
 v_mfma_f32_16x16x32_bf16 a[88:91], v[68:71], v[96:99], a[88:91]
 ds_write_b128 v200, a[80:83] offset:33792
 v_mfma_f32_16x16x32_bf16 a[92:95], a[208:211], a[148:151], a[92:95]
 v_mfma_f32_16x16x32_bf16 a[92:95], a[228:231], a[176:179], a[92:95]
 v_mfma_f32_16x16x32_bf16 a[92:95], v[168:171], v[48:51], a[92:95]
 v_mfma_f32_16x16x32_bf16 a[92:95], v[68:71], v[104:107], a[92:95]
 ds_write_b128 v201, a[84:87] offset:38912
 v_mfma_f32_16x16x32_bf16 a[100:103], a[208:211], a[156:159], a[100:103]
 v_mfma_f32_16x16x32_bf16 a[100:103], a[228:231], a[184:187], a[100:103]
 v_mfma_f32_16x16x32_bf16 a[100:103], v[168:171], v[64:67], a[100:103]
 v_mfma_f32_16x16x32_bf16 a[100:103], v[68:71], v[120:123], a[100:103]
 ds_write_b128 v200, a[88:91] offset:14336
 v_mfma_f32_16x16x32_bf16 a[104:107], a[208:211], a[160:163], a[104:107]
 v_mfma_f32_16x16x32_bf16 a[104:107], a[228:231], a[188:191], a[104:107]
 v_mfma_f32_16x16x32_bf16 a[104:107], v[168:171], v[72:75], a[104:107]
 v_mfma_f32_16x16x32_bf16 a[104:107], v[68:71], v[128:131], a[104:107]
 ds_write_b128 v200, a[92:95] offset:32768
 v_mfma_f32_16x16x32_bf16 a[108:111], a[208:211], a[164:167], a[108:111]
 v_mfma_f32_16x16x32_bf16 a[108:111], a[228:231], a[192:195], a[108:111]
 v_mfma_f32_16x16x32_bf16 a[108:111], v[168:171], v[80:83], a[108:111]
 v_mfma_f32_16x16x32_bf16 a[108:111], v[68:71], v[136:139], a[108:111]
 s_waitcnt vmcnt(24)
 ds_write_b128 v201, a[100:103] offset:40960
 v_mfma_f32_16x16x32_bf16 a[112:115], a[212:215], a[140:143], a[112:115]
 v_mfma_f32_16x16x32_bf16 a[112:115], a[232:235], a[168:171], a[112:115]
 s_waitcnt vmcnt(0)
 v_mfma_f32_16x16x32_bf16 a[112:115], v[176:179], v[32:35], a[112:115]
 v_mfma_f32_16x16x32_bf16 a[112:115], v[100:103], v[88:91], a[112:115]
 ds_write_b128 v200, a[104:107] offset:16384
 v_mfma_f32_16x16x32_bf16 a[116:119], a[212:215], a[144:147], a[116:119]
 v_mfma_f32_16x16x32_bf16 a[116:119], a[232:235], a[172:175], a[116:119]
 v_mfma_f32_16x16x32_bf16 a[116:119], v[176:179], v[40:43], a[116:119]
 v_mfma_f32_16x16x32_bf16 a[116:119], v[100:103], v[96:99], a[116:119]
 ds_write_b128 v200, a[108:111] offset:34816
 v_mfma_f32_16x16x32_bf16 a[132:135], a[212:215], a[160:163], a[132:135]
 v_mfma_f32_16x16x32_bf16 a[132:135], a[232:235], a[188:191], a[132:135]
 v_mfma_f32_16x16x32_bf16 a[132:135], v[176:179], v[72:75], a[132:135]
 v_mfma_f32_16x16x32_bf16 a[132:135], v[100:103], v[128:131], a[132:135]
 ds_write_b128 v200, a[112:115] offset:17408
 v_mfma_f32_16x16x32_bf16 a[136:139], a[212:215], a[164:167], a[136:139]
 v_mfma_f32_16x16x32_bf16 a[136:139], a[232:235], a[192:195], a[136:139]
 v_mfma_f32_16x16x32_bf16 a[136:139], v[176:179], v[80:83], a[136:139]
 v_mfma_f32_16x16x32_bf16 a[136:139], v[100:103], v[136:139], a[136:139]
 ds_write_b128 v200, a[116:119] offset:35840
 v_mfma_f32_16x16x32_bf16 a[8:11], a[196:199], a[148:151], a[8:11]
 v_mfma_f32_16x16x32_bf16 a[8:11], a[216:219], a[176:179], a[8:11]
 v_mfma_f32_16x16x32_bf16 a[8:11], v[144:147], v[48:51], a[8:11]
 v_mfma_f32_16x16x32_bf16 a[8:11], v[184:187], v[104:107], a[8:11]
 ds_write_b128 v201, a[132:135] offset:41984
 v_mfma_f32_16x16x32_bf16 a[36:39], a[200:203], a[148:151], a[36:39]
 v_mfma_f32_16x16x32_bf16 a[36:39], a[220:223], a[176:179], a[36:39]
 v_mfma_f32_16x16x32_bf16 a[36:39], v[152:155], v[48:51], a[36:39]
 v_mfma_f32_16x16x32_bf16 a[36:39], v[192:195], v[104:107], a[36:39]
 ds_write_b128 v201, a[136:139] offset:43008
 v_mfma_f32_16x16x32_bf16 a[24:27], a[196:199], a[164:167], a[24:27]
 v_mfma_f32_16x16x32_bf16 a[24:27], a[216:219], a[192:195], a[24:27]
 s_waitcnt lgkmcnt(0)
 s_barrier
 v_mfma_f32_16x16x32_bf16 a[24:27], v[144:147], v[80:83], a[24:27]
 ds_read_b128 v[8:11], v200 offset:55296
 v_mfma_f32_16x16x32_bf16 a[24:27], v[184:187], v[136:139], a[24:27]
 ds_read_b128 v[12:15], v200 offset:64512
 v_mfma_f32_16x16x32_bf16 a[52:55], a[200:203], a[164:167], a[52:55]
 ds_read_b128 v[16:19], v201 offset:8192
 v_mfma_f32_16x16x32_bf16 a[52:55], a[220:223], a[192:195], a[52:55]
 ds_read_b128 v[20:23], v200 offset:56320
 v_mfma_f32_16x16x32_bf16 a[52:55], v[152:155], v[80:83], a[52:55]
 ds_read_b128 v[24:27], v201 offset:0
 v_mfma_f32_16x16x32_bf16 a[52:55], v[192:195], v[136:139], a[52:55]
 ds_read_b128 v[28:31], v201 offset:9216
 v_mfma_f32_16x16x32_bf16 a[68:71], a[204:207], a[152:155], a[68:71]
 ds_read_b128 v[44:47], v200 offset:57344
 v_mfma_f32_16x16x32_bf16 a[68:71], a[224:227], a[180:183], a[68:71]
 ds_read_b128 v[52:55], v201 offset:1024
 v_mfma_f32_16x16x32_bf16 a[68:71], v[160:163], v[56:59], a[68:71]
 ds_read_b128 v[60:63], v201 offset:10240
 v_accvgpr_read_b32 v220, a8
 v_mfma_f32_16x16x32_bf16 a[68:71], v[36:39], v[112:115], a[68:71]
 ds_read_b128 v[76:79], v200 offset:58368
 v_accvgpr_read_b32 v221, a9
 v_mfma_f32_16x16x32_bf16 a[96:99], a[208:211], a[152:155], a[96:99]
 ds_read_b128 v[84:87], v201 offset:2048
 v_accvgpr_read_b32 v222, a10
 v_mfma_f32_16x16x32_bf16 a[96:99], a[228:231], a[180:183], a[96:99]
 ds_read_b128 v[92:95], v201 offset:11264
 v_accvgpr_read_b32 v223, a11
 s_waitcnt lgkmcnt(9)
 v_mfma_f32_16x16x32_bf16 a[96:99], v[168:171], v[56:59], a[96:99]
 ds_read_b128 v[108:111], v200 offset:59392
 v_add_f32 v12, v12, v16
 v_mfma_f32_16x16x32_bf16 a[96:99], v[68:71], v[112:115], a[96:99]
 ds_read_b128 v[116:119], v201 offset:3072
 v_add_f32 v13, v13, v17
 v_mfma_f32_16x16x32_bf16 a[120:123], a[212:215], a[148:151], a[120:123]
 ds_read_b128 v[124:127], v201 offset:12288
 v_add_f32 v14, v14, v18
 v_mfma_f32_16x16x32_bf16 a[120:123], a[232:235], a[176:179], a[120:123]
 ds_read_b128 v[132:135], v200 offset:60416
 v_add_f32 v15, v15, v19
 v_mfma_f32_16x16x32_bf16 a[120:123], v[176:179], v[48:51], a[120:123]
 ds_read_b128 v[140:143], v201 offset:4096
 v_add_f32 v220, v220, v8
 v_mfma_f32_16x16x32_bf16 a[120:123], v[100:103], v[104:107], a[120:123]
 ds_read_b128 v[148:151], v201 offset:13312
 v_add_f32 v221, v221, v9
 v_mfma_f32_16x16x32_bf16 a[124:127], a[212:215], a[152:155], a[124:127]
 ds_read_b128 v[156:159], v200 offset:61440
 v_add_f32 v222, v222, v10
 v_mfma_f32_16x16x32_bf16 a[124:127], a[232:235], a[180:183], a[124:127]
 ds_read_b128 v[164:167], v201 offset:5120
 v_add_f32 v223, v223, v11
 v_mfma_f32_16x16x32_bf16 a[124:127], v[176:179], v[56:59], a[124:127]
 ds_read_b128 v[172:175], v201 offset:14336
 v_add_f32 v12, v12, v220
 v_mfma_f32_16x16x32_bf16 a[124:127], v[100:103], v[112:115], a[124:127]
 ds_read_b128 v[180:183], v200 offset:62464
 v_add_f32 v13, v13, v221
 v_mfma_f32_16x16x32_bf16 a[128:131], a[212:215], a[156:159], a[128:131]
 ds_read_b128 v[188:191], v201 offset:6144
 v_add_f32 v14, v14, v222
 v_mfma_f32_16x16x32_bf16 a[128:131], a[232:235], a[184:187], a[128:131]
 ds_read_b128 v[196:199], v201 offset:15360
 v_add_f32 v15, v15, v223
 v_mfma_f32_16x16x32_bf16 a[128:131], v[176:179], v[64:67], a[128:131]
 ds_read_b128 v[208:211], v200 offset:63488
 v_cvt_pk_bf16_f32 v12, v12, v13
 v_mfma_f32_16x16x32_bf16 a[128:131], v[100:103], v[120:123], a[128:131]
 ds_read_b128 v[212:215], v201 offset:7168
 v_cvt_pk_bf16_f32 v13, v14, v15
 ds_read_b128 v[216:219], v201 offset:16384
 s_nop 5
 v_accvgpr_read_b32 v224, a36
 v_accvgpr_read_b32 v225, a37
 v_accvgpr_read_b32 v226, a38
 v_accvgpr_read_b32 v227, a39
 s_waitcnt lgkmcnt(15)
 v_pk_add_f32 v[24:25], v[24:25], v[28:29]
 v_pk_add_f32 v[26:27], v[26:27], v[30:31]
 v_pk_add_f32 v[224:225], v[224:225], v[20:21]
 v_pk_add_f32 v[226:227], v[226:227], v[22:23]
 v_pk_add_f32 v[24:25], v[24:25], v[224:225]
 v_pk_add_f32 v[26:27], v[26:27], v[226:227]
 v_cvt_pk_bf16_f32 v14, v24, v25
 v_cvt_pk_bf16_f32 v15, v26, v27
 buffer_store_dwordx4 v[12:15], v206, s[12:15], s58 offen
 v_accvgpr_read_b32 v228, a24
 v_accvgpr_read_b32 v229, a25
 v_accvgpr_read_b32 v230, a26
 v_accvgpr_read_b32 v231, a27
 s_waitcnt lgkmcnt(15)
 v_pk_add_f32 v[52:53], v[52:53], v[60:61]
 v_pk_add_f32 v[54:55], v[54:55], v[62:63]
 v_pk_add_f32 v[228:229], v[228:229], v[44:45]
 v_pk_add_f32 v[230:231], v[230:231], v[46:47]
 v_pk_add_f32 v[52:53], v[52:53], v[228:229]
 v_pk_add_f32 v[54:55], v[54:55], v[230:231]
 v_cvt_pk_bf16_f32 v52, v52, v53
 v_cvt_pk_bf16_f32 v53, v54, v55
 v_accvgpr_read_b32 v232, a52
 v_accvgpr_read_b32 v233, a53
 v_accvgpr_read_b32 v234, a54
 v_accvgpr_read_b32 v235, a55
 s_waitcnt lgkmcnt(15)
 v_pk_add_f32 v[84:85], v[84:85], v[92:93]
 v_pk_add_f32 v[86:87], v[86:87], v[94:95]
 v_pk_add_f32 v[232:233], v[232:233], v[76:77]
 v_pk_add_f32 v[234:235], v[234:235], v[78:79]
 v_pk_add_f32 v[84:85], v[84:85], v[232:233]
 v_pk_add_f32 v[86:87], v[86:87], v[234:235]
 v_cvt_pk_bf16_f32 v54, v84, v85
 v_cvt_pk_bf16_f32 v55, v86, v87
 buffer_store_dwordx4 v[52:55], v206, s[12:15], s60 offen
 v_accvgpr_read_b32 v236, a68
 v_accvgpr_read_b32 v237, a69
 v_accvgpr_read_b32 v238, a70
 v_accvgpr_read_b32 v239, a71
 s_waitcnt lgkmcnt(12)
 v_pk_add_f32 v[116:117], v[116:117], v[124:125]
 v_pk_add_f32 v[118:119], v[118:119], v[126:127]
 v_pk_add_f32 v[236:237], v[236:237], v[108:109]
 v_pk_add_f32 v[238:239], v[238:239], v[110:111]
 v_pk_add_f32 v[116:117], v[116:117], v[236:237]
 v_pk_add_f32 v[118:119], v[118:119], v[238:239]
 v_cvt_pk_bf16_f32 v116, v116, v117
 v_cvt_pk_bf16_f32 v117, v118, v119
 v_accvgpr_read_b32 v240, a96
 v_accvgpr_read_b32 v241, a97
 v_accvgpr_read_b32 v242, a98
 v_accvgpr_read_b32 v243, a99
 s_waitcnt lgkmcnt(9)
 v_pk_add_f32 v[140:141], v[140:141], v[148:149]
 v_pk_add_f32 v[142:143], v[142:143], v[150:151]
 s_branch SK11119
PG11119:
 s_branch PG10415
SK11119:
 v_pk_add_f32 v[240:241], v[240:241], v[132:133]
 v_pk_add_f32 v[242:243], v[242:243], v[134:135]
 v_pk_add_f32 v[140:141], v[140:141], v[240:241]
 v_pk_add_f32 v[142:143], v[142:143], v[242:243]
 v_cvt_pk_bf16_f32 v118, v140, v141
 v_cvt_pk_bf16_f32 v119, v142, v143
 buffer_store_dwordx4 v[116:119], v206, s[12:15], s62 offen
 v_accvgpr_read_b32 v244, a120
 v_accvgpr_read_b32 v245, a121
 v_accvgpr_read_b32 v246, a122
 v_accvgpr_read_b32 v247, a123
 s_waitcnt lgkmcnt(6)
 v_pk_add_f32 v[164:165], v[164:165], v[172:173]
 v_pk_add_f32 v[166:167], v[166:167], v[174:175]
 v_pk_add_f32 v[244:245], v[244:245], v[156:157]
 v_pk_add_f32 v[246:247], v[246:247], v[158:159]
 v_pk_add_f32 v[164:165], v[164:165], v[244:245]
 v_pk_add_f32 v[166:167], v[166:167], v[246:247]
 v_cvt_pk_bf16_f32 v164, v164, v165
 v_cvt_pk_bf16_f32 v165, v166, v167
 buffer_store_dwordx2 v[164:165], v204, s[12:15], s64 offen
 v_accvgpr_read_b32 v248, a124
 v_accvgpr_read_b32 v249, a125
 v_accvgpr_read_b32 v250, a126
 v_accvgpr_read_b32 v251, a127
 s_waitcnt lgkmcnt(3)
 v_pk_add_f32 v[188:189], v[188:189], v[196:197]
 v_pk_add_f32 v[190:191], v[190:191], v[198:199]
 v_pk_add_f32 v[248:249], v[248:249], v[180:181]
 v_pk_add_f32 v[250:251], v[250:251], v[182:183]
 v_pk_add_f32 v[188:189], v[188:189], v[248:249]
 v_pk_add_f32 v[190:191], v[190:191], v[250:251]
 v_cvt_pk_bf16_f32 v188, v188, v189
 v_cvt_pk_bf16_f32 v189, v190, v191
 buffer_store_dwordx2 v[188:189], v204, s[12:15], s65 offen
 v_accvgpr_read_b32 v252, a128
 v_accvgpr_read_b32 v253, a129
 v_accvgpr_read_b32 v254, a130
 v_accvgpr_read_b32 v255, a131
 s_waitcnt lgkmcnt(0)
 v_pk_add_f32 v[212:213], v[212:213], v[216:217]
 v_pk_add_f32 v[214:215], v[214:215], v[218:219]
 v_pk_add_f32 v[252:253], v[252:253], v[208:209]
 v_pk_add_f32 v[254:255], v[254:255], v[210:211]
 v_pk_add_f32 v[212:213], v[212:213], v[252:253]
 v_pk_add_f32 v[214:215], v[214:215], v[254:255]
 v_cvt_pk_bf16_f32 v212, v212, v213
 v_cvt_pk_bf16_f32 v213, v214, v215
 buffer_store_dwordx2 v[212:213], v204, s[12:15], s48 offen
 s_endpgm
PG11170:
 s_branch RET2
P2_V3:
 s_waitcnt vmcnt(44)
 v_mfma_f32_16x16x32_bf16 a[0:3], a[196:199], a[140:143], a[0:3]
 v_mfma_f32_16x16x32_bf16 a[0:3], a[216:219], a[168:171], a[0:3]
 s_waitcnt vmcnt(20)
 v_mfma_f32_16x16x32_bf16 a[0:3], v[144:147], v[32:35], a[0:3]
 v_mfma_f32_16x16x32_bf16 a[0:3], v[184:187], v[88:91], a[0:3]
 s_waitcnt vmcnt(42)
 v_mfma_f32_16x16x32_bf16 a[4:7], a[196:199], a[144:147], a[4:7]
 s_mul_i32 s58, s87, 40
 v_mfma_f32_16x16x32_bf16 a[4:7], a[216:219], a[172:175], a[4:7]
 s_waitcnt vmcnt(18)
 s_lshr_b32 s54, s20, 5
 v_mfma_f32_16x16x32_bf16 a[4:7], v[144:147], v[40:43], a[4:7]
 s_add_u32 s58, s58, s54
 v_mfma_f32_16x16x32_bf16 a[4:7], v[184:187], v[96:99], a[4:7]
 s_waitcnt vmcnt(40)
 v_mfma_f32_16x16x32_bf16 a[8:11], a[196:199], a[148:151], a[8:11]
 s_mul_i32 s59, s87, 40
 v_mfma_f32_16x16x32_bf16 a[8:11], a[216:219], a[176:179], a[8:11]
 s_waitcnt vmcnt(16)
 s_lshr_b32 s54, s21, 5
 v_mfma_f32_16x16x32_bf16 a[8:11], v[144:147], v[48:51], a[8:11]
 s_add_u32 s59, s59, s54
 v_mfma_f32_16x16x32_bf16 a[8:11], v[184:187], v[104:107], a[8:11]
 s_waitcnt vmcnt(36)
 ds_write_b128 v200, a[0:3] offset:18432
 v_mfma_f32_16x16x32_bf16 a[16:19], a[196:199], a[156:159], a[16:19]
 s_mul_i32 s60, s84, 40
 v_mfma_f32_16x16x32_bf16 a[16:19], a[216:219], a[184:187], a[16:19]
 s_waitcnt vmcnt(12)
 s_lshr_b32 s54, s22, 5
 v_mfma_f32_16x16x32_bf16 a[16:19], v[144:147], v[64:67], a[16:19]
 s_add_u32 s60, s60, s54
 v_mfma_f32_16x16x32_bf16 a[16:19], v[184:187], v[120:123], a[16:19]
 s_waitcnt vmcnt(34)
 ds_write_b128 v200, a[4:7] offset:36864
 v_mfma_f32_16x16x32_bf16 a[20:23], a[196:199], a[160:163], a[20:23]
 s_mul_i32 s61, s84, 40
 v_mfma_f32_16x16x32_bf16 a[20:23], a[216:219], a[188:191], a[20:23]
 s_waitcnt vmcnt(10)
 s_lshr_b32 s54, s23, 5
 v_mfma_f32_16x16x32_bf16 a[20:23], v[144:147], v[72:75], a[20:23]
 s_add_u32 s61, s61, s54
 v_mfma_f32_16x16x32_bf16 a[20:23], v[184:187], v[128:131], a[20:23]
 s_waitcnt vmcnt(32)
 ds_write_b128 v200, a[8:11] offset:55296
 v_mfma_f32_16x16x32_bf16 a[24:27], a[196:199], a[164:167], a[24:27]
 s_mul_i32 s62, s96, 40
 v_mfma_f32_16x16x32_bf16 a[24:27], a[216:219], a[192:195], a[24:27]
 s_waitcnt vmcnt(8)
 s_lshr_b32 s54, s22, 5
 v_mfma_f32_16x16x32_bf16 a[24:27], v[144:147], v[80:83], a[24:27]
 s_add_u32 s62, s62, s54
 v_mfma_f32_16x16x32_bf16 a[24:27], v[184:187], v[136:139], a[24:27]
 s_waitcnt vmcnt(30)
 ds_write_b128 v200, a[16:19] offset:20480
 v_mfma_f32_16x16x32_bf16 a[28:31], a[200:203], a[140:143], a[28:31]
 s_mul_i32 s63, s96, 40
 v_mfma_f32_16x16x32_bf16 a[28:31], a[220:223], a[168:171], a[28:31]
 s_waitcnt vmcnt(6)
 s_lshr_b32 s54, s23, 5
 v_mfma_f32_16x16x32_bf16 a[28:31], v[152:155], v[32:35], a[28:31]
 s_add_u32 s63, s63, s54
 v_mfma_f32_16x16x32_bf16 a[28:31], v[192:195], v[88:91], a[28:31]
 ds_write_b128 v200, a[20:23] offset:38912
 v_mfma_f32_16x16x32_bf16 a[32:35], a[200:203], a[144:147], a[32:35]
 s_mul_i32 s64, s97, 40
 v_mfma_f32_16x16x32_bf16 a[32:35], a[220:223], a[172:175], a[32:35]
 s_lshr_b32 s54, s28, 5
 v_mfma_f32_16x16x32_bf16 a[32:35], v[152:155], v[40:43], a[32:35]
 s_add_u32 s64, s64, s54
 v_mfma_f32_16x16x32_bf16 a[32:35], v[192:195], v[96:99], a[32:35]
 ds_write_b128 v200, a[24:27] offset:57344
 v_mfma_f32_16x16x32_bf16 a[36:39], a[200:203], a[148:151], a[36:39]
 s_mul_i32 s65, s98, 40
 v_mfma_f32_16x16x32_bf16 a[36:39], a[220:223], a[176:179], a[36:39]
 s_lshr_b32 s54, s28, 5
 v_mfma_f32_16x16x32_bf16 a[36:39], v[152:155], v[48:51], a[36:39]
 s_add_u32 s65, s65, s54
 v_mfma_f32_16x16x32_bf16 a[36:39], v[192:195], v[104:107], a[36:39]
 ds_write_b128 v200, a[28:31] offset:19456
 v_mfma_f32_16x16x32_bf16 a[44:47], a[200:203], a[156:159], a[44:47]
 v_mfma_f32_16x16x32_bf16 a[44:47], a[220:223], a[184:187], a[44:47]
 v_mfma_f32_16x16x32_bf16 a[44:47], v[152:155], v[64:67], a[44:47]
 v_mfma_f32_16x16x32_bf16 a[44:47], v[192:195], v[120:123], a[44:47]
 ds_write_b128 v200, a[32:35] offset:37888
 v_mfma_f32_16x16x32_bf16 a[48:51], a[200:203], a[160:163], a[48:51]
 v_mfma_f32_16x16x32_bf16 a[48:51], a[220:223], a[188:191], a[48:51]
 v_mfma_f32_16x16x32_bf16 a[48:51], v[152:155], v[72:75], a[48:51]
 v_mfma_f32_16x16x32_bf16 a[48:51], v[192:195], v[128:131], a[48:51]
 ds_write_b128 v200, a[36:39] offset:56320
 v_mfma_f32_16x16x32_bf16 a[52:55], a[200:203], a[164:167], a[52:55]
 v_mfma_f32_16x16x32_bf16 a[52:55], a[220:223], a[192:195], a[52:55]
 v_mfma_f32_16x16x32_bf16 a[52:55], v[152:155], v[80:83], a[52:55]
 v_mfma_f32_16x16x32_bf16 a[52:55], v[192:195], v[136:139], a[52:55]
 s_waitcnt vmcnt(28)
 ds_write_b128 v200, a[44:47] offset:21504
 v_mfma_f32_16x16x32_bf16 a[60:63], a[204:207], a[144:147], a[60:63]
 v_mfma_f32_16x16x32_bf16 a[60:63], a[224:227], a[172:175], a[60:63]
 s_waitcnt vmcnt(4)
 v_mfma_f32_16x16x32_bf16 a[60:63], v[160:163], v[40:43], a[60:63]
 v_mfma_f32_16x16x32_bf16 a[60:63], v[36:39], v[96:99], a[60:63]
 ds_write_b128 v200, a[48:51] offset:39936
 v_mfma_f32_16x16x32_bf16 a[64:67], a[204:207], a[148:151], a[64:67]
 v_mfma_f32_16x16x32_bf16 a[64:67], a[224:227], a[176:179], a[64:67]
 v_mfma_f32_16x16x32_bf16 a[64:67], v[160:163], v[48:51], a[64:67]
 v_mfma_f32_16x16x32_bf16 a[64:67], v[36:39], v[104:107], a[64:67]
 s_waitcnt vmcnt(38)
 ds_write_b128 v200, a[52:55] offset:58368
 v_mfma_f32_16x16x32_bf16 a[68:71], a[204:207], a[152:155], a[68:71]
 v_mfma_f32_16x16x32_bf16 a[68:71], a[224:227], a[180:183], a[68:71]
 s_waitcnt vmcnt(14)
 v_mfma_f32_16x16x32_bf16 a[68:71], v[160:163], v[56:59], a[68:71]
 v_mfma_f32_16x16x32_bf16 a[68:71], v[36:39], v[112:115], a[68:71]
 ds_write_b128 v200, a[60:63] offset:22528
 v_mfma_f32_16x16x32_bf16 a[76:79], a[204:207], a[160:163], a[76:79]
 v_mfma_f32_16x16x32_bf16 a[76:79], a[224:227], a[188:191], a[76:79]
 v_mfma_f32_16x16x32_bf16 a[76:79], v[160:163], v[72:75], a[76:79]
 v_mfma_f32_16x16x32_bf16 a[76:79], v[36:39], v[128:131], a[76:79]
 ds_write_b128 v200, a[64:67] offset:40960
 v_mfma_f32_16x16x32_bf16 a[80:83], a[204:207], a[164:167], a[80:83]
 v_mfma_f32_16x16x32_bf16 a[80:83], a[224:227], a[192:195], a[80:83]
 v_mfma_f32_16x16x32_bf16 a[80:83], v[160:163], v[80:83], a[80:83]
 v_mfma_f32_16x16x32_bf16 a[80:83], v[36:39], v[136:139], a[80:83]
 s_waitcnt vmcnt(26)
 ds_write_b128 v200, a[68:71] offset:59392
 v_mfma_f32_16x16x32_bf16 a[88:91], a[208:211], a[144:147], a[88:91]
 v_mfma_f32_16x16x32_bf16 a[88:91], a[228:231], a[172:175], a[88:91]
 s_waitcnt vmcnt(2)
 v_mfma_f32_16x16x32_bf16 a[88:91], v[168:171], v[40:43], a[88:91]
 v_mfma_f32_16x16x32_bf16 a[88:91], v[68:71], v[96:99], a[88:91]
 ds_write_b128 v200, a[76:79] offset:24576
 v_mfma_f32_16x16x32_bf16 a[92:95], a[208:211], a[148:151], a[92:95]
 v_mfma_f32_16x16x32_bf16 a[92:95], a[228:231], a[176:179], a[92:95]
 v_mfma_f32_16x16x32_bf16 a[92:95], v[168:171], v[48:51], a[92:95]
 v_mfma_f32_16x16x32_bf16 a[92:95], v[68:71], v[104:107], a[92:95]
 ds_write_b128 v200, a[80:83] offset:43008
 v_mfma_f32_16x16x32_bf16 a[96:99], a[208:211], a[152:155], a[96:99]
 v_mfma_f32_16x16x32_bf16 a[96:99], a[228:231], a[180:183], a[96:99]
 v_mfma_f32_16x16x32_bf16 a[96:99], v[168:171], v[56:59], a[96:99]
 v_mfma_f32_16x16x32_bf16 a[96:99], v[68:71], v[112:115], a[96:99]
 ds_write_b128 v200, a[88:91] offset:23552
 v_mfma_f32_16x16x32_bf16 a[104:107], a[208:211], a[160:163], a[104:107]
 v_mfma_f32_16x16x32_bf16 a[104:107], a[228:231], a[188:191], a[104:107]
 v_mfma_f32_16x16x32_bf16 a[104:107], v[168:171], v[72:75], a[104:107]
 v_mfma_f32_16x16x32_bf16 a[104:107], v[68:71], v[128:131], a[104:107]
 ds_write_b128 v200, a[92:95] offset:41984
 v_mfma_f32_16x16x32_bf16 a[108:111], a[208:211], a[164:167], a[108:111]
 v_mfma_f32_16x16x32_bf16 a[108:111], a[228:231], a[192:195], a[108:111]
 v_mfma_f32_16x16x32_bf16 a[108:111], v[168:171], v[80:83], a[108:111]
 v_mfma_f32_16x16x32_bf16 a[108:111], v[68:71], v[136:139], a[108:111]
 s_waitcnt vmcnt(24)
 ds_write_b128 v200, a[96:99] offset:60416
 v_mfma_f32_16x16x32_bf16 a[112:115], a[212:215], a[140:143], a[112:115]
 v_mfma_f32_16x16x32_bf16 a[112:115], a[232:235], a[168:171], a[112:115]
 s_waitcnt vmcnt(0)
 v_mfma_f32_16x16x32_bf16 a[112:115], v[176:179], v[32:35], a[112:115]
 v_mfma_f32_16x16x32_bf16 a[112:115], v[100:103], v[88:91], a[112:115]
 ds_write_b128 v200, a[104:107] offset:25600
 v_mfma_f32_16x16x32_bf16 a[116:119], a[212:215], a[144:147], a[116:119]
 v_mfma_f32_16x16x32_bf16 a[116:119], a[232:235], a[172:175], a[116:119]
 v_mfma_f32_16x16x32_bf16 a[116:119], v[176:179], v[40:43], a[116:119]
 v_mfma_f32_16x16x32_bf16 a[116:119], v[100:103], v[96:99], a[116:119]
 ds_write_b128 v200, a[108:111] offset:44032
 v_mfma_f32_16x16x32_bf16 a[120:123], a[212:215], a[148:151], a[120:123]
 v_mfma_f32_16x16x32_bf16 a[120:123], a[232:235], a[176:179], a[120:123]
 v_mfma_f32_16x16x32_bf16 a[120:123], v[176:179], v[48:51], a[120:123]
 v_mfma_f32_16x16x32_bf16 a[120:123], v[100:103], v[104:107], a[120:123]
 ds_write_b128 v200, a[112:115] offset:26624
 v_mfma_f32_16x16x32_bf16 a[124:127], a[212:215], a[152:155], a[124:127]
 v_mfma_f32_16x16x32_bf16 a[124:127], a[232:235], a[180:183], a[124:127]
 v_mfma_f32_16x16x32_bf16 a[124:127], v[176:179], v[56:59], a[124:127]
 v_mfma_f32_16x16x32_bf16 a[124:127], v[100:103], v[112:115], a[124:127]
 ds_write_b128 v200, a[116:119] offset:45056
 v_mfma_f32_16x16x32_bf16 a[128:131], a[212:215], a[156:159], a[128:131]
 v_mfma_f32_16x16x32_bf16 a[128:131], a[232:235], a[184:187], a[128:131]
 v_mfma_f32_16x16x32_bf16 a[128:131], v[176:179], v[64:67], a[128:131]
 v_mfma_f32_16x16x32_bf16 a[128:131], v[100:103], v[120:123], a[128:131]
 ds_write_b128 v200, a[120:123] offset:61440
 v_mfma_f32_16x16x32_bf16 a[12:15], a[196:199], a[152:155], a[12:15]
 v_mfma_f32_16x16x32_bf16 a[12:15], a[216:219], a[180:183], a[12:15]
 v_mfma_f32_16x16x32_bf16 a[12:15], v[144:147], v[56:59], a[12:15]
 v_mfma_f32_16x16x32_bf16 a[12:15], v[184:187], v[112:115], a[12:15]
 ds_write_b128 v200, a[124:127] offset:62464
 v_mfma_f32_16x16x32_bf16 a[40:43], a[200:203], a[152:155], a[40:43]
 v_mfma_f32_16x16x32_bf16 a[40:43], a[220:223], a[180:183], a[40:43]
 v_mfma_f32_16x16x32_bf16 a[40:43], v[152:155], v[56:59], a[40:43]
 v_mfma_f32_16x16x32_bf16 a[40:43], v[192:195], v[112:115], a[40:43]
 ds_write_b128 v200, a[128:131] offset:63488
 v_mfma_f32_16x16x32_bf16 a[56:59], a[204:207], a[140:143], a[56:59]
 v_mfma_f32_16x16x32_bf16 a[56:59], a[224:227], a[168:171], a[56:59]
 s_waitcnt lgkmcnt(0)
 s_barrier
 v_mfma_f32_16x16x32_bf16 a[56:59], v[160:163], v[32:35], a[56:59]
 ds_read_b128 v[8:11], v201 offset:17408
 v_mfma_f32_16x16x32_bf16 a[56:59], v[36:39], v[88:91], a[56:59]
 ds_read_b128 v[12:15], v201 offset:26624
 v_mfma_f32_16x16x32_bf16 a[84:87], a[208:211], a[140:143], a[84:87]
 ds_read_b128 v[16:19], v201 offset:35840
 v_mfma_f32_16x16x32_bf16 a[84:87], a[228:231], a[168:171], a[84:87]
 ds_read_b128 v[20:23], v201 offset:18432
 v_mfma_f32_16x16x32_bf16 a[84:87], v[168:171], v[32:35], a[84:87]
 ds_read_b128 v[24:27], v201 offset:27648
 v_mfma_f32_16x16x32_bf16 a[84:87], v[68:71], v[88:91], a[84:87]
 ds_read_b128 v[28:31], v201 offset:36864
 v_mfma_f32_16x16x32_bf16 a[72:75], a[204:207], a[156:159], a[72:75]
 ds_read_b128 v[44:47], v201 offset:19456
 v_mfma_f32_16x16x32_bf16 a[72:75], a[224:227], a[184:187], a[72:75]
 ds_read_b128 v[52:55], v201 offset:28672
 v_mfma_f32_16x16x32_bf16 a[72:75], v[160:163], v[64:67], a[72:75]
 ds_read_b128 v[60:63], v201 offset:37888
 v_accvgpr_read_b32 v220, a12
 v_mfma_f32_16x16x32_bf16 a[72:75], v[36:39], v[120:123], a[72:75]
 ds_read_b128 v[76:79], v201 offset:20480
 v_accvgpr_read_b32 v221, a13
 v_mfma_f32_16x16x32_bf16 a[100:103], a[208:211], a[156:159], a[100:103]
 ds_read_b128 v[84:87], v201 offset:29696
 v_accvgpr_read_b32 v222, a14
 v_mfma_f32_16x16x32_bf16 a[100:103], a[228:231], a[184:187], a[100:103]
 ds_read_b128 v[92:95], v201 offset:38912
 v_accvgpr_read_b32 v223, a15
 s_waitcnt lgkmcnt(9)
 v_mfma_f32_16x16x32_bf16 a[100:103], v[168:171], v[64:67], a[100:103]
 ds_read_b128 v[108:111], v201 offset:21504
 v_add_f32 v8, v8, v12
 v_mfma_f32_16x16x32_bf16 a[100:103], v[68:71], v[120:123], a[100:103]
 ds_read_b128 v[116:119], v201 offset:30720
 v_add_f32 v9, v9, v13
 v_mfma_f32_16x16x32_bf16 a[132:135], a[212:215], a[160:163], a[132:135]
 ds_read_b128 v[124:127], v201 offset:39936
 v_add_f32 v10, v10, v14
 v_mfma_f32_16x16x32_bf16 a[132:135], a[232:235], a[188:191], a[132:135]
 ds_read_b128 v[132:135], v201 offset:22528
 v_add_f32 v11, v11, v15
 v_mfma_f32_16x16x32_bf16 a[132:135], v[176:179], v[72:75], a[132:135]
 ds_read_b128 v[140:143], v201 offset:31744
 v_add_f32 v16, v16, v220
 v_mfma_f32_16x16x32_bf16 a[132:135], v[100:103], v[128:131], a[132:135]
 ds_read_b128 v[148:151], v201 offset:40960
 v_add_f32 v17, v17, v221
 v_mfma_f32_16x16x32_bf16 a[136:139], a[212:215], a[164:167], a[136:139]
 ds_read_b128 v[156:159], v201 offset:23552
 v_add_f32 v18, v18, v222
 v_mfma_f32_16x16x32_bf16 a[136:139], a[232:235], a[192:195], a[136:139]
 ds_read_b128 v[164:167], v201 offset:32768
 v_add_f32 v19, v19, v223
 v_mfma_f32_16x16x32_bf16 a[136:139], v[176:179], v[80:83], a[136:139]
 ds_read_b128 v[172:175], v201 offset:41984
 v_add_f32 v8, v8, v16
 v_mfma_f32_16x16x32_bf16 a[136:139], v[100:103], v[136:139], a[136:139]
 ds_read_b128 v[180:183], v201 offset:24576
 v_add_f32 v9, v9, v17
 ds_read_b128 v[188:191], v201 offset:33792
 ds_read_b128 v[196:199], v201 offset:43008
 s_nop 5
 v_pk_add_f32 v[10:11], v[10:11], v[18:19]
 v_cvt_pk_bf16_f32 v8, v8, v9
 v_cvt_pk_bf16_f32 v9, v10, v11
 v_accvgpr_read_b32 v224, a40
 v_accvgpr_read_b32 v225, a41
 v_accvgpr_read_b32 v226, a42
 v_accvgpr_read_b32 v227, a43
 s_waitcnt lgkmcnt(15)
 v_pk_add_f32 v[20:21], v[20:21], v[24:25]
 v_pk_add_f32 v[22:23], v[22:23], v[26:27]
 v_pk_add_f32 v[28:29], v[28:29], v[224:225]
 v_pk_add_f32 v[30:31], v[30:31], v[226:227]
 v_pk_add_f32 v[20:21], v[20:21], v[28:29]
 v_pk_add_f32 v[22:23], v[22:23], v[30:31]
 v_cvt_pk_bf16_f32 v10, v20, v21
 v_cvt_pk_bf16_f32 v11, v22, v23
 buffer_store_dwordx4 v[8:11], v206, s[12:15], s58 offen
 v_accvgpr_read_b32 v228, a56
 v_accvgpr_read_b32 v229, a57
 v_accvgpr_read_b32 v230, a58
 v_accvgpr_read_b32 v231, a59
 s_waitcnt lgkmcnt(15)
 v_pk_add_f32 v[44:45], v[44:45], v[52:53]
 v_pk_add_f32 v[46:47], v[46:47], v[54:55]
 v_pk_add_f32 v[60:61], v[60:61], v[228:229]
 v_pk_add_f32 v[62:63], v[62:63], v[230:231]
 v_pk_add_f32 v[44:45], v[44:45], v[60:61]
 v_pk_add_f32 v[46:47], v[46:47], v[62:63]
 v_cvt_pk_bf16_f32 v44, v44, v45
 v_cvt_pk_bf16_f32 v45, v46, v47
 v_accvgpr_read_b32 v232, a84
 v_accvgpr_read_b32 v233, a85
 v_accvgpr_read_b32 v234, a86
 v_accvgpr_read_b32 v235, a87
 s_waitcnt lgkmcnt(12)
 v_pk_add_f32 v[76:77], v[76:77], v[84:85]
 v_pk_add_f32 v[78:79], v[78:79], v[86:87]
 v_pk_add_f32 v[92:93], v[92:93], v[232:233]
 v_pk_add_f32 v[94:95], v[94:95], v[234:235]
 v_pk_add_f32 v[76:77], v[76:77], v[92:93]
 v_pk_add_f32 v[78:79], v[78:79], v[94:95]
 v_cvt_pk_bf16_f32 v46, v76, v77
 v_cvt_pk_bf16_f32 v47, v78, v79
 buffer_store_dwordx4 v[44:47], v206, s[12:15], s60 offen
 v_accvgpr_read_b32 v236, a72
 v_accvgpr_read_b32 v237, a73
 v_accvgpr_read_b32 v238, a74
 v_accvgpr_read_b32 v239, a75
 s_waitcnt lgkmcnt(9)
 v_pk_add_f32 v[108:109], v[108:109], v[116:117]
 v_pk_add_f32 v[110:111], v[110:111], v[118:119]
 v_pk_add_f32 v[124:125], v[124:125], v[236:237]
 v_pk_add_f32 v[126:127], v[126:127], v[238:239]
 v_pk_add_f32 v[108:109], v[108:109], v[124:125]
 v_pk_add_f32 v[110:111], v[110:111], v[126:127]
 v_cvt_pk_bf16_f32 v108, v108, v109
 v_cvt_pk_bf16_f32 v109, v110, v111
 v_accvgpr_read_b32 v240, a100
 v_accvgpr_read_b32 v241, a101
 v_accvgpr_read_b32 v242, a102
 v_accvgpr_read_b32 v243, a103
 s_waitcnt lgkmcnt(6)
 v_pk_add_f32 v[132:133], v[132:133], v[140:141]
 v_pk_add_f32 v[134:135], v[134:135], v[142:143]
 v_pk_add_f32 v[148:149], v[148:149], v[240:241]
 v_pk_add_f32 v[150:151], v[150:151], v[242:243]
 v_pk_add_f32 v[132:133], v[132:133], v[148:149]
 v_pk_add_f32 v[134:135], v[134:135], v[150:151]
 v_cvt_pk_bf16_f32 v110, v132, v133
 v_cvt_pk_bf16_f32 v111, v134, v135
 buffer_store_dwordx4 v[108:111], v206, s[12:15], s62 offen
 v_accvgpr_read_b32 v244, a132
 v_accvgpr_read_b32 v245, a133
 v_accvgpr_read_b32 v246, a134
 v_accvgpr_read_b32 v247, a135
 s_waitcnt lgkmcnt(3)
 v_pk_add_f32 v[156:157], v[156:157], v[164:165]
 v_pk_add_f32 v[158:159], v[158:159], v[166:167]
 v_pk_add_f32 v[172:173], v[172:173], v[244:245]
 v_pk_add_f32 v[174:175], v[174:175], v[246:247]
 v_pk_add_f32 v[156:157], v[156:157], v[172:173]
 v_pk_add_f32 v[158:159], v[158:159], v[174:175]
 v_cvt_pk_bf16_f32 v156, v156, v157
 v_cvt_pk_bf16_f32 v157, v158, v159
 buffer_store_dwordx2 v[156:157], v204, s[12:15], s64 offen
 v_accvgpr_read_b32 v248, a136
 v_accvgpr_read_b32 v249, a137
 v_accvgpr_read_b32 v250, a138
 v_accvgpr_read_b32 v251, a139
 s_waitcnt lgkmcnt(0)
 v_pk_add_f32 v[180:181], v[180:181], v[188:189]
 v_pk_add_f32 v[182:183], v[182:183], v[190:191]
 v_pk_add_f32 v[196:197], v[196:197], v[248:249]
 v_pk_add_f32 v[198:199], v[198:199], v[250:251]
 v_pk_add_f32 v[180:181], v[180:181], v[196:197]
 v_pk_add_f32 v[182:183], v[182:183], v[198:199]
 v_cvt_pk_bf16_f32 v180, v180, v181
 v_cvt_pk_bf16_f32 v181, v182, v183
 buffer_store_dwordx2 v[180:181], v204, s[12:15], s65 offen
 s_endpgm
P2_SPINW:
 s_cmp_eq_u32 s56, 0
 s_cbranch_scc1 P2_GOW
 s_sub_u32 s56, s56, 1
 s_sleep 8
 buffer_load_dword v26, v3, s[84:87], 0 offen sc1
 s_waitcnt vmcnt(0)
 v_cmp_ne_u32 vcc, 0x01010101, v26
 s_nop 1
 s_cmp_lg_u64 vcc, 0
 s_cbranch_scc1 P2_SPINW
 s_branch P2_GOW
P2_SPINa:
 s_load_dwordx4 s[44:47], s[80:81], s92 glc
 s_waitcnt lgkmcnt(0)
 s_min_u32 s55, s44, s46
 s_cmp_ge_u32 s55, 2
 s_cbranch_scc1 P2_GOa
 s_load_dwordx4 s[44:47], s[80:81], s92 glc
 s_waitcnt lgkmcnt(0)
 s_min_u32 s55, s44, s46
 s_cmp_ge_u32 s55, 2
 s_cbranch_scc1 P2_GOa
 v_mov_b32 v5, 5
 s_waitcnt vmcnt(0)
 s_mov_b64 exec, 1
 buffer_store_dword v5, v7, s[80:83], s100 offen sc1
 s_mov_b64 exec, -1
P2_LPa:
 s_cmp_eq_u32 s56, 0
 s_cbranch_scc1 P2_GOa
 s_sub_u32 s56, s56, 1
 s_sleep 8
 s_load_dwordx4 s[44:47], s[80:81], s92 glc
 s_waitcnt lgkmcnt(0)
 s_min_u32 s55, s44, s46
 s_cmp_ge_u32 s55, 2
 s_cbranch_scc0 P2_LPa
 s_branch P2_GOa
P2_SPINb:
 s_load_dwordx4 s[44:47], s[80:81], s92 glc
 s_waitcnt lgkmcnt(0)
 s_min_u32 s55, s44, s46
 s_cmp_ge_u32 s55, 3
 s_cbranch_scc1 P2_GOb
 s_load_dwordx4 s[44:47], s[80:81], s92 glc
 s_waitcnt lgkmcnt(0)
 s_min_u32 s55, s44, s46
 s_cmp_ge_u32 s55, 3
 s_cbranch_scc1 P2_GOb
 v_mov_b32 v5, 5
 s_waitcnt vmcnt(0)
 s_mov_b64 exec, 1
 buffer_store_dword v5, v7, s[80:83], s100 offen sc1
 s_mov_b64 exec, -1
P2_LPb:
 s_cmp_eq_u32 s56, 0
 s_cbranch_scc1 P2_GOb
 s_sub_u32 s56, s56, 1
 s_sleep 8
 s_load_dwordx4 s[44:47], s[80:81], s92 glc
 s_waitcnt lgkmcnt(0)
 s_min_u32 s55, s44, s46
 s_cmp_ge_u32 s55, 3
 s_cbranch_scc0 P2_LPb
 s_branch P2_GOb
P2_SPINc:
 s_cmp_eq_u32 s56, 0
 s_cbranch_scc1 P2_GOc
 s_sub_u32 s56, s56, 1
 s_sleep 8
 s_load_dwordx4 s[44:47], s[80:81], s92 glc
 s_waitcnt lgkmcnt(0)
 s_min_u32 s55, s44, s46
 s_cmp_ge_u32 s55, 5
 s_cbranch_scc0 P2_SPINc
 s_branch P2_GOc
P2_SPIN2:
 s_cmp_eq_u32 s56, 0
 s_cbranch_scc1 P2_GO2
 s_sub_u32 s56, s56, 1
 s_sleep 8
 s_load_dwordx4 s[44:47], s[80:81], s93 glc
 s_waitcnt lgkmcnt(0)
 s_min_u32 s55, s44, s46
 s_cmp_ge_u32 s55, 5
 s_cbranch_scc0 P2_SPIN2
 s_branch P2_GO2
P2_SPIN6:
 s_cmp_eq_u32 s56, 0
 s_cbranch_scc1 P2_GO6
 s_sub_u32 s56, s56, 1
 s_sleep 8
 s_load_dwordx4 s[44:47], s[80:81], s94 glc
 s_waitcnt lgkmcnt(0)
 s_min_u32 s55, s44, s46
 s_cmp_ge_u32 s55, 5
 s_cbranch_scc0 P2_SPIN6
 s_branch P2_GO6
P2_SPIN10:
 s_cmp_eq_u32 s56, 0
 s_cbranch_scc1 P2_GO10
 s_sub_u32 s56, s56, 1
 s_sleep 8
 s_load_dwordx4 s[44:47], s[80:81], s67 glc
 s_waitcnt lgkmcnt(0)
 s_min_u32 s55, s44, s46
 s_cmp_ge_u32 s55, 5
 s_cbranch_scc0 P2_SPIN10
 s_branch P2_GO10
K1_SLOW:
 s_waitcnt vmcnt(0) lgkmcnt(0)
 s_nop 7
 s_add_u32 s74, s57, 32768
 s_lshl_b32 s75, s37, 14
 s_sub_u32 s48, s74, s75
 s_sub_u32 s49, s48, 65536
 v_add_u32 v10, s48, v10
 v_add_u32 v11, s48, v11
 v_add_u32 v12, s48, v12
 v_add_u32 v13, s48, v13
 v_add_u32 v14, s49, v14
 v_add_u32 v15, s49, v15
 v_add_u32 v16, s49, v16
 v_add_u32 v17, s49, v17
 v_add_u32 v18, s49, v18
 v_add_u32 v19, s49, v19
 v_add_u32 v20, s49, v20
 v_add_u32 v21, s49, v21
 v_lshrrev_b32 v62, 8, v0
 v_bfe_u32 v63, v0, 4, 4
 v_xor_b32 v244, v62, v63
 v_lshlrev_b32 v244, 4, v244
 v_lshl_add_u32 v244, v62, 8, v244
 v_xor_b32 v245, 64, v244
 v_xor_b32 v246, 128, v244
 v_xor_b32 v247, 192, v244
 v_lshlrev_b32 v60, 1, v62
 v_xor_b32 v60, v60, v63
 v_lshlrev_b32 v60, 4, v60
 v_lshl_add_u32 v60, v62, 8, v60
 v_xor_b32 v61, 128, v60
 s_add_u32 s75, s74, 8192
 v_mov_b32 v25, 0xff800000
 v_mov_b32 v26, 0xff800000
 v_mov_b32 v27, 0xff800000
 v_mov_b32 v28, 0xff800000
 v_mov_b32 v29, 0xff800000
 v_mov_b32 v30, 0xff800000
 v_mov_b32 v31, 0xff800000
 s_mov_b32 s50, 0
K1_SL1:
 s_mov_b32 m0, s74
 s_nop 0
 buffer_load_dwordx4 v244, s[12:15], s50 offen offset:0 lds
 buffer_load_dwordx4 v245, s[12:15], s50 offen offset:1024 lds
 buffer_load_dwordx4 v246, s[12:15], s50 offen offset:2048 lds
 buffer_load_dwordx4 v247, s[12:15], s50 offen offset:3072 lds
 s_mov_b32 m0, s75
 s_add_u32 s51, s50, 4096
 buffer_load_dwordx4 v244, s[12:15], s51 offen offset:0 lds
 buffer_load_dwordx4 v245, s[12:15], s51 offen offset:1024 lds
 buffer_load_dwordx4 v246, s[12:15], s51 offen offset:2048 lds
 buffer_load_dwordx4 v247, s[12:15], s51 offen offset:3072 lds
 s_waitcnt vmcnt(0)
 ds_read_b128 v[36:39], v10 offset:0
 ds_read_b128 v[68:71], v11 offset:0
 ds_read_b128 v[100:103], v12 offset:0
 ds_read_b128 v[132:135], v13 offset:0
 ds_read_b128 v[164:167], v10 offset:8192
 ds_read_b128 v[196:199], v11 offset:8192
 ds_read_b128 v[228:231], v12 offset:8192
 ds_read_b128 v[44:47], v13 offset:8192
 s_waitcnt lgkmcnt(0)
 v_mfma_f32_16x16x32_bf16 v[76:79], v[36:39], v[32:35], 0
 v_mfma_f32_16x16x32_bf16 v[76:79], v[68:71], v[40:43], v[76:79]
 v_mfma_f32_16x16x32_bf16 v[76:79], v[100:103], v[48:51], v[76:79]
 v_mfma_f32_16x16x32_bf16 v[76:79], v[132:135], v[56:59], v[76:79]
 v_mfma_f32_16x16x32_bf16 v[108:111], v[164:167], v[32:35], 0
 v_mfma_f32_16x16x32_bf16 v[108:111], v[196:199], v[40:43], v[108:111]
 v_mfma_f32_16x16x32_bf16 v[108:111], v[228:231], v[48:51], v[108:111]
 v_mfma_f32_16x16x32_bf16 v[108:111], v[44:47], v[56:59], v[108:111]
 s_nop 7
 v_max3_f32 v25, v25, v76, v77
 v_max3_f32 v25, v25, v78, v79
 v_max3_f32 v25, v25, v108, v109
 v_max3_f32 v25, v25, v110, v111
 v_mfma_f32_16x16x32_bf16 v[76:79], v[36:39], v[64:67], 0
 v_mfma_f32_16x16x32_bf16 v[76:79], v[68:71], v[72:75], v[76:79]
 v_mfma_f32_16x16x32_bf16 v[76:79], v[100:103], v[80:83], v[76:79]
 v_mfma_f32_16x16x32_bf16 v[76:79], v[132:135], v[88:91], v[76:79]
 v_mfma_f32_16x16x32_bf16 v[108:111], v[164:167], v[64:67], 0
 v_mfma_f32_16x16x32_bf16 v[108:111], v[196:199], v[72:75], v[108:111]
 v_mfma_f32_16x16x32_bf16 v[108:111], v[228:231], v[80:83], v[108:111]
 v_mfma_f32_16x16x32_bf16 v[108:111], v[44:47], v[88:91], v[108:111]
 s_nop 7
 v_max3_f32 v26, v26, v76, v77
 v_max3_f32 v26, v26, v78, v79
 v_max3_f32 v26, v26, v108, v109
 v_max3_f32 v26, v26, v110, v111
 v_mfma_f32_16x16x32_bf16 v[76:79], v[36:39], v[96:99], 0
 v_mfma_f32_16x16x32_bf16 v[76:79], v[68:71], v[104:107], v[76:79]
 v_mfma_f32_16x16x32_bf16 v[76:79], v[100:103], v[112:115], v[76:79]
 v_mfma_f32_16x16x32_bf16 v[76:79], v[132:135], v[120:123], v[76:79]
 v_mfma_f32_16x16x32_bf16 v[108:111], v[164:167], v[96:99], 0
 v_mfma_f32_16x16x32_bf16 v[108:111], v[196:199], v[104:107], v[108:111]
 v_mfma_f32_16x16x32_bf16 v[108:111], v[228:231], v[112:115], v[108:111]
 v_mfma_f32_16x16x32_bf16 v[108:111], v[44:47], v[120:123], v[108:111]
 s_nop 7
 v_max3_f32 v27, v27, v76, v77
 v_max3_f32 v27, v27, v78, v79
 v_max3_f32 v27, v27, v108, v109
 v_max3_f32 v27, v27, v110, v111
 v_mfma_f32_16x16x32_bf16 v[76:79], v[36:39], v[128:131], 0
 v_mfma_f32_16x16x32_bf16 v[76:79], v[68:71], v[136:139], v[76:79]
 v_mfma_f32_16x16x32_bf16 v[76:79], v[100:103], v[144:147], v[76:79]
 v_mfma_f32_16x16x32_bf16 v[76:79], v[132:135], v[152:155], v[76:79]
 v_mfma_f32_16x16x32_bf16 v[108:111], v[164:167], v[128:131], 0
 v_mfma_f32_16x16x32_bf16 v[108:111], v[196:199], v[136:139], v[108:111]
 v_mfma_f32_16x16x32_bf16 v[108:111], v[228:231], v[144:147], v[108:111]
 v_mfma_f32_16x16x32_bf16 v[108:111], v[44:47], v[152:155], v[108:111]
 s_nop 7
 v_max3_f32 v28, v28, v76, v77
 v_max3_f32 v28, v28, v78, v79
 v_max3_f32 v28, v28, v108, v109
 v_max3_f32 v28, v28, v110, v111
 v_mfma_f32_16x16x32_bf16 v[76:79], v[36:39], v[160:163], 0
 v_mfma_f32_16x16x32_bf16 v[76:79], v[68:71], v[168:171], v[76:79]
 v_mfma_f32_16x16x32_bf16 v[76:79], v[100:103], v[176:179], v[76:79]
 v_mfma_f32_16x16x32_bf16 v[76:79], v[132:135], v[184:187], v[76:79]
 v_mfma_f32_16x16x32_bf16 v[108:111], v[164:167], v[160:163], 0
 v_mfma_f32_16x16x32_bf16 v[108:111], v[196:199], v[168:171], v[108:111]
 v_mfma_f32_16x16x32_bf16 v[108:111], v[228:231], v[176:179], v[108:111]
 v_mfma_f32_16x16x32_bf16 v[108:111], v[44:47], v[184:187], v[108:111]
 s_nop 7
 v_max3_f32 v29, v29, v76, v77
 v_max3_f32 v29, v29, v78, v79
 v_max3_f32 v29, v29, v108, v109
 v_max3_f32 v29, v29, v110, v111
 v_mfma_f32_16x16x32_bf16 v[76:79], v[36:39], v[192:195], 0
 v_mfma_f32_16x16x32_bf16 v[76:79], v[68:71], v[200:203], v[76:79]
 v_mfma_f32_16x16x32_bf16 v[76:79], v[100:103], v[208:211], v[76:79]
 v_mfma_f32_16x16x32_bf16 v[76:79], v[132:135], v[216:219], v[76:79]
 v_mfma_f32_16x16x32_bf16 v[108:111], v[164:167], v[192:195], 0
 v_mfma_f32_16x16x32_bf16 v[108:111], v[196:199], v[200:203], v[108:111]
 v_mfma_f32_16x16x32_bf16 v[108:111], v[228:231], v[208:211], v[108:111]
 v_mfma_f32_16x16x32_bf16 v[108:111], v[44:47], v[216:219], v[108:111]
 s_nop 7
 v_max3_f32 v30, v30, v76, v77
 v_max3_f32 v30, v30, v78, v79
 v_max3_f32 v30, v30, v108, v109
 v_max3_f32 v30, v30, v110, v111
 v_mfma_f32_16x16x32_bf16 v[76:79], v[36:39], v[224:227], 0
 v_mfma_f32_16x16x32_bf16 v[76:79], v[68:71], v[232:235], v[76:79]
 v_mfma_f32_16x16x32_bf16 v[76:79], v[100:103], v[240:243], v[76:79]
 v_mfma_f32_16x16x32_bf16 v[76:79], v[132:135], v[248:251], v[76:79]
 v_mfma_f32_16x16x32_bf16 v[108:111], v[164:167], v[224:227], 0
 v_mfma_f32_16x16x32_bf16 v[108:111], v[196:199], v[232:235], v[108:111]
 v_mfma_f32_16x16x32_bf16 v[108:111], v[228:231], v[240:243], v[108:111]
 v_mfma_f32_16x16x32_bf16 v[108:111], v[44:47], v[248:251], v[108:111]
 s_nop 7
 v_max3_f32 v31, v31, v76, v77
 v_max3_f32 v31, v31, v78, v79
 v_max3_f32 v31, v31, v108, v109
 v_max3_f32 v31, v31, v110, v111
 s_add_u32 s50, s50, 8192
 s_cmp_lt_u32 s50, 131072
 s_cbranch_scc1 K1_SL1
 v_mov_b32 v36, v25
 v_mov_b32 v37, v26
 v_mov_b32 v38, v27
 v_mov_b32 v39, v28
 v_mov_b32 v68, v29
 v_mov_b32 v69, v30
 v_mov_b32 v70, v31
 s_nop 0
 v_permlane32_swap_b32 v25, v36
 v_permlane32_swap_b32 v26, v37
 v_permlane32_swap_b32 v27, v38
 v_permlane32_swap_b32 v28, v39
 v_permlane32_swap_b32 v29, v68
 v_permlane32_swap_b32 v30, v69
 v_permlane32_swap_b32 v31, v70
 v_max_f32 v25, v25, v36
 v_max_f32 v26, v26, v37
 v_max_f32 v27, v27, v38
 v_max_f32 v28, v28, v39
 v_max_f32 v29, v29, v68
 v_max_f32 v30, v30, v69
 v_max_f32 v31, v31, v70
 v_mov_b32 v36, v25
 v_mov_b32 v37, v26
 v_mov_b32 v38, v27
 v_mov_b32 v39, v28
 v_mov_b32 v68, v29
 v_mov_b32 v69, v30
 v_mov_b32 v70, v31
 s_nop 0
 v_permlane16_swap_b32 v25, v36
 v_permlane16_swap_b32 v26, v37
 v_permlane16_swap_b32 v27, v38
 v_permlane16_swap_b32 v28, v39
 v_permlane16_swap_b32 v29, v68
 v_permlane16_swap_b32 v30, v69
 v_permlane16_swap_b32 v31, v70
 v_max_f32 v25, v25, v36
 v_max_f32 v26, v26, v37
 v_max_f32 v27, v27, v38
 v_max_f32 v28, v28, v39
 v_max_f32 v29, v29, v68
 v_max_f32 v30, v30, v69
 v_max_f32 v31, v31, v70
 v_mov_b32 v2, v25
 v_mov_b32 v3, v26
 v_mov_b32 v4, v27
 v_mov_b32 v5, v28
 v_mov_b32 v6, v29
 v_mov_b32 v7, v30
 v_mov_b32 v8, v31
 v_mov_b32 v25, 0
 v_mov_b32 v26, 0
 v_mov_b32 v27, 0
 v_mov_b32 v28, 0
 v_mov_b32 v29, 0
 v_mov_b32 v30, 0
 v_mov_b32 v31, 0
 v_accvgpr_write_b32 a0, 0
 v_accvgpr_write_b32 a1, 0
 v_accvgpr_write_b32 a2, 0
 v_accvgpr_write_b32 a3, 0
 v_accvgpr_write_b32 a4, 0
 v_accvgpr_write_b32 a5, 0
 v_accvgpr_write_b32 a6, 0
 v_accvgpr_write_b32 a7, 0
 v_accvgpr_write_b32 a8, 0
 v_accvgpr_write_b32 a9, 0
 v_accvgpr_write_b32 a10, 0
 v_accvgpr_write_b32 a11, 0
 v_accvgpr_write_b32 a12, 0
 v_accvgpr_write_b32 a13, 0
 v_accvgpr_write_b32 a14, 0
 v_accvgpr_write_b32 a15, 0
 v_accvgpr_write_b32 a16, 0
 v_accvgpr_write_b32 a17, 0
 v_accvgpr_write_b32 a18, 0
 v_accvgpr_write_b32 a19, 0
 v_accvgpr_write_b32 a20, 0
 v_accvgpr_write_b32 a21, 0
 v_accvgpr_write_b32 a22, 0
 v_accvgpr_write_b32 a23, 0
 v_accvgpr_write_b32 a24, 0
 v_accvgpr_write_b32 a25, 0
 v_accvgpr_write_b32 a26, 0
 v_accvgpr_write_b32 a27, 0
 v_accvgpr_write_b32 a28, 0
 v_accvgpr_write_b32 a29, 0
 v_accvgpr_write_b32 a30, 0
 v_accvgpr_write_b32 a31, 0
 v_accvgpr_write_b32 a32, 0
 v_accvgpr_write_b32 a33, 0
 v_accvgpr_write_b32 a34, 0
 v_accvgpr_write_b32 a35, 0
 v_accvgpr_write_b32 a36, 0
 v_accvgpr_write_b32 a37, 0
 v_accvgpr_write_b32 a38, 0
 v_accvgpr_write_b32 a39, 0
 v_accvgpr_write_b32 a40, 0
 v_accvgpr_write_b32 a41, 0
 v_accvgpr_write_b32 a42, 0
 v_accvgpr_write_b32 a43, 0
 v_accvgpr_write_b32 a44, 0
 v_accvgpr_write_b32 a45, 0
 v_accvgpr_write_b32 a46, 0
 v_accvgpr_write_b32 a47, 0
 v_accvgpr_write_b32 a48, 0
 v_accvgpr_write_b32 a49, 0
 v_accvgpr_write_b32 a50, 0
 v_accvgpr_write_b32 a51, 0
 v_accvgpr_write_b32 a52, 0
 v_accvgpr_write_b32 a53, 0
 v_accvgpr_write_b32 a54, 0
 v_accvgpr_write_b32 a55, 0
 v_accvgpr_write_b32 a56, 0
 v_accvgpr_write_b32 a57, 0
 v_accvgpr_write_b32 a58, 0
 v_accvgpr_write_b32 a59, 0
 v_accvgpr_write_b32 a60, 0
 v_accvgpr_write_b32 a61, 0
 v_accvgpr_write_b32 a62, 0
 v_accvgpr_write_b32 a63, 0
 v_accvgpr_write_b32 a64, 0
 v_accvgpr_write_b32 a65, 0
 v_accvgpr_write_b32 a66, 0
 v_accvgpr_write_b32 a67, 0
 v_accvgpr_write_b32 a68, 0
 v_accvgpr_write_b32 a69, 0
 v_accvgpr_write_b32 a70, 0
 v_accvgpr_write_b32 a71, 0
 v_accvgpr_write_b32 a72, 0
 v_accvgpr_write_b32 a73, 0
 v_accvgpr_write_b32 a74, 0
 v_accvgpr_write_b32 a75, 0
 v_accvgpr_write_b32 a76, 0
 v_accvgpr_write_b32 a77, 0
 v_accvgpr_write_b32 a78, 0
 v_accvgpr_write_b32 a79, 0
 v_accvgpr_write_b32 a80, 0
 v_accvgpr_write_b32 a81, 0
 v_accvgpr_write_b32 a82, 0
 v_accvgpr_write_b32 a83, 0
 v_accvgpr_write_b32 a84, 0
 v_accvgpr_write_b32 a85, 0
 v_accvgpr_write_b32 a86, 0
 v_accvgpr_write_b32 a87, 0
 v_accvgpr_write_b32 a88, 0
 v_accvgpr_write_b32 a89, 0
 v_accvgpr_write_b32 a90, 0
 v_accvgpr_write_b32 a91, 0
 v_accvgpr_write_b32 a92, 0
 v_accvgpr_write_b32 a93, 0
 v_accvgpr_write_b32 a94, 0
 v_accvgpr_write_b32 a95, 0
 v_accvgpr_write_b32 a96, 0
 v_accvgpr_write_b32 a97, 0
 v_accvgpr_write_b32 a98, 0
 v_accvgpr_write_b32 a99, 0
 v_accvgpr_write_b32 a100, 0
 v_accvgpr_write_b32 a101, 0
 v_accvgpr_write_b32 a102, 0
 v_accvgpr_write_b32 a103, 0
 v_accvgpr_write_b32 a104, 0
 v_accvgpr_write_b32 a105, 0
 v_accvgpr_write_b32 a106, 0
 v_accvgpr_write_b32 a107, 0
 v_accvgpr_write_b32 a108, 0
 v_accvgpr_write_b32 a109, 0
 v_accvgpr_write_b32 a110, 0
 v_accvgpr_write_b32 a111, 0
 v_accvgpr_write_b32 a112, 0
 v_accvgpr_write_b32 a113, 0
 v_accvgpr_write_b32 a114, 0
 v_accvgpr_write_b32 a115, 0
 v_accvgpr_write_b32 a116, 0
 v_accvgpr_write_b32 a117, 0
 v_accvgpr_write_b32 a118, 0
 v_accvgpr_write_b32 a119, 0
 v_accvgpr_write_b32 a120, 0
 v_accvgpr_write_b32 a121, 0
 v_accvgpr_write_b32 a122, 0
 v_accvgpr_write_b32 a123, 0
 v_accvgpr_write_b32 a124, 0
 v_accvgpr_write_b32 a125, 0
 v_accvgpr_write_b32 a126, 0
 v_accvgpr_write_b32 a127, 0
 v_accvgpr_write_b32 a128, 0
 v_accvgpr_write_b32 a129, 0
 v_accvgpr_write_b32 a130, 0
 v_accvgpr_write_b32 a131, 0
 v_accvgpr_write_b32 a132, 0
 v_accvgpr_write_b32 a133, 0
 v_accvgpr_write_b32 a134, 0
 v_accvgpr_write_b32 a135, 0
 v_accvgpr_write_b32 a136, 0
 v_accvgpr_write_b32 a137, 0
 v_accvgpr_write_b32 a138, 0
 v_accvgpr_write_b32 a139, 0
 v_accvgpr_write_b32 a140, 0
 v_accvgpr_write_b32 a141, 0
 v_accvgpr_write_b32 a142, 0
 v_accvgpr_write_b32 a143, 0
 v_accvgpr_write_b32 a144, 0
 v_accvgpr_write_b32 a145, 0
 v_accvgpr_write_b32 a146, 0
 v_accvgpr_write_b32 a147, 0
 v_accvgpr_write_b32 a148, 0
 v_accvgpr_write_b32 a149, 0
 v_accvgpr_write_b32 a150, 0
 v_accvgpr_write_b32 a151, 0
 v_accvgpr_write_b32 a152, 0
 v_accvgpr_write_b32 a153, 0
 v_accvgpr_write_b32 a154, 0
 v_accvgpr_write_b32 a155, 0
 v_accvgpr_write_b32 a156, 0
 v_accvgpr_write_b32 a157, 0
 v_accvgpr_write_b32 a158, 0
 v_accvgpr_write_b32 a159, 0
 v_accvgpr_write_b32 a160, 0
 v_accvgpr_write_b32 a161, 0
 v_accvgpr_write_b32 a162, 0
 v_accvgpr_write_b32 a163, 0
 v_accvgpr_write_b32 a164, 0
 v_accvgpr_write_b32 a165, 0
 v_accvgpr_write_b32 a166, 0
 v_accvgpr_write_b32 a167, 0
 v_accvgpr_write_b32 a168, 0
 v_accvgpr_write_b32 a169, 0
 v_accvgpr_write_b32 a170, 0
 v_accvgpr_write_b32 a171, 0
 v_accvgpr_write_b32 a172, 0
 v_accvgpr_write_b32 a173, 0
 v_accvgpr_write_b32 a174, 0
 v_accvgpr_write_b32 a175, 0
 v_accvgpr_write_b32 a176, 0
 v_accvgpr_write_b32 a177, 0
 v_accvgpr_write_b32 a178, 0
 v_accvgpr_write_b32 a179, 0
 v_accvgpr_write_b32 a180, 0
 v_accvgpr_write_b32 a181, 0
 v_accvgpr_write_b32 a182, 0
 v_accvgpr_write_b32 a183, 0
 v_accvgpr_write_b32 a184, 0
 v_accvgpr_write_b32 a185, 0
 v_accvgpr_write_b32 a186, 0
 v_accvgpr_write_b32 a187, 0
 v_accvgpr_write_b32 a188, 0
 v_accvgpr_write_b32 a189, 0
 v_accvgpr_write_b32 a190, 0
 v_accvgpr_write_b32 a191, 0
 v_accvgpr_write_b32 a192, 0
 v_accvgpr_write_b32 a193, 0
 v_accvgpr_write_b32 a194, 0
 v_accvgpr_write_b32 a195, 0
 v_accvgpr_write_b32 a196, 0
 v_accvgpr_write_b32 a197, 0
 v_accvgpr_write_b32 a198, 0
 v_accvgpr_write_b32 a199, 0
 v_accvgpr_write_b32 a200, 0
 v_accvgpr_write_b32 a201, 0
 v_accvgpr_write_b32 a202, 0
 v_accvgpr_write_b32 a203, 0
 v_accvgpr_write_b32 a204, 0
 v_accvgpr_write_b32 a205, 0
 v_accvgpr_write_b32 a206, 0
 v_accvgpr_write_b32 a207, 0
 v_accvgpr_write_b32 a208, 0
 v_accvgpr_write_b32 a209, 0
 v_accvgpr_write_b32 a210, 0
 v_accvgpr_write_b32 a211, 0
 v_accvgpr_write_b32 a212, 0
 v_accvgpr_write_b32 a213, 0
 v_accvgpr_write_b32 a214, 0
 v_accvgpr_write_b32 a215, 0
 v_accvgpr_write_b32 a216, 0
 v_accvgpr_write_b32 a217, 0
 v_accvgpr_write_b32 a218, 0
 v_accvgpr_write_b32 a219, 0
 v_accvgpr_write_b32 a220, 0
 v_accvgpr_write_b32 a221, 0
 v_accvgpr_write_b32 a222, 0
 v_accvgpr_write_b32 a223, 0
 s_mov_b32 s50, 0
K1_SL2:
 s_mov_b32 m0, s74
 s_nop 0
 buffer_load_dwordx4 v244, s[12:15], s50 offen offset:0 lds
 buffer_load_dwordx4 v245, s[12:15], s50 offen offset:1024 lds
 buffer_load_dwordx4 v246, s[12:15], s50 offen offset:2048 lds
 buffer_load_dwordx4 v247, s[12:15], s50 offen offset:3072 lds
 s_mov_b32 m0, s75
 s_add_u32 s51, s50, 4096
 buffer_load_dwordx4 v244, s[12:15], s51 offen offset:0 lds
 buffer_load_dwordx4 v245, s[12:15], s51 offen offset:1024 lds
 buffer_load_dwordx4 v246, s[12:15], s51 offen offset:2048 lds
 buffer_load_dwordx4 v247, s[12:15], s51 offen offset:3072 lds
 s_waitcnt vmcnt(0)
 ds_read_b128 v[36:39], v10 offset:0
 ds_read_b128 v[68:71], v11 offset:0
 ds_read_b128 v[100:103], v12 offset:0
 ds_read_b128 v[132:135], v13 offset:0
 ds_read_b128 v[164:167], v10 offset:8192
 ds_read_b128 v[196:199], v11 offset:8192
 ds_read_b128 v[228:231], v12 offset:8192
 ds_read_b128 v[44:47], v13 offset:8192
 s_waitcnt lgkmcnt(0)
 s_mov_b32 m0, s74
 s_nop 0
 buffer_load_dwordx4 v60, s[16:19], s50 offen offset:0 lds
 buffer_load_dwordx4 v61, s[16:19], s50 offen offset:1024 lds
 buffer_load_dwordx4 v60, s[16:19], s50 offen offset:2048 lds
 buffer_load_dwordx4 v61, s[16:19], s50 offen offset:3072 lds
 s_mov_b32 m0, s75
 s_add_u32 s51, s50, 4096
 buffer_load_dwordx4 v60, s[16:19], s51 offen offset:0 lds
 buffer_load_dwordx4 v61, s[16:19], s51 offen offset:1024 lds
 buffer_load_dwordx4 v60, s[16:19], s51 offen offset:2048 lds
 buffer_load_dwordx4 v61, s[16:19], s51 offen offset:3072 lds
 v_mfma_f32_16x16x32_bf16 v[76:79], v[36:39], v[32:35], 0
 v_mfma_f32_16x16x32_bf16 v[76:79], v[68:71], v[40:43], v[76:79]
 v_mfma_f32_16x16x32_bf16 v[76:79], v[100:103], v[48:51], v[76:79]
 v_mfma_f32_16x16x32_bf16 v[76:79], v[132:135], v[56:59], v[76:79]
 v_mfma_f32_16x16x32_bf16 v[108:111], v[164:167], v[32:35], 0
 v_mfma_f32_16x16x32_bf16 v[108:111], v[196:199], v[40:43], v[108:111]
 v_mfma_f32_16x16x32_bf16 v[108:111], v[228:231], v[48:51], v[108:111]
 v_mfma_f32_16x16x32_bf16 v[108:111], v[44:47], v[56:59], v[108:111]
 s_nop 7
 v_sub_f32 v76, v76, v2
 v_sub_f32 v77, v77, v2
 v_sub_f32 v78, v78, v2
 v_sub_f32 v79, v79, v2
 v_exp_f32 v76, v76
 v_exp_f32 v77, v77
 v_exp_f32 v78, v78
 v_exp_f32 v79, v79
 s_nop 0
 v_add_f32 v25, v25, v76
 v_add_f32 v25, v25, v77
 v_add_f32 v25, v25, v78
 v_add_f32 v25, v25, v79
 v_cvt_pk_bf16_f32 v140, v76, v77
 v_cvt_pk_bf16_f32 v141, v78, v79
 v_sub_f32 v108, v108, v2
 v_sub_f32 v109, v109, v2
 v_sub_f32 v110, v110, v2
 v_sub_f32 v111, v111, v2
 v_exp_f32 v108, v108
 v_exp_f32 v109, v109
 v_exp_f32 v110, v110
 v_exp_f32 v111, v111
 s_nop 0
 v_add_f32 v25, v25, v108
 v_add_f32 v25, v25, v109
 v_add_f32 v25, v25, v110
 v_add_f32 v25, v25, v111
 v_cvt_pk_bf16_f32 v142, v108, v109
 v_cvt_pk_bf16_f32 v143, v110, v111
 v_mfma_f32_16x16x32_bf16 v[76:79], v[36:39], v[64:67], 0
 v_mfma_f32_16x16x32_bf16 v[76:79], v[68:71], v[72:75], v[76:79]
 v_mfma_f32_16x16x32_bf16 v[76:79], v[100:103], v[80:83], v[76:79]
 v_mfma_f32_16x16x32_bf16 v[76:79], v[132:135], v[88:91], v[76:79]
 v_mfma_f32_16x16x32_bf16 v[108:111], v[164:167], v[64:67], 0
 v_mfma_f32_16x16x32_bf16 v[108:111], v[196:199], v[72:75], v[108:111]
 v_mfma_f32_16x16x32_bf16 v[108:111], v[228:231], v[80:83], v[108:111]
 v_mfma_f32_16x16x32_bf16 v[108:111], v[44:47], v[88:91], v[108:111]
 s_nop 7
 v_sub_f32 v76, v76, v3
 v_sub_f32 v77, v77, v3
 v_sub_f32 v78, v78, v3
 v_sub_f32 v79, v79, v3
 v_exp_f32 v76, v76
 v_exp_f32 v77, v77
 v_exp_f32 v78, v78
 v_exp_f32 v79, v79
 s_nop 0
 v_add_f32 v26, v26, v76
 v_add_f32 v26, v26, v77
 v_add_f32 v26, v26, v78
 v_add_f32 v26, v26, v79
 v_cvt_pk_bf16_f32 v172, v76, v77
 v_cvt_pk_bf16_f32 v173, v78, v79
 v_sub_f32 v108, v108, v3
 v_sub_f32 v109, v109, v3
 v_sub_f32 v110, v110, v3
 v_sub_f32 v111, v111, v3
 v_exp_f32 v108, v108
 v_exp_f32 v109, v109
 v_exp_f32 v110, v110
 v_exp_f32 v111, v111
 s_nop 0
 v_add_f32 v26, v26, v108
 v_add_f32 v26, v26, v109
 v_add_f32 v26, v26, v110
 v_add_f32 v26, v26, v111
 v_cvt_pk_bf16_f32 v174, v108, v109
 v_cvt_pk_bf16_f32 v175, v110, v111
 v_mfma_f32_16x16x32_bf16 v[76:79], v[36:39], v[96:99], 0
 v_mfma_f32_16x16x32_bf16 v[76:79], v[68:71], v[104:107], v[76:79]
 v_mfma_f32_16x16x32_bf16 v[76:79], v[100:103], v[112:115], v[76:79]
 v_mfma_f32_16x16x32_bf16 v[76:79], v[132:135], v[120:123], v[76:79]
 v_mfma_f32_16x16x32_bf16 v[108:111], v[164:167], v[96:99], 0
 v_mfma_f32_16x16x32_bf16 v[108:111], v[196:199], v[104:107], v[108:111]
 v_mfma_f32_16x16x32_bf16 v[108:111], v[228:231], v[112:115], v[108:111]
 v_mfma_f32_16x16x32_bf16 v[108:111], v[44:47], v[120:123], v[108:111]
 s_nop 7
 v_sub_f32 v76, v76, v4
 v_sub_f32 v77, v77, v4
 v_sub_f32 v78, v78, v4
 v_sub_f32 v79, v79, v4
 v_exp_f32 v76, v76
 v_exp_f32 v77, v77
 v_exp_f32 v78, v78
 v_exp_f32 v79, v79
 s_nop 0
 v_add_f32 v27, v27, v76
 v_add_f32 v27, v27, v77
 v_add_f32 v27, v27, v78
 v_add_f32 v27, v27, v79
 v_cvt_pk_bf16_f32 v204, v76, v77
 v_cvt_pk_bf16_f32 v205, v78, v79
 v_sub_f32 v108, v108, v4
 v_sub_f32 v109, v109, v4
 v_sub_f32 v110, v110, v4
 v_sub_f32 v111, v111, v4
 v_exp_f32 v108, v108
 v_exp_f32 v109, v109
 v_exp_f32 v110, v110
 v_exp_f32 v111, v111
 s_nop 0
 v_add_f32 v27, v27, v108
 v_add_f32 v27, v27, v109
 v_add_f32 v27, v27, v110
 v_add_f32 v27, v27, v111
 v_cvt_pk_bf16_f32 v206, v108, v109
 v_cvt_pk_bf16_f32 v207, v110, v111
 v_mfma_f32_16x16x32_bf16 v[76:79], v[36:39], v[128:131], 0
 v_mfma_f32_16x16x32_bf16 v[76:79], v[68:71], v[136:139], v[76:79]
 v_mfma_f32_16x16x32_bf16 v[76:79], v[100:103], v[144:147], v[76:79]
 v_mfma_f32_16x16x32_bf16 v[76:79], v[132:135], v[152:155], v[76:79]
 v_mfma_f32_16x16x32_bf16 v[108:111], v[164:167], v[128:131], 0
 v_mfma_f32_16x16x32_bf16 v[108:111], v[196:199], v[136:139], v[108:111]
 v_mfma_f32_16x16x32_bf16 v[108:111], v[228:231], v[144:147], v[108:111]
 v_mfma_f32_16x16x32_bf16 v[108:111], v[44:47], v[152:155], v[108:111]
 s_nop 7
 v_sub_f32 v76, v76, v5
 v_sub_f32 v77, v77, v5
 v_sub_f32 v78, v78, v5
 v_sub_f32 v79, v79, v5
 v_exp_f32 v76, v76
 v_exp_f32 v77, v77
 v_exp_f32 v78, v78
 v_exp_f32 v79, v79
 s_nop 0
 v_add_f32 v28, v28, v76
 v_add_f32 v28, v28, v77
 v_add_f32 v28, v28, v78
 v_add_f32 v28, v28, v79
 v_cvt_pk_bf16_f32 v236, v76, v77
 v_cvt_pk_bf16_f32 v237, v78, v79
 v_sub_f32 v108, v108, v5
 v_sub_f32 v109, v109, v5
 v_sub_f32 v110, v110, v5
 v_sub_f32 v111, v111, v5
 v_exp_f32 v108, v108
 v_exp_f32 v109, v109
 v_exp_f32 v110, v110
 v_exp_f32 v111, v111
 s_nop 0
 v_add_f32 v28, v28, v108
 v_add_f32 v28, v28, v109
 v_add_f32 v28, v28, v110
 v_add_f32 v28, v28, v111
 v_cvt_pk_bf16_f32 v238, v108, v109
 v_cvt_pk_bf16_f32 v239, v110, v111
 v_mfma_f32_16x16x32_bf16 v[76:79], v[36:39], v[160:163], 0
 v_mfma_f32_16x16x32_bf16 v[76:79], v[68:71], v[168:171], v[76:79]
 v_mfma_f32_16x16x32_bf16 v[76:79], v[100:103], v[176:179], v[76:79]
 v_mfma_f32_16x16x32_bf16 v[76:79], v[132:135], v[184:187], v[76:79]
 v_mfma_f32_16x16x32_bf16 v[108:111], v[164:167], v[160:163], 0
 v_mfma_f32_16x16x32_bf16 v[108:111], v[196:199], v[168:171], v[108:111]
 v_mfma_f32_16x16x32_bf16 v[108:111], v[228:231], v[176:179], v[108:111]
 v_mfma_f32_16x16x32_bf16 v[108:111], v[44:47], v[184:187], v[108:111]
 s_nop 7
 v_sub_f32 v76, v76, v6
 v_sub_f32 v77, v77, v6
 v_sub_f32 v78, v78, v6
 v_sub_f32 v79, v79, v6
 v_exp_f32 v76, v76
 v_exp_f32 v77, v77
 v_exp_f32 v78, v78
 v_exp_f32 v79, v79
 s_nop 0
 v_add_f32 v29, v29, v76
 v_add_f32 v29, v29, v77
 v_add_f32 v29, v29, v78
 v_add_f32 v29, v29, v79
 v_cvt_pk_bf16_f32 v52, v76, v77
 v_cvt_pk_bf16_f32 v53, v78, v79
 v_sub_f32 v108, v108, v6
 v_sub_f32 v109, v109, v6
 v_sub_f32 v110, v110, v6
 v_sub_f32 v111, v111, v6
 v_exp_f32 v108, v108
 v_exp_f32 v109, v109
 v_exp_f32 v110, v110
 v_exp_f32 v111, v111
 s_nop 0
 v_add_f32 v29, v29, v108
 v_add_f32 v29, v29, v109
 v_add_f32 v29, v29, v110
 v_add_f32 v29, v29, v111
 v_cvt_pk_bf16_f32 v54, v108, v109
 v_cvt_pk_bf16_f32 v55, v110, v111
 v_mfma_f32_16x16x32_bf16 v[76:79], v[36:39], v[192:195], 0
 v_mfma_f32_16x16x32_bf16 v[76:79], v[68:71], v[200:203], v[76:79]
 v_mfma_f32_16x16x32_bf16 v[76:79], v[100:103], v[208:211], v[76:79]
 v_mfma_f32_16x16x32_bf16 v[76:79], v[132:135], v[216:219], v[76:79]
 v_mfma_f32_16x16x32_bf16 v[108:111], v[164:167], v[192:195], 0
 v_mfma_f32_16x16x32_bf16 v[108:111], v[196:199], v[200:203], v[108:111]
 v_mfma_f32_16x16x32_bf16 v[108:111], v[228:231], v[208:211], v[108:111]
 v_mfma_f32_16x16x32_bf16 v[108:111], v[44:47], v[216:219], v[108:111]
 s_nop 7
 v_sub_f32 v76, v76, v7
 v_sub_f32 v77, v77, v7
 v_sub_f32 v78, v78, v7
 v_sub_f32 v79, v79, v7
 v_exp_f32 v76, v76
 v_exp_f32 v77, v77
 v_exp_f32 v78, v78
 v_exp_f32 v79, v79
 s_nop 0
 v_add_f32 v30, v30, v76
 v_add_f32 v30, v30, v77
 v_add_f32 v30, v30, v78
 v_add_f32 v30, v30, v79
 v_cvt_pk_bf16_f32 v84, v76, v77
 v_cvt_pk_bf16_f32 v85, v78, v79
 v_sub_f32 v108, v108, v7
 v_sub_f32 v109, v109, v7
 v_sub_f32 v110, v110, v7
 v_sub_f32 v111, v111, v7
 v_exp_f32 v108, v108
 v_exp_f32 v109, v109
 v_exp_f32 v110, v110
 v_exp_f32 v111, v111
 s_nop 0
 v_add_f32 v30, v30, v108
 v_add_f32 v30, v30, v109
 v_add_f32 v30, v30, v110
 v_add_f32 v30, v30, v111
 v_cvt_pk_bf16_f32 v86, v108, v109
 v_cvt_pk_bf16_f32 v87, v110, v111
 v_mfma_f32_16x16x32_bf16 v[76:79], v[36:39], v[224:227], 0
 v_mfma_f32_16x16x32_bf16 v[76:79], v[68:71], v[232:235], v[76:79]
 v_mfma_f32_16x16x32_bf16 v[76:79], v[100:103], v[240:243], v[76:79]
 v_mfma_f32_16x16x32_bf16 v[76:79], v[132:135], v[248:251], v[76:79]
 v_mfma_f32_16x16x32_bf16 v[108:111], v[164:167], v[224:227], 0
 v_mfma_f32_16x16x32_bf16 v[108:111], v[196:199], v[232:235], v[108:111]
 v_mfma_f32_16x16x32_bf16 v[108:111], v[228:231], v[240:243], v[108:111]
 v_mfma_f32_16x16x32_bf16 v[108:111], v[44:47], v[248:251], v[108:111]
 s_nop 7
 v_sub_f32 v76, v76, v8
 v_sub_f32 v77, v77, v8
 v_sub_f32 v78, v78, v8
 v_sub_f32 v79, v79, v8
 v_exp_f32 v76, v76
 v_exp_f32 v77, v77
 v_exp_f32 v78, v78
 v_exp_f32 v79, v79
 s_nop 0
 v_add_f32 v31, v31, v76
 v_add_f32 v31, v31, v77
 v_add_f32 v31, v31, v78
 v_add_f32 v31, v31, v79
 v_cvt_pk_bf16_f32 v116, v76, v77
 v_cvt_pk_bf16_f32 v117, v78, v79
 v_sub_f32 v108, v108, v8
 v_sub_f32 v109, v109, v8
 v_sub_f32 v110, v110, v8
 v_sub_f32 v111, v111, v8
 v_exp_f32 v108, v108
 v_exp_f32 v109, v109
 v_exp_f32 v110, v110
 v_exp_f32 v111, v111
 s_nop 0
 v_add_f32 v31, v31, v108
 v_add_f32 v31, v31, v109
 v_add_f32 v31, v31, v110
 v_add_f32 v31, v31, v111
 v_cvt_pk_bf16_f32 v118, v108, v109
 v_cvt_pk_bf16_f32 v119, v110, v111
 s_waitcnt vmcnt(0)
 ds_read_b64_tr_b16 v[148:149], v14 offset:0
 ds_read_b64_tr_b16 v[150:151], v14 offset:8192
 s_waitcnt lgkmcnt(0)
 v_mfma_f32_16x16x32_bf16 a[0:3], v[148:151], v[140:143], a[0:3]
 v_mfma_f32_16x16x32_bf16 a[4:7], v[148:151], v[172:175], a[4:7]
 v_mfma_f32_16x16x32_bf16 a[8:11], v[148:151], v[204:207], a[8:11]
 v_mfma_f32_16x16x32_bf16 a[12:15], v[148:151], v[236:239], a[12:15]
 v_mfma_f32_16x16x32_bf16 a[16:19], v[148:151], v[52:55], a[16:19]
 v_mfma_f32_16x16x32_bf16 a[20:23], v[148:151], v[84:87], a[20:23]
 v_mfma_f32_16x16x32_bf16 a[24:27], v[148:151], v[116:119], a[24:27]
 ds_read_b64_tr_b16 v[148:149], v15 offset:0
 ds_read_b64_tr_b16 v[150:151], v15 offset:8192
 s_waitcnt lgkmcnt(0)
 v_mfma_f32_16x16x32_bf16 a[28:31], v[148:151], v[140:143], a[28:31]
 v_mfma_f32_16x16x32_bf16 a[32:35], v[148:151], v[172:175], a[32:35]
 v_mfma_f32_16x16x32_bf16 a[36:39], v[148:151], v[204:207], a[36:39]
 v_mfma_f32_16x16x32_bf16 a[40:43], v[148:151], v[236:239], a[40:43]
 v_mfma_f32_16x16x32_bf16 a[44:47], v[148:151], v[52:55], a[44:47]
 v_mfma_f32_16x16x32_bf16 a[48:51], v[148:151], v[84:87], a[48:51]
 v_mfma_f32_16x16x32_bf16 a[52:55], v[148:151], v[116:119], a[52:55]
 ds_read_b64_tr_b16 v[148:149], v16 offset:0
 ds_read_b64_tr_b16 v[150:151], v16 offset:8192
 s_waitcnt lgkmcnt(0)
 v_mfma_f32_16x16x32_bf16 a[56:59], v[148:151], v[140:143], a[56:59]
 v_mfma_f32_16x16x32_bf16 a[60:63], v[148:151], v[172:175], a[60:63]
 v_mfma_f32_16x16x32_bf16 a[64:67], v[148:151], v[204:207], a[64:67]
 v_mfma_f32_16x16x32_bf16 a[68:71], v[148:151], v[236:239], a[68:71]
 v_mfma_f32_16x16x32_bf16 a[72:75], v[148:151], v[52:55], a[72:75]
 v_mfma_f32_16x16x32_bf16 a[76:79], v[148:151], v[84:87], a[76:79]
 v_mfma_f32_16x16x32_bf16 a[80:83], v[148:151], v[116:119], a[80:83]
 ds_read_b64_tr_b16 v[148:149], v17 offset:0
 ds_read_b64_tr_b16 v[150:151], v17 offset:8192
 s_waitcnt lgkmcnt(0)
 v_mfma_f32_16x16x32_bf16 a[84:87], v[148:151], v[140:143], a[84:87]
 v_mfma_f32_16x16x32_bf16 a[88:91], v[148:151], v[172:175], a[88:91]
 v_mfma_f32_16x16x32_bf16 a[92:95], v[148:151], v[204:207], a[92:95]
 v_mfma_f32_16x16x32_bf16 a[96:99], v[148:151], v[236:239], a[96:99]
 v_mfma_f32_16x16x32_bf16 a[100:103], v[148:151], v[52:55], a[100:103]
 v_mfma_f32_16x16x32_bf16 a[104:107], v[148:151], v[84:87], a[104:107]
 v_mfma_f32_16x16x32_bf16 a[108:111], v[148:151], v[116:119], a[108:111]
 ds_read_b64_tr_b16 v[148:149], v18 offset:0
 ds_read_b64_tr_b16 v[150:151], v18 offset:8192
 s_waitcnt lgkmcnt(0)
 v_mfma_f32_16x16x32_bf16 a[112:115], v[148:151], v[140:143], a[112:115]
 v_mfma_f32_16x16x32_bf16 a[116:119], v[148:151], v[172:175], a[116:119]
 v_mfma_f32_16x16x32_bf16 a[120:123], v[148:151], v[204:207], a[120:123]
 v_mfma_f32_16x16x32_bf16 a[124:127], v[148:151], v[236:239], a[124:127]
 v_mfma_f32_16x16x32_bf16 a[128:131], v[148:151], v[52:55], a[128:131]
 v_mfma_f32_16x16x32_bf16 a[132:135], v[148:151], v[84:87], a[132:135]
 v_mfma_f32_16x16x32_bf16 a[136:139], v[148:151], v[116:119], a[136:139]
 ds_read_b64_tr_b16 v[148:149], v19 offset:0
 ds_read_b64_tr_b16 v[150:151], v19 offset:8192
 s_waitcnt lgkmcnt(0)
 v_mfma_f32_16x16x32_bf16 a[140:143], v[148:151], v[140:143], a[140:143]
 v_mfma_f32_16x16x32_bf16 a[144:147], v[148:151], v[172:175], a[144:147]
 v_mfma_f32_16x16x32_bf16 a[148:151], v[148:151], v[204:207], a[148:151]
 v_mfma_f32_16x16x32_bf16 a[152:155], v[148:151], v[236:239], a[152:155]
 v_mfma_f32_16x16x32_bf16 a[156:159], v[148:151], v[52:55], a[156:159]
 v_mfma_f32_16x16x32_bf16 a[160:163], v[148:151], v[84:87], a[160:163]
 v_mfma_f32_16x16x32_bf16 a[164:167], v[148:151], v[116:119], a[164:167]
 ds_read_b64_tr_b16 v[148:149], v20 offset:0
 ds_read_b64_tr_b16 v[150:151], v20 offset:8192
 s_waitcnt lgkmcnt(0)
 v_mfma_f32_16x16x32_bf16 a[168:171], v[148:151], v[140:143], a[168:171]
 v_mfma_f32_16x16x32_bf16 a[172:175], v[148:151], v[172:175], a[172:175]
 v_mfma_f32_16x16x32_bf16 a[176:179], v[148:151], v[204:207], a[176:179]
 v_mfma_f32_16x16x32_bf16 a[180:183], v[148:151], v[236:239], a[180:183]
 v_mfma_f32_16x16x32_bf16 a[184:187], v[148:151], v[52:55], a[184:187]
 v_mfma_f32_16x16x32_bf16 a[188:191], v[148:151], v[84:87], a[188:191]
 v_mfma_f32_16x16x32_bf16 a[192:195], v[148:151], v[116:119], a[192:195]
 ds_read_b64_tr_b16 v[148:149], v21 offset:0
 ds_read_b64_tr_b16 v[150:151], v21 offset:8192
 s_waitcnt lgkmcnt(0)
 v_mfma_f32_16x16x32_bf16 a[196:199], v[148:151], v[140:143], a[196:199]
 v_mfma_f32_16x16x32_bf16 a[200:203], v[148:151], v[172:175], a[200:203]
 v_mfma_f32_16x16x32_bf16 a[204:207], v[148:151], v[204:207], a[204:207]
 v_mfma_f32_16x16x32_bf16 a[208:211], v[148:151], v[236:239], a[208:211]
 v_mfma_f32_16x16x32_bf16 a[212:215], v[148:151], v[52:55], a[212:215]
 v_mfma_f32_16x16x32_bf16 a[216:219], v[148:151], v[84:87], a[216:219]
 v_mfma_f32_16x16x32_bf16 a[220:223], v[148:151], v[116:119], a[220:223]
 s_add_u32 s50, s50, 8192
 s_cmp_lt_u32 s50, 131072
 s_cbranch_scc1 K1_SL2
 s_nop 7
 v_mov_b32 v36, v25
 v_mov_b32 v37, v26
 v_mov_b32 v38, v27
 v_mov_b32 v39, v28
 v_mov_b32 v68, v29
 v_mov_b32 v69, v30
 v_mov_b32 v70, v31
 s_nop 0
 v_permlane32_swap_b32 v25, v36
 v_permlane32_swap_b32 v26, v37
 v_permlane32_swap_b32 v27, v38
 v_permlane32_swap_b32 v28, v39
 v_permlane32_swap_b32 v29, v68
 v_permlane32_swap_b32 v30, v69
 v_permlane32_swap_b32 v31, v70
 v_add_f32 v25, v25, v36
 v_add_f32 v26, v26, v37
 v_add_f32 v27, v27, v38
 v_add_f32 v28, v28, v39
 v_add_f32 v29, v29, v68
 v_add_f32 v30, v30, v69
 v_add_f32 v31, v31, v70
 v_mov_b32 v36, v25
 v_mov_b32 v37, v26
 v_mov_b32 v38, v27
 v_mov_b32 v39, v28
 v_mov_b32 v68, v29
 v_mov_b32 v69, v30
 v_mov_b32 v70, v31
 s_nop 0
 v_permlane16_swap_b32 v25, v36
 v_permlane16_swap_b32 v26, v37
 v_permlane16_swap_b32 v27, v38
 v_permlane16_swap_b32 v28, v39
 v_permlane16_swap_b32 v29, v68
 v_permlane16_swap_b32 v30, v69
 v_permlane16_swap_b32 v31, v70
 v_add_f32 v25, v25, v36
 v_add_f32 v26, v26, v37
 v_add_f32 v27, v27, v38
 v_add_f32 v28, v28, v39
 v_add_f32 v29, v29, v68
 v_add_f32 v30, v30, v69
 v_add_f32 v31, v31, v70
 v_rcp_f32 v25, v25
 v_rcp_f32 v26, v26
 v_rcp_f32 v27, v27
 v_rcp_f32 v28, v28
 v_rcp_f32 v29, v29
 v_rcp_f32 v30, v30
 v_rcp_f32 v31, v31
 v_accvgpr_read_b32 v52, a0
 v_accvgpr_read_b32 v53, a1
 v_accvgpr_read_b32 v54, a2
 v_accvgpr_read_b32 v55, a3
 v_accvgpr_read_b32 v84, a28
 v_accvgpr_read_b32 v85, a29
 v_accvgpr_read_b32 v86, a30
 v_accvgpr_read_b32 v87, a31
 v_mul_f32 v52, v25, v52
 v_mul_f32 v53, v25, v53
 v_mul_f32 v54, v25, v54
 v_mul_f32 v55, v25, v55
 v_mul_f32 v84, v25, v84
 v_mul_f32 v85, v25, v85
 v_mul_f32 v86, v25, v86
 v_mul_f32 v87, v25, v87
 v_cvt_pk_bf16_f32 v52, v52, v53
 v_cvt_pk_bf16_f32 v53, v54, v55
 v_cvt_pk_bf16_f32 v54, v84, v85
 v_cvt_pk_bf16_f32 v55, v86, v87
 s_mov_b32 s41, 0
 buffer_store_dwordx4 v[52:55], v0, s[24:27], s41 offen sc1
 v_accvgpr_read_b32 v76, a4
 v_accvgpr_read_b32 v77, a5
 v_accvgpr_read_b32 v78, a6
 v_accvgpr_read_b32 v79, a7
 v_accvgpr_read_b32 v108, a32
 v_accvgpr_read_b32 v109, a33
 v_accvgpr_read_b32 v110, a34
 v_accvgpr_read_b32 v111, a35
 v_mul_f32 v76, v26, v76
 v_mul_f32 v77, v26, v77
 v_mul_f32 v78, v26, v78
 v_mul_f32 v79, v26, v79
 v_mul_f32 v108, v26, v108
 v_mul_f32 v109, v26, v109
 v_mul_f32 v110, v26, v110
 v_mul_f32 v111, v26, v111
 v_cvt_pk_bf16_f32 v76, v76, v77
 v_cvt_pk_bf16_f32 v77, v78, v79
 v_cvt_pk_bf16_f32 v78, v108, v109
 v_cvt_pk_bf16_f32 v79, v110, v111
 buffer_store_dwordx4 v[76:79], v0, s[24:27], s41 offen offset:1024 sc1
 v_accvgpr_read_b32 v52, a8
 v_accvgpr_read_b32 v53, a9
 v_accvgpr_read_b32 v54, a10
 v_accvgpr_read_b32 v55, a11
 v_accvgpr_read_b32 v84, a36
 v_accvgpr_read_b32 v85, a37
 v_accvgpr_read_b32 v86, a38
 v_accvgpr_read_b32 v87, a39
 v_mul_f32 v52, v27, v52
 v_mul_f32 v53, v27, v53
 v_mul_f32 v54, v27, v54
 v_mul_f32 v55, v27, v55
 v_mul_f32 v84, v27, v84
 v_mul_f32 v85, v27, v85
 v_mul_f32 v86, v27, v86
 v_mul_f32 v87, v27, v87
 v_cvt_pk_bf16_f32 v52, v52, v53
 v_cvt_pk_bf16_f32 v53, v54, v55
 v_cvt_pk_bf16_f32 v54, v84, v85
 v_cvt_pk_bf16_f32 v55, v86, v87
 buffer_store_dwordx4 v[52:55], v0, s[24:27], s41 offen offset:2048 sc1
 v_accvgpr_read_b32 v76, a12
 v_accvgpr_read_b32 v77, a13
 v_accvgpr_read_b32 v78, a14
 v_accvgpr_read_b32 v79, a15
 v_accvgpr_read_b32 v108, a40
 v_accvgpr_read_b32 v109, a41
 v_accvgpr_read_b32 v110, a42
 v_accvgpr_read_b32 v111, a43
 v_mul_f32 v76, v28, v76
 v_mul_f32 v77, v28, v77
 v_mul_f32 v78, v28, v78
 v_mul_f32 v79, v28, v79
 v_mul_f32 v108, v28, v108
 v_mul_f32 v109, v28, v109
 v_mul_f32 v110, v28, v110
 v_mul_f32 v111, v28, v111
 v_cvt_pk_bf16_f32 v76, v76, v77
 v_cvt_pk_bf16_f32 v77, v78, v79
 v_cvt_pk_bf16_f32 v78, v108, v109
 v_cvt_pk_bf16_f32 v79, v110, v111
 buffer_store_dwordx4 v[76:79], v0, s[24:27], s41 offen offset:3072 sc1
 v_accvgpr_read_b32 v52, a16
 v_accvgpr_read_b32 v53, a17
 v_accvgpr_read_b32 v54, a18
 v_accvgpr_read_b32 v55, a19
 v_accvgpr_read_b32 v84, a44
 v_accvgpr_read_b32 v85, a45
 v_accvgpr_read_b32 v86, a46
 v_accvgpr_read_b32 v87, a47
 v_mul_f32 v52, v29, v52
 v_mul_f32 v53, v29, v53
 v_mul_f32 v54, v29, v54
 v_mul_f32 v55, v29, v55
 v_mul_f32 v84, v29, v84
 v_mul_f32 v85, v29, v85
 v_mul_f32 v86, v29, v86
 v_mul_f32 v87, v29, v87
 v_cvt_pk_bf16_f32 v52, v52, v53
 v_cvt_pk_bf16_f32 v53, v54, v55
 v_cvt_pk_bf16_f32 v54, v84, v85
 v_cvt_pk_bf16_f32 v55, v86, v87
 s_mov_b32 s41, 4096
 buffer_store_dwordx4 v[52:55], v0, s[24:27], s41 offen sc1
 v_accvgpr_read_b32 v76, a20
 v_accvgpr_read_b32 v77, a21
 v_accvgpr_read_b32 v78, a22
 v_accvgpr_read_b32 v79, a23
 v_accvgpr_read_b32 v108, a48
 v_accvgpr_read_b32 v109, a49
 v_accvgpr_read_b32 v110, a50
 v_accvgpr_read_b32 v111, a51
 v_mul_f32 v76, v30, v76
 v_mul_f32 v77, v30, v77
 v_mul_f32 v78, v30, v78
 v_mul_f32 v79, v30, v79
 v_mul_f32 v108, v30, v108
 v_mul_f32 v109, v30, v109
 v_mul_f32 v110, v30, v110
 v_mul_f32 v111, v30, v111
 v_cvt_pk_bf16_f32 v76, v76, v77
 v_cvt_pk_bf16_f32 v77, v78, v79
 v_cvt_pk_bf16_f32 v78, v108, v109
 v_cvt_pk_bf16_f32 v79, v110, v111
 buffer_store_dwordx4 v[76:79], v0, s[24:27], s41 offen offset:1024 sc1
 v_accvgpr_read_b32 v52, a24
 v_accvgpr_read_b32 v53, a25
 v_accvgpr_read_b32 v54, a26
 v_accvgpr_read_b32 v55, a27
 v_accvgpr_read_b32 v84, a52
 v_accvgpr_read_b32 v85, a53
 v_accvgpr_read_b32 v86, a54
 v_accvgpr_read_b32 v87, a55
 v_mul_f32 v52, v31, v52
 v_mul_f32 v53, v31, v53
 v_mul_f32 v54, v31, v54
 v_mul_f32 v55, v31, v55
 v_mul_f32 v84, v31, v84
 v_mul_f32 v85, v31, v85
 v_mul_f32 v86, v31, v86
 v_mul_f32 v87, v31, v87
 v_cvt_pk_bf16_f32 v52, v52, v53
 v_cvt_pk_bf16_f32 v53, v54, v55
 v_cvt_pk_bf16_f32 v54, v84, v85
 v_cvt_pk_bf16_f32 v55, v86, v87
 buffer_store_dwordx4 v[52:55], v0, s[24:27], s41 offen offset:2048 sc1
 v_accvgpr_read_b32 v76, a56
 v_accvgpr_read_b32 v77, a57
 v_accvgpr_read_b32 v78, a58
 v_accvgpr_read_b32 v79, a59
 v_accvgpr_read_b32 v108, a84
 v_accvgpr_read_b32 v109, a85
 v_accvgpr_read_b32 v110, a86
 v_accvgpr_read_b32 v111, a87
 v_mul_f32 v76, v25, v76
 v_mul_f32 v77, v25, v77
 v_mul_f32 v78, v25, v78
 v_mul_f32 v79, v25, v79
 v_mul_f32 v108, v25, v108
 v_mul_f32 v109, v25, v109
 v_mul_f32 v110, v25, v110
 v_mul_f32 v111, v25, v111
 v_cvt_pk_bf16_f32 v76, v76, v77
 v_cvt_pk_bf16_f32 v77, v78, v79
 v_cvt_pk_bf16_f32 v78, v108, v109
 v_cvt_pk_bf16_f32 v79, v110, v111
 s_mov_b32 s41, 229376
 buffer_store_dwordx4 v[76:79], v0, s[24:27], s41 offen sc1
 v_accvgpr_read_b32 v52, a60
 v_accvgpr_read_b32 v53, a61
 v_accvgpr_read_b32 v54, a62
 v_accvgpr_read_b32 v55, a63
 v_accvgpr_read_b32 v84, a88
 v_accvgpr_read_b32 v85, a89
 v_accvgpr_read_b32 v86, a90
 v_accvgpr_read_b32 v87, a91
 v_mul_f32 v52, v26, v52
 v_mul_f32 v53, v26, v53
 v_mul_f32 v54, v26, v54
 v_mul_f32 v55, v26, v55
 v_mul_f32 v84, v26, v84
 v_mul_f32 v85, v26, v85
 v_mul_f32 v86, v26, v86
 v_mul_f32 v87, v26, v87
 v_cvt_pk_bf16_f32 v52, v52, v53
 v_cvt_pk_bf16_f32 v53, v54, v55
 v_cvt_pk_bf16_f32 v54, v84, v85
 v_cvt_pk_bf16_f32 v55, v86, v87
 buffer_store_dwordx4 v[52:55], v0, s[24:27], s41 offen offset:1024 sc1
 v_accvgpr_read_b32 v76, a64
 v_accvgpr_read_b32 v77, a65
 v_accvgpr_read_b32 v78, a66
 v_accvgpr_read_b32 v79, a67
 v_accvgpr_read_b32 v108, a92
 v_accvgpr_read_b32 v109, a93
 v_accvgpr_read_b32 v110, a94
 v_accvgpr_read_b32 v111, a95
 v_mul_f32 v76, v27, v76
 v_mul_f32 v77, v27, v77
 v_mul_f32 v78, v27, v78
 v_mul_f32 v79, v27, v79
 v_mul_f32 v108, v27, v108
 v_mul_f32 v109, v27, v109
 v_mul_f32 v110, v27, v110
 v_mul_f32 v111, v27, v111
 v_cvt_pk_bf16_f32 v76, v76, v77
 v_cvt_pk_bf16_f32 v77, v78, v79
 v_cvt_pk_bf16_f32 v78, v108, v109
 v_cvt_pk_bf16_f32 v79, v110, v111
 buffer_store_dwordx4 v[76:79], v0, s[24:27], s41 offen offset:2048 sc1
 v_accvgpr_read_b32 v52, a68
 v_accvgpr_read_b32 v53, a69
 v_accvgpr_read_b32 v54, a70
 v_accvgpr_read_b32 v55, a71
 v_accvgpr_read_b32 v84, a96
 v_accvgpr_read_b32 v85, a97
 v_accvgpr_read_b32 v86, a98
 v_accvgpr_read_b32 v87, a99
 v_mul_f32 v52, v28, v52
 v_mul_f32 v53, v28, v53
 v_mul_f32 v54, v28, v54
 v_mul_f32 v55, v28, v55
 v_mul_f32 v84, v28, v84
 v_mul_f32 v85, v28, v85
 v_mul_f32 v86, v28, v86
 v_mul_f32 v87, v28, v87
 v_cvt_pk_bf16_f32 v52, v52, v53
 v_cvt_pk_bf16_f32 v53, v54, v55
 v_cvt_pk_bf16_f32 v54, v84, v85
 v_cvt_pk_bf16_f32 v55, v86, v87
 buffer_store_dwordx4 v[52:55], v0, s[24:27], s41 offen offset:3072 sc1
 v_accvgpr_read_b32 v76, a72
 v_accvgpr_read_b32 v77, a73
 v_accvgpr_read_b32 v78, a74
 v_accvgpr_read_b32 v79, a75
 v_accvgpr_read_b32 v108, a100
 v_accvgpr_read_b32 v109, a101
 v_accvgpr_read_b32 v110, a102
 v_accvgpr_read_b32 v111, a103
 v_mul_f32 v76, v29, v76
 v_mul_f32 v77, v29, v77
 v_mul_f32 v78, v29, v78
 v_mul_f32 v79, v29, v79
 v_mul_f32 v108, v29, v108
 v_mul_f32 v109, v29, v109
 v_mul_f32 v110, v29, v110
 v_mul_f32 v111, v29, v111
 v_cvt_pk_bf16_f32 v76, v76, v77
 v_cvt_pk_bf16_f32 v77, v78, v79
 v_cvt_pk_bf16_f32 v78, v108, v109
 v_cvt_pk_bf16_f32 v79, v110, v111
 s_mov_b32 s41, 233472
 buffer_store_dwordx4 v[76:79], v0, s[24:27], s41 offen sc1
 v_accvgpr_read_b32 v52, a76
 v_accvgpr_read_b32 v53, a77
 v_accvgpr_read_b32 v54, a78
 v_accvgpr_read_b32 v55, a79
 v_accvgpr_read_b32 v84, a104
 v_accvgpr_read_b32 v85, a105
 v_accvgpr_read_b32 v86, a106
 v_accvgpr_read_b32 v87, a107
 v_mul_f32 v52, v30, v52
 v_mul_f32 v53, v30, v53
 v_mul_f32 v54, v30, v54
 v_mul_f32 v55, v30, v55
 v_mul_f32 v84, v30, v84
 v_mul_f32 v85, v30, v85
 v_mul_f32 v86, v30, v86
 v_mul_f32 v87, v30, v87
 v_cvt_pk_bf16_f32 v52, v52, v53
 v_cvt_pk_bf16_f32 v53, v54, v55
 v_cvt_pk_bf16_f32 v54, v84, v85
 v_cvt_pk_bf16_f32 v55, v86, v87
 buffer_store_dwordx4 v[52:55], v0, s[24:27], s41 offen offset:1024 sc1
 v_accvgpr_read_b32 v76, a80
 v_accvgpr_read_b32 v77, a81
 v_accvgpr_read_b32 v78, a82
 v_accvgpr_read_b32 v79, a83
 v_accvgpr_read_b32 v108, a108
 v_accvgpr_read_b32 v109, a109
 v_accvgpr_read_b32 v110, a110
 v_accvgpr_read_b32 v111, a111
 v_mul_f32 v76, v31, v76
 v_mul_f32 v77, v31, v77
 v_mul_f32 v78, v31, v78
 v_mul_f32 v79, v31, v79
 v_mul_f32 v108, v31, v108
 v_mul_f32 v109, v31, v109
 v_mul_f32 v110, v31, v110
 v_mul_f32 v111, v31, v111
 v_cvt_pk_bf16_f32 v76, v76, v77
 v_cvt_pk_bf16_f32 v77, v78, v79
 v_cvt_pk_bf16_f32 v78, v108, v109
 v_cvt_pk_bf16_f32 v79, v110, v111
 buffer_store_dwordx4 v[76:79], v0, s[24:27], s41 offen offset:2048 sc1
 v_accvgpr_read_b32 v52, a112
 v_accvgpr_read_b32 v53, a113
 v_accvgpr_read_b32 v54, a114
 v_accvgpr_read_b32 v55, a115
 v_accvgpr_read_b32 v84, a140
 v_accvgpr_read_b32 v85, a141
 v_accvgpr_read_b32 v86, a142
 v_accvgpr_read_b32 v87, a143
 v_mul_f32 v52, v25, v52
 v_mul_f32 v53, v25, v53
 v_mul_f32 v54, v25, v54
 v_mul_f32 v55, v25, v55
 v_mul_f32 v84, v25, v84
 v_mul_f32 v85, v25, v85
 v_mul_f32 v86, v25, v86
 v_mul_f32 v87, v25, v87
 v_cvt_pk_bf16_f32 v52, v52, v53
 v_cvt_pk_bf16_f32 v53, v54, v55
 v_cvt_pk_bf16_f32 v54, v84, v85
 v_cvt_pk_bf16_f32 v55, v86, v87
 s_mov_b32 s41, 458752
 buffer_store_dwordx4 v[52:55], v0, s[24:27], s41 offen sc1
 v_accvgpr_read_b32 v76, a116
 v_accvgpr_read_b32 v77, a117
 v_accvgpr_read_b32 v78, a118
 v_accvgpr_read_b32 v79, a119
 v_accvgpr_read_b32 v108, a144
 v_accvgpr_read_b32 v109, a145
 v_accvgpr_read_b32 v110, a146
 v_accvgpr_read_b32 v111, a147
 v_mul_f32 v76, v26, v76
 v_mul_f32 v77, v26, v77
 v_mul_f32 v78, v26, v78
 v_mul_f32 v79, v26, v79
 v_mul_f32 v108, v26, v108
 v_mul_f32 v109, v26, v109
 v_mul_f32 v110, v26, v110
 v_mul_f32 v111, v26, v111
 v_cvt_pk_bf16_f32 v76, v76, v77
 v_cvt_pk_bf16_f32 v77, v78, v79
 v_cvt_pk_bf16_f32 v78, v108, v109
 v_cvt_pk_bf16_f32 v79, v110, v111
 buffer_store_dwordx4 v[76:79], v0, s[24:27], s41 offen offset:1024 sc1
 v_accvgpr_read_b32 v52, a120
 v_accvgpr_read_b32 v53, a121
 v_accvgpr_read_b32 v54, a122
 v_accvgpr_read_b32 v55, a123
 v_accvgpr_read_b32 v84, a148
 v_accvgpr_read_b32 v85, a149
 v_accvgpr_read_b32 v86, a150
 v_accvgpr_read_b32 v87, a151
 v_mul_f32 v52, v27, v52
 v_mul_f32 v53, v27, v53
 v_mul_f32 v54, v27, v54
 v_mul_f32 v55, v27, v55
 v_mul_f32 v84, v27, v84
 v_mul_f32 v85, v27, v85
 v_mul_f32 v86, v27, v86
 v_mul_f32 v87, v27, v87
 v_cvt_pk_bf16_f32 v52, v52, v53
 v_cvt_pk_bf16_f32 v53, v54, v55
 v_cvt_pk_bf16_f32 v54, v84, v85
 v_cvt_pk_bf16_f32 v55, v86, v87
 buffer_store_dwordx4 v[52:55], v0, s[24:27], s41 offen offset:2048 sc1
 v_accvgpr_read_b32 v76, a124
 v_accvgpr_read_b32 v77, a125
 v_accvgpr_read_b32 v78, a126
 v_accvgpr_read_b32 v79, a127
 v_accvgpr_read_b32 v108, a152
 v_accvgpr_read_b32 v109, a153
 v_accvgpr_read_b32 v110, a154
 v_accvgpr_read_b32 v111, a155
 v_mul_f32 v76, v28, v76
 v_mul_f32 v77, v28, v77
 v_mul_f32 v78, v28, v78
 v_mul_f32 v79, v28, v79
 v_mul_f32 v108, v28, v108
 v_mul_f32 v109, v28, v109
 v_mul_f32 v110, v28, v110
 v_mul_f32 v111, v28, v111
 v_cvt_pk_bf16_f32 v76, v76, v77
 v_cvt_pk_bf16_f32 v77, v78, v79
 v_cvt_pk_bf16_f32 v78, v108, v109
 v_cvt_pk_bf16_f32 v79, v110, v111
 buffer_store_dwordx4 v[76:79], v0, s[24:27], s41 offen offset:3072 sc1
 v_accvgpr_read_b32 v52, a128
 v_accvgpr_read_b32 v53, a129
 v_accvgpr_read_b32 v54, a130
 v_accvgpr_read_b32 v55, a131
 v_accvgpr_read_b32 v84, a156
 v_accvgpr_read_b32 v85, a157
 v_accvgpr_read_b32 v86, a158
 v_accvgpr_read_b32 v87, a159
 v_mul_f32 v52, v29, v52
 v_mul_f32 v53, v29, v53
 v_mul_f32 v54, v29, v54
 v_mul_f32 v55, v29, v55
 v_mul_f32 v84, v29, v84
 v_mul_f32 v85, v29, v85
 v_mul_f32 v86, v29, v86
 v_mul_f32 v87, v29, v87
 v_cvt_pk_bf16_f32 v52, v52, v53
 v_cvt_pk_bf16_f32 v53, v54, v55
 v_cvt_pk_bf16_f32 v54, v84, v85
 v_cvt_pk_bf16_f32 v55, v86, v87
 s_mov_b32 s41, 462848
 buffer_store_dwordx4 v[52:55], v0, s[24:27], s41 offen sc1
 v_accvgpr_read_b32 v76, a132
 v_accvgpr_read_b32 v77, a133
 v_accvgpr_read_b32 v78, a134
 v_accvgpr_read_b32 v79, a135
 v_accvgpr_read_b32 v108, a160
 v_accvgpr_read_b32 v109, a161
 v_accvgpr_read_b32 v110, a162
 v_accvgpr_read_b32 v111, a163
 v_mul_f32 v76, v30, v76
 v_mul_f32 v77, v30, v77
 v_mul_f32 v78, v30, v78
 v_mul_f32 v79, v30, v79
 v_mul_f32 v108, v30, v108
 v_mul_f32 v109, v30, v109
 v_mul_f32 v110, v30, v110
 v_mul_f32 v111, v30, v111
 v_cvt_pk_bf16_f32 v76, v76, v77
 v_cvt_pk_bf16_f32 v77, v78, v79
 v_cvt_pk_bf16_f32 v78, v108, v109
 v_cvt_pk_bf16_f32 v79, v110, v111
 buffer_store_dwordx4 v[76:79], v0, s[24:27], s41 offen offset:1024 sc1
 v_accvgpr_read_b32 v52, a136
 v_accvgpr_read_b32 v53, a137
 v_accvgpr_read_b32 v54, a138
 v_accvgpr_read_b32 v55, a139
 v_accvgpr_read_b32 v84, a164
 v_accvgpr_read_b32 v85, a165
 v_accvgpr_read_b32 v86, a166
 v_accvgpr_read_b32 v87, a167
 v_mul_f32 v52, v31, v52
 v_mul_f32 v53, v31, v53
 v_mul_f32 v54, v31, v54
 v_mul_f32 v55, v31, v55
 v_mul_f32 v84, v31, v84
 v_mul_f32 v85, v31, v85
 v_mul_f32 v86, v31, v86
 v_mul_f32 v87, v31, v87
 v_cvt_pk_bf16_f32 v52, v52, v53
 v_cvt_pk_bf16_f32 v53, v54, v55
 v_cvt_pk_bf16_f32 v54, v84, v85
 v_cvt_pk_bf16_f32 v55, v86, v87
 buffer_store_dwordx4 v[52:55], v0, s[24:27], s41 offen offset:2048 sc1
 v_accvgpr_read_b32 v76, a168
 v_accvgpr_read_b32 v77, a169
 v_accvgpr_read_b32 v78, a170
 v_accvgpr_read_b32 v79, a171
 v_accvgpr_read_b32 v108, a196
 v_accvgpr_read_b32 v109, a197
 v_accvgpr_read_b32 v110, a198
 v_accvgpr_read_b32 v111, a199
 v_mul_f32 v76, v25, v76
 v_mul_f32 v77, v25, v77
 v_mul_f32 v78, v25, v78
 v_mul_f32 v79, v25, v79
 v_mul_f32 v108, v25, v108
 v_mul_f32 v109, v25, v109
 v_mul_f32 v110, v25, v110
 v_mul_f32 v111, v25, v111
 v_cvt_pk_bf16_f32 v76, v76, v77
 v_cvt_pk_bf16_f32 v77, v78, v79
 v_cvt_pk_bf16_f32 v78, v108, v109
 v_cvt_pk_bf16_f32 v79, v110, v111
 s_mov_b32 s41, 688128
 buffer_store_dwordx4 v[76:79], v0, s[24:27], s41 offen sc1
 v_accvgpr_read_b32 v52, a172
 v_accvgpr_read_b32 v53, a173
 v_accvgpr_read_b32 v54, a174
 v_accvgpr_read_b32 v55, a175
 v_accvgpr_read_b32 v84, a200
 v_accvgpr_read_b32 v85, a201
 v_accvgpr_read_b32 v86, a202
 v_accvgpr_read_b32 v87, a203
 v_mul_f32 v52, v26, v52
 v_mul_f32 v53, v26, v53
 v_mul_f32 v54, v26, v54
 v_mul_f32 v55, v26, v55
 v_mul_f32 v84, v26, v84
 v_mul_f32 v85, v26, v85
 v_mul_f32 v86, v26, v86
 v_mul_f32 v87, v26, v87
 v_cvt_pk_bf16_f32 v52, v52, v53
 v_cvt_pk_bf16_f32 v53, v54, v55
 v_cvt_pk_bf16_f32 v54, v84, v85
 v_cvt_pk_bf16_f32 v55, v86, v87
 buffer_store_dwordx4 v[52:55], v0, s[24:27], s41 offen offset:1024 sc1
 v_accvgpr_read_b32 v76, a176
 v_accvgpr_read_b32 v77, a177
 v_accvgpr_read_b32 v78, a178
 v_accvgpr_read_b32 v79, a179
 v_accvgpr_read_b32 v108, a204
 v_accvgpr_read_b32 v109, a205
 v_accvgpr_read_b32 v110, a206
 v_accvgpr_read_b32 v111, a207
 v_mul_f32 v76, v27, v76
 v_mul_f32 v77, v27, v77
 v_mul_f32 v78, v27, v78
 v_mul_f32 v79, v27, v79
 v_mul_f32 v108, v27, v108
 v_mul_f32 v109, v27, v109
 v_mul_f32 v110, v27, v110
 v_mul_f32 v111, v27, v111
 v_cvt_pk_bf16_f32 v76, v76, v77
 v_cvt_pk_bf16_f32 v77, v78, v79
 v_cvt_pk_bf16_f32 v78, v108, v109
 v_cvt_pk_bf16_f32 v79, v110, v111
 buffer_store_dwordx4 v[76:79], v0, s[24:27], s41 offen offset:2048 sc1
 v_accvgpr_read_b32 v52, a180
 v_accvgpr_read_b32 v53, a181
 v_accvgpr_read_b32 v54, a182
 v_accvgpr_read_b32 v55, a183
 v_accvgpr_read_b32 v84, a208
 v_accvgpr_read_b32 v85, a209
 v_accvgpr_read_b32 v86, a210
 v_accvgpr_read_b32 v87, a211
 v_mul_f32 v52, v28, v52
 v_mul_f32 v53, v28, v53
 v_mul_f32 v54, v28, v54
 v_mul_f32 v55, v28, v55
 v_mul_f32 v84, v28, v84
 v_mul_f32 v85, v28, v85
 v_mul_f32 v86, v28, v86
 v_mul_f32 v87, v28, v87
 v_cvt_pk_bf16_f32 v52, v52, v53
 v_cvt_pk_bf16_f32 v53, v54, v55
 v_cvt_pk_bf16_f32 v54, v84, v85
 v_cvt_pk_bf16_f32 v55, v86, v87
 buffer_store_dwordx4 v[52:55], v0, s[24:27], s41 offen offset:3072 sc1
 v_accvgpr_read_b32 v76, a184
 v_accvgpr_read_b32 v77, a185
 v_accvgpr_read_b32 v78, a186
 v_accvgpr_read_b32 v79, a187
 v_accvgpr_read_b32 v108, a212
 v_accvgpr_read_b32 v109, a213
 v_accvgpr_read_b32 v110, a214
 v_accvgpr_read_b32 v111, a215
 v_mul_f32 v76, v29, v76
 v_mul_f32 v77, v29, v77
 v_mul_f32 v78, v29, v78
 v_mul_f32 v79, v29, v79
 v_mul_f32 v108, v29, v108
 v_mul_f32 v109, v29, v109
 v_mul_f32 v110, v29, v110
 v_mul_f32 v111, v29, v111
 v_cvt_pk_bf16_f32 v76, v76, v77
 v_cvt_pk_bf16_f32 v77, v78, v79
 v_cvt_pk_bf16_f32 v78, v108, v109
 v_cvt_pk_bf16_f32 v79, v110, v111
 s_mov_b32 s41, 692224
 buffer_store_dwordx4 v[76:79], v0, s[24:27], s41 offen sc1
 v_accvgpr_read_b32 v52, a188
 v_accvgpr_read_b32 v53, a189
 v_accvgpr_read_b32 v54, a190
 v_accvgpr_read_b32 v55, a191
 v_accvgpr_read_b32 v84, a216
 v_accvgpr_read_b32 v85, a217
 v_accvgpr_read_b32 v86, a218
 v_accvgpr_read_b32 v87, a219
 v_mul_f32 v52, v30, v52
 v_mul_f32 v53, v30, v53
 v_mul_f32 v54, v30, v54
 v_mul_f32 v55, v30, v55
 v_mul_f32 v84, v30, v84
 v_mul_f32 v85, v30, v85
 v_mul_f32 v86, v30, v86
 v_mul_f32 v87, v30, v87
 v_cvt_pk_bf16_f32 v52, v52, v53
 v_cvt_pk_bf16_f32 v53, v54, v55
 v_cvt_pk_bf16_f32 v54, v84, v85
 v_cvt_pk_bf16_f32 v55, v86, v87
 buffer_store_dwordx4 v[52:55], v0, s[24:27], s41 offen offset:1024 sc1
 v_accvgpr_read_b32 v76, a192
 v_accvgpr_read_b32 v77, a193
 v_accvgpr_read_b32 v78, a194
 v_accvgpr_read_b32 v79, a195
 v_accvgpr_read_b32 v108, a220
 v_accvgpr_read_b32 v109, a221
 v_accvgpr_read_b32 v110, a222
 v_accvgpr_read_b32 v111, a223
 v_mul_f32 v76, v31, v76
 v_mul_f32 v77, v31, v77
 v_mul_f32 v78, v31, v78
 v_mul_f32 v79, v31, v79
 v_mul_f32 v108, v31, v108
 v_mul_f32 v109, v31, v109
 v_mul_f32 v110, v31, v110
 v_mul_f32 v111, v31, v111
 v_cvt_pk_bf16_f32 v76, v76, v77
 v_cvt_pk_bf16_f32 v77, v78, v79
 v_cvt_pk_bf16_f32 v78, v108, v109
 v_cvt_pk_bf16_f32 v79, v110, v111
 buffer_store_dwordx4 v[76:79], v0, s[24:27], s41 offen offset:2048 sc1
 s_add_u32 m0, s57, 32768
 s_add_u32 s40, s62, 0
 s_add_u32 s40, s40, s28
 buffer_load_dwordx4 v0, s[8:11], s40 offen sc1 lds
 s_add_u32 m0, s57, 33792
 s_add_u32 s40, s62, 5120
 s_add_u32 s40, s40, s20
 buffer_load_dwordx4 v0, s[8:11], s40 offen sc1 lds
 s_add_u32 m0, s57, 34816
 s_add_u32 s40, s62, 5120
 s_add_u32 s40, s40, s21
 buffer_load_dwordx4 v0, s[8:11], s40 offen sc1 lds
 s_add_u32 m0, s57, 35840
 s_add_u32 s40, s62, 5120
 s_add_u32 s40, s40, s22
 buffer_load_dwordx4 v0, s[8:11], s40 offen sc1 lds
 s_add_u32 m0, s57, 40960
 s_add_u32 s40, s62, 5120
 s_add_u32 s40, s40, s23
 buffer_load_dwordx4 v0, s[8:11], s40 offen sc1 lds
 s_add_u32 m0, s57, 41984
 s_add_u32 s40, s62, 5120
 s_add_u32 s40, s40, s28
 buffer_load_dwordx4 v0, s[8:11], s40 offen sc1 lds
 s_add_u32 m0, s57, 43008
 s_add_u32 s40, s62, 163840
 s_add_u32 s40, s40, s20
 buffer_load_dwordx4 v0, s[8:11], s40 offen sc1 lds
 s_add_u32 m0, s57, 44032
 s_add_u32 s40, s62, 163840
 s_add_u32 s40, s40, s21
 buffer_load_dwordx4 v0, s[8:11], s40 offen sc1 lds
 v_mov_b32 v7, 0
 v_mov_b32 v5, 5
 s_waitcnt vmcnt(0)
 s_mov_b64 exec, 1
 buffer_store_dword v5, v7, s[80:83], s100 offen sc1
 s_mov_b64 exec, -1
 s_load_dwordx4 s[44:47], s[80:81], s92 glc
 s_branch K1_DONE
.section .rodata,"a"
.p2align 6
.amdhsa_kernel concat_heads__mha_block_cached__gqa_block_cached__near_ridge_kernel
  .amdhsa_next_free_vgpr 512
  .amdhsa_next_free_sgpr 102
  .amdhsa_accum_offset 256
  .amdhsa_group_segment_fixed_size 0
  .amdhsa_kernarg_size 104
  .amdhsa_user_sgpr_count 2
  .amdhsa_user_sgpr_kernarg_segment_ptr 1
  .amdhsa_system_sgpr_workgroup_id_x 1
.end_amdhsa_kernel
```
